```python
import torch

def _softmax(x, axis=-1):
    return torch.softmax(x, dim=axis)
def _gelu(x):
    return torch.nn.functional.gelu(x, approximate="tanh")
def _silu(x):
    return torch.nn.functional.silu(x)
def _sigmoid(x):
    return torch.sigmoid(x)
def _layernorm(x, axis=-1, eps=1e-5):
    m = x.mean(dim=axis, keepdim=True)
    v = x.var(dim=axis, keepdim=True, unbiased=False)
    return (x - m) / torch.sqrt(v + eps)
def _scatter_add(tgt, idx, src, axis=0):
    return tgt.clone().index_add_(axis, idx, src)
def _segment_sum(src, seg, n):
    out = torch.zeros((n,) + src.shape[1:], dtype=src.dtype)
    return out.index_add_(0, seg, src)
def _pad(x, pw):
    flat = tuple(v for pair in reversed(pw) for v in pair)
    return torch.nn.functional.pad(x, flat)

kernel_name = 'recurrent_scan__mha_block_cached__mixer_token_mlp__prompt'

def setup_inputs():

    _w = (lambda a: (lambda t: t.to(torch.bfloat16) if t.is_floating_point() else t)(torch.as_tensor(a)))
    def _A_setup():
        B, Sq, D = 1, 2048, 1024
        H, Sk, Dh = 32, 2048, 128
        return {
            "x": _w((lambda *s: torch.randn(*s, dtype=torch.bfloat16) * 0.05)(B, Sq, D)),
            "k_cache": _w((lambda *s: torch.randn(*s, dtype=torch.bfloat16) * 3.2)(B, H, Sk, Dh)),
            "v_cache": _w((lambda *s: torch.randn(*s, dtype=torch.bfloat16) * 3.2)(B, H, Sk, Dh)),
            "wq": _w((lambda *s: torch.randn(*s, dtype=torch.bfloat16) * 3.2)(D, H * Dh) * (D ** -0.5)),
            "wo": _w((lambda *s: torch.randn(*s, dtype=torch.bfloat16) * 3.2)(H * Dh, D) * ((H * Dh) ** -0.5)),
        }
    _A_in = _A_setup()

    def _B_setup():
        B, S, D, F = 1, 2048, 1024, 3584
        return {
            "x": _w((lambda *s: torch.randn(*s, dtype=torch.bfloat16) * 0.05)(B, S, D)),
            "w1": _w((lambda *s: torch.randn(*s, dtype=torch.bfloat16) * 3.2)(S, F) * (S ** -0.5)),
            "b1": _w((lambda *s: torch.randn(*s, dtype=torch.bfloat16) * 3.2)(F) * 0.02),
            "w2": _w((lambda *s: torch.randn(*s, dtype=torch.bfloat16) * 0.4)(F, S) * (F ** -0.5)),
            "b2": _w((lambda *s: torch.randn(*s, dtype=torch.bfloat16) * 0.4)(S) * 0.02),
        }
    _B_in = _B_setup()

    return {
        "A_x": _A_in["x"],
        "A_k_cache": _A_in["k_cache"],
        "A_v_cache": _A_in["v_cache"],
        "A_wq": _A_in["wq"],
        "A_wo": _A_in["wo"],
        "B_x": _B_in["x"],
        "B_w1": _B_in["w1"],
        "B_b1": _B_in["b1"],
        "B_w2": _B_in["w2"],
        "B_b2": _B_in["b2"],
    }

def reference(A_x, A_k_cache, A_v_cache, A_wq, A_wo, B_x, B_w1, B_b1, B_w2, B_b2):
    def _A_ref(x, k_cache, v_cache, wq, wo):
        B, Sq, D = x.shape
        H, Dh = 32, 128
        q = (lambda x, *d: x.permute(*d))((x @ wq).reshape(B, Sq, H, Dh), 0, 2, 1, 3)
        scores = torch.einsum("bhqd,bhkd->bhqk", q, k_cache) * (Dh ** -0.5)
        p = _softmax(scores, axis=-1)
        o = torch.einsum("bhqk,bhkd->bhqd", p, v_cache)
        return (lambda x, *d: x.permute(*d))(o, 0, 2, 1, 3).reshape(B, Sq, H * Dh) @ wo

    def _B_ref(x, w1, b1, w2, b2):
        B, S, D = x.shape
        h = _layernorm(x, axis=-1)
        u = torch.einsum("bsd,sf->bdf", h, w1) + b1
        u = _gelu(u)
        y = torch.einsum("bdf,fs->bds", u, w2) + b2
        return (lambda x, *d: x.permute(*d))(y, 0, 2, 1)

    x = A_x
    xn = _layernorm(x, axis=-1)
    s = _A_ref(xn, A_k_cache, A_v_cache, A_wq, A_wo)
    g = _silu(_B_ref(xn, B_w1, B_b1, B_w2, B_b2))
    return x + s * g
```

```asm
; @launch grid=(256,1,1) block=(256,1,1) lds=163840
.amdgcn_target "amdgcn-amd-amdhsa--gfx950"
.text
.globl recurrent_scan__mha_block_cached__mixer_token_mlp__prompt_kernel
.p2align 8
.type recurrent_scan__mha_block_cached__mixer_token_mlp__prompt_kernel,@function
recurrent_scan__mha_block_cached__mixer_token_mlp__prompt_kernel:
s_cmp_ge_u32 s2, 256
s_cbranch_scc1 L2_end
s_load_dwordx2 s[68:69], s[0:1], 0
s_load_dwordx2 s[8:9], s[0:1], 24
v_lshrrev_b32 v39, 5, v0
v_and_b32 v40, 31, v0
v_lshlrev_b32 v40, 4, v40
v_lshl_add_u32 v212, v39, 11, v40
v_lshlrev_b32 v252, 7, v0
s_lshl_b32 s67, s2, 14
s_lshl_b32 s54, s2, 15
s_nop 0
s_mov_b32 s70, 4194304
s_mov_b32 s71, 0x20000
s_mov_b32 s10, 8388608
s_mov_b32 s11, 0x20000
s_lshl_b32 s45, s2, 14
s_waitcnt lgkmcnt(0)
buffer_load_dwordx4 v[108:111], v212, s[68:71], s45 offen offset:0
buffer_load_dwordx4 v[112:115], v212, s[68:71], s45 offen offset:512
buffer_load_dwordx4 v[116:119], v212, s[68:71], s45 offen offset:1024
buffer_load_dwordx4 v[120:123], v212, s[68:71], s45 offen offset:1536
s_load_dwordx2 s[4:5], s[0:1], 96
s_lshr_b32 s94, s2, 7
s_cmp_eq_u32 s94, 0
s_cselect_b32 s54, 80, 48
s_cselect_b32 s55, 64, 32
s_nop 0
s_cselect_b32 s66, 72, 56
s_load_dwordx2 s[20:21], s[0:1], s54
s_load_dwordx2 s[24:25], s[0:1], s55
s_load_dwordx2 s[32:33], s[0:1], s66
s_load_dwordx2 s[12:13], s[0:1], 8
s_load_dwordx2 s[16:17], s[0:1], 16
s_load_dwordx2 s[28:29], s[0:1], 32
s_load_dwordx2 s[72:73], s[0:1], 88
s_load_dwordx2 s[58:59], s[0:1], 48
s_mov_b32 s22, 14680064
s_cselect_b32 s26, s22, 8388608
s_cselect_b32 s22, 4194304, s22
s_movk_i32 s34, 7168
s_cselect_b32 s34, 4096, s34
v_lshrrev_b32 v38, 6, v0
v_mul_u32_u24 v213, 2112, v39
v_readfirstlane_b32 s36, v38
v_add_u32 v213, v213, v40
v_and_b32 v1, 63, v0
v_lshlrev_b32 v36, 6, v1
s_mov_b32 s90, 8192
s_getpc_b64 s[56:57]
L2_pc:
s_lshr_b32 s54, s2, 3
s_lshl_b32 s54, s54, 2
s_add_u32 s54, s54, s36
s_mul_i32 s54, s54, 704
s_min_u32 s54, s54, L2_redo-L2_pc
s_add_u32 s56, s56, s54
s_addc_u32 s57, s57, 0
v_lshrrev_b32 v42, 2, v36
s_nop 0
v_min_u32 v42, 0x2b0, v42
global_load_dword a60, v42, s[56:57]
s_mov_b32 s6, 134217728
s_mov_b32 s7, 0x20000
s_mov_b32 s14, 16777216
s_mov_b32 s15, 0x20000
s_mov_b32 s18, 16777216
s_mov_b32 s19, 0x20000
s_mov_b32 s23, 0x20000
s_mov_b32 s27, 0x20000
s_mov_b32 s30, 8388608
s_mov_b32 s31, 0x20000
s_mov_b32 s35, 0x20000
s_mov_b32 s74, 256
s_mov_b32 s75, 0x20000
s_bfe_u32 s61, s2, 0x40003
s_and_b32 s60, s2, 7
s_lshr_b32 s62, s61, 3
s_lshl_b32 s63, s60, 1
s_add_u32 s62, s62, s63
s_cmp_eq_u32 s94, 0
s_cselect_b32 s54, 3, 3
s_cselect_b32 s55, 3, 3
s_cselect_b32 s63, 3, 10
s_cmp_ge_u32 s62, s54
s_cselect_b32 s55, s55, 0
s_addc_u32 s92, 1, 0
s_lshl_b32 s54, s54, 1
s_cmp_ge_u32 s62, s54
s_cselect_b32 s63, s63, 0
s_addc_u32 s92, s92, 0
s_mul_i32 s92, s92, s94
s_mul_i32 s54, s94, 3
s_add_u32 s62, s62, s54
s_add_u32 s62, s62, s55
s_add_u32 s62, s62, s63
s_and_b32 s63, s61, 7
s_lshl_b32 s63, s63, 2
s_add_u32 s63, s63, s36
s_lshl_b32 s37, s36, 12
s_lshl_b32 s39, s62, 8
s_lshl_b32 s40, s63, 17
s_add_u32 s3, s40, 65536
v_bfe_u32 v38, v0, 4, 2
v_lshrrev_b32 v39, 6, v0
v_lshl_add_u32 v39, v39, 4, v38
v_and_b32 v41, 15, v0
v_add_u32 v2, 0, v39
v_mul_u32_u24 v2, s90, v2
v_or_b32 v40, 0, v38
v_lshlrev_b32 v40, 1, v40
v_xor_b32 v40, v40, v41
v_lshl_add_u32 v2, v40, 4, v2
v_add_u32 v3, 4, v39
v_mul_u32_u24 v3, s90, v3
v_or_b32 v40, 0, v38
v_lshlrev_b32 v40, 1, v40
v_xor_b32 v40, v40, v41
v_lshl_add_u32 v3, v40, 4, v3
v_subrev_u32 v3, 1024, v3
v_add_u32 v4, 8, v39
v_mul_u32_u24 v4, s90, v4
v_or_b32 v40, 4, v38
v_lshlrev_b32 v40, 1, v40
v_xor_b32 v40, v40, v41
v_lshl_add_u32 v4, v40, 4, v4
v_subrev_u32 v4, 2048, v4
v_add_u32 v5, 12, v39
v_mul_u32_u24 v5, s90, v5
v_or_b32 v40, 4, v38
v_lshlrev_b32 v40, 1, v40
v_xor_b32 v40, v40, v41
v_lshl_add_u32 v5, v40, 4, v5
v_subrev_u32 v5, 3072, v5
v_bfe_u32 v38, v0, 3, 3
v_and_b32 v39, 7, v0
v_lshrrev_b32 v40, 1, v38
v_xor_b32 v39, v39, v40
v_lshlrev_b32 v39, 4, v39
v_lshl_add_u32 v60, v38, 11, v39
v_xor_b32 v61, 64, v60
v_add_u32 v61, 15360, v61
v_add_u32 v62, 30720, v60
v_add_u32 v63, 30720, v61
s_add_u32 m0, s37, 98304
s_nop 0
buffer_load_dwordx4 v2, s[8:11], s39 offen offset:0 lds
buffer_load_dwordx4 v3, s[8:11], s39 offen offset:1024 lds
buffer_load_dwordx4 v4, s[8:11], s39 offen offset:2048 lds
buffer_load_dwordx4 v5, s[8:11], s39 offen offset:3072 lds
s_add_u32 s39, s39, 524288
s_add_u32 m0, s37, 65536
s_nop 0
buffer_load_dwordx4 v60, s[68:71], s40 offen offset:0 lds
buffer_load_dwordx4 v61, s[68:71], s40 offen offset:1024 lds
buffer_load_dwordx4 v62, s[68:71], s40 offen offset:2048 lds
buffer_load_dwordx4 v63, s[68:71], s40 offen offset:3072 lds
s_add_u32 s40, s40, 128
s_add_u32 m0, s37, 81920
s_nop 0
buffer_load_dwordx4 v60, s[68:71], s3 offen offset:0 lds
buffer_load_dwordx4 v61, s[68:71], s3 offen offset:1024 lds
buffer_load_dwordx4 v62, s[68:71], s3 offen offset:2048 lds
buffer_load_dwordx4 v63, s[68:71], s3 offen offset:3072 lds
s_add_u32 s3, s3, 128
v_lshlrev_b32 v1, 4, v1
v_cmp_eq_u32 vcc, 3, v38
v_add_u32 v39, 67108992, v1
s_nop 0
v_cndmask_b32 v1, v1, v39, vcc
v_add_u32 v253, 4096, v1
s_and_b32 s54, s63, 31
s_lshl_b32 s54, s54, 14
v_bfe_u32 v38, v0, 2, 1
v_bfe_u32 v39, v0, 3, 1
v_lshlrev_b32 v38, 7, v38
v_lshl_add_u32 v38, v39, 13, v38
v_add_u32 v38, s54, v38
v_add_u32 v49, 2097152, v38
v_bfe_u32 v39, v0, 4, 2
v_min_u32 v39, 3, v39
v_lshl_add_u32 v50, v39, 19, v38
s_lshl_b32 s100, s62, 8
s_add_u32 s100, s100, 1572864
v_bfe_u32 v38, v0, 4, 2
v_bfe_u32 v39, v0, 2, 2
v_and_b32 v40, 1, v38
v_lshl_or_b32 v40, v40, 2, v39
v_lshl_add_u32 v38, v38, 3, v39
v_lshlrev_b32 v38, 8, v38
v_and_b32 v39, 3, v0
v_lshl_add_u32 v38, v39, 3, v38
v_add_u32 v38, 98304, v38
v_xor_b32 v39, 0, v40
v_lshl_add_u32 v28, v39, 5, v38
v_xor_b32 v39, 1, v40
v_lshl_add_u32 v29, v39, 5, v38
v_xor_b32 v39, 2, v40
v_lshl_add_u32 v30, v39, 5, v38
v_xor_b32 v39, 3, v40
v_lshl_add_u32 v31, v39, 5, v38
v_xor_b32 v39, 4, v40
v_lshl_add_u32 v32, v39, 5, v38
v_xor_b32 v39, 5, v40
v_lshl_add_u32 v33, v39, 5, v38
v_xor_b32 v39, 6, v40
v_lshl_add_u32 v34, v39, 5, v38
v_xor_b32 v39, 7, v40
v_lshl_add_u32 v35, v39, 5, v38
s_lshl_b32 s49, s36, 6
v_xor_b32 v28, s49, v28
v_xor_b32 v29, s49, v29
v_xor_b32 v30, s49, v30
v_xor_b32 v31, s49, v31
v_xor_b32 v32, s49, v32
v_xor_b32 v33, s49, v33
v_xor_b32 v34, s49, v34
v_xor_b32 v35, s49, v35
v_and_b32 v38, 15, v0
v_bfe_u32 v39, v0, 4, 2
v_lshrrev_b32 v40, 1, v38
v_xor_b32 v40, v40, v39
v_lshlrev_b32 v40, 4, v40
v_lshl_add_u32 v40, v38, 7, v40
s_add_u32 s54, s37, 32768
v_add_u32 v64, s54, v40
v_xor_b32 v65, 64, v64
s_add_u32 s54, s37, 49152
v_lshl_add_u32 v66, v38, 2, s54
s_xor_b32 s54, s54, 0x2000
v_lshl_add_u32 v68, v39, 4, s54
v_xor_b32 v69, 0x1000, v68
v_xor_b32 v70, 0x2000, v68
v_xor_b32 v71, 0x3000, v68
v_and_b32 v48, 1, v0
v_sub_u32 v48, 0, v48
v_and_b32 v48, 0xaaaaaaaa, v48
v_or_b32 v48, 0x44444444, v48
v_mov_b32 v37, 0
v_mov_b32 v43, 1
v_bfe_u32 v214, v0, 2, 2
v_mul_u32_u24 v214, 2112, v214
v_lshrrev_b32 v40, 4, v0
v_lshl_add_u32 v214, v40, 5, v214
v_and_b32 v40, 3, v0
v_lshl_add_u32 v214, v40, 3, v214
v_lshlrev_b32 v215, 10, v39
v_lshl_add_u32 v215, v38, 4, v215
s_and_b32 s54, s2, 3
s_lshl_b32 s54, s54, 8
v_add_u32 v215, s54, v215
v_bfe_u32 v40, v215, 7, 3
v_cmp_eq_u32 vcc, 3, v40
v_add_u32 v41, 67108992, v215
s_lshr_b32 s55, s2, 2
v_cndmask_b32 v215, v215, v41, vcc
s_lshl_b32 s55, s55, 12
s_lshl_b32 s54, s36, 18
s_add_u32 s55, s55, s54
s_add_u32 s55, s55, 4194304
v_and_b32 v40, 31, v0
v_cmp_eq_u32 vcc, 0, v40
v_lshrrev_b32 v216, 2, v0
v_mov_b32 v41, 0x40000000
v_cndmask_b32 v216, v41, v216, vcc
v_cmp_gt_u32 vcc, 0x80, v0
v_lshlrev_b32 v217, 2, v0
s_lshl_b32 s66, s2, 7
v_cndmask_b32 v217, v41, v217, vcc
s_lshl_b32 s67, s2, 9
s_add_u32 s67, s67, 41943040
s_bfe_u32 s82, s2, 0x20004
s_and_b32 s82, s82, 3
s_and_b32 s46, s82, 3
s_add_u32 s46, s46, 0
s_add_u32 s82, s82, 2
s_bfe_u32 s84, s2, 0x10003
s_lshl_b32 s84, s84, 7
s_mov_b32 s48, 0
s_cmp_eq_u32 s36, 0
s_cselect_b32 s82, s82, 0
s_cselect_b32 s101, 0x80, 0
s_cselect_b32 s93, 0, 0x1000
v_and_b32 v74, 1, v0
v_lshlrev_b32 v74, 7, v74
v_mov_b32 v44, 0x3f803f80
v_mov_b64 v[52:53], 0
v_mov_b32 v45, 0x3f803f80
v_mov_b64 v[54:55], 0
v_mov_b32 v46, 0x3f803f80
v_mov_b64 v[56:57], 0
v_mov_b32 v47, 0x3f803f80
v_mov_b64 v[58:59], 0
v_mov_b64 v[164:165], 0
v_mov_b64 v[166:167], 0
v_mov_b64 v[168:169], 0
v_mov_b64 v[170:171], 0
v_mov_b64 v[172:173], 0
v_mov_b64 v[174:175], 0
v_mov_b64 v[176:177], 0
v_mov_b64 v[178:179], 0
v_mov_b64 v[180:181], 0
v_mov_b64 v[182:183], 0
v_mov_b64 v[184:185], 0
v_mov_b64 v[186:187], 0
v_mov_b64 v[188:189], 0
v_mov_b64 v[190:191], 0
v_mov_b64 v[192:193], 0
v_mov_b64 v[194:195], 0
v_mov_b64 v[220:221], 0
v_mov_b64 v[222:223], 0
v_mov_b64 v[224:225], 0
v_mov_b64 v[226:227], 0
v_mov_b64 v[228:229], 0
v_mov_b64 v[230:231], 0
v_mov_b64 v[232:233], 0
v_mov_b64 v[234:235], 0
s_waitcnt lgkmcnt(0)
s_waitcnt vmcnt(13)
v_lshlrev_b32 v124, 16, v108
v_and_b32 v125, 0xffff0000, v108
v_lshlrev_b32 v126, 16, v109
v_and_b32 v127, 0xffff0000, v109
v_lshlrev_b32 v128, 16, v110
v_and_b32 v129, 0xffff0000, v110
v_lshlrev_b32 v130, 16, v111
v_and_b32 v131, 0xffff0000, v111
v_lshlrev_b32 v132, 16, v112
v_and_b32 v133, 0xffff0000, v112
v_lshlrev_b32 v134, 16, v113
v_and_b32 v135, 0xffff0000, v113
v_lshlrev_b32 v136, 16, v114
v_and_b32 v137, 0xffff0000, v114
buffer_load_dword a60, v50, s[8:11], s100 offen
v_lshlrev_b32 v138, 16, v115
v_and_b32 v139, 0xffff0000, v115
v_lshlrev_b32 v140, 16, v116
v_and_b32 v141, 0xffff0000, v116
v_lshlrev_b32 v142, 16, v117
v_and_b32 v143, 0xffff0000, v117
v_lshlrev_b32 v144, 16, v118
v_and_b32 v145, 0xffff0000, v118
v_lshlrev_b32 v146, 16, v119
v_and_b32 v147, 0xffff0000, v119
v_lshlrev_b32 v148, 16, v120
v_and_b32 v149, 0xffff0000, v120
v_lshlrev_b32 v150, 16, v121
s_add_u32 m0, s37, 114688
s_nop 0
buffer_load_dwordx4 v2, s[8:11], s39 offen offset:0 lds
v_and_b32 v151, 0xffff0000, v121
v_lshlrev_b32 v152, 16, v122
v_and_b32 v153, 0xffff0000, v122
v_lshlrev_b32 v154, 16, v123
v_and_b32 v155, 0xffff0000, v123
v_pk_add_f32 v[108:109], v[124:125], v[140:141]
v_pk_add_f32 v[110:111], v[126:127], v[142:143]
v_pk_add_f32 v[112:113], v[128:129], v[144:145]
v_pk_add_f32 v[114:115], v[130:131], v[146:147]
v_pk_add_f32 v[116:117], v[132:133], v[148:149]
v_pk_add_f32 v[118:119], v[134:135], v[150:151]
v_pk_add_f32 v[120:121], v[136:137], v[152:153]
v_pk_add_f32 v[122:123], v[138:139], v[154:155]
buffer_load_dwordx4 v3, s[8:11], s39 offen offset:1024 lds
v_pk_add_f32 v[108:109], v[108:109], v[116:117]
v_pk_add_f32 v[110:111], v[110:111], v[118:119]
v_pk_add_f32 v[112:113], v[112:113], v[120:121]
v_pk_add_f32 v[114:115], v[114:115], v[122:123]
v_pk_add_f32 v[108:109], v[108:109], v[112:113]
v_pk_add_f32 v[110:111], v[110:111], v[114:115]
v_pk_add_f32 v[108:109], v[108:109], v[110:111]
v_add_f32 v156, v108, v109
s_nop 1
v_add_f32_dpp v156, v156, v156 quad_perm:[1,0,3,2] row_mask:0xf bank_mask:0xf
s_nop 1
v_add_f32_dpp v156, v156, v156 quad_perm:[2,3,0,1] row_mask:0xf bank_mask:0xf
s_nop 1
buffer_load_dwordx4 v4, s[8:11], s39 offen offset:2048 lds
v_add_f32_dpp v156, v156, v156 row_half_mirror row_mask:0xf bank_mask:0xf
s_nop 1
s_nop 0
v_add_f32_dpp v156, v156, v156 row_mirror row_mask:0xf bank_mask:0xf
v_mov_b32 v160, v156
s_nop 1
v_permlane16_swap_b32 v160, v156
v_add_f32 v156, v156, v160
v_mul_f32 v156, 0x3a800000, v156
v_pk_add_f32 v[124:125], v[124:125], v[156:157] op_sel_hi:[1,0] neg_lo:[0,1] neg_hi:[0,1]
v_pk_add_f32 v[126:127], v[126:127], v[156:157] op_sel_hi:[1,0] neg_lo:[0,1] neg_hi:[0,1]
v_pk_add_f32 v[128:129], v[128:129], v[156:157] op_sel_hi:[1,0] neg_lo:[0,1] neg_hi:[0,1]
v_pk_add_f32 v[130:131], v[130:131], v[156:157] op_sel_hi:[1,0] neg_lo:[0,1] neg_hi:[0,1]
v_pk_add_f32 v[132:133], v[132:133], v[156:157] op_sel_hi:[1,0] neg_lo:[0,1] neg_hi:[0,1]
buffer_load_dwordx4 v5, s[8:11], s39 offen offset:3072 lds
s_add_u32 s39, s39, 524288
v_pk_add_f32 v[134:135], v[134:135], v[156:157] op_sel_hi:[1,0] neg_lo:[0,1] neg_hi:[0,1]
v_pk_add_f32 v[136:137], v[136:137], v[156:157] op_sel_hi:[1,0] neg_lo:[0,1] neg_hi:[0,1]
v_pk_add_f32 v[138:139], v[138:139], v[156:157] op_sel_hi:[1,0] neg_lo:[0,1] neg_hi:[0,1]
v_pk_add_f32 v[140:141], v[140:141], v[156:157] op_sel_hi:[1,0] neg_lo:[0,1] neg_hi:[0,1]
v_pk_add_f32 v[142:143], v[142:143], v[156:157] op_sel_hi:[1,0] neg_lo:[0,1] neg_hi:[0,1]
v_pk_add_f32 v[144:145], v[144:145], v[156:157] op_sel_hi:[1,0] neg_lo:[0,1] neg_hi:[0,1]
v_pk_add_f32 v[146:147], v[146:147], v[156:157] op_sel_hi:[1,0] neg_lo:[0,1] neg_hi:[0,1]
v_pk_add_f32 v[148:149], v[148:149], v[156:157] op_sel_hi:[1,0] neg_lo:[0,1] neg_hi:[0,1]
v_pk_add_f32 v[150:151], v[150:151], v[156:157] op_sel_hi:[1,0] neg_lo:[0,1] neg_hi:[0,1]
v_pk_add_f32 v[152:153], v[152:153], v[156:157] op_sel_hi:[1,0] neg_lo:[0,1] neg_hi:[0,1]
v_pk_add_f32 v[154:155], v[154:155], v[156:157] op_sel_hi:[1,0] neg_lo:[0,1] neg_hi:[0,1]
v_pk_mul_f32 v[158:159], v[124:125], v[124:125]
v_pk_mul_f32 v[160:161], v[126:127], v[126:127]
s_add_u32 m0, s37, 32768
s_nop 0
s_nop 0
buffer_load_dwordx4 v60, s[68:71], s40 offen offset:0 lds
v_pk_fma_f32 v[158:159], v[128:129], v[128:129], v[158:159]
v_pk_fma_f32 v[160:161], v[130:131], v[130:131], v[160:161]
v_pk_fma_f32 v[158:159], v[132:133], v[132:133], v[158:159]
v_pk_fma_f32 v[160:161], v[134:135], v[134:135], v[160:161]
v_pk_fma_f32 v[158:159], v[136:137], v[136:137], v[158:159]
v_pk_fma_f32 v[160:161], v[138:139], v[138:139], v[160:161]
v_pk_fma_f32 v[158:159], v[140:141], v[140:141], v[158:159]
v_pk_fma_f32 v[160:161], v[142:143], v[142:143], v[160:161]
v_pk_fma_f32 v[158:159], v[144:145], v[144:145], v[158:159]
v_pk_fma_f32 v[160:161], v[146:147], v[146:147], v[160:161]
v_pk_fma_f32 v[158:159], v[148:149], v[148:149], v[158:159]
v_pk_fma_f32 v[160:161], v[150:151], v[150:151], v[160:161]
v_pk_fma_f32 v[158:159], v[152:153], v[152:153], v[158:159]
buffer_load_dwordx4 v61, s[68:71], s40 offen offset:1024 lds
v_pk_fma_f32 v[160:161], v[154:155], v[154:155], v[160:161]
v_pk_add_f32 v[158:159], v[158:159], v[160:161]
v_add_f32 v158, v158, v159
s_nop 1
v_add_f32_dpp v158, v158, v158 quad_perm:[1,0,3,2] row_mask:0xf bank_mask:0xf
s_nop 1
v_add_f32_dpp v158, v158, v158 quad_perm:[2,3,0,1] row_mask:0xf bank_mask:0xf
s_nop 1
v_add_f32_dpp v158, v158, v158 row_half_mirror row_mask:0xf bank_mask:0xf
s_nop 1
v_add_f32_dpp v158, v158, v158 row_mirror row_mask:0xf bank_mask:0xf
v_mov_b32 v160, v158
s_nop 1
buffer_load_dwordx4 v62, s[68:71], s40 offen offset:2048 lds
v_permlane16_swap_b32 v160, v158
v_add_f32 v158, v158, v160
v_mul_f32 v158, 0x3a800000, v158
v_cvt_pk_bf16_f32 v159, v158, v158
v_lshlrev_b32 v159, 16, v159
v_add_f32 v159, 0x3727c5ac, v159
v_cvt_pk_bf16_f32 v159, v159, v159
v_lshlrev_b32 v159, 16, v159
v_sqrt_f32 v159, v159
v_cvt_pk_bf16_f32 v157, v156, v156
v_cvt_pk_bf16_f32 v159, v159, v159
v_lshlrev_b32 v159, 16, v159
v_rcp_f32 v159, v159
buffer_load_dwordx4 v63, s[68:71], s40 offen offset:3072 lds
s_add_u32 s40, s40, 128
v_lshlrev_b32 v157, 16, v157
v_mul_f32 v219, 0x3e0293ee, v159
v_sub_f32 v156, v156, v157
v_mul_f32_e64 v218, -v157, v219
buffer_store_dwordx2 v[218:219], v216, s[4:7], s66 offen sc1
buffer_store_dword v37, v217, s[4:7], s67 offen sc1
v_mul_f32 v156, v156, v159
v_mul_f32 v158, v158, v159
v_mul_f32 v158, v158, v159
v_cvt_pk_bf16_f32 v161, v158, v158
v_lshlrev_b32 v161, 16, v161
v_add_f32 v161, 0x3727c5ac, v161
v_cvt_pk_bf16_f32 v161, v161, v161
s_add_u32 m0, s37, 49152
s_nop 0
s_nop 0
buffer_load_dwordx4 v60, s[68:71], s3 offen offset:0 lds
v_lshlrev_b32 v161, 16, v161
v_sqrt_f32 v161, v161
v_cvt_pk_bf16_f32 v160, v156, v156
v_cvt_pk_bf16_f32 v161, v161, v161
v_lshlrev_b32 v161, 16, v161
v_rcp_f32 v161, v161
v_lshlrev_b32 v160, 16, v160
v_sub_f32 v156, v156, v160
v_mul_f32 v162, v159, v161
v_mul_f32 v163, v156, v161
v_pk_fma_f32 v[124:125], v[124:125], v[162:163], v[162:163] op_sel:[0,0,1] op_sel_hi:[1,0,1]
v_pk_fma_f32 v[126:127], v[126:127], v[162:163], v[162:163] op_sel:[0,0,1] op_sel_hi:[1,0,1]
v_pk_fma_f32 v[128:129], v[128:129], v[162:163], v[162:163] op_sel:[0,0,1] op_sel_hi:[1,0,1]
buffer_load_dwordx4 v61, s[68:71], s3 offen offset:1024 lds
v_pk_fma_f32 v[130:131], v[130:131], v[162:163], v[162:163] op_sel:[0,0,1] op_sel_hi:[1,0,1]
v_pk_fma_f32 v[132:133], v[132:133], v[162:163], v[162:163] op_sel:[0,0,1] op_sel_hi:[1,0,1]
v_pk_fma_f32 v[134:135], v[134:135], v[162:163], v[162:163] op_sel:[0,0,1] op_sel_hi:[1,0,1]
v_pk_fma_f32 v[136:137], v[136:137], v[162:163], v[162:163] op_sel:[0,0,1] op_sel_hi:[1,0,1]
v_pk_fma_f32 v[138:139], v[138:139], v[162:163], v[162:163] op_sel:[0,0,1] op_sel_hi:[1,0,1]
v_pk_fma_f32 v[140:141], v[140:141], v[162:163], v[162:163] op_sel:[0,0,1] op_sel_hi:[1,0,1]
v_pk_fma_f32 v[142:143], v[142:143], v[162:163], v[162:163] op_sel:[0,0,1] op_sel_hi:[1,0,1]
v_pk_fma_f32 v[144:145], v[144:145], v[162:163], v[162:163] op_sel:[0,0,1] op_sel_hi:[1,0,1]
v_pk_fma_f32 v[146:147], v[146:147], v[162:163], v[162:163] op_sel:[0,0,1] op_sel_hi:[1,0,1]
v_pk_fma_f32 v[148:149], v[148:149], v[162:163], v[162:163] op_sel:[0,0,1] op_sel_hi:[1,0,1]
v_pk_fma_f32 v[150:151], v[150:151], v[162:163], v[162:163] op_sel:[0,0,1] op_sel_hi:[1,0,1]
v_pk_fma_f32 v[152:153], v[152:153], v[162:163], v[162:163] op_sel:[0,0,1] op_sel_hi:[1,0,1]
v_pk_fma_f32 v[154:155], v[154:155], v[162:163], v[162:163] op_sel:[0,0,1] op_sel_hi:[1,0,1]
buffer_load_dwordx4 v62, s[68:71], s3 offen offset:2048 lds
v_cvt_pk_bf16_f32 v108, v124, v125
v_cvt_pk_bf16_f32 v109, v126, v127
v_cvt_pk_bf16_f32 v110, v128, v129
v_cvt_pk_bf16_f32 v111, v130, v131
v_cvt_pk_bf16_f32 v112, v132, v133
v_cvt_pk_bf16_f32 v113, v134, v135
v_cvt_pk_bf16_f32 v114, v136, v137
v_cvt_pk_bf16_f32 v115, v138, v139
v_cvt_pk_bf16_f32 v116, v140, v141
v_cvt_pk_bf16_f32 v117, v142, v143
v_cvt_pk_bf16_f32 v118, v144, v145
v_cvt_pk_bf16_f32 v119, v146, v147
v_cvt_pk_bf16_f32 v120, v148, v149
v_cvt_pk_bf16_f32 v121, v150, v151
v_cvt_pk_bf16_f32 v122, v152, v153
v_cvt_pk_bf16_f32 v123, v154, v155
ds_write_b128 v213, v[108:111] offset:0
ds_write_b128 v213, v[112:115] offset:512
ds_write_b128 v213, v[116:119] offset:1024
ds_write_b128 v213, v[120:123] offset:1536
buffer_load_dwordx4 v63, s[68:71], s3 offen offset:3072 lds
s_add_u32 s3, s3, 128
v_mov_b64 v[162:163], 0
v_mov_b64 v[160:161], 0
s_add_u32 m0, s37, 131072
s_nop 0
s_nop 0
buffer_load_dwordx4 v2, s[8:11], s39 offen offset:0 lds
v_mov_b64 v[158:159], 0
v_mov_b64 v[156:157], 0
buffer_load_dwordx4 v3, s[8:11], s39 offen offset:1024 lds
v_mov_b64 v[154:155], 0
v_mov_b64 v[152:153], 0
v_mov_b64 v[124:125], 0
v_mov_b64 v[126:127], 0
v_mov_b64 v[128:129], 0
v_mov_b64 v[130:131], 0
v_mov_b64 v[132:133], 0
v_mov_b64 v[134:135], 0
v_mov_b64 v[136:137], 0
v_mov_b64 v[138:139], 0
v_mov_b64 v[140:141], 0
v_mov_b64 v[142:143], 0
v_mov_b64 v[144:145], 0
v_mov_b64 v[146:147], 0
v_mov_b64 v[148:149], 0
v_mov_b64 v[150:151], 0
s_waitcnt vmcnt(25) lgkmcnt(0)
s_barrier
ds_read_b64_tr_b16 v[196:197], v214 offset:0
ds_read_b64_tr_b16 v[198:199], v214 offset:8448
ds_read_b64_tr_b16 v[200:201], v214 offset:512
ds_read_b64_tr_b16 v[202:203], v214 offset:8960
ds_read_b64_tr_b16 v[204:205], v214 offset:1024
ds_read_b64_tr_b16 v[206:207], v214 offset:9472
ds_read_b64_tr_b16 v[208:209], v214 offset:1536
ds_read_b64_tr_b16 v[210:211], v214 offset:9984
v_mov_b64 v[108:109], 0
v_mov_b64 v[110:111], 0
v_mov_b64 v[112:113], 0
v_mov_b64 v[114:115], 0
v_mov_b64 v[116:117], 0
v_mov_b64 v[118:119], 0
v_mov_b64 v[120:121], 0
v_mov_b64 v[122:123], 0
s_waitcnt lgkmcnt(6)
buffer_store_dwordx4 v[196:199], v215, s[4:7], s55 offen sc1
s_add_u32 s55, s55, 1048576
s_waitcnt vmcnt(24)
ds_read_b128 a[128:131], v64 offset:32768
ds_read_b128 a[144:147], v65 offset:32768
s_waitcnt lgkmcnt(6)
buffer_store_dwordx4 v[200:203], v215, s[4:7], s55 offen sc1
s_add_u32 s55, s55, 1048576
s_waitcnt vmcnt(23)
ds_read_b128 a[132:135], v64 offset:34816
ds_read_b128 a[148:151], v65 offset:34816
s_waitcnt lgkmcnt(6)
buffer_store_dwordx4 v[204:207], v215, s[4:7], s55 offen sc1
s_add_u32 s55, s55, 1048576
s_waitcnt vmcnt(22)
ds_read_b128 a[136:139], v64 offset:49152
ds_read_b128 a[152:155], v65 offset:49152
s_waitcnt lgkmcnt(6)
buffer_store_dwordx4 v[208:211], v215, s[4:7], s55 offen sc1
s_add_u32 s55, s55, 1048576
s_waitcnt vmcnt(21)
ds_read_b128 a[140:143], v64 offset:51200
ds_read_b128 a[156:159], v65 offset:51200
ds_read_b64_tr_b16 a[0:1], v28 offset:0
ds_read_b64_tr_b16 a[2:3], v28 offset:1024
ds_read_b64_tr_b16 a[4:5], v28 offset:8192
ds_read_b64_tr_b16 a[6:7], v28 offset:9216
v_mov_b64 v[196:197], 0
v_mov_b64 v[198:199], 0
v_mov_b64 v[200:201], 0
v_mov_b64 v[202:203], 0
v_mov_b64 v[204:205], 0
v_mov_b64 v[206:207], 0
v_mov_b64 v[208:209], 0
v_mov_b64 v[210:211], 0
v_mov_b64 v[212:213], 0
v_mov_b64 v[214:215], 0
v_mov_b64 v[216:217], 0
v_mov_b64 v[218:219], 0
ds_read_b64_tr_b16 a[8:9], v29 offset:0
ds_read_b64_tr_b16 a[10:11], v29 offset:1024
ds_read_b64_tr_b16 a[12:13], v29 offset:8192
s_waitcnt lgkmcnt(14)
ds_read_b64_tr_b16 a[14:15], v29 offset:9216
s_waitcnt lgkmcnt(6)
v_mfma_f32_16x16x32_bf16 v[108:111], a[0:3], a[128:131], v[108:111]
s_waitcnt lgkmcnt(4)
ds_read_b64_tr_b16 a[16:17], v30 offset:0
v_mfma_f32_16x16x32_bf16 v[108:111], a[4:7], a[144:147], v[108:111]
buffer_load_dwordx4 v4, s[8:11], s39 offen offset:2048 lds
v_mfma_f32_16x16x32_bf16 v[112:115], a[4:7], a[148:151], v[112:115]
ds_read_b64_tr_b16 a[18:19], v30 offset:1024
v_mfma_f32_16x16x32_bf16 v[112:115], a[0:3], a[132:135], v[112:115]
s_waitcnt vmcnt(15)
ds_read_b128 a[160:163], v64 offset:0
v_mfma_f32_16x16x32_bf16 v[116:119], a[0:3], a[136:139], v[116:119]
ds_read_b64_tr_b16 a[20:21], v30 offset:8192
v_mfma_f32_16x16x32_bf16 v[116:119], a[4:7], a[152:155], v[116:119]
buffer_load_dwordx4 v5, s[8:11], s39 offen offset:3072 lds
v_mfma_f32_16x16x32_bf16 v[120:123], a[4:7], a[156:159], v[120:123]
s_add_u32 s39, s39, 524288
ds_read_b64_tr_b16 a[22:23], v30 offset:9216
v_mfma_f32_16x16x32_bf16 v[120:123], a[0:3], a[140:143], v[120:123]
s_waitcnt lgkmcnt(7)
ds_read_b128 a[176:179], v65 offset:0
buffer_load_dword a60, v49, s[8:11], s39 offen
v_mfma_f32_16x16x32_bf16 v[124:127], a[8:11], a[128:131], v[124:127]
s_waitcnt lgkmcnt(6)
s_add_u32 m0, s37, 65536
ds_read_b64_tr_b16 a[24:25], v31 offset:0
v_mfma_f32_16x16x32_bf16 v[124:127], a[12:15], a[144:147], v[124:127]
buffer_load_dwordx4 v60, s[68:71], s40 offen offset:0 lds
v_mfma_f32_16x16x32_bf16 v[128:131], a[12:15], a[148:151], v[128:131]
ds_read_b64_tr_b16 a[26:27], v31 offset:1024
v_mfma_f32_16x16x32_bf16 v[128:131], a[8:11], a[132:135], v[128:131]
s_waitcnt vmcnt(16)
ds_read_b128 a[164:167], v64 offset:2048
buffer_load_dwordx4 v61, s[68:71], s40 offen offset:1024 lds
v_mfma_f32_16x16x32_bf16 v[132:135], a[8:11], a[136:139], v[132:135]
ds_read_b64_tr_b16 a[28:29], v31 offset:8192
v_mfma_f32_16x16x32_bf16 v[132:135], a[12:15], a[152:155], v[132:135]
buffer_load_dwordx4 v62, s[68:71], s40 offen offset:2048 lds
v_mfma_f32_16x16x32_bf16 v[136:139], a[12:15], a[156:159], v[136:139]
ds_read_b64_tr_b16 a[30:31], v31 offset:9216
v_mfma_f32_16x16x32_bf16 v[136:139], a[8:11], a[140:143], v[136:139]
s_waitcnt lgkmcnt(9)
ds_read_b128 a[180:183], v65 offset:2048
buffer_load_dwordx4 v63, s[68:71], s40 offen offset:3072 lds
v_mfma_f32_16x16x32_bf16 v[140:143], a[16:19], a[128:131], v[140:143]
s_waitcnt lgkmcnt(7)
s_add_u32 s40, s40, 128
s_add_u32 m0, s37, 81920
ds_read_b64_tr_b16 a[0:1], v32 offset:0
v_mfma_f32_16x16x32_bf16 v[140:143], a[20:23], a[144:147], v[140:143]
buffer_load_dwordx4 v60, s[68:71], s3 offen offset:0 lds
v_mfma_f32_16x16x32_bf16 v[144:147], a[20:23], a[148:151], v[144:147]
ds_read_b64_tr_b16 a[2:3], v32 offset:1024
v_mfma_f32_16x16x32_bf16 v[144:147], a[16:19], a[132:135], v[144:147]
s_waitcnt vmcnt(16)
ds_read_b128 a[168:171], v64 offset:16384
buffer_load_dwordx4 v61, s[68:71], s3 offen offset:1024 lds
v_mfma_f32_16x16x32_bf16 v[148:151], a[16:19], a[136:139], v[148:151]
ds_read_b64_tr_b16 a[4:5], v32 offset:8192
v_mfma_f32_16x16x32_bf16 v[148:151], a[20:23], a[152:155], v[148:151]
buffer_load_dwordx4 v62, s[68:71], s3 offen offset:2048 lds
v_mfma_f32_16x16x32_bf16 v[152:155], a[20:23], a[156:159], v[152:155]
ds_read_b64_tr_b16 a[6:7], v32 offset:9216
buffer_load_dwordx4 v63, s[68:71], s3 offen offset:3072 lds
v_mfma_f32_16x16x32_bf16 v[152:155], a[16:19], a[140:143], v[152:155]
s_waitcnt lgkmcnt(9)
s_add_u32 s3, s3, 128
ds_read_b128 a[184:187], v65 offset:16384
s_barrier
v_mfma_f32_16x16x32_bf16 v[156:159], a[24:27], a[128:131], v[156:159]
s_waitcnt lgkmcnt(7)
s_add_u32 m0, s37, 147456
ds_read_b64_tr_b16 a[8:9], v32 offset:16384
v_mfma_f32_16x16x32_bf16 v[156:159], a[28:31], a[144:147], v[156:159]
buffer_load_dwordx4 v2, s[8:11], s39 offen offset:0 lds
v_mfma_f32_16x16x32_bf16 v[160:163], a[28:31], a[148:151], v[160:163]
ds_read_b64_tr_b16 a[10:11], v32 offset:17408
v_mfma_f32_16x16x32_bf16 v[160:163], a[24:27], a[132:135], v[160:163]
ds_read_b64_tr_b16 a[12:13], v32 offset:24576
v_mfma_f32_16x16x32_bf16 v[164:167], a[24:27], a[136:139], v[164:167]
ds_read_b64_tr_b16 a[14:15], v32 offset:25600
v_mfma_f32_16x16x32_bf16 v[164:167], a[28:31], a[152:155], v[164:167]
buffer_load_dwordx4 v3, s[8:11], s39 offen offset:1024 lds
v_mfma_f32_16x16x32_bf16 v[168:171], a[28:31], a[156:159], v[168:171]
s_waitcnt vmcnt(19)
ds_read_b128 a[172:175], v64 offset:18432
v_mfma_f32_16x16x32_bf16 v[168:171], a[24:27], a[140:143], v[168:171]
s_waitcnt lgkmcnt(9)
ds_read_b128 a[188:191], v65 offset:18432
s_mov_b32 s38, -3
.p2align 3
L2_q:
v_mfma_f32_16x16x32_bf16 v[172:175], a[0:3], a[128:131], v[172:175]
s_waitcnt lgkmcnt(7)
ds_read_b64_tr_b16 a[16:17], v33 offset:0
v_mfma_f32_16x16x32_bf16 v[172:175], a[4:7], a[144:147], v[172:175]
s_waitcnt lgkmcnt(5)
buffer_load_dwordx4 v4, s[8:11], s39 offen offset:2048 lds
v_mfma_f32_16x16x32_bf16 v[172:175], a[8:11], a[160:163], v[172:175]
s_waitcnt lgkmcnt(3)
ds_read_b64_tr_b16 a[18:19], v33 offset:1024
v_mfma_f32_16x16x32_bf16 v[172:175], a[12:15], a[176:179], v[172:175]
v_mfma_f32_16x16x32_bf16 v[176:179], a[12:15], a[180:183], v[176:179]
ds_read_b64_tr_b16 a[20:21], v33 offset:8192
v_mfma_f32_16x16x32_bf16 v[176:179], a[8:11], a[164:167], v[176:179]
buffer_load_dwordx4 v5, s[8:11], s39 offen offset:3072 lds
v_mfma_f32_16x16x32_bf16 v[176:179], a[4:7], a[148:151], v[176:179]
s_add_u32 s39, s39, 524288
ds_read_b64_tr_b16 a[22:23], v33 offset:9216
v_mfma_f32_16x16x32_bf16 v[176:179], a[0:3], a[132:135], v[176:179]
v_smfmac_f32_16x16x64_bf16 v[52:55], v[44:47], a[0:7], v48
v_mfma_f32_16x16x32_bf16 v[180:183], a[0:3], a[136:139], v[180:183]
s_add_u32 m0, s37, 32768
ds_read_b64_tr_b16 a[24:25], v33 offset:16384
v_mfma_f32_16x16x32_bf16 v[180:183], a[4:7], a[152:155], v[180:183]
buffer_load_dwordx4 v60, s[68:71], s40 offen offset:0 lds
v_mfma_f32_16x16x32_bf16 v[180:183], a[8:11], a[168:171], v[180:183]
ds_read_b64_tr_b16 a[26:27], v33 offset:17408
v_mfma_f32_16x16x32_bf16 v[180:183], a[12:15], a[184:187], v[180:183]
s_waitcnt lgkmcnt(6)
ds_read_b64_tr_b16 a[28:29], v33 offset:24576
v_mfma_f32_16x16x32_bf16 v[184:187], a[12:15], a[188:191], v[184:187]
ds_read_b64_tr_b16 a[30:31], v33 offset:25600
v_mfma_f32_16x16x32_bf16 v[184:187], a[8:11], a[172:175], v[184:187]
buffer_load_dwordx4 v61, s[68:71], s40 offen offset:1024 lds
v_mfma_f32_16x16x32_bf16 v[184:187], a[4:7], a[156:159], v[184:187]
v_mfma_f32_16x16x32_bf16 v[184:187], a[0:3], a[140:143], v[184:187]
v_smfmac_f32_16x16x64_bf16 v[52:55], v[44:47], a[8:15], v48
s_waitcnt lgkmcnt(6)
v_mfma_f32_16x16x32_bf16 v[188:191], a[16:19], a[128:131], v[188:191]
s_waitcnt lgkmcnt(4)
ds_read_b64_tr_b16 a[0:1], v34 offset:0
v_mfma_f32_16x16x32_bf16 v[188:191], a[20:23], a[144:147], v[188:191]
s_waitcnt lgkmcnt(3)
buffer_load_dwordx4 v62, s[68:71], s40 offen offset:2048 lds
v_mfma_f32_16x16x32_bf16 v[188:191], a[24:27], a[160:163], v[188:191]
s_waitcnt lgkmcnt(1)
ds_read_b64_tr_b16 a[2:3], v34 offset:1024
v_mfma_f32_16x16x32_bf16 v[188:191], a[28:31], a[176:179], v[188:191]
s_add_u32 s48, s48, 1
v_mfma_f32_16x16x32_bf16 v[192:195], a[28:31], a[180:183], v[192:195]
ds_read_b64_tr_b16 a[4:5], v34 offset:8192
v_mfma_f32_16x16x32_bf16 v[192:195], a[24:27], a[164:167], v[192:195]
buffer_load_dwordx4 v63, s[68:71], s40 offen offset:3072 lds
v_mfma_f32_16x16x32_bf16 v[192:195], a[20:23], a[148:151], v[192:195]
s_add_u32 s40, s40, 128
ds_read_b64_tr_b16 a[6:7], v34 offset:9216
v_mfma_f32_16x16x32_bf16 v[192:195], a[16:19], a[132:135], v[192:195]
s_cmp_eq_u32 s48, s82
s_cbranch_scc1 L2_sl1
L2_sl1_r:
v_smfmac_f32_16x16x64_bf16 v[56:59], v[44:47], a[16:23], v48
v_mfma_f32_16x16x32_bf16 v[196:199], a[16:19], a[136:139], v[196:199]
s_add_u32 m0, s37, 49152
ds_read_b64_tr_b16 a[8:9], v34 offset:16384
v_mfma_f32_16x16x32_bf16 v[196:199], a[20:23], a[152:155], v[196:199]
buffer_load_dwordx4 v60, s[68:71], s3 offen offset:0 lds
v_mfma_f32_16x16x32_bf16 v[196:199], a[24:27], a[168:171], v[196:199]
ds_read_b64_tr_b16 a[10:11], v34 offset:17408
v_mfma_f32_16x16x32_bf16 v[196:199], a[28:31], a[184:187], v[196:199]
ds_read_b64_tr_b16 a[12:13], v34 offset:24576
v_mfma_f32_16x16x32_bf16 v[200:203], a[28:31], a[188:191], v[200:203]
ds_read_b64_tr_b16 a[14:15], v34 offset:25600
v_mfma_f32_16x16x32_bf16 v[200:203], a[24:27], a[172:175], v[200:203]
buffer_load_dwordx4 v61, s[68:71], s3 offen offset:1024 lds
v_mfma_f32_16x16x32_bf16 v[200:203], a[20:23], a[156:159], v[200:203]
v_mfma_f32_16x16x32_bf16 v[200:203], a[16:19], a[140:143], v[200:203]
v_smfmac_f32_16x16x64_bf16 v[56:59], v[44:47], a[24:31], v48
s_waitcnt lgkmcnt(6)
v_mfma_f32_16x16x32_bf16 v[204:207], a[0:3], a[128:131], v[204:207]
s_waitcnt lgkmcnt(4)
ds_read_b64_tr_b16 a[16:17], v35 offset:0
v_mfma_f32_16x16x32_bf16 v[204:207], a[4:7], a[144:147], v[204:207]
s_waitcnt lgkmcnt(3)
buffer_load_dwordx4 v62, s[68:71], s3 offen offset:2048 lds
v_mfma_f32_16x16x32_bf16 v[204:207], a[8:11], a[160:163], v[204:207]
s_waitcnt lgkmcnt(1)
ds_read_b64_tr_b16 a[18:19], v35 offset:1024
v_mfma_f32_16x16x32_bf16 v[204:207], a[12:15], a[176:179], v[204:207]
s_waitcnt vmcnt(17)
ds_read_b128 a[192:195], v64 offset:32768
v_mfma_f32_16x16x32_bf16 v[208:211], a[12:15], a[180:183], v[208:211]
ds_read_b64_tr_b16 a[20:21], v35 offset:8192
v_mfma_f32_16x16x32_bf16 v[208:211], a[8:11], a[164:167], v[208:211]
buffer_load_dwordx4 v63, s[68:71], s3 offen offset:3072 lds
v_mfma_f32_16x16x32_bf16 v[208:211], a[4:7], a[148:151], v[208:211]
s_add_u32 s3, s3, 128
ds_read_b64_tr_b16 a[22:23], v35 offset:9216
v_mfma_f32_16x16x32_bf16 v[208:211], a[0:3], a[132:135], v[208:211]
ds_read_b128 a[208:211], v65 offset:32768
v_mfma_f32_16x16x32_bf16 v[212:215], a[0:3], a[136:139], v[212:215]
ds_read_b64_tr_b16 a[24:25], v35 offset:16384
v_mfma_f32_16x16x32_bf16 v[212:215], a[4:7], a[152:155], v[212:215]
buffer_load_dword a60, v49, s[8:11], s39 offen
v_mfma_f32_16x16x32_bf16 v[212:215], a[8:11], a[168:171], v[212:215]
ds_read_b64_tr_b16 a[26:27], v35 offset:17408
v_mfma_f32_16x16x32_bf16 v[212:215], a[12:15], a[184:187], v[212:215]
ds_read_b64_tr_b16 a[28:29], v35 offset:24576
v_mfma_f32_16x16x32_bf16 v[216:219], a[12:15], a[188:191], v[216:219]
ds_read_b64_tr_b16 a[30:31], v35 offset:25600
v_mfma_f32_16x16x32_bf16 v[216:219], a[8:11], a[172:175], v[216:219]
v_mfma_f32_16x16x32_bf16 v[216:219], a[4:7], a[156:159], v[216:219]
s_waitcnt vmcnt(17)
ds_read_b128 a[196:199], v64 offset:34816
v_mfma_f32_16x16x32_bf16 v[216:219], a[0:3], a[140:143], v[216:219]
s_waitcnt lgkmcnt(9)
ds_read_b128 a[212:215], v65 offset:34816
v_mfma_f32_16x16x32_bf16 v[220:223], a[16:19], a[128:131], v[220:223]
s_waitcnt lgkmcnt(7)
ds_read_b64_tr_b16 a[0:1], v28 offset:16384
v_mfma_f32_16x16x32_bf16 v[220:223], a[20:23], a[144:147], v[220:223]
s_waitcnt lgkmcnt(5)
v_mfma_f32_16x16x32_bf16 v[220:223], a[24:27], a[160:163], v[220:223]
s_waitcnt lgkmcnt(3)
ds_read_b64_tr_b16 a[2:3], v28 offset:17408
v_mfma_f32_16x16x32_bf16 v[220:223], a[28:31], a[176:179], v[220:223]
s_waitcnt vmcnt(15)
ds_read_b128 a[200:203], v64 offset:49152
v_mfma_f32_16x16x32_bf16 v[224:227], a[28:31], a[180:183], v[224:227]
ds_read_b64_tr_b16 a[4:5], v28 offset:24576
v_mfma_f32_16x16x32_bf16 v[224:227], a[24:27], a[164:167], v[224:227]
v_mfma_f32_16x16x32_bf16 v[224:227], a[20:23], a[148:151], v[224:227]
ds_read_b64_tr_b16 a[6:7], v28 offset:25600
v_mfma_f32_16x16x32_bf16 v[224:227], a[16:19], a[132:135], v[224:227]
ds_read_b128 a[216:219], v65 offset:49152
s_barrier
v_mfma_f32_16x16x32_bf16 v[228:231], a[16:19], a[136:139], v[228:231]
s_add_u32 m0, s37, 98304
ds_read_b64_tr_b16 a[8:9], v28 offset:32768
v_mfma_f32_16x16x32_bf16 v[228:231], a[20:23], a[152:155], v[228:231]
buffer_load_dwordx4 v2, s[8:11], s39 offen offset:0 lds
v_mfma_f32_16x16x32_bf16 v[228:231], a[24:27], a[168:171], v[228:231]
ds_read_b64_tr_b16 a[10:11], v28 offset:33792
v_mfma_f32_16x16x32_bf16 v[228:231], a[28:31], a[184:187], v[228:231]
ds_read_b64_tr_b16 a[12:13], v28 offset:40960
v_mfma_f32_16x16x32_bf16 v[232:235], a[28:31], a[188:191], v[232:235]
ds_read_b64_tr_b16 a[14:15], v28 offset:41984
v_mfma_f32_16x16x32_bf16 v[232:235], a[24:27], a[172:175], v[232:235]
buffer_load_dwordx4 v3, s[8:11], s39 offen offset:1024 lds
v_mfma_f32_16x16x32_bf16 v[232:235], a[20:23], a[156:159], v[232:235]
s_waitcnt vmcnt(15)
ds_read_b128 a[204:207], v64 offset:51200
v_mfma_f32_16x16x32_bf16 v[232:235], a[16:19], a[140:143], v[232:235]
s_waitcnt lgkmcnt(9)
ds_read_b128 a[220:223], v65 offset:51200
v_mfma_f32_16x16x32_bf16 v[108:111], a[0:3], a[160:163], v[108:111]
s_waitcnt lgkmcnt(7)
ds_read_b64_tr_b16 a[16:17], v29 offset:16384
v_mfma_f32_16x16x32_bf16 v[108:111], a[4:7], a[176:179], v[108:111]
s_waitcnt lgkmcnt(5)
buffer_load_dwordx4 v4, s[8:11], s39 offen offset:2048 lds
v_mfma_f32_16x16x32_bf16 v[108:111], a[8:11], a[192:195], v[108:111]
s_waitcnt lgkmcnt(3)
ds_read_b64_tr_b16 a[18:19], v29 offset:17408
v_mfma_f32_16x16x32_bf16 v[108:111], a[12:15], a[208:211], v[108:111]
v_mfma_f32_16x16x32_bf16 v[112:115], a[12:15], a[212:215], v[112:115]
ds_read_b64_tr_b16 a[20:21], v29 offset:24576
v_mfma_f32_16x16x32_bf16 v[112:115], a[8:11], a[196:199], v[112:115]
buffer_load_dwordx4 v5, s[8:11], s39 offen offset:3072 lds
v_mfma_f32_16x16x32_bf16 v[112:115], a[4:7], a[180:183], v[112:115]
s_add_u32 s39, s39, 524288
ds_read_b64_tr_b16 a[22:23], v29 offset:25600
v_mfma_f32_16x16x32_bf16 v[112:115], a[0:3], a[164:167], v[112:115]
v_mfma_f32_16x16x32_bf16 v[116:119], a[0:3], a[168:171], v[116:119]
s_add_u32 m0, s37, 65536
ds_read_b64_tr_b16 a[24:25], v29 offset:32768
v_mfma_f32_16x16x32_bf16 v[116:119], a[4:7], a[184:187], v[116:119]
buffer_load_dwordx4 v60, s[68:71], s40 offen offset:0 lds
v_mfma_f32_16x16x32_bf16 v[116:119], a[8:11], a[200:203], v[116:119]
ds_read_b64_tr_b16 a[26:27], v29 offset:33792
v_mfma_f32_16x16x32_bf16 v[116:119], a[12:15], a[216:219], v[116:119]
s_waitcnt lgkmcnt(6)
ds_read_b64_tr_b16 a[28:29], v29 offset:40960
v_mfma_f32_16x16x32_bf16 v[120:123], a[12:15], a[220:223], v[120:123]
ds_read_b64_tr_b16 a[30:31], v29 offset:41984
v_mfma_f32_16x16x32_bf16 v[120:123], a[8:11], a[204:207], v[120:123]
buffer_load_dwordx4 v61, s[68:71], s40 offen offset:1024 lds
v_mfma_f32_16x16x32_bf16 v[120:123], a[4:7], a[188:191], v[120:123]
v_mfma_f32_16x16x32_bf16 v[120:123], a[0:3], a[172:175], v[120:123]
s_waitcnt lgkmcnt(6)
v_mfma_f32_16x16x32_bf16 v[124:127], a[16:19], a[160:163], v[124:127]
s_waitcnt lgkmcnt(4)
ds_read_b64_tr_b16 a[0:1], v30 offset:16384
v_mfma_f32_16x16x32_bf16 v[124:127], a[20:23], a[176:179], v[124:127]
s_waitcnt lgkmcnt(3)
buffer_load_dwordx4 v62, s[68:71], s40 offen offset:2048 lds
v_mfma_f32_16x16x32_bf16 v[124:127], a[24:27], a[192:195], v[124:127]
s_waitcnt lgkmcnt(1)
ds_read_b64_tr_b16 a[2:3], v30 offset:17408
v_mfma_f32_16x16x32_bf16 v[124:127], a[28:31], a[208:211], v[124:127]
s_add_u32 s48, s48, 1
v_mfma_f32_16x16x32_bf16 v[128:131], a[28:31], a[212:215], v[128:131]
ds_read_b64_tr_b16 a[4:5], v30 offset:24576
v_mfma_f32_16x16x32_bf16 v[128:131], a[24:27], a[196:199], v[128:131]
buffer_load_dwordx4 v63, s[68:71], s40 offen offset:3072 lds
v_mfma_f32_16x16x32_bf16 v[128:131], a[20:23], a[180:183], v[128:131]
s_add_u32 s40, s40, 128
ds_read_b64_tr_b16 a[6:7], v30 offset:25600
v_mfma_f32_16x16x32_bf16 v[128:131], a[16:19], a[164:167], v[128:131]
s_cmp_eq_u32 s48, s82
s_cbranch_scc1 L2_sl2
L2_sl2_r:
v_mfma_f32_16x16x32_bf16 v[132:135], a[16:19], a[168:171], v[132:135]
s_add_u32 m0, s37, 81920
ds_read_b64_tr_b16 a[8:9], v30 offset:32768
v_mfma_f32_16x16x32_bf16 v[132:135], a[20:23], a[184:187], v[132:135]
buffer_load_dwordx4 v60, s[68:71], s3 offen offset:0 lds
v_mfma_f32_16x16x32_bf16 v[132:135], a[24:27], a[200:203], v[132:135]
ds_read_b64_tr_b16 a[10:11], v30 offset:33792
v_mfma_f32_16x16x32_bf16 v[132:135], a[28:31], a[216:219], v[132:135]
ds_read_b64_tr_b16 a[12:13], v30 offset:40960
v_mfma_f32_16x16x32_bf16 v[136:139], a[28:31], a[220:223], v[136:139]
ds_read_b64_tr_b16 a[14:15], v30 offset:41984
v_mfma_f32_16x16x32_bf16 v[136:139], a[24:27], a[204:207], v[136:139]
buffer_load_dwordx4 v61, s[68:71], s3 offen offset:1024 lds
v_mfma_f32_16x16x32_bf16 v[136:139], a[20:23], a[188:191], v[136:139]
v_mfma_f32_16x16x32_bf16 v[136:139], a[16:19], a[172:175], v[136:139]
s_waitcnt lgkmcnt(6)
v_mfma_f32_16x16x32_bf16 v[140:143], a[0:3], a[160:163], v[140:143]
s_waitcnt lgkmcnt(4)
ds_read_b64_tr_b16 a[16:17], v31 offset:16384
v_mfma_f32_16x16x32_bf16 v[140:143], a[4:7], a[176:179], v[140:143]
s_waitcnt lgkmcnt(3)
buffer_load_dwordx4 v62, s[68:71], s3 offen offset:2048 lds
v_mfma_f32_16x16x32_bf16 v[140:143], a[8:11], a[192:195], v[140:143]
s_waitcnt lgkmcnt(1)
ds_read_b64_tr_b16 a[18:19], v31 offset:17408
v_mfma_f32_16x16x32_bf16 v[140:143], a[12:15], a[208:211], v[140:143]
s_waitcnt vmcnt(18)
ds_read_b128 a[224:227], v64 offset:0
v_mfma_f32_16x16x32_bf16 v[144:147], a[12:15], a[212:215], v[144:147]
ds_read_b64_tr_b16 a[20:21], v31 offset:24576
v_mfma_f32_16x16x32_bf16 v[144:147], a[8:11], a[196:199], v[144:147]
buffer_load_dwordx4 v63, s[68:71], s3 offen offset:3072 lds
v_mfma_f32_16x16x32_bf16 v[144:147], a[4:7], a[180:183], v[144:147]
s_add_u32 s3, s3, 128
ds_read_b64_tr_b16 a[22:23], v31 offset:25600
v_mfma_f32_16x16x32_bf16 v[144:147], a[0:3], a[164:167], v[144:147]
ds_read_b128 a[240:243], v65 offset:0
v_mfma_f32_16x16x32_bf16 v[148:151], a[0:3], a[168:171], v[148:151]
ds_read_b64_tr_b16 a[24:25], v31 offset:32768
v_mfma_f32_16x16x32_bf16 v[148:151], a[4:7], a[184:187], v[148:151]
buffer_load_dword a60, v49, s[8:11], s39 offen
v_mfma_f32_16x16x32_bf16 v[148:151], a[8:11], a[200:203], v[148:151]
ds_read_b64_tr_b16 a[26:27], v31 offset:33792
v_mfma_f32_16x16x32_bf16 v[148:151], a[12:15], a[216:219], v[148:151]
ds_read_b64_tr_b16 a[28:29], v31 offset:40960
v_mfma_f32_16x16x32_bf16 v[152:155], a[12:15], a[220:223], v[152:155]
ds_read_b64_tr_b16 a[30:31], v31 offset:41984
v_mfma_f32_16x16x32_bf16 v[152:155], a[8:11], a[204:207], v[152:155]
v_mfma_f32_16x16x32_bf16 v[152:155], a[4:7], a[188:191], v[152:155]
s_waitcnt vmcnt(18)
ds_read_b128 a[228:231], v64 offset:2048
v_mfma_f32_16x16x32_bf16 v[152:155], a[0:3], a[172:175], v[152:155]
s_waitcnt lgkmcnt(9)
ds_read_b128 a[244:247], v65 offset:2048
v_mfma_f32_16x16x32_bf16 v[156:159], a[16:19], a[160:163], v[156:159]
s_waitcnt lgkmcnt(7)
ds_read_b64_tr_b16 a[0:1], v32 offset:32768
v_mfma_f32_16x16x32_bf16 v[156:159], a[20:23], a[176:179], v[156:159]
s_waitcnt lgkmcnt(5)
v_mfma_f32_16x16x32_bf16 v[156:159], a[24:27], a[192:195], v[156:159]
s_waitcnt lgkmcnt(3)
ds_read_b64_tr_b16 a[2:3], v32 offset:33792
v_mfma_f32_16x16x32_bf16 v[156:159], a[28:31], a[208:211], v[156:159]
s_waitcnt vmcnt(16)
ds_read_b128 a[232:235], v64 offset:16384
v_mfma_f32_16x16x32_bf16 v[160:163], a[28:31], a[212:215], v[160:163]
ds_read_b64_tr_b16 a[4:5], v32 offset:40960
v_mfma_f32_16x16x32_bf16 v[160:163], a[24:27], a[196:199], v[160:163]
v_mfma_f32_16x16x32_bf16 v[160:163], a[20:23], a[180:183], v[160:163]
ds_read_b64_tr_b16 a[6:7], v32 offset:41984
v_mfma_f32_16x16x32_bf16 v[160:163], a[16:19], a[164:167], v[160:163]
ds_read_b128 a[248:251], v65 offset:16384
s_barrier
v_mfma_f32_16x16x32_bf16 v[164:167], a[16:19], a[168:171], v[164:167]
s_add_u32 m0, s37, 114688
ds_read_b64_tr_b16 a[8:9], v32 offset:49152
v_mfma_f32_16x16x32_bf16 v[164:167], a[20:23], a[184:187], v[164:167]
buffer_load_dwordx4 v2, s[8:11], s39 offen offset:0 lds
v_mfma_f32_16x16x32_bf16 v[164:167], a[24:27], a[200:203], v[164:167]
ds_read_b64_tr_b16 a[10:11], v32 offset:50176
v_mfma_f32_16x16x32_bf16 v[164:167], a[28:31], a[216:219], v[164:167]
ds_read_b64_tr_b16 a[12:13], v32 offset:57344
v_mfma_f32_16x16x32_bf16 v[168:171], a[28:31], a[220:223], v[168:171]
ds_read_b64_tr_b16 a[14:15], v32 offset:58368
v_mfma_f32_16x16x32_bf16 v[168:171], a[24:27], a[204:207], v[168:171]
buffer_load_dwordx4 v3, s[8:11], s39 offen offset:1024 lds
v_mfma_f32_16x16x32_bf16 v[168:171], a[20:23], a[188:191], v[168:171]
s_waitcnt vmcnt(16)
ds_read_b128 a[236:239], v64 offset:18432
v_mfma_f32_16x16x32_bf16 v[168:171], a[16:19], a[172:175], v[168:171]
s_waitcnt lgkmcnt(9)
ds_read_b128 a[252:255], v65 offset:18432
v_mfma_f32_16x16x32_bf16 v[172:175], a[0:3], a[192:195], v[172:175]
s_waitcnt lgkmcnt(7)
ds_read_b64_tr_b16 a[16:17], v33 offset:32768
v_mfma_f32_16x16x32_bf16 v[172:175], a[4:7], a[208:211], v[172:175]
s_waitcnt lgkmcnt(5)
buffer_load_dwordx4 v4, s[8:11], s39 offen offset:2048 lds
v_mfma_f32_16x16x32_bf16 v[172:175], a[8:11], a[224:227], v[172:175]
s_waitcnt lgkmcnt(3)
ds_read_b64_tr_b16 a[18:19], v33 offset:33792
v_mfma_f32_16x16x32_bf16 v[172:175], a[12:15], a[240:243], v[172:175]
v_mfma_f32_16x16x32_bf16 v[176:179], a[12:15], a[244:247], v[176:179]
ds_read_b64_tr_b16 a[20:21], v33 offset:40960
v_mfma_f32_16x16x32_bf16 v[176:179], a[8:11], a[228:231], v[176:179]
buffer_load_dwordx4 v5, s[8:11], s39 offen offset:3072 lds
v_mfma_f32_16x16x32_bf16 v[176:179], a[4:7], a[212:215], v[176:179]
s_add_u32 s39, s39, 524288
ds_read_b64_tr_b16 a[22:23], v33 offset:41984
v_mfma_f32_16x16x32_bf16 v[176:179], a[0:3], a[196:199], v[176:179]
v_smfmac_f32_16x16x64_bf16 v[52:55], v[44:47], a[0:7], v48
v_mfma_f32_16x16x32_bf16 v[180:183], a[0:3], a[200:203], v[180:183]
s_add_u32 m0, s37, 32768
ds_read_b64_tr_b16 a[24:25], v33 offset:49152
v_mfma_f32_16x16x32_bf16 v[180:183], a[4:7], a[216:219], v[180:183]
buffer_load_dwordx4 v60, s[68:71], s40 offen offset:0 lds
v_mfma_f32_16x16x32_bf16 v[180:183], a[8:11], a[232:235], v[180:183]
ds_read_b64_tr_b16 a[26:27], v33 offset:50176
v_mfma_f32_16x16x32_bf16 v[180:183], a[12:15], a[248:251], v[180:183]
s_waitcnt lgkmcnt(6)
ds_read_b64_tr_b16 a[28:29], v33 offset:57344
v_mfma_f32_16x16x32_bf16 v[184:187], a[12:15], a[252:255], v[184:187]
ds_read_b64_tr_b16 a[30:31], v33 offset:58368
v_mfma_f32_16x16x32_bf16 v[184:187], a[8:11], a[236:239], v[184:187]
buffer_load_dwordx4 v61, s[68:71], s40 offen offset:1024 lds
v_mfma_f32_16x16x32_bf16 v[184:187], a[4:7], a[220:223], v[184:187]
v_mfma_f32_16x16x32_bf16 v[184:187], a[0:3], a[204:207], v[184:187]
v_smfmac_f32_16x16x64_bf16 v[52:55], v[44:47], a[8:15], v48
s_waitcnt lgkmcnt(6)
v_mfma_f32_16x16x32_bf16 v[188:191], a[16:19], a[192:195], v[188:191]
s_waitcnt lgkmcnt(4)
ds_read_b64_tr_b16 a[0:1], v34 offset:32768
v_mfma_f32_16x16x32_bf16 v[188:191], a[20:23], a[208:211], v[188:191]
s_waitcnt lgkmcnt(3)
buffer_load_dwordx4 v62, s[68:71], s40 offen offset:2048 lds
v_mfma_f32_16x16x32_bf16 v[188:191], a[24:27], a[224:227], v[188:191]
s_waitcnt lgkmcnt(1)
ds_read_b64_tr_b16 a[2:3], v34 offset:33792
v_mfma_f32_16x16x32_bf16 v[188:191], a[28:31], a[240:243], v[188:191]
s_add_u32 s48, s48, 1
v_mfma_f32_16x16x32_bf16 v[192:195], a[28:31], a[244:247], v[192:195]
ds_read_b64_tr_b16 a[4:5], v34 offset:40960
v_mfma_f32_16x16x32_bf16 v[192:195], a[24:27], a[228:231], v[192:195]
buffer_load_dwordx4 v63, s[68:71], s40 offen offset:3072 lds
v_mfma_f32_16x16x32_bf16 v[192:195], a[20:23], a[212:215], v[192:195]
s_add_u32 s40, s40, 128
ds_read_b64_tr_b16 a[6:7], v34 offset:41984
v_mfma_f32_16x16x32_bf16 v[192:195], a[16:19], a[196:199], v[192:195]
s_cmp_eq_u32 s48, s82
s_cbranch_scc1 L2_sl3
L2_sl3_r:
v_smfmac_f32_16x16x64_bf16 v[56:59], v[44:47], a[16:23], v48
v_mfma_f32_16x16x32_bf16 v[196:199], a[16:19], a[200:203], v[196:199]
s_add_u32 m0, s37, 49152
ds_read_b64_tr_b16 a[8:9], v34 offset:49152
v_mfma_f32_16x16x32_bf16 v[196:199], a[20:23], a[216:219], v[196:199]
buffer_load_dwordx4 v60, s[68:71], s3 offen offset:0 lds
v_mfma_f32_16x16x32_bf16 v[196:199], a[24:27], a[232:235], v[196:199]
ds_read_b64_tr_b16 a[10:11], v34 offset:50176
v_mfma_f32_16x16x32_bf16 v[196:199], a[28:31], a[248:251], v[196:199]
ds_read_b64_tr_b16 a[12:13], v34 offset:57344
v_mfma_f32_16x16x32_bf16 v[200:203], a[28:31], a[252:255], v[200:203]
ds_read_b64_tr_b16 a[14:15], v34 offset:58368
v_mfma_f32_16x16x32_bf16 v[200:203], a[24:27], a[236:239], v[200:203]
buffer_load_dwordx4 v61, s[68:71], s3 offen offset:1024 lds
v_mfma_f32_16x16x32_bf16 v[200:203], a[20:23], a[220:223], v[200:203]
v_mfma_f32_16x16x32_bf16 v[200:203], a[16:19], a[204:207], v[200:203]
v_smfmac_f32_16x16x64_bf16 v[56:59], v[44:47], a[24:31], v48
s_waitcnt lgkmcnt(6)
v_mfma_f32_16x16x32_bf16 v[204:207], a[0:3], a[192:195], v[204:207]
s_waitcnt lgkmcnt(4)
ds_read_b64_tr_b16 a[16:17], v35 offset:32768
v_mfma_f32_16x16x32_bf16 v[204:207], a[4:7], a[208:211], v[204:207]
s_waitcnt lgkmcnt(3)
buffer_load_dwordx4 v62, s[68:71], s3 offen offset:2048 lds
v_mfma_f32_16x16x32_bf16 v[204:207], a[8:11], a[224:227], v[204:207]
s_waitcnt lgkmcnt(1)
ds_read_b64_tr_b16 a[18:19], v35 offset:33792
v_mfma_f32_16x16x32_bf16 v[204:207], a[12:15], a[240:243], v[204:207]
s_waitcnt vmcnt(18)
ds_read_b128 a[128:131], v64 offset:32768
v_mfma_f32_16x16x32_bf16 v[208:211], a[12:15], a[244:247], v[208:211]
ds_read_b64_tr_b16 a[20:21], v35 offset:40960
v_mfma_f32_16x16x32_bf16 v[208:211], a[8:11], a[228:231], v[208:211]
buffer_load_dwordx4 v63, s[68:71], s3 offen offset:3072 lds
v_mfma_f32_16x16x32_bf16 v[208:211], a[4:7], a[212:215], v[208:211]
s_add_u32 s3, s3, 128
ds_read_b64_tr_b16 a[22:23], v35 offset:41984
v_mfma_f32_16x16x32_bf16 v[208:211], a[0:3], a[196:199], v[208:211]
ds_read_b128 a[144:147], v65 offset:32768
v_mfma_f32_16x16x32_bf16 v[212:215], a[0:3], a[200:203], v[212:215]
ds_read_b64_tr_b16 a[24:25], v35 offset:49152
v_mfma_f32_16x16x32_bf16 v[212:215], a[4:7], a[216:219], v[212:215]
buffer_load_dword a60, v49, s[8:11], s39 offen
v_mfma_f32_16x16x32_bf16 v[212:215], a[8:11], a[232:235], v[212:215]
ds_read_b64_tr_b16 a[26:27], v35 offset:50176
v_mfma_f32_16x16x32_bf16 v[212:215], a[12:15], a[248:251], v[212:215]
ds_read_b64_tr_b16 a[28:29], v35 offset:57344
v_mfma_f32_16x16x32_bf16 v[216:219], a[12:15], a[252:255], v[216:219]
ds_read_b64_tr_b16 a[30:31], v35 offset:58368
v_mfma_f32_16x16x32_bf16 v[216:219], a[8:11], a[236:239], v[216:219]
v_mfma_f32_16x16x32_bf16 v[216:219], a[4:7], a[220:223], v[216:219]
s_waitcnt vmcnt(18)
ds_read_b128 a[132:135], v64 offset:34816
v_mfma_f32_16x16x32_bf16 v[216:219], a[0:3], a[204:207], v[216:219]
s_waitcnt lgkmcnt(9)
ds_read_b128 a[148:151], v65 offset:34816
v_mfma_f32_16x16x32_bf16 v[220:223], a[16:19], a[192:195], v[220:223]
s_waitcnt lgkmcnt(7)
ds_read_b64_tr_b16 a[0:1], v28 offset:49152
v_mfma_f32_16x16x32_bf16 v[220:223], a[20:23], a[208:211], v[220:223]
s_waitcnt lgkmcnt(5)
v_mfma_f32_16x16x32_bf16 v[220:223], a[24:27], a[224:227], v[220:223]
s_waitcnt lgkmcnt(3)
ds_read_b64_tr_b16 a[2:3], v28 offset:50176
v_mfma_f32_16x16x32_bf16 v[220:223], a[28:31], a[240:243], v[220:223]
s_waitcnt vmcnt(16)
ds_read_b128 a[136:139], v64 offset:49152
v_mfma_f32_16x16x32_bf16 v[224:227], a[28:31], a[244:247], v[224:227]
ds_read_b64_tr_b16 a[4:5], v28 offset:57344
v_mfma_f32_16x16x32_bf16 v[224:227], a[24:27], a[228:231], v[224:227]
v_mfma_f32_16x16x32_bf16 v[224:227], a[20:23], a[212:215], v[224:227]
ds_read_b64_tr_b16 a[6:7], v28 offset:58368
v_mfma_f32_16x16x32_bf16 v[224:227], a[16:19], a[196:199], v[224:227]
ds_read_b128 a[152:155], v65 offset:49152
s_barrier
v_mfma_f32_16x16x32_bf16 v[228:231], a[16:19], a[200:203], v[228:231]
s_add_u32 m0, s37, 131072
ds_read_b64_tr_b16 a[8:9], v28 offset:0
v_mfma_f32_16x16x32_bf16 v[228:231], a[20:23], a[216:219], v[228:231]
buffer_load_dwordx4 v2, s[8:11], s39 offen offset:0 lds
v_mfma_f32_16x16x32_bf16 v[228:231], a[24:27], a[232:235], v[228:231]
ds_read_b64_tr_b16 a[10:11], v28 offset:1024
v_mfma_f32_16x16x32_bf16 v[228:231], a[28:31], a[248:251], v[228:231]
ds_read_b64_tr_b16 a[12:13], v28 offset:8192
v_mfma_f32_16x16x32_bf16 v[232:235], a[28:31], a[252:255], v[232:235]
ds_read_b64_tr_b16 a[14:15], v28 offset:9216
v_mfma_f32_16x16x32_bf16 v[232:235], a[24:27], a[236:239], v[232:235]
buffer_load_dwordx4 v3, s[8:11], s39 offen offset:1024 lds
v_mfma_f32_16x16x32_bf16 v[232:235], a[20:23], a[220:223], v[232:235]
s_waitcnt vmcnt(16)
ds_read_b128 a[140:143], v64 offset:51200
v_mfma_f32_16x16x32_bf16 v[232:235], a[16:19], a[204:207], v[232:235]
s_waitcnt lgkmcnt(9)
ds_read_b128 a[156:159], v65 offset:51200
v_mfma_f32_16x16x32_bf16 v[108:111], a[0:3], a[224:227], v[108:111]
s_waitcnt lgkmcnt(7)
ds_read_b64_tr_b16 a[16:17], v29 offset:49152
v_mfma_f32_16x16x32_bf16 v[108:111], a[4:7], a[240:243], v[108:111]
s_waitcnt lgkmcnt(5)
buffer_load_dwordx4 v4, s[8:11], s39 offen offset:2048 lds
v_mfma_f32_16x16x32_bf16 v[108:111], a[8:11], a[128:131], v[108:111]
s_waitcnt lgkmcnt(3)
ds_read_b64_tr_b16 a[18:19], v29 offset:50176
v_mfma_f32_16x16x32_bf16 v[108:111], a[12:15], a[144:147], v[108:111]
s_cmp_eq_u32 s38, -1
s_cselect_b32 s54, s93, 0x1000
v_mfma_f32_16x16x32_bf16 v[112:115], a[12:15], a[148:151], v[112:115]
ds_read_b64_tr_b16 a[20:21], v29 offset:57344
v_mfma_f32_16x16x32_bf16 v[112:115], a[8:11], a[132:135], v[112:115]
buffer_load_dwordx4 v5, s[8:11], s39 offen offset:3072 lds
v_mfma_f32_16x16x32_bf16 v[112:115], a[4:7], a[244:247], v[112:115]
s_add_u32 s39, s39, 524288
ds_read_b64_tr_b16 a[22:23], v29 offset:58368
v_mfma_f32_16x16x32_bf16 v[112:115], a[0:3], a[228:231], v[112:115]
buffer_load_dword v75, v74, s[72:75], s54 offen sc1
v_mfma_f32_16x16x32_bf16 v[116:119], a[0:3], a[232:235], v[116:119]
s_add_u32 m0, s37, 65536
ds_read_b64_tr_b16 a[24:25], v29 offset:0
v_mfma_f32_16x16x32_bf16 v[116:119], a[4:7], a[248:251], v[116:119]
buffer_load_dwordx4 v60, s[68:71], s40 offen offset:0 lds
v_mfma_f32_16x16x32_bf16 v[116:119], a[8:11], a[136:139], v[116:119]
ds_read_b64_tr_b16 a[26:27], v29 offset:1024
v_mfma_f32_16x16x32_bf16 v[116:119], a[12:15], a[152:155], v[116:119]
s_waitcnt lgkmcnt(6)
ds_read_b64_tr_b16 a[28:29], v29 offset:8192
v_mfma_f32_16x16x32_bf16 v[120:123], a[12:15], a[156:159], v[120:123]
ds_read_b64_tr_b16 a[30:31], v29 offset:9216
v_mfma_f32_16x16x32_bf16 v[120:123], a[8:11], a[140:143], v[120:123]
buffer_load_dwordx4 v61, s[68:71], s40 offen offset:1024 lds
v_mfma_f32_16x16x32_bf16 v[120:123], a[4:7], a[252:255], v[120:123]
v_mfma_f32_16x16x32_bf16 v[120:123], a[0:3], a[236:239], v[120:123]
s_waitcnt lgkmcnt(6)
v_mfma_f32_16x16x32_bf16 v[124:127], a[16:19], a[224:227], v[124:127]
s_waitcnt lgkmcnt(4)
ds_read_b64_tr_b16 a[0:1], v30 offset:49152
v_mfma_f32_16x16x32_bf16 v[124:127], a[20:23], a[240:243], v[124:127]
s_waitcnt lgkmcnt(3)
buffer_load_dwordx4 v62, s[68:71], s40 offen offset:2048 lds
v_mfma_f32_16x16x32_bf16 v[124:127], a[24:27], a[128:131], v[124:127]
s_waitcnt lgkmcnt(1)
ds_read_b64_tr_b16 a[2:3], v30 offset:50176
v_mfma_f32_16x16x32_bf16 v[124:127], a[28:31], a[144:147], v[124:127]
s_add_u32 s48, s48, 1
v_mfma_f32_16x16x32_bf16 v[128:131], a[28:31], a[148:151], v[128:131]
ds_read_b64_tr_b16 a[4:5], v30 offset:57344
v_mfma_f32_16x16x32_bf16 v[128:131], a[24:27], a[132:135], v[128:131]
buffer_load_dwordx4 v63, s[68:71], s40 offen offset:3072 lds
v_mfma_f32_16x16x32_bf16 v[128:131], a[20:23], a[244:247], v[128:131]
s_add_u32 s40, s40, 128
ds_read_b64_tr_b16 a[6:7], v30 offset:58368
v_mfma_f32_16x16x32_bf16 v[128:131], a[16:19], a[228:231], v[128:131]
s_cmp_eq_u32 s48, s82
s_cbranch_scc1 L2_sl0
L2_sl0_r:
v_mfma_f32_16x16x32_bf16 v[132:135], a[16:19], a[232:235], v[132:135]
s_add_u32 m0, s37, 81920
ds_read_b64_tr_b16 a[8:9], v30 offset:0
v_mfma_f32_16x16x32_bf16 v[132:135], a[20:23], a[248:251], v[132:135]
buffer_load_dwordx4 v60, s[68:71], s3 offen offset:0 lds
v_mfma_f32_16x16x32_bf16 v[132:135], a[24:27], a[136:139], v[132:135]
ds_read_b64_tr_b16 a[10:11], v30 offset:1024
v_mfma_f32_16x16x32_bf16 v[132:135], a[28:31], a[152:155], v[132:135]
ds_read_b64_tr_b16 a[12:13], v30 offset:8192
v_mfma_f32_16x16x32_bf16 v[136:139], a[28:31], a[156:159], v[136:139]
ds_read_b64_tr_b16 a[14:15], v30 offset:9216
v_mfma_f32_16x16x32_bf16 v[136:139], a[24:27], a[140:143], v[136:139]
buffer_load_dwordx4 v61, s[68:71], s3 offen offset:1024 lds
v_mfma_f32_16x16x32_bf16 v[136:139], a[20:23], a[252:255], v[136:139]
v_mfma_f32_16x16x32_bf16 v[136:139], a[16:19], a[236:239], v[136:139]
s_waitcnt lgkmcnt(6)
v_mfma_f32_16x16x32_bf16 v[140:143], a[0:3], a[224:227], v[140:143]
s_waitcnt lgkmcnt(4)
ds_read_b64_tr_b16 a[16:17], v31 offset:49152
v_mfma_f32_16x16x32_bf16 v[140:143], a[4:7], a[240:243], v[140:143]
s_waitcnt lgkmcnt(3)
buffer_load_dwordx4 v62, s[68:71], s3 offen offset:2048 lds
v_mfma_f32_16x16x32_bf16 v[140:143], a[8:11], a[128:131], v[140:143]
s_waitcnt lgkmcnt(1)
ds_read_b64_tr_b16 a[18:19], v31 offset:50176
v_mfma_f32_16x16x32_bf16 v[140:143], a[12:15], a[144:147], v[140:143]
s_waitcnt vmcnt(19)
ds_read_b128 a[160:163], v64 offset:0
v_mfma_f32_16x16x32_bf16 v[144:147], a[12:15], a[148:151], v[144:147]
ds_read_b64_tr_b16 a[20:21], v31 offset:57344
v_mfma_f32_16x16x32_bf16 v[144:147], a[8:11], a[132:135], v[144:147]
buffer_load_dwordx4 v63, s[68:71], s3 offen offset:3072 lds
v_mfma_f32_16x16x32_bf16 v[144:147], a[4:7], a[244:247], v[144:147]
s_add_u32 s3, s3, 128
ds_read_b64_tr_b16 a[22:23], v31 offset:58368
v_mfma_f32_16x16x32_bf16 v[144:147], a[0:3], a[228:231], v[144:147]
ds_read_b128 a[176:179], v65 offset:0
v_mfma_f32_16x16x32_bf16 v[148:151], a[0:3], a[232:235], v[148:151]
ds_read_b64_tr_b16 a[24:25], v31 offset:0
v_mfma_f32_16x16x32_bf16 v[148:151], a[4:7], a[248:251], v[148:151]
buffer_load_dword a60, v49, s[8:11], s39 offen
v_mfma_f32_16x16x32_bf16 v[148:151], a[8:11], a[136:139], v[148:151]
ds_read_b64_tr_b16 a[26:27], v31 offset:1024
v_mfma_f32_16x16x32_bf16 v[148:151], a[12:15], a[152:155], v[148:151]
ds_read_b64_tr_b16 a[28:29], v31 offset:8192
v_mfma_f32_16x16x32_bf16 v[152:155], a[12:15], a[156:159], v[152:155]
ds_read_b64_tr_b16 a[30:31], v31 offset:9216
v_mfma_f32_16x16x32_bf16 v[152:155], a[8:11], a[140:143], v[152:155]
v_mfma_f32_16x16x32_bf16 v[152:155], a[4:7], a[252:255], v[152:155]
s_waitcnt vmcnt(19)
ds_read_b128 a[164:167], v64 offset:2048
v_mfma_f32_16x16x32_bf16 v[152:155], a[0:3], a[236:239], v[152:155]
s_waitcnt lgkmcnt(9)
ds_read_b128 a[180:183], v65 offset:2048
v_mfma_f32_16x16x32_bf16 v[156:159], a[16:19], a[224:227], v[156:159]
s_waitcnt lgkmcnt(7)
ds_read_b64_tr_b16 a[0:1], v32 offset:0
v_mfma_f32_16x16x32_bf16 v[156:159], a[20:23], a[240:243], v[156:159]
s_waitcnt lgkmcnt(5)
v_mfma_f32_16x16x32_bf16 v[156:159], a[24:27], a[128:131], v[156:159]
s_waitcnt lgkmcnt(3)
ds_read_b64_tr_b16 a[2:3], v32 offset:1024
v_mfma_f32_16x16x32_bf16 v[156:159], a[28:31], a[144:147], v[156:159]
s_waitcnt vmcnt(17)
ds_read_b128 a[168:171], v64 offset:16384
v_mfma_f32_16x16x32_bf16 v[160:163], a[28:31], a[148:151], v[160:163]
ds_read_b64_tr_b16 a[4:5], v32 offset:8192
v_mfma_f32_16x16x32_bf16 v[160:163], a[24:27], a[132:135], v[160:163]
v_mfma_f32_16x16x32_bf16 v[160:163], a[20:23], a[244:247], v[160:163]
ds_read_b64_tr_b16 a[6:7], v32 offset:9216
v_mfma_f32_16x16x32_bf16 v[160:163], a[16:19], a[228:231], v[160:163]
ds_read_b128 a[184:187], v65 offset:16384
s_barrier
v_mfma_f32_16x16x32_bf16 v[164:167], a[16:19], a[232:235], v[164:167]
s_add_u32 m0, s37, 147456
ds_read_b64_tr_b16 a[8:9], v32 offset:16384
v_mfma_f32_16x16x32_bf16 v[164:167], a[20:23], a[248:251], v[164:167]
buffer_load_dwordx4 v2, s[8:11], s39 offen offset:0 lds
v_mfma_f32_16x16x32_bf16 v[164:167], a[24:27], a[136:139], v[164:167]
ds_read_b64_tr_b16 a[10:11], v32 offset:17408
v_mfma_f32_16x16x32_bf16 v[164:167], a[28:31], a[152:155], v[164:167]
ds_read_b64_tr_b16 a[12:13], v32 offset:24576
v_mfma_f32_16x16x32_bf16 v[168:171], a[28:31], a[156:159], v[168:171]
ds_read_b64_tr_b16 a[14:15], v32 offset:25600
v_mfma_f32_16x16x32_bf16 v[168:171], a[24:27], a[140:143], v[168:171]
buffer_load_dwordx4 v3, s[8:11], s39 offen offset:1024 lds
v_mfma_f32_16x16x32_bf16 v[168:171], a[20:23], a[252:255], v[168:171]
s_waitcnt vmcnt(17)
ds_read_b128 a[172:175], v64 offset:18432
v_mfma_f32_16x16x32_bf16 v[168:171], a[16:19], a[236:239], v[168:171]
s_waitcnt lgkmcnt(9)
ds_read_b128 a[188:191], v65 offset:18432
s_add_u32 s38, s38, 1
s_cbranch_scc0 L2_q
s_cmp_lt_u32 s61, 14
s_cselect_b32 s54, s94, 0
s_cmp_lg_u32 s54, 0
s_cbranch_scc1 L2_G
v_mfma_f32_16x16x32_bf16 v[172:175], a[0:3], a[128:131], v[172:175]
s_waitcnt lgkmcnt(7)
s_lshl_b32 s50, s62, 19
ds_read_b64_tr_b16 a[16:17], v33 offset:0
v_mfma_f32_16x16x32_bf16 v[172:175], a[4:7], a[144:147], v[172:175]
s_waitcnt lgkmcnt(5)
buffer_load_dwordx4 v4, s[8:11], s39 offen offset:2048 lds
v_mfma_f32_16x16x32_bf16 v[172:175], a[8:11], a[160:163], v[172:175]
s_waitcnt lgkmcnt(3)
s_mov_b32 s41, s50
ds_read_b64_tr_b16 a[18:19], v33 offset:1024
v_mfma_f32_16x16x32_bf16 v[172:175], a[12:15], a[176:179], v[172:175]
s_mov_b32 s42, s50
v_bfe_u32 v72, v0, 3, 1
v_and_b32 v73, 7, v0
v_mfma_f32_16x16x32_bf16 v[176:179], a[12:15], a[180:183], v[176:179]
ds_read_b64_tr_b16 a[20:21], v33 offset:8192
v_bfe_u32 v38, v0, 4, 2
v_mfma_f32_16x16x32_bf16 v[176:179], a[8:11], a[164:167], v[176:179]
buffer_load_dwordx4 v5, s[8:11], s39 offen offset:3072 lds
v_mfma_f32_16x16x32_bf16 v[176:179], a[4:7], a[148:151], v[176:179]
s_add_u32 s39, s39, 524288
ds_read_b64_tr_b16 a[22:23], v33 offset:9216
v_lshrrev_b32 v39, 6, v0
v_mfma_f32_16x16x32_bf16 v[176:179], a[0:3], a[132:135], v[176:179]
v_lshlrev_b32 v72, 7, v72
v_lshl_add_u32 v72, v73, 3, v72
v_smfmac_f32_16x16x64_bf16 v[52:55], v[44:47], a[0:7], v48
v_lshl_add_u32 v39, v39, 4, v38
v_lshlrev_b32 v39, 8, v39
v_mfma_f32_16x16x32_bf16 v[180:183], a[0:3], a[136:139], v[180:183]
s_add_u32 m0, s37, 32768
ds_read_b64_tr_b16 a[24:25], v33 offset:16384
v_and_b32 v40, 15, v0
v_mfma_f32_16x16x32_bf16 v[180:183], a[4:7], a[152:155], v[180:183]
buffer_load_dwordx4 v60, s[68:71], s40 offen offset:0 lds
v_mfma_f32_16x16x32_bf16 v[180:183], a[8:11], a[168:171], v[180:183]
ds_read_b64_tr_b16 a[26:27], v33 offset:17408
v_or_b32 v41, 0, v38
v_mfma_f32_16x16x32_bf16 v[180:183], a[12:15], a[184:187], v[180:183]
s_waitcnt lgkmcnt(6)
ds_read_b64_tr_b16 a[28:29], v33 offset:24576
v_xor_b32 v41, v41, v40
v_mfma_f32_16x16x32_bf16 v[184:187], a[12:15], a[188:191], v[184:187]
ds_read_b64_tr_b16 a[30:31], v33 offset:25600
v_lshl_add_u32 v10, v41, 4, v39
v_mfma_f32_16x16x32_bf16 v[184:187], a[8:11], a[172:175], v[184:187]
buffer_load_dwordx4 v61, s[68:71], s40 offen offset:1024 lds
v_mfma_f32_16x16x32_bf16 v[184:187], a[4:7], a[156:159], v[184:187]
v_or_b32 v41, 4, v38
v_xor_b32 v41, v41, v40
v_mfma_f32_16x16x32_bf16 v[184:187], a[0:3], a[140:143], v[184:187]
s_lshl_b32 s100, s63, 10
v_lshl_add_u32 v11, v41, 4, v39
v_or_b32 v41, 8, v38
v_smfmac_f32_16x16x64_bf16 v[52:55], v[44:47], a[8:15], v48
s_waitcnt lgkmcnt(6)
v_xor_b32 v41, v41, v40
v_lshl_add_u32 v12, v41, 4, v39
v_mfma_f32_16x16x32_bf16 v[188:191], a[16:19], a[128:131], v[188:191]
s_waitcnt lgkmcnt(4)
ds_read_b64_tr_b16 a[0:1], v34 offset:0
v_or_b32 v41, 12, v38
v_mfma_f32_16x16x32_bf16 v[188:191], a[20:23], a[144:147], v[188:191]
s_waitcnt lgkmcnt(3)
buffer_load_dwordx4 v62, s[68:71], s40 offen offset:2048 lds
v_mfma_f32_16x16x32_bf16 v[188:191], a[24:27], a[160:163], v[188:191]
s_waitcnt lgkmcnt(1)
ds_read_b64_tr_b16 a[2:3], v34 offset:1024
v_xor_b32 v41, v41, v40
v_mfma_f32_16x16x32_bf16 v[188:191], a[28:31], a[176:179], v[188:191]
v_lshl_add_u32 v13, v41, 4, v39
v_or_b32 v41, 0, v38
v_mfma_f32_16x16x32_bf16 v[192:195], a[28:31], a[180:183], v[192:195]
ds_read_b64_tr_b16 a[4:5], v34 offset:8192
v_lshlrev_b32 v41, 1, v41
v_mfma_f32_16x16x32_bf16 v[192:195], a[24:27], a[164:167], v[192:195]
buffer_load_dwordx4 v63, s[68:71], s40 offen offset:3072 lds
v_mfma_f32_16x16x32_bf16 v[192:195], a[20:23], a[148:151], v[192:195]
s_add_u32 s40, s40, 128
ds_read_b64_tr_b16 a[6:7], v34 offset:9216
v_xor_b32 v41, v41, v40
v_mfma_f32_16x16x32_bf16 v[192:195], a[16:19], a[132:135], v[192:195]
v_lshl_add_u32 v14, v41, 4, v39
v_or_b32 v41, 4, v38
v_smfmac_f32_16x16x64_bf16 v[56:59], v[44:47], a[16:23], v48
v_lshlrev_b32 v41, 1, v41
v_xor_b32 v41, v41, v40
v_mfma_f32_16x16x32_bf16 v[196:199], a[16:19], a[136:139], v[196:199]
s_add_u32 m0, s37, 49152
ds_read_b64_tr_b16 a[8:9], v34 offset:16384
v_lshl_add_u32 v15, v41, 4, v39
v_mfma_f32_16x16x32_bf16 v[196:199], a[20:23], a[152:155], v[196:199]
buffer_load_dwordx4 v60, s[68:71], s3 offen offset:0 lds
v_mfma_f32_16x16x32_bf16 v[196:199], a[24:27], a[168:171], v[196:199]
ds_read_b64_tr_b16 a[10:11], v34 offset:17408
v_and_b32 v39, 1, v38
v_mfma_f32_16x16x32_bf16 v[196:199], a[28:31], a[184:187], v[196:199]
ds_read_b64_tr_b16 a[12:13], v34 offset:24576
v_lshlrev_b32 v39, 1, v39
v_mfma_f32_16x16x32_bf16 v[200:203], a[28:31], a[188:191], v[200:203]
ds_read_b64_tr_b16 a[14:15], v34 offset:25600
v_lshrrev_b32 v41, 1, v38
v_mfma_f32_16x16x32_bf16 v[200:203], a[24:27], a[172:175], v[200:203]
buffer_load_dwordx4 v61, s[68:71], s3 offen offset:1024 lds
v_mfma_f32_16x16x32_bf16 v[200:203], a[20:23], a[156:159], v[200:203]
v_or_b32 v39, v39, v41
s_lshl_b32 s54, s36, 2
v_mfma_f32_16x16x32_bf16 v[200:203], a[16:19], a[140:143], v[200:203]
v_xor_b32 v39, s54, v39
v_xor_b32 v39, v39, v40
v_smfmac_f32_16x16x64_bf16 v[56:59], v[44:47], a[24:31], v48
s_waitcnt lgkmcnt(6)
v_lshlrev_b32 v40, 8, v40
v_xor_b32 v41, 0, v39
v_mfma_f32_16x16x32_bf16 v[204:207], a[0:3], a[128:131], v[204:207]
s_waitcnt lgkmcnt(4)
ds_read_b64_tr_b16 a[16:17], v35 offset:0
v_lshl_add_u32 v16, v41, 4, v40
v_mfma_f32_16x16x32_bf16 v[204:207], a[4:7], a[144:147], v[204:207]
s_waitcnt lgkmcnt(3)
buffer_load_dwordx4 v62, s[68:71], s3 offen offset:2048 lds
v_mfma_f32_16x16x32_bf16 v[204:207], a[8:11], a[160:163], v[204:207]
s_waitcnt lgkmcnt(1)
ds_read_b64_tr_b16 a[18:19], v35 offset:1024
v_xor_b32 v41, 4, v39
v_mfma_f32_16x16x32_bf16 v[204:207], a[12:15], a[176:179], v[204:207]
s_waitcnt vmcnt(18)
ds_read_b128 a[192:195], v64 offset:32768
v_lshl_add_u32 v17, v41, 4, v40
v_mfma_f32_16x16x32_bf16 v[208:211], a[12:15], a[180:183], v[208:211]
ds_read_b64_tr_b16 a[20:21], v35 offset:8192
v_xor_b32 v41, 8, v39
v_mfma_f32_16x16x32_bf16 v[208:211], a[8:11], a[164:167], v[208:211]
buffer_load_dwordx4 v63, s[68:71], s3 offen offset:3072 lds
v_mfma_f32_16x16x32_bf16 v[208:211], a[4:7], a[148:151], v[208:211]
s_add_u32 s3, s3, 128
ds_read_b64_tr_b16 a[22:23], v35 offset:9216
v_lshl_add_u32 v18, v41, 4, v40
v_mfma_f32_16x16x32_bf16 v[208:211], a[0:3], a[132:135], v[208:211]
ds_read_b128 a[208:211], v65 offset:32768
v_xor_b32 v41, 12, v39
v_mfma_f32_16x16x32_bf16 v[212:215], a[0:3], a[136:139], v[212:215]
ds_read_b64_tr_b16 a[24:25], v35 offset:16384
v_lshl_add_u32 v19, v41, 4, v40
v_mfma_f32_16x16x32_bf16 v[212:215], a[4:7], a[152:155], v[212:215]
v_cmp_gt_u32 vcc, s101, v75
v_bfe_u32 v38, v0, 4, 2
v_mfma_f32_16x16x32_bf16 v[212:215], a[8:11], a[168:171], v[212:215]
ds_read_b64_tr_b16 a[26:27], v35 offset:17408
v_bfe_u32 v39, v0, 2, 2
v_mfma_f32_16x16x32_bf16 v[212:215], a[12:15], a[184:187], v[212:215]
ds_read_b64_tr_b16 a[28:29], v35 offset:24576
v_and_b32 v40, 1, v38
v_mfma_f32_16x16x32_bf16 v[216:219], a[12:15], a[188:191], v[216:219]
ds_read_b64_tr_b16 a[30:31], v35 offset:25600
v_lshl_or_b32 v40, v40, 2, v39
v_mfma_f32_16x16x32_bf16 v[216:219], a[8:11], a[172:175], v[216:219]
s_cbranch_vccnz L2_wa
L2_wa_r:
v_lshl_add_u32 v38, v38, 2, v39
v_lshlrev_b32 v38, 8, v38
v_mfma_f32_16x16x32_bf16 v[216:219], a[4:7], a[156:159], v[216:219]
s_waitcnt vmcnt(17)
ds_read_b128 a[196:199], v64 offset:34816
v_and_b32 v39, 3, v0
v_mfma_f32_16x16x32_bf16 v[216:219], a[0:3], a[140:143], v[216:219]
s_waitcnt lgkmcnt(9)
ds_read_b128 a[212:215], v65 offset:34816
v_lshl_add_u32 v38, v39, 3, v38
v_mfma_f32_16x16x32_bf16 v[220:223], a[16:19], a[128:131], v[220:223]
s_waitcnt lgkmcnt(7)
ds_read_b64_tr_b16 a[0:1], v28 offset:16384
v_add_u32 v38, 65536, v38
v_mfma_f32_16x16x32_bf16 v[220:223], a[20:23], a[144:147], v[220:223]
s_waitcnt lgkmcnt(5)
v_xor_b32 v39, 0, v40
v_lshl_add_u32 v20, v39, 5, v38
v_mfma_f32_16x16x32_bf16 v[220:223], a[24:27], a[160:163], v[220:223]
s_waitcnt lgkmcnt(3)
ds_read_b64_tr_b16 a[2:3], v28 offset:17408
v_xor_b32 v39, 1, v40
v_mfma_f32_16x16x32_bf16 v[220:223], a[28:31], a[176:179], v[220:223]
s_waitcnt vmcnt(15)
ds_read_b128 a[200:203], v64 offset:49152
v_lshl_add_u32 v21, v39, 5, v38
v_mfma_f32_16x16x32_bf16 v[224:227], a[28:31], a[180:183], v[224:227]
ds_read_b64_tr_b16 a[4:5], v28 offset:24576
v_xor_b32 v39, 2, v40
v_mfma_f32_16x16x32_bf16 v[224:227], a[24:27], a[164:167], v[224:227]
v_lshl_add_u32 v22, v39, 5, v38
v_xor_b32 v39, 3, v40
v_mfma_f32_16x16x32_bf16 v[224:227], a[20:23], a[148:151], v[224:227]
ds_read_b64_tr_b16 a[6:7], v28 offset:25600
v_lshl_add_u32 v23, v39, 5, v38
v_mfma_f32_16x16x32_bf16 v[224:227], a[16:19], a[132:135], v[224:227]
ds_read_b128 a[216:219], v65 offset:49152
s_barrier
v_mfma_f32_16x16x32_bf16 v[228:231], a[16:19], a[136:139], v[228:231]
s_add_u32 m0, s37, 0
ds_read_b64_tr_b16 a[8:9], v28 offset:32768
v_xor_b32 v39, 4, v40
v_mfma_f32_16x16x32_bf16 v[228:231], a[20:23], a[152:155], v[228:231]
buffer_load_dwordx4 v10, s[12:15], s41 offen offset:0 lds
v_mfma_f32_16x16x32_bf16 v[228:231], a[24:27], a[168:171], v[228:231]
ds_read_b64_tr_b16 a[10:11], v28 offset:33792
v_lshl_add_u32 v24, v39, 5, v38
v_mfma_f32_16x16x32_bf16 v[228:231], a[28:31], a[184:187], v[228:231]
ds_read_b64_tr_b16 a[12:13], v28 offset:40960
v_xor_b32 v39, 5, v40
v_mfma_f32_16x16x32_bf16 v[232:235], a[28:31], a[188:191], v[232:235]
ds_read_b64_tr_b16 a[14:15], v28 offset:41984
v_lshl_add_u32 v25, v39, 5, v38
v_mfma_f32_16x16x32_bf16 v[232:235], a[24:27], a[172:175], v[232:235]
buffer_load_dwordx4 v11, s[12:15], s41 offen offset:1024 lds
v_mfma_f32_16x16x32_bf16 v[232:235], a[20:23], a[156:159], v[232:235]
s_waitcnt vmcnt(15)
ds_read_b128 a[204:207], v64 offset:51200
v_xor_b32 v39, 6, v40
v_mfma_f32_16x16x32_bf16 v[232:235], a[16:19], a[140:143], v[232:235]
s_waitcnt lgkmcnt(9)
ds_read_b128 a[220:223], v65 offset:51200
v_lshl_add_u32 v26, v39, 5, v38
v_mfma_f32_16x16x32_bf16 v[108:111], a[0:3], a[160:163], v[108:111]
s_waitcnt lgkmcnt(7)
ds_read_b64_tr_b16 a[16:17], v29 offset:16384
v_xor_b32 v39, 7, v40
v_mfma_f32_16x16x32_bf16 v[108:111], a[4:7], a[176:179], v[108:111]
s_waitcnt lgkmcnt(5)
buffer_load_dwordx4 v12, s[12:15], s41 offen offset:2048 lds
v_mfma_f32_16x16x32_bf16 v[108:111], a[8:11], a[192:195], v[108:111]
s_waitcnt lgkmcnt(3)
ds_read_b64_tr_b16 a[18:19], v29 offset:17408
v_lshl_add_u32 v27, v39, 5, v38
v_mfma_f32_16x16x32_bf16 v[108:111], a[12:15], a[208:211], v[108:111]
s_lshl_b32 s45, s63, 19
s_lshl_b32 s54, s62, 13
s_add_u32 s45, s45, s54
v_mfma_f32_16x16x32_bf16 v[112:115], a[12:15], a[212:215], v[112:115]
s_add_u32 s45, s45, 16777216
ds_read_b64_tr_b16 a[20:21], v29 offset:24576
s_lshl_b32 s55, s92, 3
v_mfma_f32_16x16x32_bf16 v[112:115], a[8:11], a[196:199], v[112:115]
s_and_b32 s54, s61, 7
buffer_load_dwordx4 v13, s[12:15], s41 offen offset:3072 lds
v_mfma_f32_16x16x32_bf16 v[112:115], a[4:7], a[180:183], v[112:115]
s_add_u32 s54, s54, s55
s_add_u32 s41, s41, 16384
ds_read_b64_tr_b16 a[22:23], v29 offset:25600
v_mfma_f32_16x16x32_bf16 v[112:115], a[0:3], a[164:167], v[112:115]
s_lshl_b32 s54, s54, 8
s_add_u32 s83, s54, 41943040
s_and_b32 s64, s60, 3
v_mfma_f32_16x16x32_bf16 v[116:119], a[0:3], a[168:171], v[116:119]
s_lshl_b32 s64, s64, 2
s_add_u32 m0, s37, 16384
ds_read_b64_tr_b16 a[24:25], v29 offset:32768
v_mfma_f32_16x16x32_bf16 v[116:119], a[4:7], a[184:187], v[116:119]
s_and_b32 s54, s61, 3
buffer_load_dwordx4 v10, s[12:15], s41 offen offset:0 lds
v_mfma_f32_16x16x32_bf16 v[116:119], a[8:11], a[200:203], v[116:119]
s_add_u32 s64, s64, s54
ds_read_b64_tr_b16 a[26:27], v29 offset:33792
s_and_b32 s65, s60, 4
v_mfma_f32_16x16x32_bf16 v[116:119], a[12:15], a[216:219], v[116:119]
s_waitcnt lgkmcnt(6)
s_lshr_b32 s54, s61, 2
ds_read_b64_tr_b16 a[28:29], v29 offset:40960
v_mfma_f32_16x16x32_bf16 v[120:123], a[12:15], a[220:223], v[120:123]
s_add_u32 s65, s65, s54
ds_read_b64_tr_b16 a[30:31], v29 offset:41984
s_lshl_b32 s54, s64, 3
v_mfma_f32_16x16x32_bf16 v[120:123], a[8:11], a[204:207], v[120:123]
s_add_u32 s54, s54, s65
buffer_load_dwordx4 v11, s[12:15], s41 offen offset:1024 lds
v_mfma_f32_16x16x32_bf16 v[120:123], a[4:7], a[188:191], v[120:123]
s_lshl_b32 s54, s54, 2
s_add_u32 s54, s54, s36
s_mov_b32 s87, s54
v_mfma_f32_16x16x32_bf16 v[120:123], a[0:3], a[172:175], v[120:123]
s_waitcnt lgkmcnt(6)
s_lshl_b32 s54, s61, 3
s_add_u32 s54, s54, s60
v_mfma_f32_16x16x32_bf16 v[124:127], a[16:19], a[160:163], v[124:127]
s_waitcnt lgkmcnt(4)
s_lshl_b32 s54, s54, 2
ds_read_b64_tr_b16 a[0:1], v30 offset:16384
v_mfma_f32_16x16x32_bf16 v[124:127], a[20:23], a[176:179], v[124:127]
s_waitcnt lgkmcnt(3)
buffer_load_dwordx4 v12, s[12:15], s41 offen offset:2048 lds
v_mfma_f32_16x16x32_bf16 v[124:127], a[24:27], a[192:195], v[124:127]
s_waitcnt lgkmcnt(1)
s_add_u32 s54, s54, s36
ds_read_b64_tr_b16 a[2:3], v30 offset:17408
v_mfma_f32_16x16x32_bf16 v[124:127], a[28:31], a[208:211], v[124:127]
s_mul_i32 s53, s54, 28672
s_mov_b32 s48, 0
s_lshl_b32 s55, s64, 2
v_mfma_f32_16x16x32_bf16 v[128:131], a[28:31], a[212:215], v[128:131]
s_add_u32 s55, s55, s36
ds_read_b64_tr_b16 a[4:5], v30 offset:24576
s_lshl_b32 s88, s55, 16
v_mfma_f32_16x16x32_bf16 v[128:131], a[24:27], a[196:199], v[128:131]
s_lshl_b32 s66, s65, 8
buffer_load_dwordx4 v13, s[12:15], s41 offen offset:3072 lds
v_mfma_f32_16x16x32_bf16 v[128:131], a[20:23], a[180:183], v[128:131]
s_add_u32 s88, s88, s66
s_add_u32 s41, s41, 16384
ds_read_b64_tr_b16 a[6:7], v30 offset:25600
v_mfma_f32_16x16x32_bf16 v[128:131], a[16:19], a[164:167], v[128:131]
s_add_u32 s89, s88, 32768
s_andn2_b32 s55, s55, 4
s_lshl_b32 s55, s55, 18
v_mfma_f32_16x16x32_bf16 v[132:135], a[16:19], a[168:171], v[132:135]
s_add_u32 s55, s55, 16777216
s_add_u32 m0, s37, 65536
ds_read_b64_tr_b16 a[8:9], v30 offset:32768
v_mfma_f32_16x16x32_bf16 v[132:135], a[20:23], a[184:187], v[132:135]
s_and_b32 s54, s64, 1
buffer_load_dwordx4 v14, s[16:19], s42 offen offset:0 lds
v_mfma_f32_16x16x32_bf16 v[132:135], a[24:27], a[200:203], v[132:135]
s_mul_i32 s67, s54, 49152
ds_read_b64_tr_b16 a[10:11], v30 offset:33792
s_add_u32 s55, s55, s67
v_mfma_f32_16x16x32_bf16 v[132:135], a[28:31], a[216:219], v[132:135]
s_mul_i32 s67, s54, 1572864
ds_read_b64_tr_b16 a[12:13], v30 offset:40960
s_add_u32 s66, s66, s67
v_mfma_f32_16x16x32_bf16 v[136:139], a[28:31], a[220:223], v[136:139]
s_andn2_b32 s54, s65, 1
ds_read_b64_tr_b16 a[14:15], v30 offset:41984
s_lshl_b32 s54, s54, 2
v_mfma_f32_16x16x32_bf16 v[136:139], a[24:27], a[204:207], v[136:139]
s_add_u32 s54, s54, s36
buffer_load_dwordx4 v15, s[16:19], s42 offen offset:1024 lds
v_mfma_f32_16x16x32_bf16 v[136:139], a[20:23], a[188:191], v[136:139]
s_mul_i32 s52, s54, 229376
s_add_u32 s52, s52, 8388608
s_and_b32 s54, s65, 1
v_mfma_f32_16x16x32_bf16 v[136:139], a[16:19], a[172:175], v[136:139]
s_waitcnt lgkmcnt(6)
s_mul_i32 s67, s54, 114688
s_add_u32 s52, s52, s67
v_mfma_f32_16x16x32_bf16 v[140:143], a[0:3], a[160:163], v[140:143]
s_waitcnt lgkmcnt(4)
s_mul_i32 s51, s54, 7340032
ds_read_b64_tr_b16 a[16:17], v31 offset:16384
v_mfma_f32_16x16x32_bf16 v[140:143], a[4:7], a[176:179], v[140:143]
s_waitcnt lgkmcnt(3)
buffer_load_dwordx4 v14, s[16:19], s42 offen offset:2048 lds
v_mfma_f32_16x16x32_bf16 v[140:143], a[8:11], a[192:195], v[140:143]
s_waitcnt lgkmcnt(1)
s_lshl_b32 s67, s64, 8
ds_read_b64_tr_b16 a[18:19], v31 offset:17408
v_mfma_f32_16x16x32_bf16 v[140:143], a[12:15], a[208:211], v[140:143]
s_waitcnt vmcnt(17)
s_add_u32 s51, s51, s67
ds_read_b128 a[224:227], v64 offset:0
v_mfma_f32_16x16x32_bf16 v[144:147], a[12:15], a[212:215], v[144:147]
s_lshr_b32 s85, s65, 1
ds_read_b64_tr_b16 a[20:21], v31 offset:24576
s_add_u32 s49, s85, s64
v_mfma_f32_16x16x32_bf16 v[144:147], a[8:11], a[196:199], v[144:147]
s_add_u32 s85, s85, 32
buffer_load_dwordx4 v15, s[16:19], s42 offen offset:3072 lds
v_mfma_f32_16x16x32_bf16 v[144:147], a[4:7], a[180:183], v[144:147]
s_lshr_b32 s91, s64, 1
s_add_u32 s42, s42, 16384
ds_read_b64_tr_b16 a[22:23], v31 offset:25600
v_mfma_f32_16x16x32_bf16 v[144:147], a[0:3], a[164:167], v[144:147]
s_add_u32 s54, s91, s65
ds_read_b128 a[240:243], v65 offset:0
v_mfma_f32_16x16x32_bf16 v[148:151], a[0:3], a[168:171], v[148:151]
ds_read_b64_tr_b16 a[24:25], v31 offset:32768
v_mfma_f32_16x16x32_bf16 v[148:151], a[4:7], a[184:187], v[148:151]
buffer_load_dwordx2 v[236:237], v72, s[4:7], s100 offen offset:0 sc1
v_mfma_f32_16x16x32_bf16 v[148:151], a[8:11], a[200:203], v[148:151]
ds_read_b64_tr_b16 a[26:27], v31 offset:33792
v_mfma_f32_16x16x32_bf16 v[148:151], a[12:15], a[216:219], v[148:151]
ds_read_b64_tr_b16 a[28:29], v31 offset:40960
v_mfma_f32_16x16x32_bf16 v[152:155], a[12:15], a[220:223], v[152:155]
ds_read_b64_tr_b16 a[30:31], v31 offset:41984
v_mfma_f32_16x16x32_bf16 v[152:155], a[8:11], a[204:207], v[152:155]
buffer_load_dwordx2 v[238:239], v72, s[4:7], s100 offen offset:256 sc1
v_mfma_f32_16x16x32_bf16 v[152:155], a[4:7], a[188:191], v[152:155]
s_waitcnt vmcnt(18)
ds_read_b128 a[228:231], v64 offset:2048
v_mfma_f32_16x16x32_bf16 v[152:155], a[0:3], a[172:175], v[152:155]
s_waitcnt lgkmcnt(9)
ds_read_b128 a[244:247], v65 offset:2048
v_mfma_f32_16x16x32_bf16 v[156:159], a[16:19], a[160:163], v[156:159]
s_waitcnt lgkmcnt(7)
ds_read_b64_tr_b16 a[0:1], v32 offset:32768
v_mfma_f32_16x16x32_bf16 v[156:159], a[20:23], a[176:179], v[156:159]
s_waitcnt lgkmcnt(5)
buffer_load_dwordx2 v[240:241], v72, s[4:7], s100 offen offset:512 sc1
v_mfma_f32_16x16x32_bf16 v[156:159], a[24:27], a[192:195], v[156:159]
s_waitcnt lgkmcnt(3)
ds_read_b64_tr_b16 a[2:3], v32 offset:33792
v_mfma_f32_16x16x32_bf16 v[156:159], a[28:31], a[208:211], v[156:159]
s_waitcnt vmcnt(17)
ds_read_b128 a[232:235], v64 offset:16384
v_mfma_f32_16x16x32_bf16 v[160:163], a[28:31], a[212:215], v[160:163]
ds_read_b64_tr_b16 a[4:5], v32 offset:40960
v_mfma_f32_16x16x32_bf16 v[160:163], a[24:27], a[196:199], v[160:163]
buffer_load_dwordx2 v[242:243], v72, s[4:7], s100 offen offset:768 sc1
v_mfma_f32_16x16x32_bf16 v[160:163], a[20:23], a[180:183], v[160:163]
ds_read_b64_tr_b16 a[6:7], v32 offset:41984
v_mfma_f32_16x16x32_bf16 v[160:163], a[16:19], a[164:167], v[160:163]
ds_read_b128 a[248:251], v65 offset:16384
s_barrier
v_mfma_f32_16x16x32_bf16 v[164:167], a[16:19], a[168:171], v[164:167]
s_add_u32 m0, s37, 81920
ds_read_b64_tr_b16 a[8:9], v32 offset:49152
v_mfma_f32_16x16x32_bf16 v[164:167], a[20:23], a[184:187], v[164:167]
buffer_load_dwordx4 v14, s[16:19], s42 offen offset:0 lds
v_mfma_f32_16x16x32_bf16 v[164:167], a[24:27], a[200:203], v[164:167]
ds_read_b64_tr_b16 a[10:11], v32 offset:50176
v_mfma_f32_16x16x32_bf16 v[164:167], a[28:31], a[216:219], v[164:167]
ds_read_b64_tr_b16 a[12:13], v32 offset:57344
v_mfma_f32_16x16x32_bf16 v[168:171], a[28:31], a[220:223], v[168:171]
ds_read_b64_tr_b16 a[14:15], v32 offset:58368
v_mfma_f32_16x16x32_bf16 v[168:171], a[24:27], a[204:207], v[168:171]
buffer_load_dwordx4 v15, s[16:19], s42 offen offset:1024 lds
v_mfma_f32_16x16x32_bf16 v[168:171], a[20:23], a[188:191], v[168:171]
s_waitcnt vmcnt(18)
ds_read_b128 a[236:239], v64 offset:18432
v_mfma_f32_16x16x32_bf16 v[168:171], a[16:19], a[172:175], v[168:171]
s_waitcnt lgkmcnt(9)
ds_read_b128 a[252:255], v65 offset:18432
v_mfma_f32_16x16x32_bf16 v[172:175], a[0:3], a[192:195], v[172:175]
s_waitcnt lgkmcnt(7)
ds_read_b64_tr_b16 a[16:17], v33 offset:32768
v_mfma_f32_16x16x32_bf16 v[172:175], a[4:7], a[208:211], v[172:175]
s_waitcnt lgkmcnt(5)
buffer_load_dwordx4 v14, s[16:19], s42 offen offset:2048 lds
v_mfma_f32_16x16x32_bf16 v[172:175], a[8:11], a[224:227], v[172:175]
s_waitcnt lgkmcnt(3)
ds_read_b64_tr_b16 a[18:19], v33 offset:33792
v_mfma_f32_16x16x32_bf16 v[172:175], a[12:15], a[240:243], v[172:175]
s_cmp_eq_u32 s94, 0
s_cselect_b32 s52, s52, s55
s_cselect_b32 s51, s51, s66
v_mfma_f32_16x16x32_bf16 v[176:179], a[12:15], a[244:247], v[176:179]
ds_read_b64_tr_b16 a[20:21], v33 offset:40960
v_mfma_f32_16x16x32_bf16 v[176:179], a[8:11], a[228:231], v[176:179]
buffer_load_dwordx4 v15, s[16:19], s42 offen offset:3072 lds
v_mfma_f32_16x16x32_bf16 v[176:179], a[4:7], a[212:215], v[176:179]
s_add_u32 s42, s42, 16384
ds_read_b64_tr_b16 a[22:23], v33 offset:41984
v_mfma_f32_16x16x32_bf16 v[176:179], a[0:3], a[196:199], v[176:179]
s_cmp_eq_u32 s94, 0
s_cselect_b32 s49, s49, s54
s_cselect_b32 s95, s67, 0x10000
v_smfmac_f32_16x16x64_bf16 v[52:55], v[44:47], a[0:7], v48
s_cmp_eq_u32 s94, 0
s_cselect_b32 s85, s85, s91
s_cselect_b32 s91, 28, 16
v_mfma_f32_16x16x32_bf16 v[180:183], a[0:3], a[200:203], v[180:183]
s_lshl_b32 s85, s85, 8
s_add_u32 m0, s37, 32768
ds_read_b64_tr_b16 a[24:25], v33 offset:49152
v_mfma_f32_16x16x32_bf16 v[180:183], a[4:7], a[216:219], v[180:183]
s_add_u32 s85, s85, 41943040
buffer_load_dwordx4 v10, s[12:15], s41 offen offset:0 lds
v_mfma_f32_16x16x32_bf16 v[180:183], a[8:11], a[232:235], v[180:183]
s_cmp_lt_u32 s61, 14
s_cselect_b32 s82, s94, 0
ds_read_b64_tr_b16 a[26:27], v33 offset:50176
v_mfma_f32_16x16x32_bf16 v[180:183], a[12:15], a[248:251], v[180:183]
s_waitcnt lgkmcnt(6)
ds_read_b64_tr_b16 a[28:29], v33 offset:57344
v_mfma_f32_16x16x32_bf16 v[184:187], a[12:15], a[252:255], v[184:187]
s_cmp_eq_u32 s36, 0
s_cselect_b32 s82, s82, 0
ds_read_b64_tr_b16 a[30:31], v33 offset:58368
v_mfma_f32_16x16x32_bf16 v[184:187], a[8:11], a[236:239], v[184:187]
s_mul_i32 s82, s82, -7
buffer_load_dwordx4 v11, s[12:15], s41 offen offset:1024 lds
v_mfma_f32_16x16x32_bf16 v[184:187], a[4:7], a[220:223], v[184:187]
s_lshr_b32 s90, 4096, s94
s_lshl_b32 s66, s90, 6
s_and_b32 s49, s49, 1
v_mfma_f32_16x16x32_bf16 v[184:187], a[0:3], a[204:207], v[184:187]
s_mov_b32 s8, s58
s_mov_b32 s9, s59
v_smfmac_f32_16x16x64_bf16 v[52:55], v[44:47], a[8:15], v48
s_waitcnt lgkmcnt(6)
s_cmp_eq_u32 s94, 0
s_cselect_b32 s10, 14680064, 0
v_mfma_f32_16x16x32_bf16 v[188:191], a[16:19], a[192:195], v[188:191]
s_waitcnt lgkmcnt(4)
s_lshl_b32 s39, s2, 2
ds_read_b64_tr_b16 a[0:1], v34 offset:32768
v_mfma_f32_16x16x32_bf16 v[188:191], a[20:23], a[208:211], v[188:191]
s_waitcnt lgkmcnt(3)
buffer_load_dwordx4 v12, s[12:15], s41 offen offset:2048 lds
v_mfma_f32_16x16x32_bf16 v[188:191], a[24:27], a[224:227], v[188:191]
s_waitcnt lgkmcnt(1)
s_add_u32 s39, s39, s36
ds_read_b64_tr_b16 a[2:3], v34 offset:33792
v_mfma_f32_16x16x32_bf16 v[188:191], a[28:31], a[240:243], v[188:191]
s_lshl_b32 s39, s39, 12
v_mfma_f32_16x16x32_bf16 v[192:195], a[28:31], a[244:247], v[192:195]
ds_read_b64_tr_b16 a[4:5], v34 offset:40960
v_mfma_f32_16x16x32_bf16 v[192:195], a[24:27], a[228:231], v[192:195]
buffer_load_dwordx4 v13, s[12:15], s41 offen offset:3072 lds
v_mfma_f32_16x16x32_bf16 v[192:195], a[20:23], a[212:215], v[192:195]
s_add_u32 s41, s41, 16384
ds_read_b64_tr_b16 a[6:7], v34 offset:41984
v_mfma_f32_16x16x32_bf16 v[192:195], a[16:19], a[196:199], v[192:195]
s_cmp_lg_u32 s49, 0
s_cselect_b32 s54, -1, 1
s_cselect_b32 s55, 3, 1
v_smfmac_f32_16x16x64_bf16 v[56:59], v[44:47], a[16:23], v48
s_mul_i32 s72, s54, s66
s_mul_i32 s73, s55, s66
s_mul_i32 s74, s54, 4096
v_mfma_f32_16x16x32_bf16 v[196:199], a[16:19], a[200:203], v[196:199]
s_mul_i32 s75, s55, 4096
ds_read_b64_tr_b16 a[8:9], v34 offset:49152
s_mul_i32 s54, s49, s66
v_mfma_f32_16x16x32_bf16 v[196:199], a[20:23], a[216:219], v[196:199]
s_add_u32 s51, s51, s54
s_mul_i32 s54, s49, 4096
s_add_u32 s52, s52, s54
v_mfma_f32_16x16x32_bf16 v[196:199], a[24:27], a[232:235], v[196:199]
ds_read_b64_tr_b16 a[10:11], v34 offset:50176
v_bfe_u32 v38, v0, 4, 2
v_mfma_f32_16x16x32_bf16 v[196:199], a[28:31], a[248:251], v[196:199]
ds_read_b64_tr_b16 a[12:13], v34 offset:57344
v_lshrrev_b32 v39, 6, v0
v_mfma_f32_16x16x32_bf16 v[200:203], a[28:31], a[252:255], v[200:203]
ds_read_b64_tr_b16 a[14:15], v34 offset:58368
v_lshl_add_u32 v39, v39, 4, v38
v_mfma_f32_16x16x32_bf16 v[200:203], a[24:27], a[236:239], v[200:203]
v_and_b32 v41, 15, v0
v_add_u32 v2, 0, v39
v_mfma_f32_16x16x32_bf16 v[200:203], a[20:23], a[220:223], v[200:203]
v_mul_u32_u24 v2, s90, v2
v_or_b32 v40, 0, v38
v_mfma_f32_16x16x32_bf16 v[200:203], a[16:19], a[204:207], v[200:203]
v_lshlrev_b32 v40, 1, v40
v_xor_b32 v40, v40, v41
v_smfmac_f32_16x16x64_bf16 v[56:59], v[44:47], a[24:31], v48
s_waitcnt lgkmcnt(6)
v_lshl_add_u32 v2, v40, 4, v2
v_add_u32 v3, 4, v39
v_mfma_f32_16x16x32_bf16 v[204:207], a[0:3], a[192:195], v[204:207]
s_waitcnt lgkmcnt(4)
ds_read_b64_tr_b16 a[16:17], v35 offset:32768
v_mul_u32_u24 v3, s90, v3
v_mfma_f32_16x16x32_bf16 v[204:207], a[4:7], a[208:211], v[204:207]
s_waitcnt lgkmcnt(3)
v_or_b32 v40, 4, v38
v_lshlrev_b32 v40, 1, v40
v_mfma_f32_16x16x32_bf16 v[204:207], a[8:11], a[224:227], v[204:207]
s_waitcnt lgkmcnt(1)
ds_read_b64_tr_b16 a[18:19], v35 offset:33792
v_xor_b32 v40, v40, v41
v_mfma_f32_16x16x32_bf16 v[204:207], a[12:15], a[240:243], v[204:207]
v_lshl_add_u32 v3, v40, 4, v3
v_subrev_u32 v3, 1024, v3
v_mfma_f32_16x16x32_bf16 v[208:211], a[12:15], a[244:247], v[208:211]
ds_read_b64_tr_b16 a[20:21], v35 offset:40960
v_add_u32 v4, 8, v39
v_mfma_f32_16x16x32_bf16 v[208:211], a[8:11], a[228:231], v[208:211]
v_mul_u32_u24 v4, s90, v4
v_or_b32 v40, 0, v38
v_mfma_f32_16x16x32_bf16 v[208:211], a[4:7], a[212:215], v[208:211]
ds_read_b64_tr_b16 a[22:23], v35 offset:41984
v_lshlrev_b32 v40, 1, v40
v_mfma_f32_16x16x32_bf16 v[208:211], a[0:3], a[196:199], v[208:211]
v_xor_b32 v40, v40, v41
v_lshl_add_u32 v4, v40, 4, v4
v_mfma_f32_16x16x32_bf16 v[212:215], a[0:3], a[200:203], v[212:215]
ds_read_b64_tr_b16 a[24:25], v35 offset:49152
v_subrev_u32 v4, 2048, v4
v_mfma_f32_16x16x32_bf16 v[212:215], a[4:7], a[216:219], v[212:215]
v_add_u32 v5, 12, v39
v_mul_u32_u24 v5, s90, v5
v_mfma_f32_16x16x32_bf16 v[212:215], a[8:11], a[232:235], v[212:215]
ds_read_b64_tr_b16 a[26:27], v35 offset:50176
v_or_b32 v40, 4, v38
v_mfma_f32_16x16x32_bf16 v[212:215], a[12:15], a[248:251], v[212:215]
ds_read_b64_tr_b16 a[28:29], v35 offset:57344
v_lshlrev_b32 v40, 1, v40
v_mfma_f32_16x16x32_bf16 v[216:219], a[12:15], a[252:255], v[216:219]
ds_read_b64_tr_b16 a[30:31], v35 offset:58368
v_xor_b32 v40, v40, v41
v_mfma_f32_16x16x32_bf16 v[216:219], a[8:11], a[236:239], v[216:219]
v_add_f32 v52, v52, v53
v_add_f32 v56, v56, v57
v_mfma_f32_16x16x32_bf16 v[216:219], a[4:7], a[220:223], v[216:219]
v_lshl_add_u32 v5, v40, 4, v5
v_subrev_u32 v5, 3072, v5
v_mfma_f32_16x16x32_bf16 v[216:219], a[0:3], a[204:207], v[216:219]
s_waitcnt lgkmcnt(6)
ds_write2_b32 v66, v52, v56 offset0:0 offset1:16
v_mov_b32 v39, 131072
v_mfma_f32_16x16x32_bf16 v[220:223], a[16:19], a[192:195], v[220:223]
s_waitcnt lgkmcnt(5)
ds_read_b64_tr_b16 a[0:1], v28 offset:49152
v_mfma_f32_16x16x32_bf16 v[220:223], a[20:23], a[208:211], v[220:223]
s_waitcnt lgkmcnt(4)
v_mfma_f32_16x16x32_bf16 v[220:223], a[24:27], a[224:227], v[220:223]
s_waitcnt lgkmcnt(2)
ds_read_b64_tr_b16 a[2:3], v28 offset:50176
v_mfma_f32_16x16x32_bf16 v[220:223], a[28:31], a[240:243], v[220:223]
v_mfma_f32_16x16x32_bf16 v[224:227], a[28:31], a[244:247], v[224:227]
ds_read_b64_tr_b16 a[4:5], v28 offset:57344
v_mfma_f32_16x16x32_bf16 v[224:227], a[24:27], a[228:231], v[224:227]
v_mfma_f32_16x16x32_bf16 v[224:227], a[20:23], a[212:215], v[224:227]
ds_read_b64_tr_b16 a[6:7], v28 offset:58368
v_mfma_f32_16x16x32_bf16 v[224:227], a[16:19], a[196:199], v[224:227]
s_waitcnt vmcnt(20) lgkmcnt(4)
s_barrier
v_mfma_f32_16x16x32_bf16 v[228:231], a[16:19], a[200:203], v[228:231]
ds_read_b64_tr_b16 a[8:9], v29 offset:49152
v_mfma_f32_16x16x32_bf16 v[228:231], a[20:23], a[216:219], v[228:231]
ds_read_b128 v[76:79], v68 offset:0
v_mfma_f32_16x16x32_bf16 v[228:231], a[24:27], a[232:235], v[228:231]
ds_read_b64_tr_b16 a[10:11], v29 offset:50176
v_mfma_f32_16x16x32_bf16 v[228:231], a[28:31], a[248:251], v[228:231]
ds_read_b128 v[92:95], v68 offset:64
v_mfma_f32_16x16x32_bf16 v[232:235], a[28:31], a[252:255], v[232:235]
ds_read_b64_tr_b16 a[12:13], v29 offset:57344
v_mfma_f32_16x16x32_bf16 v[232:235], a[24:27], a[236:239], v[232:235]
ds_read_b128 v[80:83], v69 offset:0
v_mfma_f32_16x16x32_bf16 v[232:235], a[20:23], a[220:223], v[232:235]
ds_read_b64_tr_b16 a[14:15], v29 offset:58368
v_mfma_f32_16x16x32_bf16 v[232:235], a[16:19], a[204:207], v[232:235]
s_waitcnt lgkmcnt(9)
ds_read_b128 v[96:99], v69 offset:64
v_mfma_f32_16x16x32_bf16 v[108:111], a[0:3], a[224:227], v[108:111]
s_waitcnt lgkmcnt(8)
ds_read_b64_tr_b16 a[16:17], v30 offset:49152
v_mfma_f32_16x16x32_bf16 v[108:111], a[4:7], a[240:243], v[108:111]
ds_read_b128 v[84:87], v70 offset:0
v_mfma_f32_16x16x32_bf16 v[112:115], a[4:7], a[244:247], v[112:115]
ds_read_b64_tr_b16 a[18:19], v30 offset:50176
v_mfma_f32_16x16x32_bf16 v[112:115], a[0:3], a[228:231], v[112:115]
ds_read_b128 v[100:103], v70 offset:64
v_mfma_f32_16x16x32_bf16 v[116:119], a[0:3], a[232:235], v[116:119]
ds_read_b64_tr_b16 a[20:21], v30 offset:57344
v_mfma_f32_16x16x32_bf16 v[116:119], a[4:7], a[248:251], v[116:119]
ds_read_b128 v[88:91], v71 offset:0
v_mfma_f32_16x16x32_bf16 v[120:123], a[4:7], a[252:255], v[120:123]
ds_read_b64_tr_b16 a[22:23], v30 offset:58368
v_mfma_f32_16x16x32_bf16 v[120:123], a[0:3], a[236:239], v[120:123]
s_waitcnt lgkmcnt(12)
ds_read_b128 v[104:107], v71 offset:64
v_mfma_f32_16x16x32_bf16 v[124:127], a[8:11], a[224:227], v[124:127]
s_waitcnt lgkmcnt(9)
ds_read_b64_tr_b16 a[24:25], v31 offset:49152
v_mfma_f32_16x16x32_bf16 v[124:127], a[12:15], a[240:243], v[124:127]
ds_read_b128 a[128:131], v16 offset:0
v_mfma_f32_16x16x32_bf16 v[128:131], a[12:15], a[244:247], v[128:131]
ds_read_b64_tr_b16 a[26:27], v31 offset:50176
v_mfma_f32_16x16x32_bf16 v[128:131], a[8:11], a[228:231], v[128:131]
ds_read_b128 a[132:135], v17 offset:0
v_mfma_f32_16x16x32_bf16 v[132:135], a[8:11], a[232:235], v[132:135]
ds_read_b64_tr_b16 a[28:29], v31 offset:57344
v_mfma_f32_16x16x32_bf16 v[132:135], a[12:15], a[248:251], v[132:135]
ds_read_b128 a[136:139], v18 offset:0
v_mfma_f32_16x16x32_bf16 v[136:139], a[12:15], a[252:255], v[136:139]
s_waitcnt lgkmcnt(14)
ds_read_b64_tr_b16 a[30:31], v31 offset:58368
v_mfma_f32_16x16x32_bf16 v[136:139], a[8:11], a[236:239], v[136:139]
s_waitcnt lgkmcnt(12)
ds_read_b128 a[140:143], v19 offset:0
v_mfma_f32_16x16x32_bf16 v[140:143], a[16:19], a[224:227], v[140:143]
s_waitcnt lgkmcnt(9)
ds_read_b128 a[144:147], v16 offset:4096
v_mfma_f32_16x16x32_bf16 v[140:143], a[20:23], a[240:243], v[140:143]
ds_write_b32 v39, v37
v_mfma_f32_16x16x32_bf16 v[144:147], a[20:23], a[244:247], v[144:147]
v_mfma_f32_16x16x32_bf16 v[144:147], a[16:19], a[228:231], v[144:147]
v_mfma_f32_16x16x32_bf16 v[148:151], a[16:19], a[232:235], v[148:151]
v_mfma_f32_16x16x32_bf16 v[148:151], a[20:23], a[248:251], v[148:151]
v_mfma_f32_16x16x32_bf16 v[152:155], a[20:23], a[252:255], v[152:155]
v_mfma_f32_16x16x32_bf16 v[152:155], a[16:19], a[236:239], v[152:155]
s_waitcnt lgkmcnt(7)
v_mfma_f32_16x16x32_bf16 v[156:159], a[24:27], a[224:227], v[156:159]
s_waitcnt lgkmcnt(3)
v_mfma_f32_16x16x32_bf16 v[156:159], a[28:31], a[240:243], v[156:159]
v_mfma_f32_16x16x32_bf16 v[160:163], a[28:31], a[244:247], v[160:163]
v_mfma_f32_16x16x32_bf16 v[160:163], a[24:27], a[228:231], v[160:163]
v_mfma_f32_16x16x32_bf16 v[164:167], a[24:27], a[232:235], v[164:167]
v_mfma_f32_16x16x32_bf16 v[164:167], a[28:31], a[248:251], v[164:167]
v_mfma_f32_16x16x32_bf16 v[168:171], a[28:31], a[252:255], v[168:171]
v_mfma_f32_16x16x32_bf16 v[168:171], a[24:27], a[236:239], v[168:171]
s_waitcnt vmcnt(11)
v_pk_mul_f32 v[108:109], v[108:109], v[236:237] op_sel:[0,1] op_sel_hi:[1,1]
v_pk_mul_f32 v[110:111], v[110:111], v[236:237] op_sel:[0,1] op_sel_hi:[1,1]
v_pk_mul_f32 v[124:125], v[124:125], v[236:237] op_sel:[0,1] op_sel_hi:[1,1]
v_pk_mul_f32 v[126:127], v[126:127], v[236:237] op_sel:[0,1] op_sel_hi:[1,1]
v_pk_fma_f32 v[108:109], v[76:77], v[236:237], v[108:109] op_sel_hi:[1,0,1]
v_pk_fma_f32 v[110:111], v[78:79], v[236:237], v[110:111] op_sel_hi:[1,0,1]
v_pk_fma_f32 v[124:125], v[92:93], v[236:237], v[124:125] op_sel_hi:[1,0,1]
v_pk_fma_f32 v[126:127], v[94:95], v[236:237], v[126:127] op_sel_hi:[1,0,1]
s_waitcnt vmcnt(10)
s_nop 0
v_pk_mul_f32 v[112:113], v[112:113], v[238:239] op_sel:[0,1] op_sel_hi:[1,1]
v_pk_mul_f32 v[114:115], v[114:115], v[238:239] op_sel:[0,1] op_sel_hi:[1,1]
v_pk_mul_f32 v[128:129], v[128:129], v[238:239] op_sel:[0,1] op_sel_hi:[1,1]
v_pk_mul_f32 v[130:131], v[130:131], v[238:239] op_sel:[0,1] op_sel_hi:[1,1]
v_pk_fma_f32 v[112:113], v[76:77], v[238:239], v[112:113] op_sel_hi:[1,0,1]
v_pk_fma_f32 v[114:115], v[78:79], v[238:239], v[114:115] op_sel_hi:[1,0,1]
v_pk_fma_f32 v[128:129], v[92:93], v[238:239], v[128:129] op_sel_hi:[1,0,1]
v_pk_fma_f32 v[130:131], v[94:95], v[238:239], v[130:131] op_sel_hi:[1,0,1]
s_waitcnt vmcnt(9)
s_nop 0
v_pk_mul_f32 v[116:117], v[116:117], v[240:241] op_sel:[0,1] op_sel_hi:[1,1]
v_pk_mul_f32 v[118:119], v[118:119], v[240:241] op_sel:[0,1] op_sel_hi:[1,1]
v_pk_mul_f32 v[132:133], v[132:133], v[240:241] op_sel:[0,1] op_sel_hi:[1,1]
v_pk_mul_f32 v[134:135], v[134:135], v[240:241] op_sel:[0,1] op_sel_hi:[1,1]
v_pk_fma_f32 v[116:117], v[76:77], v[240:241], v[116:117] op_sel_hi:[1,0,1]
v_pk_fma_f32 v[118:119], v[78:79], v[240:241], v[118:119] op_sel_hi:[1,0,1]
v_pk_fma_f32 v[132:133], v[92:93], v[240:241], v[132:133] op_sel_hi:[1,0,1]
v_pk_fma_f32 v[134:135], v[94:95], v[240:241], v[134:135] op_sel_hi:[1,0,1]
s_waitcnt vmcnt(8)
s_nop 0
v_pk_mul_f32 v[120:121], v[120:121], v[242:243] op_sel:[0,1] op_sel_hi:[1,1]
v_pk_mul_f32 v[122:123], v[122:123], v[242:243] op_sel:[0,1] op_sel_hi:[1,1]
v_pk_mul_f32 v[136:137], v[136:137], v[242:243] op_sel:[0,1] op_sel_hi:[1,1]
v_pk_mul_f32 v[138:139], v[138:139], v[242:243] op_sel:[0,1] op_sel_hi:[1,1]
v_pk_fma_f32 v[120:121], v[76:77], v[242:243], v[120:121] op_sel_hi:[1,0,1]
v_pk_fma_f32 v[122:123], v[78:79], v[242:243], v[122:123] op_sel_hi:[1,0,1]
v_pk_fma_f32 v[136:137], v[92:93], v[242:243], v[136:137] op_sel_hi:[1,0,1]
v_pk_fma_f32 v[138:139], v[94:95], v[242:243], v[138:139] op_sel_hi:[1,0,1]
v_cvt_pk_bf16_f32 v44, v108, v109
v_cvt_pk_bf16_f32 v45, v110, v111
v_cvt_pk_bf16_f32 v46, v124, v125
v_cvt_pk_bf16_f32 v47, v126, v127
v_cvt_pk_bf16_f32 v60, v112, v113
v_cvt_pk_bf16_f32 v61, v114, v115
v_cvt_pk_bf16_f32 v62, v128, v129
v_cvt_pk_bf16_f32 v63, v130, v131
v_cvt_pk_bf16_f32 v76, v116, v117
v_cvt_pk_bf16_f32 v77, v118, v119
v_cvt_pk_bf16_f32 v78, v132, v133
v_cvt_pk_bf16_f32 v79, v134, v135
v_cvt_pk_bf16_f32 v92, v120, v121
v_cvt_pk_bf16_f32 v93, v122, v123
v_cvt_pk_bf16_f32 v94, v136, v137
v_cvt_pk_bf16_f32 v95, v138, v139
v_permlane16_swap_b32 v44, v46
v_permlane16_swap_b32 v45, v47
v_permlane16_swap_b32 v60, v62
v_permlane16_swap_b32 v61, v63
v_permlane16_swap_b32 v76, v78
v_permlane16_swap_b32 v77, v79
v_permlane16_swap_b32 v92, v94
v_permlane16_swap_b32 v93, v95
v_pk_mul_f32 v[140:141], v[140:141], v[236:237] op_sel:[0,1] op_sel_hi:[1,1]
v_pk_mul_f32 v[142:143], v[142:143], v[236:237] op_sel:[0,1] op_sel_hi:[1,1]
v_pk_mul_f32 v[156:157], v[156:157], v[236:237] op_sel:[0,1] op_sel_hi:[1,1]
v_pk_mul_f32 v[158:159], v[158:159], v[236:237] op_sel:[0,1] op_sel_hi:[1,1]
v_pk_fma_f32 v[140:141], v[80:81], v[236:237], v[140:141] op_sel_hi:[1,0,1]
v_pk_fma_f32 v[142:143], v[82:83], v[236:237], v[142:143] op_sel_hi:[1,0,1]
v_pk_fma_f32 v[156:157], v[96:97], v[236:237], v[156:157] op_sel_hi:[1,0,1]
v_pk_fma_f32 v[158:159], v[98:99], v[236:237], v[158:159] op_sel_hi:[1,0,1]
v_pk_mul_f32 v[144:145], v[144:145], v[238:239] op_sel:[0,1] op_sel_hi:[1,1]
v_pk_mul_f32 v[146:147], v[146:147], v[238:239] op_sel:[0,1] op_sel_hi:[1,1]
v_pk_mul_f32 v[160:161], v[160:161], v[238:239] op_sel:[0,1] op_sel_hi:[1,1]
v_pk_mul_f32 v[162:163], v[162:163], v[238:239] op_sel:[0,1] op_sel_hi:[1,1]
v_pk_fma_f32 v[144:145], v[80:81], v[238:239], v[144:145] op_sel_hi:[1,0,1]
v_pk_fma_f32 v[146:147], v[82:83], v[238:239], v[146:147] op_sel_hi:[1,0,1]
v_pk_fma_f32 v[160:161], v[96:97], v[238:239], v[160:161] op_sel_hi:[1,0,1]
v_pk_fma_f32 v[162:163], v[98:99], v[238:239], v[162:163] op_sel_hi:[1,0,1]
v_pk_mul_f32 v[148:149], v[148:149], v[240:241] op_sel:[0,1] op_sel_hi:[1,1]
v_pk_mul_f32 v[150:151], v[150:151], v[240:241] op_sel:[0,1] op_sel_hi:[1,1]
v_pk_mul_f32 v[164:165], v[164:165], v[240:241] op_sel:[0,1] op_sel_hi:[1,1]
v_pk_mul_f32 v[166:167], v[166:167], v[240:241] op_sel:[0,1] op_sel_hi:[1,1]
v_pk_fma_f32 v[148:149], v[80:81], v[240:241], v[148:149] op_sel_hi:[1,0,1]
v_pk_fma_f32 v[150:151], v[82:83], v[240:241], v[150:151] op_sel_hi:[1,0,1]
v_pk_fma_f32 v[164:165], v[96:97], v[240:241], v[164:165] op_sel_hi:[1,0,1]
v_pk_fma_f32 v[166:167], v[98:99], v[240:241], v[166:167] op_sel_hi:[1,0,1]
v_pk_mul_f32 v[152:153], v[152:153], v[242:243] op_sel:[0,1] op_sel_hi:[1,1]
v_pk_mul_f32 v[154:155], v[154:155], v[242:243] op_sel:[0,1] op_sel_hi:[1,1]
v_pk_mul_f32 v[168:169], v[168:169], v[242:243] op_sel:[0,1] op_sel_hi:[1,1]
v_pk_mul_f32 v[170:171], v[170:171], v[242:243] op_sel:[0,1] op_sel_hi:[1,1]
v_pk_fma_f32 v[152:153], v[80:81], v[242:243], v[152:153] op_sel_hi:[1,0,1]
v_pk_fma_f32 v[154:155], v[82:83], v[242:243], v[154:155] op_sel_hi:[1,0,1]
v_pk_fma_f32 v[168:169], v[96:97], v[242:243], v[168:169] op_sel_hi:[1,0,1]
v_pk_fma_f32 v[170:171], v[98:99], v[242:243], v[170:171] op_sel_hi:[1,0,1]
v_cvt_pk_bf16_f32 v48, v140, v141
v_cvt_pk_bf16_f32 v49, v142, v143
v_cvt_pk_bf16_f32 v50, v156, v157
v_cvt_pk_bf16_f32 v51, v158, v159
v_cvt_pk_bf16_f32 v64, v144, v145
v_cvt_pk_bf16_f32 v65, v146, v147
v_cvt_pk_bf16_f32 v66, v160, v161
v_cvt_pk_bf16_f32 v67, v162, v163
v_cvt_pk_bf16_f32 v80, v148, v149
v_cvt_pk_bf16_f32 v81, v150, v151
v_cvt_pk_bf16_f32 v82, v164, v165
v_cvt_pk_bf16_f32 v83, v166, v167
v_cvt_pk_bf16_f32 v96, v152, v153
v_cvt_pk_bf16_f32 v97, v154, v155
v_cvt_pk_bf16_f32 v98, v168, v169
v_cvt_pk_bf16_f32 v99, v170, v171
v_permlane16_swap_b32 v48, v50
v_permlane16_swap_b32 v49, v51
v_permlane16_swap_b32 v64, v66
v_permlane16_swap_b32 v65, v67
v_permlane16_swap_b32 v80, v82
v_permlane16_swap_b32 v81, v83
v_permlane16_swap_b32 v96, v98
v_permlane16_swap_b32 v97, v99
v_pk_mul_f32 v[172:173], v[172:173], v[236:237] op_sel:[0,1] op_sel_hi:[1,1]
v_pk_mul_f32 v[174:175], v[174:175], v[236:237] op_sel:[0,1] op_sel_hi:[1,1]
v_pk_mul_f32 v[188:189], v[188:189], v[236:237] op_sel:[0,1] op_sel_hi:[1,1]
v_pk_mul_f32 v[190:191], v[190:191], v[236:237] op_sel:[0,1] op_sel_hi:[1,1]
v_pk_fma_f32 v[172:173], v[84:85], v[236:237], v[172:173] op_sel_hi:[1,0,1]
v_pk_fma_f32 v[174:175], v[86:87], v[236:237], v[174:175] op_sel_hi:[1,0,1]
v_pk_fma_f32 v[188:189], v[100:101], v[236:237], v[188:189] op_sel_hi:[1,0,1]
v_pk_fma_f32 v[190:191], v[102:103], v[236:237], v[190:191] op_sel_hi:[1,0,1]
v_pk_mul_f32 v[176:177], v[176:177], v[238:239] op_sel:[0,1] op_sel_hi:[1,1]
v_pk_mul_f32 v[178:179], v[178:179], v[238:239] op_sel:[0,1] op_sel_hi:[1,1]
v_pk_mul_f32 v[192:193], v[192:193], v[238:239] op_sel:[0,1] op_sel_hi:[1,1]
v_pk_mul_f32 v[194:195], v[194:195], v[238:239] op_sel:[0,1] op_sel_hi:[1,1]
v_pk_fma_f32 v[176:177], v[84:85], v[238:239], v[176:177] op_sel_hi:[1,0,1]
v_pk_fma_f32 v[178:179], v[86:87], v[238:239], v[178:179] op_sel_hi:[1,0,1]
v_pk_fma_f32 v[192:193], v[100:101], v[238:239], v[192:193] op_sel_hi:[1,0,1]
v_pk_fma_f32 v[194:195], v[102:103], v[238:239], v[194:195] op_sel_hi:[1,0,1]
v_pk_mul_f32 v[180:181], v[180:181], v[240:241] op_sel:[0,1] op_sel_hi:[1,1]
v_pk_mul_f32 v[182:183], v[182:183], v[240:241] op_sel:[0,1] op_sel_hi:[1,1]
v_pk_mul_f32 v[196:197], v[196:197], v[240:241] op_sel:[0,1] op_sel_hi:[1,1]
v_pk_mul_f32 v[198:199], v[198:199], v[240:241] op_sel:[0,1] op_sel_hi:[1,1]
v_pk_fma_f32 v[180:181], v[84:85], v[240:241], v[180:181] op_sel_hi:[1,0,1]
v_pk_fma_f32 v[182:183], v[86:87], v[240:241], v[182:183] op_sel_hi:[1,0,1]
v_pk_fma_f32 v[196:197], v[100:101], v[240:241], v[196:197] op_sel_hi:[1,0,1]
v_pk_fma_f32 v[198:199], v[102:103], v[240:241], v[198:199] op_sel_hi:[1,0,1]
v_pk_mul_f32 v[184:185], v[184:185], v[242:243] op_sel:[0,1] op_sel_hi:[1,1]
v_pk_mul_f32 v[186:187], v[186:187], v[242:243] op_sel:[0,1] op_sel_hi:[1,1]
v_pk_mul_f32 v[200:201], v[200:201], v[242:243] op_sel:[0,1] op_sel_hi:[1,1]
v_pk_mul_f32 v[202:203], v[202:203], v[242:243] op_sel:[0,1] op_sel_hi:[1,1]
v_pk_fma_f32 v[184:185], v[84:85], v[242:243], v[184:185] op_sel_hi:[1,0,1]
v_pk_fma_f32 v[186:187], v[86:87], v[242:243], v[186:187] op_sel_hi:[1,0,1]
v_pk_fma_f32 v[200:201], v[100:101], v[242:243], v[200:201] op_sel_hi:[1,0,1]
v_pk_fma_f32 v[202:203], v[102:103], v[242:243], v[202:203] op_sel_hi:[1,0,1]
v_cvt_pk_bf16_f32 v52, v172, v173
v_cvt_pk_bf16_f32 v53, v174, v175
v_cvt_pk_bf16_f32 v54, v188, v189
v_cvt_pk_bf16_f32 v55, v190, v191
v_cvt_pk_bf16_f32 v68, v176, v177
v_cvt_pk_bf16_f32 v69, v178, v179
v_cvt_pk_bf16_f32 v70, v192, v193
v_cvt_pk_bf16_f32 v71, v194, v195
v_cvt_pk_bf16_f32 v84, v180, v181
v_cvt_pk_bf16_f32 v85, v182, v183
v_cvt_pk_bf16_f32 v86, v196, v197
v_cvt_pk_bf16_f32 v87, v198, v199
v_cvt_pk_bf16_f32 v100, v184, v185
v_cvt_pk_bf16_f32 v101, v186, v187
v_cvt_pk_bf16_f32 v102, v200, v201
v_cvt_pk_bf16_f32 v103, v202, v203
v_permlane16_swap_b32 v52, v54
v_permlane16_swap_b32 v53, v55
v_permlane16_swap_b32 v68, v70
v_permlane16_swap_b32 v69, v71
v_permlane16_swap_b32 v84, v86
v_permlane16_swap_b32 v85, v87
v_permlane16_swap_b32 v100, v102
v_permlane16_swap_b32 v101, v103
v_pk_mul_f32 v[204:205], v[204:205], v[236:237] op_sel:[0,1] op_sel_hi:[1,1]
v_pk_mul_f32 v[206:207], v[206:207], v[236:237] op_sel:[0,1] op_sel_hi:[1,1]
v_pk_mul_f32 v[220:221], v[220:221], v[236:237] op_sel:[0,1] op_sel_hi:[1,1]
v_pk_mul_f32 v[222:223], v[222:223], v[236:237] op_sel:[0,1] op_sel_hi:[1,1]
v_pk_fma_f32 v[204:205], v[88:89], v[236:237], v[204:205] op_sel_hi:[1,0,1]
v_pk_fma_f32 v[206:207], v[90:91], v[236:237], v[206:207] op_sel_hi:[1,0,1]
v_pk_fma_f32 v[220:221], v[104:105], v[236:237], v[220:221] op_sel_hi:[1,0,1]
v_pk_fma_f32 v[222:223], v[106:107], v[236:237], v[222:223] op_sel_hi:[1,0,1]
v_pk_mul_f32 v[208:209], v[208:209], v[238:239] op_sel:[0,1] op_sel_hi:[1,1]
v_pk_mul_f32 v[210:211], v[210:211], v[238:239] op_sel:[0,1] op_sel_hi:[1,1]
v_pk_mul_f32 v[224:225], v[224:225], v[238:239] op_sel:[0,1] op_sel_hi:[1,1]
v_pk_mul_f32 v[226:227], v[226:227], v[238:239] op_sel:[0,1] op_sel_hi:[1,1]
v_pk_fma_f32 v[208:209], v[88:89], v[238:239], v[208:209] op_sel_hi:[1,0,1]
v_pk_fma_f32 v[210:211], v[90:91], v[238:239], v[210:211] op_sel_hi:[1,0,1]
v_pk_fma_f32 v[224:225], v[104:105], v[238:239], v[224:225] op_sel_hi:[1,0,1]
v_pk_fma_f32 v[226:227], v[106:107], v[238:239], v[226:227] op_sel_hi:[1,0,1]
v_pk_mul_f32 v[212:213], v[212:213], v[240:241] op_sel:[0,1] op_sel_hi:[1,1]
v_pk_mul_f32 v[214:215], v[214:215], v[240:241] op_sel:[0,1] op_sel_hi:[1,1]
v_pk_mul_f32 v[228:229], v[228:229], v[240:241] op_sel:[0,1] op_sel_hi:[1,1]
v_pk_mul_f32 v[230:231], v[230:231], v[240:241] op_sel:[0,1] op_sel_hi:[1,1]
v_pk_fma_f32 v[212:213], v[88:89], v[240:241], v[212:213] op_sel_hi:[1,0,1]
v_pk_fma_f32 v[214:215], v[90:91], v[240:241], v[214:215] op_sel_hi:[1,0,1]
v_pk_fma_f32 v[228:229], v[104:105], v[240:241], v[228:229] op_sel_hi:[1,0,1]
v_pk_fma_f32 v[230:231], v[106:107], v[240:241], v[230:231] op_sel_hi:[1,0,1]
v_pk_mul_f32 v[216:217], v[216:217], v[242:243] op_sel:[0,1] op_sel_hi:[1,1]
v_pk_mul_f32 v[218:219], v[218:219], v[242:243] op_sel:[0,1] op_sel_hi:[1,1]
v_pk_mul_f32 v[232:233], v[232:233], v[242:243] op_sel:[0,1] op_sel_hi:[1,1]
v_pk_mul_f32 v[234:235], v[234:235], v[242:243] op_sel:[0,1] op_sel_hi:[1,1]
v_pk_fma_f32 v[216:217], v[88:89], v[242:243], v[216:217] op_sel_hi:[1,0,1]
v_pk_fma_f32 v[218:219], v[90:91], v[242:243], v[218:219] op_sel_hi:[1,0,1]
v_pk_fma_f32 v[232:233], v[104:105], v[242:243], v[232:233] op_sel_hi:[1,0,1]
v_pk_fma_f32 v[234:235], v[106:107], v[242:243], v[234:235] op_sel_hi:[1,0,1]
v_cvt_pk_bf16_f32 v56, v204, v205
v_cvt_pk_bf16_f32 v57, v206, v207
v_cvt_pk_bf16_f32 v58, v220, v221
v_cvt_pk_bf16_f32 v59, v222, v223
v_cvt_pk_bf16_f32 v72, v208, v209
v_cvt_pk_bf16_f32 v73, v210, v211
v_cvt_pk_bf16_f32 v74, v224, v225
v_cvt_pk_bf16_f32 v75, v226, v227
v_cvt_pk_bf16_f32 v88, v212, v213
v_cvt_pk_bf16_f32 v89, v214, v215
v_cvt_pk_bf16_f32 v90, v228, v229
v_cvt_pk_bf16_f32 v91, v230, v231
v_cvt_pk_bf16_f32 v104, v216, v217
v_cvt_pk_bf16_f32 v105, v218, v219
v_cvt_pk_bf16_f32 v106, v232, v233
v_cvt_pk_bf16_f32 v107, v234, v235
v_permlane16_swap_b32 v56, v58
v_permlane16_swap_b32 v57, v59
v_permlane16_swap_b32 v72, v74
v_permlane16_swap_b32 v73, v75
v_permlane16_swap_b32 v88, v90
v_permlane16_swap_b32 v89, v91
v_permlane16_swap_b32 v104, v106
v_permlane16_swap_b32 v105, v107
L2_join:
s_nop 0
s_mov_b32 s40, 67108864
s_mov_b32 s3, 0
L2_att:
s_mov_b32 s43, s51
s_mov_b32 s44, s52
s_mov_b32 s47, s53
v_mfma_f32_16x16x32_bf16 v[108:111], a[128:131], v[44:47], 0
s_waitcnt lgkmcnt(0)
v_mov_b32 v37, 0x3f803f80
v_accvgpr_write_b32 a48, v37
v_mfma_f32_16x16x32_bf16 v[108:111], a[132:135], v[48:51], v[108:111]
ds_read_b128 a[148:151], v17 offset:4096
v_accvgpr_write_b32 a49, v37
v_mfma_f32_16x16x32_bf16 v[108:111], a[136:139], v[52:55], v[108:111]
v_accvgpr_write_b32 a50, v37
v_accvgpr_write_b32 a51, v37
v_mfma_f32_16x16x32_bf16 v[108:111], a[140:143], v[56:59], v[108:111]
v_and_b32 v37, 1, v0
v_sub_u32 v37, 0, v37
v_mfma_f32_16x16x32_bf16 v[112:115], a[128:131], v[60:63], 0
v_and_b32 v37, 0xaaaaaaaa, v37
v_or_b32 v37, 0x44444444, v37
v_mfma_f32_16x16x32_bf16 v[112:115], a[132:135], v[64:67], v[112:115]
ds_read_b128 a[152:155], v18 offset:4096
v_accvgpr_write_b32 a32, 0
v_mfma_f32_16x16x32_bf16 v[112:115], a[136:139], v[68:71], v[112:115]
v_accvgpr_write_b32 a33, 0
v_accvgpr_write_b32 a36, 0
v_mfma_f32_16x16x32_bf16 v[112:115], a[140:143], v[72:75], v[112:115]
v_accvgpr_write_b32 a37, 0
v_accvgpr_write_b32 a40, 0
v_mfma_f32_16x16x32_bf16 v[116:119], a[128:131], v[76:79], 0
v_accvgpr_write_b32 a41, 0
v_accvgpr_write_b32 a44, 0
v_mfma_f32_16x16x32_bf16 v[116:119], a[132:135], v[80:83], v[116:119]
ds_read_b128 a[156:159], v19 offset:4096
v_accvgpr_write_b32 a45, 0
v_mfma_f32_16x16x32_bf16 v[116:119], a[136:139], v[84:87], v[116:119]
v_accvgpr_write_b32 a64, v44
v_accvgpr_write_b32 a65, v45
v_mfma_f32_16x16x32_bf16 v[116:119], a[140:143], v[88:91], v[116:119]
v_max3_f32 v6, v108, v109, v110
v_max_f32 v6, v6, v111
v_mfma_f32_16x16x32_bf16 v[120:123], a[128:131], v[92:95], 0
v_accvgpr_write_b32 a66, v46
v_accvgpr_write_b32 a67, v47
v_mfma_f32_16x16x32_bf16 v[120:123], a[132:135], v[96:99], v[120:123]
ds_read_b128 a[128:131], v16 offset:8192
v_accvgpr_write_b32 a68, v48
v_mfma_f32_16x16x32_bf16 v[120:123], a[136:139], v[100:103], v[120:123]
v_accvgpr_write_b32 a69, v49
v_accvgpr_write_b32 a70, v50
v_mfma_f32_16x16x32_bf16 v[120:123], a[140:143], v[104:107], v[120:123]
v_max3_f32 v7, v112, v113, v114
v_max_f32 v7, v7, v115
v_mfma_f32_16x16x32_bf16 v[124:127], a[144:147], v[44:47], 0
s_waitcnt lgkmcnt(3)
v_accvgpr_write_b32 a71, v51
v_accvgpr_write_b32 a72, v52
v_mfma_f32_16x16x32_bf16 v[124:127], a[148:151], v[48:51], v[124:127]
s_waitcnt lgkmcnt(2)
ds_read_b128 a[132:135], v17 offset:8192
v_accvgpr_write_b32 a73, v53
v_mfma_f32_16x16x32_bf16 v[124:127], a[152:155], v[52:55], v[124:127]
s_waitcnt lgkmcnt(2)
v_accvgpr_write_b32 a74, v54
v_accvgpr_write_b32 a75, v55
v_mfma_f32_16x16x32_bf16 v[124:127], a[156:159], v[56:59], v[124:127]
v_max3_f32 v8, v116, v117, v118
v_max_f32 v8, v8, v119
v_mfma_f32_16x16x32_bf16 v[128:131], a[144:147], v[60:63], 0
v_accvgpr_write_b32 a76, v56
v_accvgpr_write_b32 a77, v57
v_mfma_f32_16x16x32_bf16 v[128:131], a[148:151], v[64:67], v[128:131]
ds_read_b128 a[136:139], v18 offset:8192
v_accvgpr_write_b32 a78, v58
v_mfma_f32_16x16x32_bf16 v[128:131], a[152:155], v[68:71], v[128:131]
v_accvgpr_write_b32 a79, v59
v_accvgpr_write_b32 a80, v60
v_mfma_f32_16x16x32_bf16 v[128:131], a[156:159], v[72:75], v[128:131]
v_max3_f32 v9, v120, v121, v122
v_max_f32 v9, v9, v123
v_mfma_f32_16x16x32_bf16 v[132:135], a[144:147], v[76:79], 0
v_accvgpr_write_b32 a81, v61
v_accvgpr_write_b32 a82, v62
v_mfma_f32_16x16x32_bf16 v[132:135], a[148:151], v[80:83], v[132:135]
ds_read_b128 a[140:143], v19 offset:8192
v_accvgpr_write_b32 a83, v63
v_mfma_f32_16x16x32_bf16 v[132:135], a[152:155], v[84:87], v[132:135]
v_accvgpr_write_b32 a84, v64
v_accvgpr_write_b32 a85, v65
v_mfma_f32_16x16x32_bf16 v[132:135], a[156:159], v[88:91], v[132:135]
v_max3_f32 v6, v6, v124, v125
v_max3_f32 v6, v6, v126, v127
v_mfma_f32_16x16x32_bf16 v[136:139], a[144:147], v[92:95], 0
v_accvgpr_write_b32 a86, v66
v_accvgpr_write_b32 a87, v67
v_mfma_f32_16x16x32_bf16 v[136:139], a[148:151], v[96:99], v[136:139]
ds_read_b128 a[144:147], v16 offset:12288
v_accvgpr_write_b32 a88, v68
v_mfma_f32_16x16x32_bf16 v[136:139], a[152:155], v[100:103], v[136:139]
v_accvgpr_write_b32 a89, v69
v_accvgpr_write_b32 a90, v70
v_mfma_f32_16x16x32_bf16 v[136:139], a[156:159], v[104:107], v[136:139]
s_waitcnt lgkmcnt(4)
v_max3_f32 v7, v7, v128, v129
v_max3_f32 v7, v7, v130, v131
v_mfma_f32_16x16x32_bf16 v[140:143], a[128:131], v[44:47], 0
s_waitcnt lgkmcnt(3)
v_accvgpr_write_b32 a91, v71
v_accvgpr_write_b32 a92, v72
v_mfma_f32_16x16x32_bf16 v[140:143], a[132:135], v[48:51], v[140:143]
s_waitcnt lgkmcnt(2)
ds_read_b128 a[148:151], v17 offset:12288
v_accvgpr_write_b32 a93, v73
v_mfma_f32_16x16x32_bf16 v[140:143], a[136:139], v[52:55], v[140:143]
s_waitcnt lgkmcnt(2)
v_accvgpr_write_b32 a94, v74
v_accvgpr_write_b32 a95, v75
v_mfma_f32_16x16x32_bf16 v[140:143], a[140:143], v[56:59], v[140:143]
v_max3_f32 v8, v8, v132, v133
v_max3_f32 v8, v8, v134, v135
v_mfma_f32_16x16x32_bf16 v[144:147], a[128:131], v[60:63], 0
v_accvgpr_write_b32 a96, v76
v_accvgpr_write_b32 a97, v77
v_mfma_f32_16x16x32_bf16 v[144:147], a[132:135], v[64:67], v[144:147]
ds_read_b128 a[152:155], v18 offset:12288
v_accvgpr_write_b32 a98, v78
v_mfma_f32_16x16x32_bf16 v[144:147], a[136:139], v[68:71], v[144:147]
v_accvgpr_write_b32 a99, v79
v_accvgpr_write_b32 a100, v80
v_mfma_f32_16x16x32_bf16 v[144:147], a[140:143], v[72:75], v[144:147]
v_max3_f32 v9, v9, v136, v137
v_max3_f32 v9, v9, v138, v139
v_mfma_f32_16x16x32_bf16 v[148:151], a[128:131], v[76:79], 0
v_accvgpr_write_b32 a101, v81
v_accvgpr_write_b32 a102, v82
v_mfma_f32_16x16x32_bf16 v[148:151], a[132:135], v[80:83], v[148:151]
ds_read_b128 a[156:159], v19 offset:12288
v_accvgpr_write_b32 a103, v83
v_mfma_f32_16x16x32_bf16 v[148:151], a[136:139], v[84:87], v[148:151]
v_accvgpr_write_b32 a104, v84
v_accvgpr_write_b32 a105, v85
v_mfma_f32_16x16x32_bf16 v[148:151], a[140:143], v[88:91], v[148:151]
v_max3_f32 v6, v6, v140, v141
v_max3_f32 v6, v6, v142, v143
v_mfma_f32_16x16x32_bf16 v[152:155], a[128:131], v[92:95], 0
v_accvgpr_write_b32 a106, v86
v_accvgpr_write_b32 a107, v87
v_mfma_f32_16x16x32_bf16 v[152:155], a[132:135], v[96:99], v[152:155]
v_accvgpr_write_b32 a108, v88
v_accvgpr_write_b32 a109, v89
v_mfma_f32_16x16x32_bf16 v[152:155], a[136:139], v[100:103], v[152:155]
v_accvgpr_write_b32 a110, v90
v_accvgpr_write_b32 a111, v91
v_mfma_f32_16x16x32_bf16 v[152:155], a[140:143], v[104:107], v[152:155]
s_waitcnt lgkmcnt(3)
v_max3_f32 v7, v7, v144, v145
v_max3_f32 v7, v7, v146, v147
v_mfma_f32_16x16x32_bf16 v[156:159], a[144:147], v[44:47], 0
s_waitcnt lgkmcnt(2)
v_accvgpr_write_b32 a112, v92
v_accvgpr_write_b32 a113, v93
v_mfma_f32_16x16x32_bf16 v[156:159], a[148:151], v[48:51], v[156:159]
s_waitcnt lgkmcnt(1)
v_accvgpr_write_b32 a114, v94
v_accvgpr_write_b32 a115, v95
v_mfma_f32_16x16x32_bf16 v[156:159], a[152:155], v[52:55], v[156:159]
s_waitcnt lgkmcnt(0)
v_accvgpr_write_b32 a116, v96
v_accvgpr_write_b32 a117, v97
v_mfma_f32_16x16x32_bf16 v[156:159], a[156:159], v[56:59], v[156:159]
v_max3_f32 v8, v8, v148, v149
v_max3_f32 v8, v8, v150, v151
v_mfma_f32_16x16x32_bf16 v[160:163], a[144:147], v[60:63], 0
v_accvgpr_write_b32 a118, v98
v_accvgpr_write_b32 a119, v99
v_mfma_f32_16x16x32_bf16 v[160:163], a[148:151], v[64:67], v[160:163]
v_accvgpr_write_b32 a120, v100
v_accvgpr_write_b32 a121, v101
v_mfma_f32_16x16x32_bf16 v[160:163], a[152:155], v[68:71], v[160:163]
v_accvgpr_write_b32 a122, v102
v_accvgpr_write_b32 a123, v103
v_mfma_f32_16x16x32_bf16 v[160:163], a[156:159], v[72:75], v[160:163]
v_max3_f32 v9, v9, v152, v153
v_max3_f32 v9, v9, v154, v155
v_mfma_f32_16x16x32_bf16 v[164:167], a[144:147], v[76:79], 0
v_accvgpr_write_b32 a124, v104
v_accvgpr_write_b32 a125, v105
v_mfma_f32_16x16x32_bf16 v[164:167], a[148:151], v[80:83], v[164:167]
v_accvgpr_write_b32 a126, v106
v_accvgpr_write_b32 a127, v107
v_mfma_f32_16x16x32_bf16 v[164:167], a[152:155], v[84:87], v[164:167]
v_mov_b64 v[168:169], 0
v_mov_b64 v[170:171], 0
v_mfma_f32_16x16x32_bf16 v[164:167], a[156:159], v[88:91], v[164:167]
v_max3_f32 v6, v6, v156, v157
v_max3_f32 v6, v6, v158, v159
v_mfma_f32_16x16x32_bf16 v[32:35], a[144:147], v[92:95], 0
v_mov_b64 v[172:173], 0
v_mov_b64 v[174:175], 0
v_mfma_f32_16x16x32_bf16 v[32:35], a[148:151], v[96:99], v[32:35]
v_mov_b64 v[176:177], 0
v_mov_b64 v[178:179], 0
v_mfma_f32_16x16x32_bf16 v[32:35], a[152:155], v[100:103], v[32:35]
v_mov_b64 v[180:181], 0
v_mov_b64 v[182:183], 0
v_mfma_f32_16x16x32_bf16 v[32:35], a[156:159], v[104:107], v[32:35]
s_nop 0
v_max3_f32 v7, v7, v160, v161
v_max3_f32 v7, v7, v162, v163
v_mov_b64 v[184:185], 0
v_mov_b64 v[186:187], 0
v_mov_b64 v[188:189], 0
v_mov_b64 v[190:191], 0
v_mov_b64 v[192:193], 0
v_mov_b64 v[194:195], 0
v_mov_b64 v[196:197], 0
v_mov_b64 v[198:199], 0
v_mov_b64 v[200:201], 0
v_mov_b64 v[202:203], 0
v_mov_b64 v[204:205], 0
v_mov_b64 v[206:207], 0
v_mov_b64 v[208:209], 0
v_mov_b64 v[210:211], 0
v_mov_b64 v[212:213], 0
v_mov_b64 v[214:215], 0
v_mov_b64 v[216:217], 0
v_mov_b64 v[218:219], 0
v_mov_b64 v[220:221], 0
v_mov_b64 v[222:223], 0
v_mov_b64 v[224:225], 0
v_mov_b64 v[226:227], 0
v_mov_b64 v[228:229], 0
v_mov_b64 v[230:231], 0
v_mov_b64 v[232:233], 0
v_mov_b64 v[234:235], 0
s_cmp_lg_u32 s48, 0
s_cbranch_scc1 L2_m1
v_max3_f32 v8, v8, v164, v165
v_max3_f32 v8, v8, v166, v167
v_max3_f32 v9, v9, v32, v33
v_max3_f32 v9, v9, v34, v35
v_mov_b32 v28, v6
v_mov_b32 v29, v7
v_mov_b32 v30, v8
v_mov_b32 v31, v9
v_permlane16_swap_b32 v28, v6
v_permlane16_swap_b32 v29, v7
v_permlane16_swap_b32 v30, v8
v_permlane16_swap_b32 v31, v9
v_max_f32 v6, v6, v28
v_max_f32 v7, v7, v29
v_max_f32 v8, v8, v30
v_max_f32 v9, v9, v31
v_mov_b32 v28, v6
v_mov_b32 v29, v7
v_mov_b32 v30, v8
v_mov_b32 v31, v9
v_permlane32_swap_b32 v28, v6
v_permlane32_swap_b32 v29, v7
v_permlane32_swap_b32 v30, v8
v_permlane32_swap_b32 v31, v9
v_max_f32 v6, v6, v28
v_max_f32 v7, v7, v29
v_max_f32 v8, v8, v30
v_max_f32 v9, v9, v31
v_sub_f32 v236, 0xc2cc0000, v6
v_sub_f32 v237, 0xc2cc0000, v6
v_mov_b64 v[238:239], v[236:237]
v_sub_f32 v240, 0xc2cc0000, v7
v_sub_f32 v241, 0xc2cc0000, v7
v_mov_b64 v[242:243], v[240:241]
v_sub_f32 v244, 0xc2cc0000, v8
v_sub_f32 v245, 0xc2cc0000, v8
v_mov_b64 v[246:247], v[244:245]
v_sub_f32 v248, 0xc2cc0000, v9
v_sub_f32 v249, 0xc2cc0000, v9
v_mov_b64 v[250:251], v[248:249]
L2_m1:
v_pk_add_f32 v[108:109], v[108:109], v[236:237]
v_pk_add_f32 v[110:111], v[110:111], v[236:237]
v_exp_f32 v6, v108
v_exp_f32 v7, v109
v_exp_f32 v8, v110
v_exp_f32 v9, v111
v_cvt_pk_bf16_f32 v44, v6, v7
v_mov_b64 v[108:109], 0
v_mov_b64 v[110:111], 0
v_pk_add_f32 v[112:113], v[112:113], v[240:241]
v_pk_add_f32 v[114:115], v[114:115], v[240:241]
v_cvt_pk_bf16_f32 v45, v8, v9
v_exp_f32 v6, v112
v_exp_f32 v7, v113
v_exp_f32 v8, v114
v_exp_f32 v9, v115
v_cvt_pk_bf16_f32 v52, v6, v7
v_mov_b64 v[112:113], 0
v_mov_b64 v[114:115], 0
v_pk_add_f32 v[116:117], v[116:117], v[244:245]
v_pk_add_f32 v[118:119], v[118:119], v[244:245]
v_cvt_pk_bf16_f32 v53, v8, v9
v_exp_f32 v6, v116
v_exp_f32 v7, v117
v_exp_f32 v8, v118
v_exp_f32 v9, v119
v_cvt_pk_bf16_f32 v60, v6, v7
v_mov_b64 v[116:117], 0
v_mov_b64 v[118:119], 0
v_pk_add_f32 v[120:121], v[120:121], v[248:249]
v_pk_add_f32 v[122:123], v[122:123], v[248:249]
v_cvt_pk_bf16_f32 v61, v8, v9
v_exp_f32 v6, v120
v_exp_f32 v7, v121
v_exp_f32 v8, v122
v_exp_f32 v9, v123
v_cvt_pk_bf16_f32 v68, v6, v7
v_mov_b64 v[120:121], 0
v_mov_b64 v[122:123], 0
v_pk_add_f32 v[124:125], v[124:125], v[236:237]
v_pk_add_f32 v[126:127], v[126:127], v[236:237]
v_cvt_pk_bf16_f32 v69, v8, v9
v_exp_f32 v6, v124
v_exp_f32 v7, v125
v_exp_f32 v8, v126
v_exp_f32 v9, v127
v_cvt_pk_bf16_f32 v46, v6, v7
v_mov_b64 v[124:125], 0
v_mov_b64 v[126:127], 0
s_barrier
s_nop 0
ds_read_b128 a[128:131], v16 offset:16384
v_pk_add_f32 v[128:129], v[128:129], v[240:241]
v_pk_add_f32 v[130:131], v[130:131], v[240:241]
v_cvt_pk_bf16_f32 v47, v8, v9
v_exp_f32 v6, v128
v_exp_f32 v7, v129
v_exp_f32 v8, v130
v_exp_f32 v9, v131
v_cvt_pk_bf16_f32 v54, v6, v7
v_mov_b64 v[128:129], 0
v_mov_b64 v[130:131], 0
ds_read_b128 a[132:135], v17 offset:16384
ds_read_b128 a[136:139], v18 offset:16384
v_pk_add_f32 v[132:133], v[132:133], v[244:245]
v_pk_add_f32 v[134:135], v[134:135], v[244:245]
v_cvt_pk_bf16_f32 v55, v8, v9
v_exp_f32 v6, v132
v_exp_f32 v7, v133
v_exp_f32 v8, v134
v_exp_f32 v9, v135
v_cvt_pk_bf16_f32 v62, v6, v7
v_mov_b64 v[132:133], 0
v_mov_b64 v[134:135], 0
ds_read_b128 a[140:143], v19 offset:16384
ds_read_b128 a[144:147], v16 offset:20480
v_pk_add_f32 v[136:137], v[136:137], v[248:249]
v_pk_add_f32 v[138:139], v[138:139], v[248:249]
v_cvt_pk_bf16_f32 v63, v8, v9
v_exp_f32 v6, v136
v_exp_f32 v7, v137
v_exp_f32 v8, v138
v_exp_f32 v9, v139
v_cvt_pk_bf16_f32 v70, v6, v7
v_mov_b64 v[136:137], 0
v_mov_b64 v[138:139], 0
s_add_u32 m0, s37, 49152
ds_read_b64_tr_b16 a[160:161], v20 offset:0
v_pk_add_f32 v[140:141], v[140:141], v[236:237]
v_pk_add_f32 v[142:143], v[142:143], v[236:237]
v_cvt_pk_bf16_f32 v71, v8, v9
v_exp_f32 v6, v140
v_exp_f32 v7, v141
v_exp_f32 v8, v142
v_exp_f32 v9, v143
v_cvt_pk_bf16_f32 v48, v6, v7
v_mov_b64 v[140:141], 0
v_mov_b64 v[142:143], 0
buffer_load_dwordx4 v10, s[12:15], s41 offen offset:0 lds
ds_read_b64_tr_b16 a[162:163], v20 offset:4096
v_pk_add_f32 v[144:145], v[144:145], v[240:241]
v_pk_add_f32 v[146:147], v[146:147], v[240:241]
v_cvt_pk_bf16_f32 v49, v8, v9
v_exp_f32 v6, v144
v_exp_f32 v7, v145
v_exp_f32 v8, v146
v_exp_f32 v9, v147
v_cvt_pk_bf16_f32 v56, v6, v7
v_mov_b64 v[144:145], 0
v_mov_b64 v[146:147], 0
buffer_load_dwordx4 v11, s[12:15], s41 offen offset:1024 lds
ds_read_b64_tr_b16 a[164:165], v20 offset:8192
v_pk_add_f32 v[148:149], v[148:149], v[244:245]
v_pk_add_f32 v[150:151], v[150:151], v[244:245]
v_cvt_pk_bf16_f32 v57, v8, v9
v_exp_f32 v6, v148
v_exp_f32 v7, v149
v_exp_f32 v8, v150
v_exp_f32 v9, v151
v_cvt_pk_bf16_f32 v64, v6, v7
v_mov_b64 v[148:149], 0
v_mov_b64 v[150:151], 0
buffer_load_dwordx4 v12, s[12:15], s41 offen offset:2048 lds
ds_read_b64_tr_b16 a[166:167], v20 offset:12288
v_pk_add_f32 v[152:153], v[152:153], v[248:249]
v_pk_add_f32 v[154:155], v[154:155], v[248:249]
v_cvt_pk_bf16_f32 v65, v8, v9
v_exp_f32 v6, v152
v_exp_f32 v7, v153
v_exp_f32 v8, v154
v_exp_f32 v9, v155
v_cvt_pk_bf16_f32 v72, v6, v7
v_mov_b64 v[152:153], 0
v_mov_b64 v[154:155], 0
ds_read_b64_tr_b16 a[168:169], v21 offset:0
ds_read_b64_tr_b16 a[170:171], v21 offset:4096
v_pk_add_f32 v[156:157], v[156:157], v[236:237]
v_pk_add_f32 v[158:159], v[158:159], v[236:237]
v_cvt_pk_bf16_f32 v73, v8, v9
v_exp_f32 v6, v156
v_exp_f32 v7, v157
v_exp_f32 v8, v158
v_exp_f32 v9, v159
v_cvt_pk_bf16_f32 v50, v6, v7
v_mov_b64 v[156:157], 0
v_mov_b64 v[158:159], 0
v_pk_add_f32 v[160:161], v[160:161], v[240:241]
v_pk_add_f32 v[162:163], v[162:163], v[240:241]
v_cvt_pk_bf16_f32 v51, v8, v9
v_exp_f32 v6, v160
v_exp_f32 v7, v161
v_exp_f32 v8, v162
v_exp_f32 v9, v163
v_cvt_pk_bf16_f32 v58, v6, v7
v_mov_b64 v[160:161], 0
v_mov_b64 v[162:163], 0
v_pk_add_f32 v[164:165], v[164:165], v[244:245]
v_pk_add_f32 v[166:167], v[166:167], v[244:245]
v_cvt_pk_bf16_f32 v59, v8, v9
v_exp_f32 v6, v164
v_exp_f32 v7, v165
v_exp_f32 v8, v166
v_exp_f32 v9, v167
v_cvt_pk_bf16_f32 v66, v6, v7
v_mov_b64 v[164:165], 0
v_mov_b64 v[166:167], 0
v_pk_add_f32 v[32:33], v[32:33], v[248:249]
v_pk_add_f32 v[34:35], v[34:35], v[248:249]
s_mov_b32 s38, -7
.p2align 3
L2_loop:
s_waitcnt lgkmcnt(10)
v_mfma_f32_16x16x32_bf16 v[28:31], a[128:131], a[64:67], v[236:239]
s_waitcnt lgkmcnt(9)
v_exp_f32 v6, v32
v_mfma_f32_16x16x32_bf16 v[28:31], a[132:135], a[68:71], v[28:31]
s_waitcnt lgkmcnt(6)
ds_read_b64_tr_b16 a[172:173], v21 offset:8192
v_cvt_pk_bf16_f32 v67, v8, v9
v_mfma_f32_16x16x32_bf16 v[28:31], a[136:139], a[72:75], v[28:31]
s_waitcnt lgkmcnt(4)
v_exp_f32 v7, v33
v_mfma_f32_16x16x32_bf16 v[28:31], a[140:143], a[76:79], v[28:31]
s_waitcnt lgkmcnt(5)
ds_read_b64_tr_b16 a[174:175], v21 offset:12288
v_cvt_pk_bf16_f32 v74, v6, v7
v_mfma_f32_16x16x32_bf16 v[108:111], a[160:163], v[44:47], v[108:111]
s_waitcnt lgkmcnt(4)
v_exp_f32 v8, v34
v_mfma_f32_16x16x32_bf16 v[108:111], a[164:167], v[48:51], v[108:111]
ds_read_b128 a[148:151], v17 offset:20480
v_mfma_f32_16x16x32_bf16 v[112:115], a[164:167], v[56:59], v[112:115]
v_exp_f32 v9, v35
v_mfma_f32_16x16x32_bf16 v[112:115], a[160:163], v[52:55], v[112:115]
v_mfma_f32_16x16x32_bf16 v[32:35], a[128:131], a[80:83], v[240:243]
v_exp_f32 v6, v28
v_mfma_f32_16x16x32_bf16 v[32:35], a[132:135], a[84:87], v[32:35]
ds_read_b64_tr_b16 a[176:177], v22 offset:0
v_cvt_pk_bf16_f32 v75, v8, v9
v_mfma_f32_16x16x32_bf16 v[32:35], a[136:139], a[88:91], v[32:35]
v_exp_f32 v7, v29
v_mfma_f32_16x16x32_bf16 v[32:35], a[140:143], a[92:95], v[32:35]
ds_read_b64_tr_b16 a[178:179], v22 offset:4096
v_cvt_pk_bf16_f32 v76, v6, v7
v_mfma_f32_16x16x32_bf16 v[116:119], a[160:163], v[60:63], v[116:119]
v_exp_f32 v8, v30
v_mfma_f32_16x16x32_bf16 v[116:119], a[164:167], v[64:67], v[116:119]
ds_read_b128 a[152:155], v18 offset:20480
v_mfma_f32_16x16x32_bf16 v[120:123], a[164:167], v[72:75], v[120:123]
v_exp_f32 v9, v31
v_mfma_f32_16x16x32_bf16 v[120:123], a[160:163], v[68:71], v[120:123]
buffer_load_dwordx4 v13, s[12:15], s41 offen offset:3072 lds
v_mfma_f32_16x16x32_bf16 v[28:31], a[128:131], a[96:99], v[244:247]
s_add_u32 s41, s41, 16384
v_exp_f32 v6, v32
v_mfma_f32_16x16x32_bf16 v[28:31], a[132:135], a[100:103], v[28:31]
ds_read_b64_tr_b16 a[180:181], v22 offset:8192
v_cvt_pk_bf16_f32 v77, v8, v9
v_mfma_f32_16x16x32_bf16 v[28:31], a[136:139], a[104:107], v[28:31]
v_exp_f32 v7, v33
v_mfma_f32_16x16x32_bf16 v[28:31], a[140:143], a[108:111], v[28:31]
s_waitcnt lgkmcnt(7)
ds_read_b64_tr_b16 a[182:183], v22 offset:12288
v_cvt_pk_bf16_f32 v84, v6, v7
v_mfma_f32_16x16x32_bf16 v[124:127], a[168:171], v[44:47], v[124:127]
s_waitcnt lgkmcnt(6)
v_exp_f32 v8, v34
v_mfma_f32_16x16x32_bf16 v[124:127], a[172:175], v[48:51], v[124:127]
ds_read_b128 a[156:159], v19 offset:20480
v_mfma_f32_16x16x32_bf16 v[128:131], a[172:175], v[56:59], v[128:131]
v_exp_f32 v9, v35
v_mfma_f32_16x16x32_bf16 v[128:131], a[168:171], v[52:55], v[128:131]
buffer_load_dword a60, v36, s[24:27], s47 offen
v_mfma_f32_16x16x32_bf16 v[32:35], a[128:131], a[112:115], v[248:251]
s_add_u32 s47, s47, 4096
v_exp_f32 v6, v28
v_mfma_f32_16x16x32_bf16 v[32:35], a[132:135], a[116:119], v[32:35]
ds_read_b64_tr_b16 a[184:185], v23 offset:0
v_cvt_pk_bf16_f32 v85, v8, v9
v_mfma_f32_16x16x32_bf16 v[32:35], a[136:139], a[120:123], v[32:35]
v_exp_f32 v7, v29
v_mfma_f32_16x16x32_bf16 v[32:35], a[140:143], a[124:127], v[32:35]
ds_read_b64_tr_b16 a[186:187], v23 offset:4096
v_cvt_pk_bf16_f32 v92, v6, v7
v_mfma_f32_16x16x32_bf16 v[132:135], a[168:171], v[60:63], v[132:135]
v_exp_f32 v8, v30
v_mfma_f32_16x16x32_bf16 v[132:135], a[172:175], v[64:67], v[132:135]
ds_read_b128 a[128:131], v16 offset:24576
v_mfma_f32_16x16x32_bf16 v[136:139], a[172:175], v[72:75], v[136:139]
s_add_u32 m0, s37, 98304
v_exp_f32 v9, v31
v_mfma_f32_16x16x32_bf16 v[136:139], a[168:171], v[68:71], v[136:139]
buffer_load_dwordx4 v14, s[16:19], s42 offen offset:0 lds
v_smfmac_f32_16x16x64_bf16 a[32:35], a[48:51], v[44:51], v37
v_mfma_f32_16x16x32_bf16 v[28:31], a[144:147], a[64:67], v[236:239]
s_waitcnt lgkmcnt(9)
v_exp_f32 v6, v32
v_mfma_f32_16x16x32_bf16 v[28:31], a[148:151], a[68:71], v[28:31]
s_waitcnt lgkmcnt(6)
ds_read_b64_tr_b16 a[188:189], v23 offset:8192
v_cvt_pk_bf16_f32 v93, v8, v9
v_mfma_f32_16x16x32_bf16 v[28:31], a[152:155], a[72:75], v[28:31]
s_waitcnt lgkmcnt(4)
v_exp_f32 v7, v33
v_mfma_f32_16x16x32_bf16 v[28:31], a[156:159], a[76:79], v[28:31]
ds_read_b64_tr_b16 a[190:191], v23 offset:12288
v_cvt_pk_bf16_f32 v100, v6, v7
v_mfma_f32_16x16x32_bf16 v[140:143], a[176:179], v[44:47], v[140:143]
v_exp_f32 v8, v34
v_mfma_f32_16x16x32_bf16 v[140:143], a[180:183], v[48:51], v[140:143]
ds_read_b128 a[132:135], v17 offset:24576
v_mfma_f32_16x16x32_bf16 v[144:147], a[180:183], v[56:59], v[144:147]
v_exp_f32 v9, v35
v_mfma_f32_16x16x32_bf16 v[144:147], a[176:179], v[52:55], v[144:147]
v_mfma_f32_16x16x32_bf16 v[32:35], a[144:147], a[80:83], v[240:243]
v_exp_f32 v6, v28
v_mfma_f32_16x16x32_bf16 v[32:35], a[148:151], a[84:87], v[32:35]
ds_read_b64_tr_b16 a[160:161], v24 offset:0
v_cvt_pk_bf16_f32 v101, v8, v9
v_mfma_f32_16x16x32_bf16 v[32:35], a[152:155], a[88:91], v[32:35]
v_exp_f32 v7, v29
v_mfma_f32_16x16x32_bf16 v[32:35], a[156:159], a[92:95], v[32:35]
ds_read_b64_tr_b16 a[162:163], v24 offset:4096
v_cvt_pk_bf16_f32 v78, v6, v7
v_mfma_f32_16x16x32_bf16 v[148:151], a[176:179], v[60:63], v[148:151]
v_exp_f32 v8, v30
v_mfma_f32_16x16x32_bf16 v[148:151], a[180:183], v[64:67], v[148:151]
ds_read_b128 a[136:139], v18 offset:24576
v_mfma_f32_16x16x32_bf16 v[152:155], a[180:183], v[72:75], v[152:155]
v_exp_f32 v9, v31
v_mfma_f32_16x16x32_bf16 v[152:155], a[176:179], v[68:71], v[152:155]
buffer_load_dwordx4 v15, s[16:19], s42 offen offset:1024 lds
v_mfma_f32_16x16x32_bf16 v[28:31], a[144:147], a[96:99], v[244:247]
v_exp_f32 v6, v32
v_mfma_f32_16x16x32_bf16 v[28:31], a[148:151], a[100:103], v[28:31]
ds_read_b64_tr_b16 a[164:165], v24 offset:8192
v_cvt_pk_bf16_f32 v79, v8, v9
v_mfma_f32_16x16x32_bf16 v[28:31], a[152:155], a[104:107], v[28:31]
v_exp_f32 v7, v33
v_mfma_f32_16x16x32_bf16 v[28:31], a[156:159], a[108:111], v[28:31]
s_waitcnt lgkmcnt(8)
ds_read_b64_tr_b16 a[166:167], v24 offset:12288
v_cvt_pk_bf16_f32 v86, v6, v7
v_mfma_f32_16x16x32_bf16 v[156:159], a[184:187], v[44:47], v[156:159]
s_waitcnt lgkmcnt(6)
v_exp_f32 v8, v34
v_mfma_f32_16x16x32_bf16 v[156:159], a[188:191], v[48:51], v[156:159]
ds_read_b128 a[140:143], v19 offset:24576
v_mfma_f32_16x16x32_bf16 v[160:163], a[188:191], v[56:59], v[160:163]
v_exp_f32 v9, v35
v_mfma_f32_16x16x32_bf16 v[160:163], a[184:187], v[52:55], v[160:163]
v_mfma_f32_16x16x32_bf16 v[32:35], a[144:147], a[112:115], v[248:251]
v_exp_f32 v6, v28
v_mfma_f32_16x16x32_bf16 v[32:35], a[148:151], a[116:119], v[32:35]
ds_read_b64_tr_b16 a[168:169], v25 offset:0
v_cvt_pk_bf16_f32 v87, v8, v9
v_mfma_f32_16x16x32_bf16 v[32:35], a[152:155], a[120:123], v[32:35]
v_exp_f32 v7, v29
v_mfma_f32_16x16x32_bf16 v[32:35], a[156:159], a[124:127], v[32:35]
ds_read_b64_tr_b16 a[170:171], v25 offset:4096
v_cvt_pk_bf16_f32 v94, v6, v7
v_mfma_f32_16x16x32_bf16 v[164:167], a[184:187], v[60:63], v[164:167]
v_exp_f32 v8, v30
v_mfma_f32_16x16x32_bf16 v[164:167], a[188:191], v[64:67], v[164:167]
ds_read_b128 a[144:147], v16 offset:28672
v_mfma_f32_16x16x32_bf16 v[168:171], a[188:191], v[72:75], v[168:171]
v_exp_f32 v9, v31
v_mfma_f32_16x16x32_bf16 v[168:171], a[184:187], v[68:71], v[168:171]
buffer_load_dwordx4 v14, s[16:19], s42 offen offset:2048 lds
v_smfmac_f32_16x16x64_bf16 a[36:39], a[48:51], v[52:59], v37
v_mfma_f32_16x16x32_bf16 v[28:31], a[128:131], a[64:67], v[236:239]
s_waitcnt lgkmcnt(9)
v_exp_f32 v6, v32
v_mfma_f32_16x16x32_bf16 v[28:31], a[132:135], a[68:71], v[28:31]
s_waitcnt lgkmcnt(6)
ds_read_b64_tr_b16 a[172:173], v25 offset:8192
v_cvt_pk_bf16_f32 v95, v8, v9
v_mfma_f32_16x16x32_bf16 v[28:31], a[136:139], a[72:75], v[28:31]
s_waitcnt lgkmcnt(4)
v_exp_f32 v7, v33
v_mfma_f32_16x16x32_bf16 v[28:31], a[140:143], a[76:79], v[28:31]
ds_read_b64_tr_b16 a[174:175], v25 offset:12288
v_cvt_pk_bf16_f32 v102, v6, v7
v_mfma_f32_16x16x32_bf16 v[172:175], a[160:163], v[44:47], v[172:175]
v_exp_f32 v8, v34
v_mfma_f32_16x16x32_bf16 v[172:175], a[164:167], v[48:51], v[172:175]
ds_read_b128 a[148:151], v17 offset:28672
v_mfma_f32_16x16x32_bf16 v[176:179], a[164:167], v[56:59], v[176:179]
v_exp_f32 v9, v35
v_mfma_f32_16x16x32_bf16 v[176:179], a[160:163], v[52:55], v[176:179]
v_mfma_f32_16x16x32_bf16 v[32:35], a[128:131], a[80:83], v[240:243]
v_exp_f32 v6, v28
v_mfma_f32_16x16x32_bf16 v[32:35], a[132:135], a[84:87], v[32:35]
ds_read_b64_tr_b16 a[176:177], v26 offset:0
v_cvt_pk_bf16_f32 v103, v8, v9
v_mfma_f32_16x16x32_bf16 v[32:35], a[136:139], a[88:91], v[32:35]
v_exp_f32 v7, v29
v_mfma_f32_16x16x32_bf16 v[32:35], a[140:143], a[92:95], v[32:35]
ds_read_b64_tr_b16 a[178:179], v26 offset:4096
v_cvt_pk_bf16_f32 v80, v6, v7
v_mfma_f32_16x16x32_bf16 v[180:183], a[160:163], v[60:63], v[180:183]
v_exp_f32 v8, v30
v_mfma_f32_16x16x32_bf16 v[180:183], a[164:167], v[64:67], v[180:183]
ds_read_b128 a[152:155], v18 offset:28672
v_mfma_f32_16x16x32_bf16 v[184:187], a[164:167], v[72:75], v[184:187]
v_exp_f32 v9, v31
v_mfma_f32_16x16x32_bf16 v[184:187], a[160:163], v[68:71], v[184:187]
buffer_load_dwordx4 v15, s[16:19], s42 offen offset:3072 lds
v_mfma_f32_16x16x32_bf16 v[28:31], a[128:131], a[96:99], v[244:247]
s_add_u32 s42, s42, 16384
v_exp_f32 v6, v32
v_mfma_f32_16x16x32_bf16 v[28:31], a[132:135], a[100:103], v[28:31]
ds_read_b64_tr_b16 a[180:181], v26 offset:8192
v_cvt_pk_bf16_f32 v81, v8, v9
v_mfma_f32_16x16x32_bf16 v[28:31], a[136:139], a[104:107], v[28:31]
v_exp_f32 v7, v33
v_mfma_f32_16x16x32_bf16 v[28:31], a[140:143], a[108:111], v[28:31]
s_waitcnt lgkmcnt(8)
ds_read_b64_tr_b16 a[182:183], v26 offset:12288
v_cvt_pk_bf16_f32 v88, v6, v7
v_mfma_f32_16x16x32_bf16 v[188:191], a[168:171], v[44:47], v[188:191]
s_waitcnt lgkmcnt(6)
v_exp_f32 v8, v34
v_mfma_f32_16x16x32_bf16 v[188:191], a[172:175], v[48:51], v[188:191]
ds_read_b128 a[156:159], v19 offset:28672
v_mfma_f32_16x16x32_bf16 v[192:195], a[172:175], v[56:59], v[192:195]
v_exp_f32 v9, v35
v_mfma_f32_16x16x32_bf16 v[192:195], a[168:171], v[52:55], v[192:195]
s_waitcnt vmcnt(9)
s_barrier
v_mfma_f32_16x16x32_bf16 v[32:35], a[128:131], a[112:115], v[248:251]
v_exp_f32 v6, v28
v_mfma_f32_16x16x32_bf16 v[32:35], a[132:135], a[116:119], v[32:35]
ds_read_b64_tr_b16 a[184:185], v27 offset:0
v_cvt_pk_bf16_f32 v89, v8, v9
v_mfma_f32_16x16x32_bf16 v[32:35], a[136:139], a[120:123], v[32:35]
v_exp_f32 v7, v29
v_mfma_f32_16x16x32_bf16 v[32:35], a[140:143], a[124:127], v[32:35]
ds_read_b64_tr_b16 a[186:187], v27 offset:4096
v_cvt_pk_bf16_f32 v96, v6, v7
v_mfma_f32_16x16x32_bf16 v[196:199], a[168:171], v[60:63], v[196:199]
v_exp_f32 v8, v30
v_mfma_f32_16x16x32_bf16 v[196:199], a[172:175], v[64:67], v[196:199]
ds_read_b128 a[128:131], v16 offset:32768
v_mfma_f32_16x16x32_bf16 v[200:203], a[172:175], v[72:75], v[200:203]
s_add_u32 m0, s37, 0
v_exp_f32 v9, v31
v_mfma_f32_16x16x32_bf16 v[200:203], a[168:171], v[68:71], v[200:203]
buffer_load_dwordx4 v10, s[12:15], s41 offen offset:0 lds
v_smfmac_f32_16x16x64_bf16 a[40:43], a[48:51], v[60:67], v37
v_mfma_f32_16x16x32_bf16 v[28:31], a[144:147], a[64:67], v[236:239]
s_waitcnt lgkmcnt(9)
v_exp_f32 v6, v32
v_mfma_f32_16x16x32_bf16 v[28:31], a[148:151], a[68:71], v[28:31]
s_waitcnt lgkmcnt(6)
ds_read_b64_tr_b16 a[188:189], v27 offset:8192
v_cvt_pk_bf16_f32 v97, v8, v9
v_mfma_f32_16x16x32_bf16 v[28:31], a[152:155], a[72:75], v[28:31]
s_waitcnt lgkmcnt(4)
v_exp_f32 v7, v33
v_mfma_f32_16x16x32_bf16 v[28:31], a[156:159], a[76:79], v[28:31]
ds_read_b64_tr_b16 a[190:191], v27 offset:12288
v_cvt_pk_bf16_f32 v104, v6, v7
v_mfma_f32_16x16x32_bf16 v[204:207], a[176:179], v[44:47], v[204:207]
v_exp_f32 v8, v34
v_mfma_f32_16x16x32_bf16 v[204:207], a[180:183], v[48:51], v[204:207]
ds_read_b128 a[132:135], v17 offset:32768
v_mfma_f32_16x16x32_bf16 v[208:211], a[180:183], v[56:59], v[208:211]
v_exp_f32 v9, v35
v_mfma_f32_16x16x32_bf16 v[208:211], a[176:179], v[52:55], v[208:211]
v_mfma_f32_16x16x32_bf16 v[32:35], a[144:147], a[80:83], v[240:243]
v_exp_f32 v6, v28
v_mfma_f32_16x16x32_bf16 v[32:35], a[148:151], a[84:87], v[32:35]
ds_read_b64_tr_b16 a[160:161], v20 offset:16384
v_cvt_pk_bf16_f32 v105, v8, v9
v_mfma_f32_16x16x32_bf16 v[32:35], a[152:155], a[88:91], v[32:35]
v_exp_f32 v7, v29
v_mfma_f32_16x16x32_bf16 v[32:35], a[156:159], a[92:95], v[32:35]
ds_read_b64_tr_b16 a[162:163], v20 offset:20480
v_cvt_pk_bf16_f32 v82, v6, v7
v_mfma_f32_16x16x32_bf16 v[212:215], a[176:179], v[60:63], v[212:215]
v_exp_f32 v8, v30
v_mfma_f32_16x16x32_bf16 v[212:215], a[180:183], v[64:67], v[212:215]
ds_read_b128 a[136:139], v18 offset:32768
v_mfma_f32_16x16x32_bf16 v[216:219], a[180:183], v[72:75], v[216:219]
v_exp_f32 v9, v31
v_mfma_f32_16x16x32_bf16 v[216:219], a[176:179], v[68:71], v[216:219]
buffer_load_dwordx4 v11, s[12:15], s41 offen offset:1024 lds
v_mfma_f32_16x16x32_bf16 v[28:31], a[144:147], a[96:99], v[244:247]
v_exp_f32 v6, v32
v_mfma_f32_16x16x32_bf16 v[28:31], a[148:151], a[100:103], v[28:31]
ds_read_b64_tr_b16 a[164:165], v20 offset:24576
v_cvt_pk_bf16_f32 v83, v8, v9
v_mfma_f32_16x16x32_bf16 v[28:31], a[152:155], a[104:107], v[28:31]
v_exp_f32 v7, v33
v_mfma_f32_16x16x32_bf16 v[28:31], a[156:159], a[108:111], v[28:31]
s_waitcnt lgkmcnt(8)
ds_read_b64_tr_b16 a[166:167], v20 offset:28672
v_cvt_pk_bf16_f32 v90, v6, v7
v_mfma_f32_16x16x32_bf16 v[220:223], a[184:187], v[44:47], v[220:223]
s_waitcnt lgkmcnt(6)
v_exp_f32 v8, v34
v_mfma_f32_16x16x32_bf16 v[220:223], a[188:191], v[48:51], v[220:223]
ds_read_b128 a[140:143], v19 offset:32768
v_mfma_f32_16x16x32_bf16 v[224:227], a[188:191], v[56:59], v[224:227]
v_exp_f32 v9, v35
v_mfma_f32_16x16x32_bf16 v[224:227], a[184:187], v[52:55], v[224:227]
v_mfma_f32_16x16x32_bf16 v[32:35], a[144:147], a[112:115], v[248:251]
v_exp_f32 v6, v28
v_mfma_f32_16x16x32_bf16 v[32:35], a[148:151], a[116:119], v[32:35]
ds_read_b64_tr_b16 a[168:169], v21 offset:16384
v_cvt_pk_bf16_f32 v91, v8, v9
v_mfma_f32_16x16x32_bf16 v[32:35], a[152:155], a[120:123], v[32:35]
v_exp_f32 v7, v29
v_mfma_f32_16x16x32_bf16 v[32:35], a[156:159], a[124:127], v[32:35]
ds_read_b64_tr_b16 a[170:171], v21 offset:20480
v_cvt_pk_bf16_f32 v98, v6, v7
v_mfma_f32_16x16x32_bf16 v[228:231], a[184:187], v[60:63], v[228:231]
v_exp_f32 v8, v30
v_mfma_f32_16x16x32_bf16 v[228:231], a[188:191], v[64:67], v[228:231]
ds_read_b128 a[144:147], v16 offset:36864
v_mfma_f32_16x16x32_bf16 v[232:235], a[188:191], v[72:75], v[232:235]
v_exp_f32 v9, v31
v_mfma_f32_16x16x32_bf16 v[232:235], a[184:187], v[68:71], v[232:235]
buffer_load_dwordx4 v12, s[12:15], s41 offen offset:2048 lds
v_smfmac_f32_16x16x64_bf16 a[44:47], a[48:51], v[68:75], v37
v_mfma_f32_16x16x32_bf16 v[28:31], a[128:131], a[64:67], v[236:239]
s_waitcnt lgkmcnt(9)
v_exp_f32 v6, v32
v_mfma_f32_16x16x32_bf16 v[28:31], a[132:135], a[68:71], v[28:31]
s_waitcnt lgkmcnt(6)
ds_read_b64_tr_b16 a[172:173], v21 offset:24576
v_cvt_pk_bf16_f32 v99, v8, v9
v_mfma_f32_16x16x32_bf16 v[28:31], a[136:139], a[72:75], v[28:31]
s_waitcnt lgkmcnt(4)
v_exp_f32 v7, v33
v_mfma_f32_16x16x32_bf16 v[28:31], a[140:143], a[76:79], v[28:31]
ds_read_b64_tr_b16 a[174:175], v21 offset:28672
v_cvt_pk_bf16_f32 v106, v6, v7
v_mfma_f32_16x16x32_bf16 v[108:111], a[160:163], v[76:79], v[108:111]
v_exp_f32 v8, v34
v_mfma_f32_16x16x32_bf16 v[108:111], a[164:167], v[80:83], v[108:111]
ds_read_b128 a[148:151], v17 offset:36864
v_mfma_f32_16x16x32_bf16 v[112:115], a[164:167], v[88:91], v[112:115]
v_exp_f32 v9, v35
v_mfma_f32_16x16x32_bf16 v[112:115], a[160:163], v[84:87], v[112:115]
v_mfma_f32_16x16x32_bf16 v[32:35], a[128:131], a[80:83], v[240:243]
v_exp_f32 v6, v28
v_mfma_f32_16x16x32_bf16 v[32:35], a[132:135], a[84:87], v[32:35]
ds_read_b64_tr_b16 a[176:177], v22 offset:16384
v_cvt_pk_bf16_f32 v107, v8, v9
v_mfma_f32_16x16x32_bf16 v[32:35], a[136:139], a[88:91], v[32:35]
v_exp_f32 v7, v29
v_mfma_f32_16x16x32_bf16 v[32:35], a[140:143], a[92:95], v[32:35]
ds_read_b64_tr_b16 a[178:179], v22 offset:20480
v_cvt_pk_bf16_f32 v44, v6, v7
v_mfma_f32_16x16x32_bf16 v[116:119], a[160:163], v[92:95], v[116:119]
v_exp_f32 v8, v30
v_mfma_f32_16x16x32_bf16 v[116:119], a[164:167], v[96:99], v[116:119]
ds_read_b128 a[152:155], v18 offset:36864
v_mfma_f32_16x16x32_bf16 v[120:123], a[164:167], v[104:107], v[120:123]
v_exp_f32 v9, v31
v_mfma_f32_16x16x32_bf16 v[120:123], a[160:163], v[100:103], v[120:123]
buffer_load_dwordx4 v13, s[12:15], s41 offen offset:3072 lds
v_mfma_f32_16x16x32_bf16 v[28:31], a[128:131], a[96:99], v[244:247]
s_add_u32 s41, s41, 16384
v_exp_f32 v6, v32
v_mfma_f32_16x16x32_bf16 v[28:31], a[132:135], a[100:103], v[28:31]
ds_read_b64_tr_b16 a[180:181], v22 offset:24576
v_cvt_pk_bf16_f32 v45, v8, v9
v_mfma_f32_16x16x32_bf16 v[28:31], a[136:139], a[104:107], v[28:31]
v_exp_f32 v7, v33
v_mfma_f32_16x16x32_bf16 v[28:31], a[140:143], a[108:111], v[28:31]
s_waitcnt lgkmcnt(8)
ds_read_b64_tr_b16 a[182:183], v22 offset:28672
v_cvt_pk_bf16_f32 v52, v6, v7
v_mfma_f32_16x16x32_bf16 v[124:127], a[168:171], v[76:79], v[124:127]
s_waitcnt lgkmcnt(6)
v_exp_f32 v8, v34
v_mfma_f32_16x16x32_bf16 v[124:127], a[172:175], v[80:83], v[124:127]
ds_read_b128 a[156:159], v19 offset:36864
v_mfma_f32_16x16x32_bf16 v[128:131], a[172:175], v[88:91], v[128:131]
v_exp_f32 v9, v35
v_mfma_f32_16x16x32_bf16 v[128:131], a[168:171], v[84:87], v[128:131]
v_mfma_f32_16x16x32_bf16 v[32:35], a[128:131], a[112:115], v[248:251]
v_exp_f32 v6, v28
v_mfma_f32_16x16x32_bf16 v[32:35], a[132:135], a[116:119], v[32:35]
ds_read_b64_tr_b16 a[184:185], v23 offset:16384
v_cvt_pk_bf16_f32 v53, v8, v9
v_mfma_f32_16x16x32_bf16 v[32:35], a[136:139], a[120:123], v[32:35]
v_exp_f32 v7, v29
v_mfma_f32_16x16x32_bf16 v[32:35], a[140:143], a[124:127], v[32:35]
ds_read_b64_tr_b16 a[186:187], v23 offset:20480
v_cvt_pk_bf16_f32 v60, v6, v7
v_mfma_f32_16x16x32_bf16 v[132:135], a[168:171], v[92:95], v[132:135]
v_exp_f32 v8, v30
v_mfma_f32_16x16x32_bf16 v[132:135], a[172:175], v[96:99], v[132:135]
ds_read_b128 a[128:131], v16 offset:40960
v_mfma_f32_16x16x32_bf16 v[136:139], a[172:175], v[104:107], v[136:139]
s_add_u32 m0, s37, 114688
v_exp_f32 v9, v31
v_mfma_f32_16x16x32_bf16 v[136:139], a[168:171], v[100:103], v[136:139]
buffer_load_dwordx4 v14, s[16:19], s42 offen offset:0 lds
v_smfmac_f32_16x16x64_bf16 a[32:35], a[48:51], v[76:83], v37
v_mfma_f32_16x16x32_bf16 v[28:31], a[144:147], a[64:67], v[236:239]
s_waitcnt lgkmcnt(9)
v_exp_f32 v6, v32
v_mfma_f32_16x16x32_bf16 v[28:31], a[148:151], a[68:71], v[28:31]
s_waitcnt lgkmcnt(6)
ds_read_b64_tr_b16 a[188:189], v23 offset:24576
v_cvt_pk_bf16_f32 v61, v8, v9
v_mfma_f32_16x16x32_bf16 v[28:31], a[152:155], a[72:75], v[28:31]
s_waitcnt lgkmcnt(4)
v_exp_f32 v7, v33
v_mfma_f32_16x16x32_bf16 v[28:31], a[156:159], a[76:79], v[28:31]
ds_read_b64_tr_b16 a[190:191], v23 offset:28672
v_cvt_pk_bf16_f32 v68, v6, v7
v_mfma_f32_16x16x32_bf16 v[140:143], a[176:179], v[76:79], v[140:143]
v_exp_f32 v8, v34
v_mfma_f32_16x16x32_bf16 v[140:143], a[180:183], v[80:83], v[140:143]
ds_read_b128 a[132:135], v17 offset:40960
v_mfma_f32_16x16x32_bf16 v[144:147], a[180:183], v[88:91], v[144:147]
v_exp_f32 v9, v35
v_mfma_f32_16x16x32_bf16 v[144:147], a[176:179], v[84:87], v[144:147]
v_mfma_f32_16x16x32_bf16 v[32:35], a[144:147], a[80:83], v[240:243]
v_exp_f32 v6, v28
v_mfma_f32_16x16x32_bf16 v[32:35], a[148:151], a[84:87], v[32:35]
ds_read_b64_tr_b16 a[160:161], v24 offset:16384
v_cvt_pk_bf16_f32 v69, v8, v9
v_mfma_f32_16x16x32_bf16 v[32:35], a[152:155], a[88:91], v[32:35]
v_exp_f32 v7, v29
v_mfma_f32_16x16x32_bf16 v[32:35], a[156:159], a[92:95], v[32:35]
ds_read_b64_tr_b16 a[162:163], v24 offset:20480
v_cvt_pk_bf16_f32 v46, v6, v7
v_mfma_f32_16x16x32_bf16 v[148:151], a[176:179], v[92:95], v[148:151]
v_exp_f32 v8, v30
v_mfma_f32_16x16x32_bf16 v[148:151], a[180:183], v[96:99], v[148:151]
ds_read_b128 a[136:139], v18 offset:40960
v_mfma_f32_16x16x32_bf16 v[152:155], a[180:183], v[104:107], v[152:155]
v_exp_f32 v9, v31
v_mfma_f32_16x16x32_bf16 v[152:155], a[176:179], v[100:103], v[152:155]
buffer_load_dwordx4 v15, s[16:19], s42 offen offset:1024 lds
v_mfma_f32_16x16x32_bf16 v[28:31], a[144:147], a[96:99], v[244:247]
v_exp_f32 v6, v32
v_mfma_f32_16x16x32_bf16 v[28:31], a[148:151], a[100:103], v[28:31]
ds_read_b64_tr_b16 a[164:165], v24 offset:24576
v_cvt_pk_bf16_f32 v47, v8, v9
v_mfma_f32_16x16x32_bf16 v[28:31], a[152:155], a[104:107], v[28:31]
v_exp_f32 v7, v33
v_mfma_f32_16x16x32_bf16 v[28:31], a[156:159], a[108:111], v[28:31]
s_waitcnt lgkmcnt(8)
ds_read_b64_tr_b16 a[166:167], v24 offset:28672
v_cvt_pk_bf16_f32 v54, v6, v7
v_mfma_f32_16x16x32_bf16 v[156:159], a[184:187], v[76:79], v[156:159]
s_waitcnt lgkmcnt(6)
v_exp_f32 v8, v34
v_mfma_f32_16x16x32_bf16 v[156:159], a[188:191], v[80:83], v[156:159]
ds_read_b128 a[140:143], v19 offset:40960
v_mfma_f32_16x16x32_bf16 v[160:163], a[188:191], v[88:91], v[160:163]
v_exp_f32 v9, v35
v_mfma_f32_16x16x32_bf16 v[160:163], a[184:187], v[84:87], v[160:163]
v_mfma_f32_16x16x32_bf16 v[32:35], a[144:147], a[112:115], v[248:251]
v_exp_f32 v6, v28
v_mfma_f32_16x16x32_bf16 v[32:35], a[148:151], a[116:119], v[32:35]
ds_read_b64_tr_b16 a[168:169], v25 offset:16384
v_cvt_pk_bf16_f32 v55, v8, v9
v_mfma_f32_16x16x32_bf16 v[32:35], a[152:155], a[120:123], v[32:35]
v_exp_f32 v7, v29
v_mfma_f32_16x16x32_bf16 v[32:35], a[156:159], a[124:127], v[32:35]
ds_read_b64_tr_b16 a[170:171], v25 offset:20480
v_cvt_pk_bf16_f32 v62, v6, v7
v_mfma_f32_16x16x32_bf16 v[164:167], a[184:187], v[92:95], v[164:167]
v_exp_f32 v8, v30
v_mfma_f32_16x16x32_bf16 v[164:167], a[188:191], v[96:99], v[164:167]
ds_read_b128 a[144:147], v16 offset:45056
v_mfma_f32_16x16x32_bf16 v[168:171], a[188:191], v[104:107], v[168:171]
v_exp_f32 v9, v31
v_mfma_f32_16x16x32_bf16 v[168:171], a[184:187], v[100:103], v[168:171]
buffer_load_dwordx4 v14, s[16:19], s42 offen offset:2048 lds
v_smfmac_f32_16x16x64_bf16 a[36:39], a[48:51], v[84:91], v37
v_mfma_f32_16x16x32_bf16 v[28:31], a[128:131], a[64:67], v[236:239]
s_waitcnt lgkmcnt(9)
v_exp_f32 v6, v32
v_mfma_f32_16x16x32_bf16 v[28:31], a[132:135], a[68:71], v[28:31]
s_waitcnt lgkmcnt(6)
ds_read_b64_tr_b16 a[172:173], v25 offset:24576
v_cvt_pk_bf16_f32 v63, v8, v9
v_mfma_f32_16x16x32_bf16 v[28:31], a[136:139], a[72:75], v[28:31]
s_waitcnt lgkmcnt(4)
v_exp_f32 v7, v33
v_mfma_f32_16x16x32_bf16 v[28:31], a[140:143], a[76:79], v[28:31]
ds_read_b64_tr_b16 a[174:175], v25 offset:28672
v_cvt_pk_bf16_f32 v70, v6, v7
v_mfma_f32_16x16x32_bf16 v[172:175], a[160:163], v[76:79], v[172:175]
v_exp_f32 v8, v34
v_mfma_f32_16x16x32_bf16 v[172:175], a[164:167], v[80:83], v[172:175]
ds_read_b128 a[148:151], v17 offset:45056
v_mfma_f32_16x16x32_bf16 v[176:179], a[164:167], v[88:91], v[176:179]
v_exp_f32 v9, v35
v_mfma_f32_16x16x32_bf16 v[176:179], a[160:163], v[84:87], v[176:179]
v_mfma_f32_16x16x32_bf16 v[32:35], a[128:131], a[80:83], v[240:243]
v_exp_f32 v6, v28
v_mfma_f32_16x16x32_bf16 v[32:35], a[132:135], a[84:87], v[32:35]
ds_read_b64_tr_b16 a[176:177], v26 offset:16384
v_cvt_pk_bf16_f32 v71, v8, v9
v_mfma_f32_16x16x32_bf16 v[32:35], a[136:139], a[88:91], v[32:35]
v_exp_f32 v7, v29
v_mfma_f32_16x16x32_bf16 v[32:35], a[140:143], a[92:95], v[32:35]
ds_read_b64_tr_b16 a[178:179], v26 offset:20480
v_cvt_pk_bf16_f32 v48, v6, v7
v_mfma_f32_16x16x32_bf16 v[180:183], a[160:163], v[92:95], v[180:183]
v_exp_f32 v8, v30
v_mfma_f32_16x16x32_bf16 v[180:183], a[164:167], v[96:99], v[180:183]
ds_read_b128 a[152:155], v18 offset:45056
v_mfma_f32_16x16x32_bf16 v[184:187], a[164:167], v[104:107], v[184:187]
v_exp_f32 v9, v31
v_mfma_f32_16x16x32_bf16 v[184:187], a[160:163], v[100:103], v[184:187]
buffer_load_dwordx4 v15, s[16:19], s42 offen offset:3072 lds
v_mfma_f32_16x16x32_bf16 v[28:31], a[128:131], a[96:99], v[244:247]
s_add_u32 s42, s42, 16384
v_exp_f32 v6, v32
v_mfma_f32_16x16x32_bf16 v[28:31], a[132:135], a[100:103], v[28:31]
ds_read_b64_tr_b16 a[180:181], v26 offset:24576
v_cvt_pk_bf16_f32 v49, v8, v9
v_mfma_f32_16x16x32_bf16 v[28:31], a[136:139], a[104:107], v[28:31]
v_exp_f32 v7, v33
v_mfma_f32_16x16x32_bf16 v[28:31], a[140:143], a[108:111], v[28:31]
s_waitcnt lgkmcnt(8)
ds_read_b64_tr_b16 a[182:183], v26 offset:28672
v_cvt_pk_bf16_f32 v56, v6, v7
v_mfma_f32_16x16x32_bf16 v[188:191], a[168:171], v[76:79], v[188:191]
s_waitcnt lgkmcnt(6)
v_exp_f32 v8, v34
v_mfma_f32_16x16x32_bf16 v[188:191], a[172:175], v[80:83], v[188:191]
ds_read_b128 a[156:159], v19 offset:45056
v_mfma_f32_16x16x32_bf16 v[192:195], a[172:175], v[88:91], v[192:195]
v_exp_f32 v9, v35
v_mfma_f32_16x16x32_bf16 v[192:195], a[168:171], v[84:87], v[192:195]
s_waitcnt vmcnt(8)
s_barrier
v_mfma_f32_16x16x32_bf16 v[32:35], a[128:131], a[112:115], v[248:251]
v_exp_f32 v6, v28
v_mfma_f32_16x16x32_bf16 v[32:35], a[132:135], a[116:119], v[32:35]
ds_read_b64_tr_b16 a[184:185], v27 offset:16384
v_cvt_pk_bf16_f32 v57, v8, v9
v_mfma_f32_16x16x32_bf16 v[32:35], a[136:139], a[120:123], v[32:35]
v_exp_f32 v7, v29
v_mfma_f32_16x16x32_bf16 v[32:35], a[140:143], a[124:127], v[32:35]
ds_read_b64_tr_b16 a[186:187], v27 offset:20480
v_cvt_pk_bf16_f32 v64, v6, v7
v_mfma_f32_16x16x32_bf16 v[196:199], a[168:171], v[92:95], v[196:199]
v_exp_f32 v8, v30
v_mfma_f32_16x16x32_bf16 v[196:199], a[172:175], v[96:99], v[196:199]
ds_read_b128 a[128:131], v16 offset:49152
v_mfma_f32_16x16x32_bf16 v[200:203], a[172:175], v[104:107], v[200:203]
s_add_u32 m0, s37, 16384
v_exp_f32 v9, v31
v_mfma_f32_16x16x32_bf16 v[200:203], a[168:171], v[100:103], v[200:203]
buffer_load_dwordx4 v10, s[12:15], s41 offen offset:0 lds
v_smfmac_f32_16x16x64_bf16 a[40:43], a[48:51], v[92:99], v37
v_mfma_f32_16x16x32_bf16 v[28:31], a[144:147], a[64:67], v[236:239]
s_waitcnt lgkmcnt(9)
v_exp_f32 v6, v32
v_mfma_f32_16x16x32_bf16 v[28:31], a[148:151], a[68:71], v[28:31]
s_waitcnt lgkmcnt(6)
ds_read_b64_tr_b16 a[188:189], v27 offset:24576
v_cvt_pk_bf16_f32 v65, v8, v9
v_mfma_f32_16x16x32_bf16 v[28:31], a[152:155], a[72:75], v[28:31]
s_waitcnt lgkmcnt(4)
v_exp_f32 v7, v33
v_mfma_f32_16x16x32_bf16 v[28:31], a[156:159], a[76:79], v[28:31]
ds_read_b64_tr_b16 a[190:191], v27 offset:28672
v_cvt_pk_bf16_f32 v72, v6, v7
v_mfma_f32_16x16x32_bf16 v[204:207], a[176:179], v[76:79], v[204:207]
v_exp_f32 v8, v34
v_mfma_f32_16x16x32_bf16 v[204:207], a[180:183], v[80:83], v[204:207]
ds_read_b128 a[132:135], v17 offset:49152
v_mfma_f32_16x16x32_bf16 v[208:211], a[180:183], v[88:91], v[208:211]
v_exp_f32 v9, v35
v_mfma_f32_16x16x32_bf16 v[208:211], a[176:179], v[84:87], v[208:211]
v_mfma_f32_16x16x32_bf16 v[32:35], a[144:147], a[80:83], v[240:243]
v_exp_f32 v6, v28
v_mfma_f32_16x16x32_bf16 v[32:35], a[148:151], a[84:87], v[32:35]
ds_read_b64_tr_b16 a[160:161], v20 offset:32768
v_cvt_pk_bf16_f32 v73, v8, v9
v_mfma_f32_16x16x32_bf16 v[32:35], a[152:155], a[88:91], v[32:35]
v_exp_f32 v7, v29
v_mfma_f32_16x16x32_bf16 v[32:35], a[156:159], a[92:95], v[32:35]
ds_read_b64_tr_b16 a[162:163], v20 offset:36864
v_cvt_pk_bf16_f32 v50, v6, v7
v_mfma_f32_16x16x32_bf16 v[212:215], a[176:179], v[92:95], v[212:215]
v_exp_f32 v8, v30
v_mfma_f32_16x16x32_bf16 v[212:215], a[180:183], v[96:99], v[212:215]
ds_read_b128 a[136:139], v18 offset:49152
v_mfma_f32_16x16x32_bf16 v[216:219], a[180:183], v[104:107], v[216:219]
v_exp_f32 v9, v31
v_mfma_f32_16x16x32_bf16 v[216:219], a[176:179], v[100:103], v[216:219]
buffer_load_dwordx4 v11, s[12:15], s41 offen offset:1024 lds
v_mfma_f32_16x16x32_bf16 v[28:31], a[144:147], a[96:99], v[244:247]
v_exp_f32 v6, v32
v_mfma_f32_16x16x32_bf16 v[28:31], a[148:151], a[100:103], v[28:31]
ds_read_b64_tr_b16 a[164:165], v20 offset:40960
v_cvt_pk_bf16_f32 v51, v8, v9
v_mfma_f32_16x16x32_bf16 v[28:31], a[152:155], a[104:107], v[28:31]
v_exp_f32 v7, v33
v_mfma_f32_16x16x32_bf16 v[28:31], a[156:159], a[108:111], v[28:31]
s_waitcnt lgkmcnt(8)
ds_read_b64_tr_b16 a[166:167], v20 offset:45056
v_cvt_pk_bf16_f32 v58, v6, v7
v_mfma_f32_16x16x32_bf16 v[220:223], a[184:187], v[76:79], v[220:223]
s_waitcnt lgkmcnt(6)
v_exp_f32 v8, v34
v_mfma_f32_16x16x32_bf16 v[220:223], a[188:191], v[80:83], v[220:223]
ds_read_b128 a[140:143], v19 offset:49152
v_mfma_f32_16x16x32_bf16 v[224:227], a[188:191], v[88:91], v[224:227]
v_exp_f32 v9, v35
v_mfma_f32_16x16x32_bf16 v[224:227], a[184:187], v[84:87], v[224:227]
v_mfma_f32_16x16x32_bf16 v[32:35], a[144:147], a[112:115], v[248:251]
v_exp_f32 v6, v28
v_mfma_f32_16x16x32_bf16 v[32:35], a[148:151], a[116:119], v[32:35]
ds_read_b64_tr_b16 a[168:169], v21 offset:32768
v_cvt_pk_bf16_f32 v59, v8, v9
v_mfma_f32_16x16x32_bf16 v[32:35], a[152:155], a[120:123], v[32:35]
v_exp_f32 v7, v29
v_mfma_f32_16x16x32_bf16 v[32:35], a[156:159], a[124:127], v[32:35]
ds_read_b64_tr_b16 a[170:171], v21 offset:36864
v_cvt_pk_bf16_f32 v66, v6, v7
v_mfma_f32_16x16x32_bf16 v[228:231], a[184:187], v[92:95], v[228:231]
v_exp_f32 v8, v30
v_mfma_f32_16x16x32_bf16 v[228:231], a[188:191], v[96:99], v[228:231]
ds_read_b128 a[144:147], v16 offset:53248
v_mfma_f32_16x16x32_bf16 v[232:235], a[188:191], v[104:107], v[232:235]
v_exp_f32 v9, v31
v_mfma_f32_16x16x32_bf16 v[232:235], a[184:187], v[100:103], v[232:235]
buffer_load_dwordx4 v12, s[12:15], s41 offen offset:2048 lds
v_smfmac_f32_16x16x64_bf16 a[44:47], a[48:51], v[100:107], v37
s_bitcmp1_b32 s40, s38
s_cbranch_scc1 L2_ra
L2_ra_r:
v_mfma_f32_16x16x32_bf16 v[28:31], a[128:131], a[64:67], v[236:239]
s_waitcnt lgkmcnt(9)
v_exp_f32 v6, v32
v_mfma_f32_16x16x32_bf16 v[28:31], a[132:135], a[68:71], v[28:31]
s_waitcnt lgkmcnt(6)
ds_read_b64_tr_b16 a[172:173], v21 offset:40960
v_cvt_pk_bf16_f32 v67, v8, v9
v_mfma_f32_16x16x32_bf16 v[28:31], a[136:139], a[72:75], v[28:31]
s_waitcnt lgkmcnt(4)
v_exp_f32 v7, v33
v_mfma_f32_16x16x32_bf16 v[28:31], a[140:143], a[76:79], v[28:31]
ds_read_b64_tr_b16 a[174:175], v21 offset:45056
v_cvt_pk_bf16_f32 v74, v6, v7
v_mfma_f32_16x16x32_bf16 v[108:111], a[160:163], v[44:47], v[108:111]
v_exp_f32 v8, v34
v_mfma_f32_16x16x32_bf16 v[108:111], a[164:167], v[48:51], v[108:111]
ds_read_b128 a[148:151], v17 offset:53248
v_mfma_f32_16x16x32_bf16 v[112:115], a[164:167], v[56:59], v[112:115]
v_exp_f32 v9, v35
v_mfma_f32_16x16x32_bf16 v[112:115], a[160:163], v[52:55], v[112:115]
v_mfma_f32_16x16x32_bf16 v[32:35], a[128:131], a[80:83], v[240:243]
v_exp_f32 v6, v28
v_mfma_f32_16x16x32_bf16 v[32:35], a[132:135], a[84:87], v[32:35]
ds_read_b64_tr_b16 a[176:177], v22 offset:32768
v_cvt_pk_bf16_f32 v75, v8, v9
v_mfma_f32_16x16x32_bf16 v[32:35], a[136:139], a[88:91], v[32:35]
v_exp_f32 v7, v29
v_mfma_f32_16x16x32_bf16 v[32:35], a[140:143], a[92:95], v[32:35]
ds_read_b64_tr_b16 a[178:179], v22 offset:36864
v_cvt_pk_bf16_f32 v76, v6, v7
v_mfma_f32_16x16x32_bf16 v[116:119], a[160:163], v[60:63], v[116:119]
v_exp_f32 v8, v30
v_mfma_f32_16x16x32_bf16 v[116:119], a[164:167], v[64:67], v[116:119]
ds_read_b128 a[152:155], v18 offset:53248
v_mfma_f32_16x16x32_bf16 v[120:123], a[164:167], v[72:75], v[120:123]
v_exp_f32 v9, v31
v_mfma_f32_16x16x32_bf16 v[120:123], a[160:163], v[68:71], v[120:123]
buffer_load_dwordx4 v13, s[12:15], s41 offen offset:3072 lds
v_mfma_f32_16x16x32_bf16 v[28:31], a[128:131], a[96:99], v[244:247]
s_add_u32 s41, s41, 16384
v_exp_f32 v6, v32
v_mfma_f32_16x16x32_bf16 v[28:31], a[132:135], a[100:103], v[28:31]
ds_read_b64_tr_b16 a[180:181], v22 offset:40960
v_cvt_pk_bf16_f32 v77, v8, v9
v_mfma_f32_16x16x32_bf16 v[28:31], a[136:139], a[104:107], v[28:31]
v_exp_f32 v7, v33
v_mfma_f32_16x16x32_bf16 v[28:31], a[140:143], a[108:111], v[28:31]
s_waitcnt lgkmcnt(8)
ds_read_b64_tr_b16 a[182:183], v22 offset:45056
v_cvt_pk_bf16_f32 v84, v6, v7
v_mfma_f32_16x16x32_bf16 v[124:127], a[168:171], v[44:47], v[124:127]
s_waitcnt lgkmcnt(6)
v_exp_f32 v8, v34
v_mfma_f32_16x16x32_bf16 v[124:127], a[172:175], v[48:51], v[124:127]
ds_read_b128 a[156:159], v19 offset:53248
v_mfma_f32_16x16x32_bf16 v[128:131], a[172:175], v[56:59], v[128:131]
v_exp_f32 v9, v35
v_mfma_f32_16x16x32_bf16 v[128:131], a[168:171], v[52:55], v[128:131]
global_load_dword a60, v42, s[56:57]
v_mfma_f32_16x16x32_bf16 v[32:35], a[128:131], a[112:115], v[248:251]
v_exp_f32 v6, v28
v_mfma_f32_16x16x32_bf16 v[32:35], a[132:135], a[116:119], v[32:35]
ds_read_b64_tr_b16 a[184:185], v23 offset:32768
v_cvt_pk_bf16_f32 v85, v8, v9
v_mfma_f32_16x16x32_bf16 v[32:35], a[136:139], a[120:123], v[32:35]
v_exp_f32 v7, v29
v_mfma_f32_16x16x32_bf16 v[32:35], a[140:143], a[124:127], v[32:35]
ds_read_b64_tr_b16 a[186:187], v23 offset:36864
v_cvt_pk_bf16_f32 v92, v6, v7
v_mfma_f32_16x16x32_bf16 v[132:135], a[168:171], v[60:63], v[132:135]
v_exp_f32 v8, v30
v_mfma_f32_16x16x32_bf16 v[132:135], a[172:175], v[64:67], v[132:135]
ds_read_b128 a[128:131], v16 offset:57344
v_mfma_f32_16x16x32_bf16 v[136:139], a[172:175], v[72:75], v[136:139]
s_add_u32 m0, s37, 65536
v_exp_f32 v9, v31
v_mfma_f32_16x16x32_bf16 v[136:139], a[168:171], v[68:71], v[136:139]
buffer_load_dwordx4 v14, s[16:19], s42 offen offset:0 lds
v_smfmac_f32_16x16x64_bf16 a[32:35], a[48:51], v[44:51], v37
v_mfma_f32_16x16x32_bf16 v[28:31], a[144:147], a[64:67], v[236:239]
s_waitcnt lgkmcnt(9)
v_exp_f32 v6, v32
v_mfma_f32_16x16x32_bf16 v[28:31], a[148:151], a[68:71], v[28:31]
s_waitcnt lgkmcnt(6)
ds_read_b64_tr_b16 a[188:189], v23 offset:40960
v_cvt_pk_bf16_f32 v93, v8, v9
v_mfma_f32_16x16x32_bf16 v[28:31], a[152:155], a[72:75], v[28:31]
s_waitcnt lgkmcnt(4)
v_exp_f32 v7, v33
v_mfma_f32_16x16x32_bf16 v[28:31], a[156:159], a[76:79], v[28:31]
ds_read_b64_tr_b16 a[190:191], v23 offset:45056
v_cvt_pk_bf16_f32 v100, v6, v7
v_mfma_f32_16x16x32_bf16 v[140:143], a[176:179], v[44:47], v[140:143]
v_exp_f32 v8, v34
v_mfma_f32_16x16x32_bf16 v[140:143], a[180:183], v[48:51], v[140:143]
ds_read_b128 a[132:135], v17 offset:57344
v_mfma_f32_16x16x32_bf16 v[144:147], a[180:183], v[56:59], v[144:147]
v_exp_f32 v9, v35
v_mfma_f32_16x16x32_bf16 v[144:147], a[176:179], v[52:55], v[144:147]
v_mfma_f32_16x16x32_bf16 v[32:35], a[144:147], a[80:83], v[240:243]
v_exp_f32 v6, v28
v_mfma_f32_16x16x32_bf16 v[32:35], a[148:151], a[84:87], v[32:35]
ds_read_b64_tr_b16 a[160:161], v24 offset:32768
v_cvt_pk_bf16_f32 v101, v8, v9
v_mfma_f32_16x16x32_bf16 v[32:35], a[152:155], a[88:91], v[32:35]
v_exp_f32 v7, v29
v_mfma_f32_16x16x32_bf16 v[32:35], a[156:159], a[92:95], v[32:35]
ds_read_b64_tr_b16 a[162:163], v24 offset:36864
v_cvt_pk_bf16_f32 v78, v6, v7
v_mfma_f32_16x16x32_bf16 v[148:151], a[176:179], v[60:63], v[148:151]
v_exp_f32 v8, v30
v_mfma_f32_16x16x32_bf16 v[148:151], a[180:183], v[64:67], v[148:151]
ds_read_b128 a[136:139], v18 offset:57344
v_mfma_f32_16x16x32_bf16 v[152:155], a[180:183], v[72:75], v[152:155]
v_exp_f32 v9, v31
v_mfma_f32_16x16x32_bf16 v[152:155], a[176:179], v[68:71], v[152:155]
buffer_load_dwordx4 v15, s[16:19], s42 offen offset:1024 lds
v_mfma_f32_16x16x32_bf16 v[28:31], a[144:147], a[96:99], v[244:247]
v_exp_f32 v6, v32
v_mfma_f32_16x16x32_bf16 v[28:31], a[148:151], a[100:103], v[28:31]
ds_read_b64_tr_b16 a[164:165], v24 offset:40960
v_cvt_pk_bf16_f32 v79, v8, v9
v_mfma_f32_16x16x32_bf16 v[28:31], a[152:155], a[104:107], v[28:31]
v_exp_f32 v7, v33
v_mfma_f32_16x16x32_bf16 v[28:31], a[156:159], a[108:111], v[28:31]
s_waitcnt lgkmcnt(8)
ds_read_b64_tr_b16 a[166:167], v24 offset:45056
v_cvt_pk_bf16_f32 v86, v6, v7
v_mfma_f32_16x16x32_bf16 v[156:159], a[184:187], v[44:47], v[156:159]
s_waitcnt lgkmcnt(6)
v_exp_f32 v8, v34
v_mfma_f32_16x16x32_bf16 v[156:159], a[188:191], v[48:51], v[156:159]
ds_read_b128 a[140:143], v19 offset:57344
v_mfma_f32_16x16x32_bf16 v[160:163], a[188:191], v[56:59], v[160:163]
v_exp_f32 v9, v35
v_mfma_f32_16x16x32_bf16 v[160:163], a[184:187], v[52:55], v[160:163]
v_mfma_f32_16x16x32_bf16 v[32:35], a[144:147], a[112:115], v[248:251]
v_exp_f32 v6, v28
v_mfma_f32_16x16x32_bf16 v[32:35], a[148:151], a[116:119], v[32:35]
ds_read_b64_tr_b16 a[168:169], v25 offset:32768
v_cvt_pk_bf16_f32 v87, v8, v9
v_mfma_f32_16x16x32_bf16 v[32:35], a[152:155], a[120:123], v[32:35]
v_exp_f32 v7, v29
v_mfma_f32_16x16x32_bf16 v[32:35], a[156:159], a[124:127], v[32:35]
ds_read_b64_tr_b16 a[170:171], v25 offset:36864
v_cvt_pk_bf16_f32 v94, v6, v7
v_mfma_f32_16x16x32_bf16 v[164:167], a[184:187], v[60:63], v[164:167]
v_exp_f32 v8, v30
v_mfma_f32_16x16x32_bf16 v[164:167], a[188:191], v[64:67], v[164:167]
ds_read_b128 a[144:147], v16 offset:61440
v_mfma_f32_16x16x32_bf16 v[168:171], a[188:191], v[72:75], v[168:171]
v_exp_f32 v9, v31
v_mfma_f32_16x16x32_bf16 v[168:171], a[184:187], v[68:71], v[168:171]
buffer_load_dwordx4 v14, s[16:19], s42 offen offset:2048 lds
v_smfmac_f32_16x16x64_bf16 a[36:39], a[48:51], v[52:59], v37
v_mfma_f32_16x16x32_bf16 v[28:31], a[128:131], a[64:67], v[236:239]
s_waitcnt lgkmcnt(9)
v_exp_f32 v6, v32
v_mfma_f32_16x16x32_bf16 v[28:31], a[132:135], a[68:71], v[28:31]
s_waitcnt lgkmcnt(6)
ds_read_b64_tr_b16 a[172:173], v25 offset:40960
v_cvt_pk_bf16_f32 v95, v8, v9
v_mfma_f32_16x16x32_bf16 v[28:31], a[136:139], a[72:75], v[28:31]
s_waitcnt lgkmcnt(4)
v_exp_f32 v7, v33
v_mfma_f32_16x16x32_bf16 v[28:31], a[140:143], a[76:79], v[28:31]
ds_read_b64_tr_b16 a[174:175], v25 offset:45056
v_cvt_pk_bf16_f32 v102, v6, v7
v_mfma_f32_16x16x32_bf16 v[172:175], a[160:163], v[44:47], v[172:175]
v_exp_f32 v8, v34
v_mfma_f32_16x16x32_bf16 v[172:175], a[164:167], v[48:51], v[172:175]
ds_read_b128 a[148:151], v17 offset:61440
v_mfma_f32_16x16x32_bf16 v[176:179], a[164:167], v[56:59], v[176:179]
v_exp_f32 v9, v35
v_mfma_f32_16x16x32_bf16 v[176:179], a[160:163], v[52:55], v[176:179]
v_mfma_f32_16x16x32_bf16 v[32:35], a[128:131], a[80:83], v[240:243]
v_exp_f32 v6, v28
v_mfma_f32_16x16x32_bf16 v[32:35], a[132:135], a[84:87], v[32:35]
ds_read_b64_tr_b16 a[176:177], v26 offset:32768
v_cvt_pk_bf16_f32 v103, v8, v9
v_mfma_f32_16x16x32_bf16 v[32:35], a[136:139], a[88:91], v[32:35]
v_exp_f32 v7, v29
v_mfma_f32_16x16x32_bf16 v[32:35], a[140:143], a[92:95], v[32:35]
ds_read_b64_tr_b16 a[178:179], v26 offset:36864
v_cvt_pk_bf16_f32 v80, v6, v7
v_mfma_f32_16x16x32_bf16 v[180:183], a[160:163], v[60:63], v[180:183]
v_exp_f32 v8, v30
v_mfma_f32_16x16x32_bf16 v[180:183], a[164:167], v[64:67], v[180:183]
ds_read_b128 a[152:155], v18 offset:61440
v_mfma_f32_16x16x32_bf16 v[184:187], a[164:167], v[72:75], v[184:187]
v_exp_f32 v9, v31
v_mfma_f32_16x16x32_bf16 v[184:187], a[160:163], v[68:71], v[184:187]
buffer_load_dwordx4 v15, s[16:19], s42 offen offset:3072 lds
v_mfma_f32_16x16x32_bf16 v[28:31], a[128:131], a[96:99], v[244:247]
s_add_u32 s42, s42, 16384
v_exp_f32 v6, v32
v_mfma_f32_16x16x32_bf16 v[28:31], a[132:135], a[100:103], v[28:31]
ds_read_b64_tr_b16 a[180:181], v26 offset:40960
v_cvt_pk_bf16_f32 v81, v8, v9
v_mfma_f32_16x16x32_bf16 v[28:31], a[136:139], a[104:107], v[28:31]
v_exp_f32 v7, v33
v_mfma_f32_16x16x32_bf16 v[28:31], a[140:143], a[108:111], v[28:31]
s_waitcnt lgkmcnt(8)
ds_read_b64_tr_b16 a[182:183], v26 offset:45056
v_cvt_pk_bf16_f32 v88, v6, v7
v_mfma_f32_16x16x32_bf16 v[188:191], a[168:171], v[44:47], v[188:191]
s_waitcnt lgkmcnt(6)
v_exp_f32 v8, v34
v_mfma_f32_16x16x32_bf16 v[188:191], a[172:175], v[48:51], v[188:191]
ds_read_b128 a[156:159], v19 offset:61440
v_mfma_f32_16x16x32_bf16 v[192:195], a[172:175], v[56:59], v[192:195]
v_exp_f32 v9, v35
v_mfma_f32_16x16x32_bf16 v[192:195], a[168:171], v[52:55], v[192:195]
s_waitcnt vmcnt(9)
s_barrier
v_mfma_f32_16x16x32_bf16 v[32:35], a[128:131], a[112:115], v[248:251]
v_exp_f32 v6, v28
v_mfma_f32_16x16x32_bf16 v[32:35], a[132:135], a[116:119], v[32:35]
ds_read_b64_tr_b16 a[184:185], v27 offset:32768
v_cvt_pk_bf16_f32 v89, v8, v9
v_mfma_f32_16x16x32_bf16 v[32:35], a[136:139], a[120:123], v[32:35]
v_exp_f32 v7, v29
v_mfma_f32_16x16x32_bf16 v[32:35], a[140:143], a[124:127], v[32:35]
ds_read_b64_tr_b16 a[186:187], v27 offset:36864
v_cvt_pk_bf16_f32 v96, v6, v7
v_mfma_f32_16x16x32_bf16 v[196:199], a[168:171], v[60:63], v[196:199]
v_exp_f32 v8, v30
v_mfma_f32_16x16x32_bf16 v[196:199], a[172:175], v[64:67], v[196:199]
ds_read_b128 a[128:131], v16 offset:0
v_mfma_f32_16x16x32_bf16 v[200:203], a[172:175], v[72:75], v[200:203]
s_add_u32 m0, s37, 32768
v_exp_f32 v9, v31
v_mfma_f32_16x16x32_bf16 v[200:203], a[168:171], v[68:71], v[200:203]
buffer_load_dwordx4 v10, s[12:15], s41 offen offset:0 lds
v_smfmac_f32_16x16x64_bf16 a[40:43], a[48:51], v[60:67], v37
v_mfma_f32_16x16x32_bf16 v[28:31], a[144:147], a[64:67], v[236:239]
s_waitcnt lgkmcnt(9)
v_exp_f32 v6, v32
v_mfma_f32_16x16x32_bf16 v[28:31], a[148:151], a[68:71], v[28:31]
s_waitcnt lgkmcnt(6)
ds_read_b64_tr_b16 a[188:189], v27 offset:40960
v_cvt_pk_bf16_f32 v97, v8, v9
v_mfma_f32_16x16x32_bf16 v[28:31], a[152:155], a[72:75], v[28:31]
s_waitcnt lgkmcnt(4)
v_exp_f32 v7, v33
v_mfma_f32_16x16x32_bf16 v[28:31], a[156:159], a[76:79], v[28:31]
ds_read_b64_tr_b16 a[190:191], v27 offset:45056
v_cvt_pk_bf16_f32 v104, v6, v7
v_mfma_f32_16x16x32_bf16 v[204:207], a[176:179], v[44:47], v[204:207]
v_exp_f32 v8, v34
v_mfma_f32_16x16x32_bf16 v[204:207], a[180:183], v[48:51], v[204:207]
ds_read_b128 a[132:135], v17 offset:0
v_mfma_f32_16x16x32_bf16 v[208:211], a[180:183], v[56:59], v[208:211]
v_exp_f32 v9, v35
v_mfma_f32_16x16x32_bf16 v[208:211], a[176:179], v[52:55], v[208:211]
v_mfma_f32_16x16x32_bf16 v[32:35], a[144:147], a[80:83], v[240:243]
v_exp_f32 v6, v28
v_mfma_f32_16x16x32_bf16 v[32:35], a[148:151], a[84:87], v[32:35]
ds_read_b64_tr_b16 a[160:161], v20 offset:49152
v_cvt_pk_bf16_f32 v105, v8, v9
v_mfma_f32_16x16x32_bf16 v[32:35], a[152:155], a[88:91], v[32:35]
v_exp_f32 v7, v29
v_mfma_f32_16x16x32_bf16 v[32:35], a[156:159], a[92:95], v[32:35]
ds_read_b64_tr_b16 a[162:163], v20 offset:53248
v_cvt_pk_bf16_f32 v82, v6, v7
v_mfma_f32_16x16x32_bf16 v[212:215], a[176:179], v[60:63], v[212:215]
v_exp_f32 v8, v30
v_mfma_f32_16x16x32_bf16 v[212:215], a[180:183], v[64:67], v[212:215]
ds_read_b128 a[136:139], v18 offset:0
v_mfma_f32_16x16x32_bf16 v[216:219], a[180:183], v[72:75], v[216:219]
v_exp_f32 v9, v31
v_mfma_f32_16x16x32_bf16 v[216:219], a[176:179], v[68:71], v[216:219]
buffer_load_dwordx4 v11, s[12:15], s41 offen offset:1024 lds
v_mfma_f32_16x16x32_bf16 v[28:31], a[144:147], a[96:99], v[244:247]
v_exp_f32 v6, v32
v_mfma_f32_16x16x32_bf16 v[28:31], a[148:151], a[100:103], v[28:31]
ds_read_b64_tr_b16 a[164:165], v20 offset:57344
v_cvt_pk_bf16_f32 v83, v8, v9
v_mfma_f32_16x16x32_bf16 v[28:31], a[152:155], a[104:107], v[28:31]
v_exp_f32 v7, v33
v_mfma_f32_16x16x32_bf16 v[28:31], a[156:159], a[108:111], v[28:31]
s_waitcnt lgkmcnt(8)
ds_read_b64_tr_b16 a[166:167], v20 offset:61440
v_cvt_pk_bf16_f32 v90, v6, v7
v_mfma_f32_16x16x32_bf16 v[220:223], a[184:187], v[44:47], v[220:223]
s_waitcnt lgkmcnt(6)
v_exp_f32 v8, v34
v_mfma_f32_16x16x32_bf16 v[220:223], a[188:191], v[48:51], v[220:223]
ds_read_b128 a[140:143], v19 offset:0
v_mfma_f32_16x16x32_bf16 v[224:227], a[188:191], v[56:59], v[224:227]
v_exp_f32 v9, v35
v_mfma_f32_16x16x32_bf16 v[224:227], a[184:187], v[52:55], v[224:227]
v_mfma_f32_16x16x32_bf16 v[32:35], a[144:147], a[112:115], v[248:251]
v_exp_f32 v6, v28
v_mfma_f32_16x16x32_bf16 v[32:35], a[148:151], a[116:119], v[32:35]
ds_read_b64_tr_b16 a[168:169], v21 offset:49152
v_cvt_pk_bf16_f32 v91, v8, v9
v_mfma_f32_16x16x32_bf16 v[32:35], a[152:155], a[120:123], v[32:35]
v_exp_f32 v7, v29
v_mfma_f32_16x16x32_bf16 v[32:35], a[156:159], a[124:127], v[32:35]
ds_read_b64_tr_b16 a[170:171], v21 offset:53248
v_cvt_pk_bf16_f32 v98, v6, v7
v_mfma_f32_16x16x32_bf16 v[228:231], a[184:187], v[60:63], v[228:231]
v_exp_f32 v8, v30
v_mfma_f32_16x16x32_bf16 v[228:231], a[188:191], v[64:67], v[228:231]
ds_read_b128 a[144:147], v16 offset:4096
v_mfma_f32_16x16x32_bf16 v[232:235], a[188:191], v[72:75], v[232:235]
v_exp_f32 v9, v31
v_mfma_f32_16x16x32_bf16 v[232:235], a[184:187], v[68:71], v[232:235]
buffer_load_dwordx4 v12, s[12:15], s41 offen offset:2048 lds
v_smfmac_f32_16x16x64_bf16 a[44:47], a[48:51], v[68:75], v37
s_cmp_lg_u32 s3, 0
s_cbranch_scc1 L2_rb
L2_rb_r:
v_mfma_f32_16x16x32_bf16 v[28:31], a[128:131], a[64:67], v[236:239]
s_waitcnt lgkmcnt(9)
v_exp_f32 v6, v32
v_mfma_f32_16x16x32_bf16 v[28:31], a[132:135], a[68:71], v[28:31]
s_waitcnt lgkmcnt(6)
ds_read_b64_tr_b16 a[172:173], v21 offset:57344
v_cvt_pk_bf16_f32 v99, v8, v9
v_mfma_f32_16x16x32_bf16 v[28:31], a[136:139], a[72:75], v[28:31]
s_waitcnt lgkmcnt(4)
v_exp_f32 v7, v33
v_mfma_f32_16x16x32_bf16 v[28:31], a[140:143], a[76:79], v[28:31]
ds_read_b64_tr_b16 a[174:175], v21 offset:61440
v_cvt_pk_bf16_f32 v106, v6, v7
v_mfma_f32_16x16x32_bf16 v[108:111], a[160:163], v[76:79], v[108:111]
v_exp_f32 v8, v34
v_mfma_f32_16x16x32_bf16 v[108:111], a[164:167], v[80:83], v[108:111]
ds_read_b128 a[148:151], v17 offset:4096
v_mfma_f32_16x16x32_bf16 v[112:115], a[164:167], v[88:91], v[112:115]
v_exp_f32 v9, v35
v_mfma_f32_16x16x32_bf16 v[112:115], a[160:163], v[84:87], v[112:115]
v_mfma_f32_16x16x32_bf16 v[32:35], a[128:131], a[80:83], v[240:243]
v_exp_f32 v6, v28
v_mfma_f32_16x16x32_bf16 v[32:35], a[132:135], a[84:87], v[32:35]
ds_read_b64_tr_b16 a[176:177], v22 offset:49152
v_cvt_pk_bf16_f32 v107, v8, v9
v_mfma_f32_16x16x32_bf16 v[32:35], a[136:139], a[88:91], v[32:35]
v_exp_f32 v7, v29
v_mfma_f32_16x16x32_bf16 v[32:35], a[140:143], a[92:95], v[32:35]
ds_read_b64_tr_b16 a[178:179], v22 offset:53248
v_cvt_pk_bf16_f32 v44, v6, v7
v_mfma_f32_16x16x32_bf16 v[116:119], a[160:163], v[92:95], v[116:119]
v_exp_f32 v8, v30
v_mfma_f32_16x16x32_bf16 v[116:119], a[164:167], v[96:99], v[116:119]
ds_read_b128 a[152:155], v18 offset:4096
v_mfma_f32_16x16x32_bf16 v[120:123], a[164:167], v[104:107], v[120:123]
v_exp_f32 v9, v31
v_mfma_f32_16x16x32_bf16 v[120:123], a[160:163], v[100:103], v[120:123]
buffer_load_dwordx4 v13, s[12:15], s41 offen offset:3072 lds
v_mfma_f32_16x16x32_bf16 v[28:31], a[128:131], a[96:99], v[244:247]
s_add_u32 s41, s41, 16384
v_exp_f32 v6, v32
v_mfma_f32_16x16x32_bf16 v[28:31], a[132:135], a[100:103], v[28:31]
ds_read_b64_tr_b16 a[180:181], v22 offset:57344
v_cvt_pk_bf16_f32 v45, v8, v9
v_mfma_f32_16x16x32_bf16 v[28:31], a[136:139], a[104:107], v[28:31]
v_exp_f32 v7, v33
v_mfma_f32_16x16x32_bf16 v[28:31], a[140:143], a[108:111], v[28:31]
s_waitcnt lgkmcnt(8)
ds_read_b64_tr_b16 a[182:183], v22 offset:61440
v_cvt_pk_bf16_f32 v52, v6, v7
v_mfma_f32_16x16x32_bf16 v[124:127], a[168:171], v[76:79], v[124:127]
s_waitcnt lgkmcnt(6)
v_exp_f32 v8, v34
v_mfma_f32_16x16x32_bf16 v[124:127], a[172:175], v[80:83], v[124:127]
ds_read_b128 a[156:159], v19 offset:4096
v_mfma_f32_16x16x32_bf16 v[128:131], a[172:175], v[88:91], v[128:131]
v_exp_f32 v9, v35
v_mfma_f32_16x16x32_bf16 v[128:131], a[168:171], v[84:87], v[128:131]
v_mfma_f32_16x16x32_bf16 v[32:35], a[128:131], a[112:115], v[248:251]
v_exp_f32 v6, v28
v_mfma_f32_16x16x32_bf16 v[32:35], a[132:135], a[116:119], v[32:35]
ds_read_b64_tr_b16 a[184:185], v23 offset:49152
v_cvt_pk_bf16_f32 v53, v8, v9
v_mfma_f32_16x16x32_bf16 v[32:35], a[136:139], a[120:123], v[32:35]
v_exp_f32 v7, v29
v_mfma_f32_16x16x32_bf16 v[32:35], a[140:143], a[124:127], v[32:35]
ds_read_b64_tr_b16 a[186:187], v23 offset:53248
v_cvt_pk_bf16_f32 v60, v6, v7
v_mfma_f32_16x16x32_bf16 v[132:135], a[168:171], v[92:95], v[132:135]
v_exp_f32 v8, v30
v_mfma_f32_16x16x32_bf16 v[132:135], a[172:175], v[96:99], v[132:135]
ds_read_b128 a[128:131], v16 offset:8192
v_mfma_f32_16x16x32_bf16 v[136:139], a[172:175], v[104:107], v[136:139]
s_add_u32 m0, s37, 81920
v_exp_f32 v9, v31
v_mfma_f32_16x16x32_bf16 v[136:139], a[168:171], v[100:103], v[136:139]
buffer_load_dwordx4 v14, s[16:19], s42 offen offset:0 lds
v_smfmac_f32_16x16x64_bf16 a[32:35], a[48:51], v[76:83], v37
v_mfma_f32_16x16x32_bf16 v[28:31], a[144:147], a[64:67], v[236:239]
s_waitcnt lgkmcnt(9)
v_exp_f32 v6, v32
v_mfma_f32_16x16x32_bf16 v[28:31], a[148:151], a[68:71], v[28:31]
s_waitcnt lgkmcnt(6)
ds_read_b64_tr_b16 a[188:189], v23 offset:57344
v_cvt_pk_bf16_f32 v61, v8, v9
v_mfma_f32_16x16x32_bf16 v[28:31], a[152:155], a[72:75], v[28:31]
s_waitcnt lgkmcnt(4)
v_exp_f32 v7, v33
v_mfma_f32_16x16x32_bf16 v[28:31], a[156:159], a[76:79], v[28:31]
ds_read_b64_tr_b16 a[190:191], v23 offset:61440
v_cvt_pk_bf16_f32 v68, v6, v7
v_mfma_f32_16x16x32_bf16 v[140:143], a[176:179], v[76:79], v[140:143]
v_exp_f32 v8, v34
v_mfma_f32_16x16x32_bf16 v[140:143], a[180:183], v[80:83], v[140:143]
ds_read_b128 a[132:135], v17 offset:8192
v_mfma_f32_16x16x32_bf16 v[144:147], a[180:183], v[88:91], v[144:147]
v_exp_f32 v9, v35
v_mfma_f32_16x16x32_bf16 v[144:147], a[176:179], v[84:87], v[144:147]
v_mfma_f32_16x16x32_bf16 v[32:35], a[144:147], a[80:83], v[240:243]
v_exp_f32 v6, v28
v_mfma_f32_16x16x32_bf16 v[32:35], a[148:151], a[84:87], v[32:35]
ds_read_b64_tr_b16 a[160:161], v24 offset:49152
v_cvt_pk_bf16_f32 v69, v8, v9
v_mfma_f32_16x16x32_bf16 v[32:35], a[152:155], a[88:91], v[32:35]
v_exp_f32 v7, v29
v_mfma_f32_16x16x32_bf16 v[32:35], a[156:159], a[92:95], v[32:35]
ds_read_b64_tr_b16 a[162:163], v24 offset:53248
v_cvt_pk_bf16_f32 v46, v6, v7
v_mfma_f32_16x16x32_bf16 v[148:151], a[176:179], v[92:95], v[148:151]
v_exp_f32 v8, v30
v_mfma_f32_16x16x32_bf16 v[148:151], a[180:183], v[96:99], v[148:151]
ds_read_b128 a[136:139], v18 offset:8192
v_mfma_f32_16x16x32_bf16 v[152:155], a[180:183], v[104:107], v[152:155]
v_exp_f32 v9, v31
v_mfma_f32_16x16x32_bf16 v[152:155], a[176:179], v[100:103], v[152:155]
buffer_load_dwordx4 v15, s[16:19], s42 offen offset:1024 lds
v_mfma_f32_16x16x32_bf16 v[28:31], a[144:147], a[96:99], v[244:247]
v_exp_f32 v6, v32
v_mfma_f32_16x16x32_bf16 v[28:31], a[148:151], a[100:103], v[28:31]
ds_read_b64_tr_b16 a[164:165], v24 offset:57344
v_cvt_pk_bf16_f32 v47, v8, v9
v_mfma_f32_16x16x32_bf16 v[28:31], a[152:155], a[104:107], v[28:31]
v_exp_f32 v7, v33
v_mfma_f32_16x16x32_bf16 v[28:31], a[156:159], a[108:111], v[28:31]
s_waitcnt lgkmcnt(8)
ds_read_b64_tr_b16 a[166:167], v24 offset:61440
v_cvt_pk_bf16_f32 v54, v6, v7
v_mfma_f32_16x16x32_bf16 v[156:159], a[184:187], v[76:79], v[156:159]
s_waitcnt lgkmcnt(6)
v_exp_f32 v8, v34
v_mfma_f32_16x16x32_bf16 v[156:159], a[188:191], v[80:83], v[156:159]
ds_read_b128 a[140:143], v19 offset:8192
v_mfma_f32_16x16x32_bf16 v[160:163], a[188:191], v[88:91], v[160:163]
v_exp_f32 v9, v35
v_mfma_f32_16x16x32_bf16 v[160:163], a[184:187], v[84:87], v[160:163]
v_mfma_f32_16x16x32_bf16 v[32:35], a[144:147], a[112:115], v[248:251]
v_exp_f32 v6, v28
v_mfma_f32_16x16x32_bf16 v[32:35], a[148:151], a[116:119], v[32:35]
ds_read_b64_tr_b16 a[168:169], v25 offset:49152
v_cvt_pk_bf16_f32 v55, v8, v9
v_mfma_f32_16x16x32_bf16 v[32:35], a[152:155], a[120:123], v[32:35]
v_exp_f32 v7, v29
v_mfma_f32_16x16x32_bf16 v[32:35], a[156:159], a[124:127], v[32:35]
ds_read_b64_tr_b16 a[170:171], v25 offset:53248
v_cvt_pk_bf16_f32 v62, v6, v7
v_mfma_f32_16x16x32_bf16 v[164:167], a[184:187], v[92:95], v[164:167]
v_exp_f32 v8, v30
v_mfma_f32_16x16x32_bf16 v[164:167], a[188:191], v[96:99], v[164:167]
ds_read_b128 a[144:147], v16 offset:12288
v_mfma_f32_16x16x32_bf16 v[168:171], a[188:191], v[104:107], v[168:171]
v_exp_f32 v9, v31
v_mfma_f32_16x16x32_bf16 v[168:171], a[184:187], v[100:103], v[168:171]
buffer_load_dwordx4 v14, s[16:19], s42 offen offset:2048 lds
v_smfmac_f32_16x16x64_bf16 a[36:39], a[48:51], v[84:91], v37
v_mfma_f32_16x16x32_bf16 v[28:31], a[128:131], a[64:67], v[236:239]
s_waitcnt lgkmcnt(9)
v_exp_f32 v6, v32
v_mfma_f32_16x16x32_bf16 v[28:31], a[132:135], a[68:71], v[28:31]
s_waitcnt lgkmcnt(6)
ds_read_b64_tr_b16 a[172:173], v25 offset:57344
v_cvt_pk_bf16_f32 v63, v8, v9
v_mfma_f32_16x16x32_bf16 v[28:31], a[136:139], a[72:75], v[28:31]
s_waitcnt lgkmcnt(4)
v_exp_f32 v7, v33
v_mfma_f32_16x16x32_bf16 v[28:31], a[140:143], a[76:79], v[28:31]
ds_read_b64_tr_b16 a[174:175], v25 offset:61440
v_cvt_pk_bf16_f32 v70, v6, v7
v_mfma_f32_16x16x32_bf16 v[172:175], a[160:163], v[76:79], v[172:175]
v_exp_f32 v8, v34
v_mfma_f32_16x16x32_bf16 v[172:175], a[164:167], v[80:83], v[172:175]
ds_read_b128 a[148:151], v17 offset:12288
v_mfma_f32_16x16x32_bf16 v[176:179], a[164:167], v[88:91], v[176:179]
v_exp_f32 v9, v35
v_mfma_f32_16x16x32_bf16 v[176:179], a[160:163], v[84:87], v[176:179]
v_mfma_f32_16x16x32_bf16 v[32:35], a[128:131], a[80:83], v[240:243]
v_exp_f32 v6, v28
v_mfma_f32_16x16x32_bf16 v[32:35], a[132:135], a[84:87], v[32:35]
ds_read_b64_tr_b16 a[176:177], v26 offset:49152
v_cvt_pk_bf16_f32 v71, v8, v9
v_mfma_f32_16x16x32_bf16 v[32:35], a[136:139], a[88:91], v[32:35]
v_exp_f32 v7, v29
v_mfma_f32_16x16x32_bf16 v[32:35], a[140:143], a[92:95], v[32:35]
ds_read_b64_tr_b16 a[178:179], v26 offset:53248
v_cvt_pk_bf16_f32 v48, v6, v7
v_mfma_f32_16x16x32_bf16 v[180:183], a[160:163], v[92:95], v[180:183]
v_exp_f32 v8, v30
v_mfma_f32_16x16x32_bf16 v[180:183], a[164:167], v[96:99], v[180:183]
ds_read_b128 a[152:155], v18 offset:12288
v_mfma_f32_16x16x32_bf16 v[184:187], a[164:167], v[104:107], v[184:187]
v_exp_f32 v9, v31
v_mfma_f32_16x16x32_bf16 v[184:187], a[160:163], v[100:103], v[184:187]
buffer_load_dwordx4 v15, s[16:19], s42 offen offset:3072 lds
v_mfma_f32_16x16x32_bf16 v[28:31], a[128:131], a[96:99], v[244:247]
s_add_u32 s42, s42, 16384
v_exp_f32 v6, v32
v_mfma_f32_16x16x32_bf16 v[28:31], a[132:135], a[100:103], v[28:31]
ds_read_b64_tr_b16 a[180:181], v26 offset:57344
v_cvt_pk_bf16_f32 v49, v8, v9
v_mfma_f32_16x16x32_bf16 v[28:31], a[136:139], a[104:107], v[28:31]
v_exp_f32 v7, v33
v_mfma_f32_16x16x32_bf16 v[28:31], a[140:143], a[108:111], v[28:31]
s_waitcnt lgkmcnt(8)
ds_read_b64_tr_b16 a[182:183], v26 offset:61440
v_cvt_pk_bf16_f32 v56, v6, v7
v_mfma_f32_16x16x32_bf16 v[188:191], a[168:171], v[76:79], v[188:191]
s_waitcnt lgkmcnt(6)
v_exp_f32 v8, v34
v_mfma_f32_16x16x32_bf16 v[188:191], a[172:175], v[80:83], v[188:191]
ds_read_b128 a[156:159], v19 offset:12288
v_mfma_f32_16x16x32_bf16 v[192:195], a[172:175], v[88:91], v[192:195]
v_exp_f32 v9, v35
v_mfma_f32_16x16x32_bf16 v[192:195], a[168:171], v[84:87], v[192:195]
s_waitcnt vmcnt(8)
s_barrier
v_mfma_f32_16x16x32_bf16 v[32:35], a[128:131], a[112:115], v[248:251]
v_exp_f32 v6, v28
v_mfma_f32_16x16x32_bf16 v[32:35], a[132:135], a[116:119], v[32:35]
ds_read_b64_tr_b16 a[184:185], v27 offset:49152
v_cvt_pk_bf16_f32 v57, v8, v9
v_mfma_f32_16x16x32_bf16 v[32:35], a[136:139], a[120:123], v[32:35]
v_exp_f32 v7, v29
v_mfma_f32_16x16x32_bf16 v[32:35], a[140:143], a[124:127], v[32:35]
ds_read_b64_tr_b16 a[186:187], v27 offset:53248
v_cvt_pk_bf16_f32 v64, v6, v7
v_mfma_f32_16x16x32_bf16 v[196:199], a[168:171], v[92:95], v[196:199]
v_exp_f32 v8, v30
v_mfma_f32_16x16x32_bf16 v[196:199], a[172:175], v[96:99], v[196:199]
ds_read_b128 a[128:131], v16 offset:16384
v_mfma_f32_16x16x32_bf16 v[200:203], a[172:175], v[104:107], v[200:203]
s_add_u32 m0, s37, 49152
v_exp_f32 v9, v31
v_mfma_f32_16x16x32_bf16 v[200:203], a[168:171], v[100:103], v[200:203]
buffer_load_dwordx4 v10, s[12:15], s41 offen offset:0 lds
v_smfmac_f32_16x16x64_bf16 a[40:43], a[48:51], v[92:99], v37
v_mfma_f32_16x16x32_bf16 v[28:31], a[144:147], a[64:67], v[236:239]
s_waitcnt lgkmcnt(9)
v_exp_f32 v6, v32
v_mfma_f32_16x16x32_bf16 v[28:31], a[148:151], a[68:71], v[28:31]
s_waitcnt lgkmcnt(6)
ds_read_b64_tr_b16 a[188:189], v27 offset:57344
v_cvt_pk_bf16_f32 v65, v8, v9
v_mfma_f32_16x16x32_bf16 v[28:31], a[152:155], a[72:75], v[28:31]
s_waitcnt lgkmcnt(4)
v_exp_f32 v7, v33
v_mfma_f32_16x16x32_bf16 v[28:31], a[156:159], a[76:79], v[28:31]
ds_read_b64_tr_b16 a[190:191], v27 offset:61440
v_cvt_pk_bf16_f32 v72, v6, v7
v_mfma_f32_16x16x32_bf16 v[204:207], a[176:179], v[76:79], v[204:207]
v_exp_f32 v8, v34
v_mfma_f32_16x16x32_bf16 v[204:207], a[180:183], v[80:83], v[204:207]
ds_read_b128 a[132:135], v17 offset:16384
v_mfma_f32_16x16x32_bf16 v[208:211], a[180:183], v[88:91], v[208:211]
v_exp_f32 v9, v35
v_mfma_f32_16x16x32_bf16 v[208:211], a[176:179], v[84:87], v[208:211]
v_mfma_f32_16x16x32_bf16 v[32:35], a[144:147], a[80:83], v[240:243]
v_exp_f32 v6, v28
v_mfma_f32_16x16x32_bf16 v[32:35], a[148:151], a[84:87], v[32:35]
ds_read_b64_tr_b16 a[160:161], v20 offset:0
v_cvt_pk_bf16_f32 v73, v8, v9
v_mfma_f32_16x16x32_bf16 v[32:35], a[152:155], a[88:91], v[32:35]
v_exp_f32 v7, v29
v_mfma_f32_16x16x32_bf16 v[32:35], a[156:159], a[92:95], v[32:35]
ds_read_b64_tr_b16 a[162:163], v20 offset:4096
v_cvt_pk_bf16_f32 v50, v6, v7
v_mfma_f32_16x16x32_bf16 v[212:215], a[176:179], v[92:95], v[212:215]
v_exp_f32 v8, v30
v_mfma_f32_16x16x32_bf16 v[212:215], a[180:183], v[96:99], v[212:215]
ds_read_b128 a[136:139], v18 offset:16384
v_mfma_f32_16x16x32_bf16 v[216:219], a[180:183], v[104:107], v[216:219]
v_exp_f32 v9, v31
v_mfma_f32_16x16x32_bf16 v[216:219], a[176:179], v[100:103], v[216:219]
buffer_load_dwordx4 v11, s[12:15], s41 offen offset:1024 lds
v_mfma_f32_16x16x32_bf16 v[28:31], a[144:147], a[96:99], v[244:247]
v_exp_f32 v6, v32
v_mfma_f32_16x16x32_bf16 v[28:31], a[148:151], a[100:103], v[28:31]
ds_read_b64_tr_b16 a[164:165], v20 offset:8192
v_cvt_pk_bf16_f32 v51, v8, v9
v_mfma_f32_16x16x32_bf16 v[28:31], a[152:155], a[104:107], v[28:31]
v_exp_f32 v7, v33
v_mfma_f32_16x16x32_bf16 v[28:31], a[156:159], a[108:111], v[28:31]
s_waitcnt lgkmcnt(8)
ds_read_b64_tr_b16 a[166:167], v20 offset:12288
v_cvt_pk_bf16_f32 v58, v6, v7
v_mfma_f32_16x16x32_bf16 v[220:223], a[184:187], v[76:79], v[220:223]
s_waitcnt lgkmcnt(6)
v_exp_f32 v8, v34
v_mfma_f32_16x16x32_bf16 v[220:223], a[188:191], v[80:83], v[220:223]
ds_read_b128 a[140:143], v19 offset:16384
v_mfma_f32_16x16x32_bf16 v[224:227], a[188:191], v[88:91], v[224:227]
v_exp_f32 v9, v35
v_mfma_f32_16x16x32_bf16 v[224:227], a[184:187], v[84:87], v[224:227]
v_mfma_f32_16x16x32_bf16 v[32:35], a[144:147], a[112:115], v[248:251]
v_exp_f32 v6, v28
v_mfma_f32_16x16x32_bf16 v[32:35], a[148:151], a[116:119], v[32:35]
ds_read_b64_tr_b16 a[168:169], v21 offset:0
v_cvt_pk_bf16_f32 v59, v8, v9
v_mfma_f32_16x16x32_bf16 v[32:35], a[152:155], a[120:123], v[32:35]
v_exp_f32 v7, v29
v_mfma_f32_16x16x32_bf16 v[32:35], a[156:159], a[124:127], v[32:35]
ds_read_b64_tr_b16 a[170:171], v21 offset:4096
v_cvt_pk_bf16_f32 v66, v6, v7
v_mfma_f32_16x16x32_bf16 v[228:231], a[184:187], v[92:95], v[228:231]
v_exp_f32 v8, v30
v_mfma_f32_16x16x32_bf16 v[228:231], a[188:191], v[96:99], v[228:231]
ds_read_b128 a[144:147], v16 offset:20480
v_mfma_f32_16x16x32_bf16 v[232:235], a[188:191], v[104:107], v[232:235]
v_exp_f32 v9, v31
v_mfma_f32_16x16x32_bf16 v[232:235], a[184:187], v[100:103], v[232:235]
buffer_load_dwordx4 v12, s[12:15], s41 offen offset:2048 lds
v_smfmac_f32_16x16x64_bf16 a[44:47], a[48:51], v[100:107], v37
s_cmp_eq_u32 s38, s82
s_cbranch_scc1 L2_su
L2_su_r:
s_add_u32 s38, s38, 1
s_cbranch_scc0 L2_loop
v_mfma_f32_16x16x32_bf16 v[28:31], a[128:131], a[64:67], v[236:239]
s_waitcnt lgkmcnt(9)
v_exp_f32 v6, v32
v_mfma_f32_16x16x32_bf16 v[28:31], a[132:135], a[68:71], v[28:31]
s_waitcnt lgkmcnt(6)
ds_read_b64_tr_b16 a[172:173], v21 offset:8192
v_cvt_pk_bf16_f32 v67, v8, v9
v_mfma_f32_16x16x32_bf16 v[28:31], a[136:139], a[72:75], v[28:31]
s_waitcnt lgkmcnt(4)
v_exp_f32 v7, v33
v_mfma_f32_16x16x32_bf16 v[28:31], a[140:143], a[76:79], v[28:31]
s_and_b32 s66, s65, 1
ds_read_b64_tr_b16 a[174:175], v21 offset:12288
v_cvt_pk_bf16_f32 v74, v6, v7
v_mfma_f32_16x16x32_bf16 v[108:111], a[160:163], v[44:47], v[108:111]
s_mov_b32 s55, 1048576
v_exp_f32 v8, v34
v_mfma_f32_16x16x32_bf16 v[108:111], a[164:167], v[48:51], v[108:111]
ds_read_b128 a[148:151], v17 offset:20480
v_mfma_f32_16x16x32_bf16 v[112:115], a[164:167], v[56:59], v[112:115]
v_exp_f32 v9, v35
v_mfma_f32_16x16x32_bf16 v[112:115], a[160:163], v[52:55], v[112:115]
v_and_b32 v38, 15, v0
v_lshlrev_b32 v38, 1, v38
v_mfma_f32_16x16x32_bf16 v[32:35], a[128:131], a[80:83], v[240:243]
v_exp_f32 v6, v28
v_mfma_f32_16x16x32_bf16 v[32:35], a[132:135], a[84:87], v[32:35]
ds_read_b64_tr_b16 a[176:177], v22 offset:0
v_cvt_pk_bf16_f32 v75, v8, v9
v_mfma_f32_16x16x32_bf16 v[32:35], a[136:139], a[88:91], v[32:35]
v_exp_f32 v7, v29
v_mfma_f32_16x16x32_bf16 v[32:35], a[140:143], a[92:95], v[32:35]
ds_read_b64_tr_b16 a[178:179], v22 offset:4096
v_cvt_pk_bf16_f32 v76, v6, v7
v_mfma_f32_16x16x32_bf16 v[116:119], a[160:163], v[60:63], v[116:119]
v_exp_f32 v8, v30
v_mfma_f32_16x16x32_bf16 v[116:119], a[164:167], v[64:67], v[116:119]
ds_read_b128 a[152:155], v18 offset:20480
v_mfma_f32_16x16x32_bf16 v[120:123], a[164:167], v[72:75], v[120:123]
v_exp_f32 v9, v31
v_mfma_f32_16x16x32_bf16 v[120:123], a[160:163], v[68:71], v[120:123]
buffer_load_dwordx4 v13, s[12:15], s41 offen offset:3072 lds
v_mfma_f32_16x16x32_bf16 v[28:31], a[128:131], a[96:99], v[244:247]
s_add_u32 s41, s41, 16384
v_exp_f32 v6, v32
v_mfma_f32_16x16x32_bf16 v[28:31], a[132:135], a[100:103], v[28:31]
ds_read_b64_tr_b16 a[180:181], v22 offset:8192
v_cvt_pk_bf16_f32 v77, v8, v9
v_mfma_f32_16x16x32_bf16 v[28:31], a[136:139], a[104:107], v[28:31]
v_exp_f32 v7, v33
v_mfma_f32_16x16x32_bf16 v[28:31], a[140:143], a[108:111], v[28:31]
s_waitcnt lgkmcnt(8)
ds_read_b64_tr_b16 a[182:183], v22 offset:12288
v_cvt_pk_bf16_f32 v84, v6, v7
v_mfma_f32_16x16x32_bf16 v[124:127], a[168:171], v[44:47], v[124:127]
s_waitcnt lgkmcnt(6)
v_exp_f32 v8, v34
v_mfma_f32_16x16x32_bf16 v[124:127], a[172:175], v[48:51], v[124:127]
ds_read_b128 a[156:159], v19 offset:20480
v_mfma_f32_16x16x32_bf16 v[128:131], a[172:175], v[56:59], v[128:131]
v_exp_f32 v9, v35
v_mfma_f32_16x16x32_bf16 v[128:131], a[168:171], v[52:55], v[128:131]
buffer_load_dword v252, off, s[4:7], s85 sc1
v_mfma_f32_16x16x32_bf16 v[32:35], a[128:131], a[112:115], v[248:251]
v_exp_f32 v6, v28
v_mfma_f32_16x16x32_bf16 v[32:35], a[132:135], a[116:119], v[32:35]
ds_read_b64_tr_b16 a[184:185], v23 offset:0
v_cvt_pk_bf16_f32 v85, v8, v9
v_mfma_f32_16x16x32_bf16 v[32:35], a[136:139], a[120:123], v[32:35]
v_exp_f32 v7, v29
v_mfma_f32_16x16x32_bf16 v[32:35], a[140:143], a[124:127], v[32:35]
ds_read_b64_tr_b16 a[186:187], v23 offset:4096
v_cvt_pk_bf16_f32 v92, v6, v7
v_mfma_f32_16x16x32_bf16 v[132:135], a[168:171], v[60:63], v[132:135]
v_exp_f32 v8, v30
v_mfma_f32_16x16x32_bf16 v[132:135], a[172:175], v[64:67], v[132:135]
ds_read_b128 a[128:131], v16 offset:24576
v_mfma_f32_16x16x32_bf16 v[136:139], a[172:175], v[72:75], v[136:139]
s_add_u32 m0, s37, 98304
v_exp_f32 v9, v31
v_mfma_f32_16x16x32_bf16 v[136:139], a[168:171], v[68:71], v[136:139]
buffer_load_dwordx4 v14, s[16:19], s42 offen offset:0 lds
v_smfmac_f32_16x16x64_bf16 a[32:35], a[48:51], v[44:51], v37
s_cmp_eq_u32 s94, 0
s_cselect_b32 s55, 917504, s55
s_cselect_b32 s66, s66, 0
v_mfma_f32_16x16x32_bf16 v[28:31], a[144:147], a[64:67], v[236:239]
s_waitcnt lgkmcnt(9)
v_exp_f32 v6, v32
v_mfma_f32_16x16x32_bf16 v[28:31], a[148:151], a[68:71], v[28:31]
s_waitcnt lgkmcnt(6)
ds_read_b64_tr_b16 a[188:189], v23 offset:8192
v_cvt_pk_bf16_f32 v93, v8, v9
v_mfma_f32_16x16x32_bf16 v[28:31], a[152:155], a[72:75], v[28:31]
s_waitcnt lgkmcnt(4)
v_exp_f32 v7, v33
v_mfma_f32_16x16x32_bf16 v[28:31], a[156:159], a[76:79], v[28:31]
s_mul_i32 s66, s66, s55
ds_read_b64_tr_b16 a[190:191], v23 offset:12288
v_cvt_pk_bf16_f32 v100, v6, v7
v_mfma_f32_16x16x32_bf16 v[140:143], a[176:179], v[44:47], v[140:143]
s_sub_u32 s55, s55, s66
v_exp_f32 v8, v34
v_mfma_f32_16x16x32_bf16 v[140:143], a[180:183], v[48:51], v[140:143]
ds_read_b128 a[132:135], v17 offset:24576
v_add_u32 v36, s66, v1
v_mfma_f32_16x16x32_bf16 v[144:147], a[180:183], v[56:59], v[144:147]
v_exp_f32 v9, v35
v_mfma_f32_16x16x32_bf16 v[144:147], a[176:179], v[52:55], v[144:147]
buffer_load_ushort a52, v38, s[32:35], s95 offen offset:0
v_mfma_f32_16x16x32_bf16 v[32:35], a[144:147], a[80:83], v[240:243]
v_exp_f32 v6, v28
v_mfma_f32_16x16x32_bf16 v[32:35], a[148:151], a[84:87], v[32:35]
ds_read_b64_tr_b16 a[160:161], v24 offset:0
v_cvt_pk_bf16_f32 v101, v8, v9
v_mfma_f32_16x16x32_bf16 v[32:35], a[152:155], a[88:91], v[32:35]
v_exp_f32 v7, v29
v_mfma_f32_16x16x32_bf16 v[32:35], a[156:159], a[92:95], v[32:35]
ds_read_b64_tr_b16 a[162:163], v24 offset:4096
v_cvt_pk_bf16_f32 v78, v6, v7
v_mfma_f32_16x16x32_bf16 v[148:151], a[176:179], v[60:63], v[148:151]
v_exp_f32 v8, v30
v_mfma_f32_16x16x32_bf16 v[148:151], a[180:183], v[64:67], v[148:151]
ds_read_b128 a[136:139], v18 offset:24576
v_add_u32 v253, s55, v1
v_mfma_f32_16x16x32_bf16 v[152:155], a[180:183], v[72:75], v[152:155]
v_exp_f32 v9, v31
v_mfma_f32_16x16x32_bf16 v[152:155], a[176:179], v[68:71], v[152:155]
buffer_load_dwordx4 v15, s[16:19], s42 offen offset:1024 lds
v_mfma_f32_16x16x32_bf16 v[28:31], a[144:147], a[96:99], v[244:247]
v_exp_f32 v6, v32
v_mfma_f32_16x16x32_bf16 v[28:31], a[148:151], a[100:103], v[28:31]
ds_read_b64_tr_b16 a[164:165], v24 offset:8192
v_cvt_pk_bf16_f32 v79, v8, v9
v_mfma_f32_16x16x32_bf16 v[28:31], a[152:155], a[104:107], v[28:31]
v_exp_f32 v7, v33
v_mfma_f32_16x16x32_bf16 v[28:31], a[156:159], a[108:111], v[28:31]
s_waitcnt lgkmcnt(8)
ds_read_b64_tr_b16 a[166:167], v24 offset:12288
v_cvt_pk_bf16_f32 v86, v6, v7
v_mfma_f32_16x16x32_bf16 v[156:159], a[184:187], v[44:47], v[156:159]
s_waitcnt lgkmcnt(6)
v_exp_f32 v8, v34
v_mfma_f32_16x16x32_bf16 v[156:159], a[188:191], v[48:51], v[156:159]
ds_read_b128 a[140:143], v19 offset:24576
v_mfma_f32_16x16x32_bf16 v[160:163], a[188:191], v[56:59], v[160:163]
v_exp_f32 v9, v35
v_mfma_f32_16x16x32_bf16 v[160:163], a[184:187], v[52:55], v[160:163]
buffer_load_ushort a53, v38, s[32:35], s95 offen offset:32
v_mfma_f32_16x16x32_bf16 v[32:35], a[144:147], a[112:115], v[248:251]
v_exp_f32 v6, v28
v_mfma_f32_16x16x32_bf16 v[32:35], a[148:151], a[116:119], v[32:35]
ds_read_b64_tr_b16 a[168:169], v25 offset:0
v_cvt_pk_bf16_f32 v87, v8, v9
v_mfma_f32_16x16x32_bf16 v[32:35], a[152:155], a[120:123], v[32:35]
v_exp_f32 v7, v29
v_mfma_f32_16x16x32_bf16 v[32:35], a[156:159], a[124:127], v[32:35]
ds_read_b64_tr_b16 a[170:171], v25 offset:4096
v_cvt_pk_bf16_f32 v94, v6, v7
v_mfma_f32_16x16x32_bf16 v[164:167], a[184:187], v[60:63], v[164:167]
v_exp_f32 v8, v30
v_mfma_f32_16x16x32_bf16 v[164:167], a[188:191], v[64:67], v[164:167]
ds_read_b128 a[144:147], v16 offset:28672
v_mfma_f32_16x16x32_bf16 v[168:171], a[188:191], v[72:75], v[168:171]
v_exp_f32 v9, v31
v_mfma_f32_16x16x32_bf16 v[168:171], a[184:187], v[68:71], v[168:171]
buffer_load_dwordx4 v14, s[16:19], s42 offen offset:2048 lds
v_smfmac_f32_16x16x64_bf16 a[36:39], a[48:51], v[52:59], v37
v_mfma_f32_16x16x32_bf16 v[28:31], a[128:131], a[64:67], v[236:239]
s_waitcnt lgkmcnt(9)
v_exp_f32 v6, v32
v_mfma_f32_16x16x32_bf16 v[28:31], a[132:135], a[68:71], v[28:31]
s_waitcnt lgkmcnt(6)
ds_read_b64_tr_b16 a[172:173], v25 offset:8192
v_cvt_pk_bf16_f32 v95, v8, v9
v_mfma_f32_16x16x32_bf16 v[28:31], a[136:139], a[72:75], v[28:31]
s_waitcnt lgkmcnt(4)
v_exp_f32 v7, v33
v_mfma_f32_16x16x32_bf16 v[28:31], a[140:143], a[76:79], v[28:31]
ds_read_b64_tr_b16 a[174:175], v25 offset:12288
v_cvt_pk_bf16_f32 v102, v6, v7
v_mfma_f32_16x16x32_bf16 v[172:175], a[160:163], v[44:47], v[172:175]
v_exp_f32 v8, v34
v_mfma_f32_16x16x32_bf16 v[172:175], a[164:167], v[48:51], v[172:175]
ds_read_b128 a[148:151], v17 offset:28672
v_mfma_f32_16x16x32_bf16 v[176:179], a[164:167], v[56:59], v[176:179]
v_exp_f32 v9, v35
v_mfma_f32_16x16x32_bf16 v[176:179], a[160:163], v[52:55], v[176:179]
buffer_load_ushort a54, v38, s[32:35], s95 offen offset:64
v_mfma_f32_16x16x32_bf16 v[32:35], a[128:131], a[80:83], v[240:243]
v_exp_f32 v6, v28
v_mfma_f32_16x16x32_bf16 v[32:35], a[132:135], a[84:87], v[32:35]
ds_read_b64_tr_b16 a[176:177], v26 offset:0
v_cvt_pk_bf16_f32 v103, v8, v9
v_mfma_f32_16x16x32_bf16 v[32:35], a[136:139], a[88:91], v[32:35]
v_exp_f32 v7, v29
v_mfma_f32_16x16x32_bf16 v[32:35], a[140:143], a[92:95], v[32:35]
ds_read_b64_tr_b16 a[178:179], v26 offset:4096
v_cvt_pk_bf16_f32 v80, v6, v7
v_mfma_f32_16x16x32_bf16 v[180:183], a[160:163], v[60:63], v[180:183]
v_exp_f32 v8, v30
v_mfma_f32_16x16x32_bf16 v[180:183], a[164:167], v[64:67], v[180:183]
ds_read_b128 a[152:155], v18 offset:28672
v_mfma_f32_16x16x32_bf16 v[184:187], a[164:167], v[72:75], v[184:187]
v_exp_f32 v9, v31
v_mfma_f32_16x16x32_bf16 v[184:187], a[160:163], v[68:71], v[184:187]
buffer_load_dwordx4 v15, s[16:19], s42 offen offset:3072 lds
v_mfma_f32_16x16x32_bf16 v[28:31], a[128:131], a[96:99], v[244:247]
s_add_u32 s42, s42, 16384
v_exp_f32 v6, v32
v_mfma_f32_16x16x32_bf16 v[28:31], a[132:135], a[100:103], v[28:31]
ds_read_b64_tr_b16 a[180:181], v26 offset:8192
v_cvt_pk_bf16_f32 v81, v8, v9
v_mfma_f32_16x16x32_bf16 v[28:31], a[136:139], a[104:107], v[28:31]
v_exp_f32 v7, v33
v_mfma_f32_16x16x32_bf16 v[28:31], a[140:143], a[108:111], v[28:31]
s_waitcnt lgkmcnt(8)
ds_read_b64_tr_b16 a[182:183], v26 offset:12288
v_cvt_pk_bf16_f32 v88, v6, v7
v_mfma_f32_16x16x32_bf16 v[188:191], a[168:171], v[44:47], v[188:191]
s_waitcnt lgkmcnt(6)
v_exp_f32 v8, v34
v_mfma_f32_16x16x32_bf16 v[188:191], a[172:175], v[48:51], v[188:191]
ds_read_b128 a[156:159], v19 offset:28672
v_mfma_f32_16x16x32_bf16 v[192:195], a[172:175], v[56:59], v[192:195]
v_exp_f32 v9, v35
v_mfma_f32_16x16x32_bf16 v[192:195], a[168:171], v[52:55], v[192:195]
s_waitcnt vmcnt(12)
s_barrier
v_mfma_f32_16x16x32_bf16 v[32:35], a[128:131], a[112:115], v[248:251]
v_exp_f32 v6, v28
v_mfma_f32_16x16x32_bf16 v[32:35], a[132:135], a[116:119], v[32:35]
ds_read_b64_tr_b16 a[184:185], v27 offset:0
v_cvt_pk_bf16_f32 v89, v8, v9
v_mfma_f32_16x16x32_bf16 v[32:35], a[136:139], a[120:123], v[32:35]
v_exp_f32 v7, v29
v_mfma_f32_16x16x32_bf16 v[32:35], a[140:143], a[124:127], v[32:35]
ds_read_b64_tr_b16 a[186:187], v27 offset:4096
v_cvt_pk_bf16_f32 v96, v6, v7
v_mfma_f32_16x16x32_bf16 v[196:199], a[168:171], v[60:63], v[196:199]
v_exp_f32 v8, v30
v_mfma_f32_16x16x32_bf16 v[196:199], a[172:175], v[64:67], v[196:199]
ds_read_b128 a[128:131], v16 offset:32768
v_mfma_f32_16x16x32_bf16 v[200:203], a[172:175], v[72:75], v[200:203]
s_add_u32 m0, s37, 0
v_exp_f32 v9, v31
v_mfma_f32_16x16x32_bf16 v[200:203], a[168:171], v[68:71], v[200:203]
buffer_load_dwordx4 v2, s[24:27], s43 offen offset:0 lds
v_smfmac_f32_16x16x64_bf16 a[40:43], a[48:51], v[60:67], v37
v_mfma_f32_16x16x32_bf16 v[28:31], a[144:147], a[64:67], v[236:239]
s_waitcnt lgkmcnt(9)
v_exp_f32 v6, v32
v_mfma_f32_16x16x32_bf16 v[28:31], a[148:151], a[68:71], v[28:31]
s_waitcnt lgkmcnt(6)
ds_read_b64_tr_b16 a[188:189], v27 offset:8192
v_cvt_pk_bf16_f32 v97, v8, v9
v_mfma_f32_16x16x32_bf16 v[28:31], a[152:155], a[72:75], v[28:31]
s_waitcnt lgkmcnt(4)
v_exp_f32 v7, v33
v_mfma_f32_16x16x32_bf16 v[28:31], a[156:159], a[76:79], v[28:31]
ds_read_b64_tr_b16 a[190:191], v27 offset:12288
v_cvt_pk_bf16_f32 v104, v6, v7
v_mfma_f32_16x16x32_bf16 v[204:207], a[176:179], v[44:47], v[204:207]
v_exp_f32 v8, v34
v_mfma_f32_16x16x32_bf16 v[204:207], a[180:183], v[48:51], v[204:207]
ds_read_b128 a[132:135], v17 offset:32768
v_mfma_f32_16x16x32_bf16 v[208:211], a[180:183], v[56:59], v[208:211]
v_exp_f32 v9, v35
v_mfma_f32_16x16x32_bf16 v[208:211], a[176:179], v[52:55], v[208:211]
buffer_load_ushort a55, v38, s[32:35], s95 offen offset:96
v_mfma_f32_16x16x32_bf16 v[32:35], a[144:147], a[80:83], v[240:243]
v_exp_f32 v6, v28
v_mfma_f32_16x16x32_bf16 v[32:35], a[148:151], a[84:87], v[32:35]
ds_read_b64_tr_b16 a[160:161], v20 offset:16384
v_cvt_pk_bf16_f32 v105, v8, v9
v_mfma_f32_16x16x32_bf16 v[32:35], a[152:155], a[88:91], v[32:35]
v_exp_f32 v7, v29
v_mfma_f32_16x16x32_bf16 v[32:35], a[156:159], a[92:95], v[32:35]
ds_read_b64_tr_b16 a[162:163], v20 offset:20480
v_cvt_pk_bf16_f32 v82, v6, v7
v_mfma_f32_16x16x32_bf16 v[212:215], a[176:179], v[60:63], v[212:215]
v_exp_f32 v8, v30
v_mfma_f32_16x16x32_bf16 v[212:215], a[180:183], v[64:67], v[212:215]
ds_read_b128 a[136:139], v18 offset:32768
v_mfma_f32_16x16x32_bf16 v[216:219], a[180:183], v[72:75], v[216:219]
v_exp_f32 v9, v31
v_mfma_f32_16x16x32_bf16 v[216:219], a[176:179], v[68:71], v[216:219]
buffer_load_dwordx4 v3, s[24:27], s43 offen offset:1024 lds
v_mfma_f32_16x16x32_bf16 v[28:31], a[144:147], a[96:99], v[244:247]
v_exp_f32 v6, v32
v_mfma_f32_16x16x32_bf16 v[28:31], a[148:151], a[100:103], v[28:31]
ds_read_b64_tr_b16 a[164:165], v20 offset:24576
v_cvt_pk_bf16_f32 v83, v8, v9
v_mfma_f32_16x16x32_bf16 v[28:31], a[152:155], a[104:107], v[28:31]
v_exp_f32 v7, v33
v_mfma_f32_16x16x32_bf16 v[28:31], a[156:159], a[108:111], v[28:31]
s_waitcnt lgkmcnt(8)
ds_read_b64_tr_b16 a[166:167], v20 offset:28672
v_cvt_pk_bf16_f32 v90, v6, v7
v_mfma_f32_16x16x32_bf16 v[220:223], a[184:187], v[44:47], v[220:223]
s_waitcnt lgkmcnt(6)
v_exp_f32 v8, v34
v_mfma_f32_16x16x32_bf16 v[220:223], a[188:191], v[48:51], v[220:223]
ds_read_b128 a[140:143], v19 offset:32768
v_mfma_f32_16x16x32_bf16 v[224:227], a[188:191], v[56:59], v[224:227]
v_exp_f32 v9, v35
v_mfma_f32_16x16x32_bf16 v[224:227], a[184:187], v[52:55], v[224:227]
v_mfma_f32_16x16x32_bf16 v[32:35], a[144:147], a[112:115], v[248:251]
v_exp_f32 v6, v28
v_mfma_f32_16x16x32_bf16 v[32:35], a[148:151], a[116:119], v[32:35]
ds_read_b64_tr_b16 a[168:169], v21 offset:16384
v_cvt_pk_bf16_f32 v91, v8, v9
v_mfma_f32_16x16x32_bf16 v[32:35], a[152:155], a[120:123], v[32:35]
v_exp_f32 v7, v29
v_mfma_f32_16x16x32_bf16 v[32:35], a[156:159], a[124:127], v[32:35]
ds_read_b64_tr_b16 a[170:171], v21 offset:20480
v_cvt_pk_bf16_f32 v98, v6, v7
v_mfma_f32_16x16x32_bf16 v[228:231], a[184:187], v[60:63], v[228:231]
v_exp_f32 v8, v30
v_mfma_f32_16x16x32_bf16 v[228:231], a[188:191], v[64:67], v[228:231]
ds_read_b128 a[144:147], v16 offset:36864
v_mfma_f32_16x16x32_bf16 v[232:235], a[188:191], v[72:75], v[232:235]
v_exp_f32 v9, v31
v_mfma_f32_16x16x32_bf16 v[232:235], a[184:187], v[68:71], v[232:235]
buffer_load_dwordx4 v4, s[24:27], s43 offen offset:2048 lds
v_smfmac_f32_16x16x64_bf16 a[44:47], a[48:51], v[68:75], v37
v_mfma_f32_16x16x32_bf16 v[28:31], a[128:131], a[64:67], v[236:239]
s_waitcnt lgkmcnt(9)
v_exp_f32 v6, v32
v_mfma_f32_16x16x32_bf16 v[28:31], a[132:135], a[68:71], v[28:31]
s_waitcnt lgkmcnt(6)
ds_read_b64_tr_b16 a[172:173], v21 offset:24576
v_cvt_pk_bf16_f32 v99, v8, v9
v_mfma_f32_16x16x32_bf16 v[28:31], a[136:139], a[72:75], v[28:31]
s_waitcnt lgkmcnt(4)
v_exp_f32 v7, v33
v_mfma_f32_16x16x32_bf16 v[28:31], a[140:143], a[76:79], v[28:31]
ds_read_b64_tr_b16 a[174:175], v21 offset:28672
v_cvt_pk_bf16_f32 v106, v6, v7
v_mfma_f32_16x16x32_bf16 v[108:111], a[160:163], v[76:79], v[108:111]
v_exp_f32 v8, v34
v_mfma_f32_16x16x32_bf16 v[108:111], a[164:167], v[80:83], v[108:111]
ds_read_b128 a[148:151], v17 offset:36864
v_mfma_f32_16x16x32_bf16 v[112:115], a[164:167], v[88:91], v[112:115]
v_exp_f32 v9, v35
v_mfma_f32_16x16x32_bf16 v[112:115], a[160:163], v[84:87], v[112:115]
v_mfma_f32_16x16x32_bf16 v[32:35], a[128:131], a[80:83], v[240:243]
v_exp_f32 v6, v28
v_mfma_f32_16x16x32_bf16 v[32:35], a[132:135], a[84:87], v[32:35]
ds_read_b64_tr_b16 a[176:177], v22 offset:16384
v_cvt_pk_bf16_f32 v107, v8, v9
v_mfma_f32_16x16x32_bf16 v[32:35], a[136:139], a[88:91], v[32:35]
v_exp_f32 v7, v29
v_mfma_f32_16x16x32_bf16 v[32:35], a[140:143], a[92:95], v[32:35]
ds_read_b64_tr_b16 a[178:179], v22 offset:20480
v_cvt_pk_bf16_f32 v44, v6, v7
v_mfma_f32_16x16x32_bf16 v[116:119], a[160:163], v[92:95], v[116:119]
v_exp_f32 v8, v30
v_mfma_f32_16x16x32_bf16 v[116:119], a[164:167], v[96:99], v[116:119]
ds_read_b128 a[152:155], v18 offset:36864
v_mfma_f32_16x16x32_bf16 v[120:123], a[164:167], v[104:107], v[120:123]
v_exp_f32 v9, v31
v_mfma_f32_16x16x32_bf16 v[120:123], a[160:163], v[100:103], v[120:123]
buffer_load_dwordx4 v5, s[24:27], s43 offen offset:3072 lds
v_mfma_f32_16x16x32_bf16 v[28:31], a[128:131], a[96:99], v[244:247]
s_add_u32 s43, s43, s72
v_exp_f32 v6, v32
v_mfma_f32_16x16x32_bf16 v[28:31], a[132:135], a[100:103], v[28:31]
ds_read_b64_tr_b16 a[180:181], v22 offset:24576
v_cvt_pk_bf16_f32 v45, v8, v9
v_mfma_f32_16x16x32_bf16 v[28:31], a[136:139], a[104:107], v[28:31]
v_exp_f32 v7, v33
v_mfma_f32_16x16x32_bf16 v[28:31], a[140:143], a[108:111], v[28:31]
s_waitcnt lgkmcnt(8)
ds_read_b64_tr_b16 a[182:183], v22 offset:28672
v_cvt_pk_bf16_f32 v52, v6, v7
v_mfma_f32_16x16x32_bf16 v[124:127], a[168:171], v[76:79], v[124:127]
s_waitcnt lgkmcnt(6)
v_exp_f32 v8, v34
v_mfma_f32_16x16x32_bf16 v[124:127], a[172:175], v[80:83], v[124:127]
ds_read_b128 a[156:159], v19 offset:36864
v_mfma_f32_16x16x32_bf16 v[128:131], a[172:175], v[88:91], v[128:131]
v_exp_f32 v9, v35
v_mfma_f32_16x16x32_bf16 v[128:131], a[168:171], v[84:87], v[128:131]
v_mfma_f32_16x16x32_bf16 v[32:35], a[128:131], a[112:115], v[248:251]
v_exp_f32 v6, v28
v_mfma_f32_16x16x32_bf16 v[32:35], a[132:135], a[116:119], v[32:35]
ds_read_b64_tr_b16 a[184:185], v23 offset:16384
v_cvt_pk_bf16_f32 v53, v8, v9
v_mfma_f32_16x16x32_bf16 v[32:35], a[136:139], a[120:123], v[32:35]
v_exp_f32 v7, v29
v_mfma_f32_16x16x32_bf16 v[32:35], a[140:143], a[124:127], v[32:35]
ds_read_b64_tr_b16 a[186:187], v23 offset:20480
v_cvt_pk_bf16_f32 v60, v6, v7
v_mfma_f32_16x16x32_bf16 v[132:135], a[168:171], v[92:95], v[132:135]
v_exp_f32 v8, v30
v_mfma_f32_16x16x32_bf16 v[132:135], a[172:175], v[96:99], v[132:135]
ds_read_b128 a[128:131], v16 offset:40960
v_mfma_f32_16x16x32_bf16 v[136:139], a[172:175], v[104:107], v[136:139]
s_add_u32 m0, s37, 114688
v_exp_f32 v9, v31
v_mfma_f32_16x16x32_bf16 v[136:139], a[168:171], v[100:103], v[136:139]
buffer_load_dwordx4 v14, s[16:19], s42 offen offset:0 lds
v_smfmac_f32_16x16x64_bf16 a[32:35], a[48:51], v[76:83], v37
v_mfma_f32_16x16x32_bf16 v[28:31], a[144:147], a[64:67], v[236:239]
s_waitcnt lgkmcnt(9)
v_exp_f32 v6, v32
v_mfma_f32_16x16x32_bf16 v[28:31], a[148:151], a[68:71], v[28:31]
s_waitcnt lgkmcnt(6)
ds_read_b64_tr_b16 a[188:189], v23 offset:24576
v_cvt_pk_bf16_f32 v61, v8, v9
v_mfma_f32_16x16x32_bf16 v[28:31], a[152:155], a[72:75], v[28:31]
s_waitcnt lgkmcnt(4)
v_exp_f32 v7, v33
v_mfma_f32_16x16x32_bf16 v[28:31], a[156:159], a[76:79], v[28:31]
ds_read_b64_tr_b16 a[190:191], v23 offset:28672
v_cvt_pk_bf16_f32 v68, v6, v7
v_mfma_f32_16x16x32_bf16 v[140:143], a[176:179], v[76:79], v[140:143]
v_exp_f32 v8, v34
v_mfma_f32_16x16x32_bf16 v[140:143], a[180:183], v[80:83], v[140:143]
ds_read_b128 a[132:135], v17 offset:40960
v_mfma_f32_16x16x32_bf16 v[144:147], a[180:183], v[88:91], v[144:147]
v_exp_f32 v9, v35
v_mfma_f32_16x16x32_bf16 v[144:147], a[176:179], v[84:87], v[144:147]
buffer_load_ushort a56, v38, s[32:35], s95 offen offset:128
v_mfma_f32_16x16x32_bf16 v[32:35], a[144:147], a[80:83], v[240:243]
v_exp_f32 v6, v28
v_mfma_f32_16x16x32_bf16 v[32:35], a[148:151], a[84:87], v[32:35]
ds_read_b64_tr_b16 a[160:161], v24 offset:16384
v_cvt_pk_bf16_f32 v69, v8, v9
v_mfma_f32_16x16x32_bf16 v[32:35], a[152:155], a[88:91], v[32:35]
v_exp_f32 v7, v29
v_mfma_f32_16x16x32_bf16 v[32:35], a[156:159], a[92:95], v[32:35]
ds_read_b64_tr_b16 a[162:163], v24 offset:20480
v_cvt_pk_bf16_f32 v46, v6, v7
v_mfma_f32_16x16x32_bf16 v[148:151], a[176:179], v[92:95], v[148:151]
v_exp_f32 v8, v30
v_mfma_f32_16x16x32_bf16 v[148:151], a[180:183], v[96:99], v[148:151]
ds_read_b128 a[136:139], v18 offset:40960
v_mfma_f32_16x16x32_bf16 v[152:155], a[180:183], v[104:107], v[152:155]
v_exp_f32 v9, v31
v_mfma_f32_16x16x32_bf16 v[152:155], a[176:179], v[100:103], v[152:155]
buffer_load_dwordx4 v15, s[16:19], s42 offen offset:1024 lds
v_mfma_f32_16x16x32_bf16 v[28:31], a[144:147], a[96:99], v[244:247]
v_exp_f32 v6, v32
v_mfma_f32_16x16x32_bf16 v[28:31], a[148:151], a[100:103], v[28:31]
ds_read_b64_tr_b16 a[164:165], v24 offset:24576
v_cvt_pk_bf16_f32 v47, v8, v9
v_mfma_f32_16x16x32_bf16 v[28:31], a[152:155], a[104:107], v[28:31]
v_exp_f32 v7, v33
v_mfma_f32_16x16x32_bf16 v[28:31], a[156:159], a[108:111], v[28:31]
s_waitcnt lgkmcnt(8)
ds_read_b64_tr_b16 a[166:167], v24 offset:28672
v_cvt_pk_bf16_f32 v54, v6, v7
v_mfma_f32_16x16x32_bf16 v[156:159], a[184:187], v[76:79], v[156:159]
s_waitcnt lgkmcnt(6)
v_exp_f32 v8, v34
v_mfma_f32_16x16x32_bf16 v[156:159], a[188:191], v[80:83], v[156:159]
ds_read_b128 a[140:143], v19 offset:40960
v_mfma_f32_16x16x32_bf16 v[160:163], a[188:191], v[88:91], v[160:163]
v_exp_f32 v9, v35
v_mfma_f32_16x16x32_bf16 v[160:163], a[184:187], v[84:87], v[160:163]
buffer_load_ushort a57, v38, s[32:35], s95 offen offset:160
v_mfma_f32_16x16x32_bf16 v[32:35], a[144:147], a[112:115], v[248:251]
v_exp_f32 v6, v28
v_mfma_f32_16x16x32_bf16 v[32:35], a[148:151], a[116:119], v[32:35]
ds_read_b64_tr_b16 a[168:169], v25 offset:16384
v_cvt_pk_bf16_f32 v55, v8, v9
v_mfma_f32_16x16x32_bf16 v[32:35], a[152:155], a[120:123], v[32:35]
v_exp_f32 v7, v29
v_mfma_f32_16x16x32_bf16 v[32:35], a[156:159], a[124:127], v[32:35]
ds_read_b64_tr_b16 a[170:171], v25 offset:20480
v_cvt_pk_bf16_f32 v62, v6, v7
v_mfma_f32_16x16x32_bf16 v[164:167], a[184:187], v[92:95], v[164:167]
v_exp_f32 v8, v30
v_mfma_f32_16x16x32_bf16 v[164:167], a[188:191], v[96:99], v[164:167]
ds_read_b128 a[144:147], v16 offset:45056
v_mfma_f32_16x16x32_bf16 v[168:171], a[188:191], v[104:107], v[168:171]
v_exp_f32 v9, v31
v_mfma_f32_16x16x32_bf16 v[168:171], a[184:187], v[100:103], v[168:171]
buffer_load_dwordx4 v14, s[16:19], s42 offen offset:2048 lds
v_smfmac_f32_16x16x64_bf16 a[36:39], a[48:51], v[84:91], v37
v_mfma_f32_16x16x32_bf16 v[28:31], a[128:131], a[64:67], v[236:239]
s_waitcnt lgkmcnt(9)
v_exp_f32 v6, v32
v_mfma_f32_16x16x32_bf16 v[28:31], a[132:135], a[68:71], v[28:31]
s_waitcnt lgkmcnt(6)
ds_read_b64_tr_b16 a[172:173], v25 offset:24576
v_cvt_pk_bf16_f32 v63, v8, v9
v_mfma_f32_16x16x32_bf16 v[28:31], a[136:139], a[72:75], v[28:31]
s_waitcnt lgkmcnt(4)
v_exp_f32 v7, v33
v_mfma_f32_16x16x32_bf16 v[28:31], a[140:143], a[76:79], v[28:31]
ds_read_b64_tr_b16 a[174:175], v25 offset:28672
v_cvt_pk_bf16_f32 v70, v6, v7
v_mfma_f32_16x16x32_bf16 v[172:175], a[160:163], v[76:79], v[172:175]
v_exp_f32 v8, v34
v_mfma_f32_16x16x32_bf16 v[172:175], a[164:167], v[80:83], v[172:175]
ds_read_b128 a[148:151], v17 offset:45056
v_mfma_f32_16x16x32_bf16 v[176:179], a[164:167], v[88:91], v[176:179]
v_exp_f32 v9, v35
v_mfma_f32_16x16x32_bf16 v[176:179], a[160:163], v[84:87], v[176:179]
buffer_load_ushort a58, v38, s[32:35], s95 offen offset:192
v_mfma_f32_16x16x32_bf16 v[32:35], a[128:131], a[80:83], v[240:243]
v_exp_f32 v6, v28
v_mfma_f32_16x16x32_bf16 v[32:35], a[132:135], a[84:87], v[32:35]
ds_read_b64_tr_b16 a[176:177], v26 offset:16384
v_cvt_pk_bf16_f32 v71, v8, v9
v_mfma_f32_16x16x32_bf16 v[32:35], a[136:139], a[88:91], v[32:35]
v_exp_f32 v7, v29
v_mfma_f32_16x16x32_bf16 v[32:35], a[140:143], a[92:95], v[32:35]
ds_read_b64_tr_b16 a[178:179], v26 offset:20480
v_cvt_pk_bf16_f32 v48, v6, v7
v_mfma_f32_16x16x32_bf16 v[180:183], a[160:163], v[92:95], v[180:183]
v_exp_f32 v8, v30
v_mfma_f32_16x16x32_bf16 v[180:183], a[164:167], v[96:99], v[180:183]
ds_read_b128 a[152:155], v18 offset:45056
v_mfma_f32_16x16x32_bf16 v[184:187], a[164:167], v[104:107], v[184:187]
v_exp_f32 v9, v31
v_mfma_f32_16x16x32_bf16 v[184:187], a[160:163], v[100:103], v[184:187]
buffer_load_dwordx4 v15, s[16:19], s42 offen offset:3072 lds
v_mfma_f32_16x16x32_bf16 v[28:31], a[128:131], a[96:99], v[244:247]
s_add_u32 s42, s42, 16384
v_exp_f32 v6, v32
v_mfma_f32_16x16x32_bf16 v[28:31], a[132:135], a[100:103], v[28:31]
ds_read_b64_tr_b16 a[180:181], v26 offset:24576
v_cvt_pk_bf16_f32 v49, v8, v9
v_mfma_f32_16x16x32_bf16 v[28:31], a[136:139], a[104:107], v[28:31]
v_exp_f32 v7, v33
v_mfma_f32_16x16x32_bf16 v[28:31], a[140:143], a[108:111], v[28:31]
s_waitcnt lgkmcnt(8)
ds_read_b64_tr_b16 a[182:183], v26 offset:28672
v_cvt_pk_bf16_f32 v56, v6, v7
v_mfma_f32_16x16x32_bf16 v[188:191], a[168:171], v[76:79], v[188:191]
s_waitcnt lgkmcnt(6)
v_exp_f32 v8, v34
v_mfma_f32_16x16x32_bf16 v[188:191], a[172:175], v[80:83], v[188:191]
ds_read_b128 a[156:159], v19 offset:45056
v_mfma_f32_16x16x32_bf16 v[192:195], a[172:175], v[88:91], v[192:195]
v_exp_f32 v9, v35
v_mfma_f32_16x16x32_bf16 v[192:195], a[168:171], v[84:87], v[192:195]
s_waitcnt vmcnt(12)
s_barrier
v_mfma_f32_16x16x32_bf16 v[32:35], a[128:131], a[112:115], v[248:251]
v_exp_f32 v6, v28
v_mfma_f32_16x16x32_bf16 v[32:35], a[132:135], a[116:119], v[32:35]
ds_read_b64_tr_b16 a[184:185], v27 offset:16384
v_cvt_pk_bf16_f32 v57, v8, v9
v_mfma_f32_16x16x32_bf16 v[32:35], a[136:139], a[120:123], v[32:35]
v_exp_f32 v7, v29
v_mfma_f32_16x16x32_bf16 v[32:35], a[140:143], a[124:127], v[32:35]
ds_read_b64_tr_b16 a[186:187], v27 offset:20480
v_cvt_pk_bf16_f32 v64, v6, v7
v_mfma_f32_16x16x32_bf16 v[196:199], a[168:171], v[92:95], v[196:199]
v_exp_f32 v8, v30
v_mfma_f32_16x16x32_bf16 v[196:199], a[172:175], v[96:99], v[196:199]
ds_read_b128 a[128:131], v16 offset:49152
v_mfma_f32_16x16x32_bf16 v[200:203], a[172:175], v[104:107], v[200:203]
s_add_u32 m0, s37, 16384
v_exp_f32 v9, v31
v_mfma_f32_16x16x32_bf16 v[200:203], a[168:171], v[100:103], v[200:203]
buffer_load_dwordx4 v2, s[24:27], s43 offen offset:0 lds
v_smfmac_f32_16x16x64_bf16 a[40:43], a[48:51], v[92:99], v37
v_mfma_f32_16x16x32_bf16 v[28:31], a[144:147], a[64:67], v[236:239]
s_waitcnt lgkmcnt(9)
v_exp_f32 v6, v32
v_mfma_f32_16x16x32_bf16 v[28:31], a[148:151], a[68:71], v[28:31]
s_waitcnt lgkmcnt(6)
ds_read_b64_tr_b16 a[188:189], v27 offset:24576
v_cvt_pk_bf16_f32 v65, v8, v9
v_mfma_f32_16x16x32_bf16 v[28:31], a[152:155], a[72:75], v[28:31]
s_waitcnt lgkmcnt(4)
v_exp_f32 v7, v33
v_mfma_f32_16x16x32_bf16 v[28:31], a[156:159], a[76:79], v[28:31]
ds_read_b64_tr_b16 a[190:191], v27 offset:28672
v_cvt_pk_bf16_f32 v72, v6, v7
v_mfma_f32_16x16x32_bf16 v[204:207], a[176:179], v[76:79], v[204:207]
v_exp_f32 v8, v34
v_mfma_f32_16x16x32_bf16 v[204:207], a[180:183], v[80:83], v[204:207]
ds_read_b128 a[132:135], v17 offset:49152
v_mfma_f32_16x16x32_bf16 v[208:211], a[180:183], v[88:91], v[208:211]
v_exp_f32 v9, v35
v_mfma_f32_16x16x32_bf16 v[208:211], a[176:179], v[84:87], v[208:211]
buffer_load_ushort a59, v38, s[32:35], s95 offen offset:224
v_mfma_f32_16x16x32_bf16 v[32:35], a[144:147], a[80:83], v[240:243]
v_exp_f32 v6, v28
v_mfma_f32_16x16x32_bf16 v[32:35], a[148:151], a[84:87], v[32:35]
ds_read_b64_tr_b16 a[160:161], v20 offset:32768
v_cvt_pk_bf16_f32 v73, v8, v9
v_mfma_f32_16x16x32_bf16 v[32:35], a[152:155], a[88:91], v[32:35]
v_exp_f32 v7, v29
v_mfma_f32_16x16x32_bf16 v[32:35], a[156:159], a[92:95], v[32:35]
ds_read_b64_tr_b16 a[162:163], v20 offset:36864
v_cvt_pk_bf16_f32 v50, v6, v7
v_mfma_f32_16x16x32_bf16 v[212:215], a[176:179], v[92:95], v[212:215]
v_exp_f32 v8, v30
v_mfma_f32_16x16x32_bf16 v[212:215], a[180:183], v[96:99], v[212:215]
ds_read_b128 a[136:139], v18 offset:49152
v_readfirstlane_b32 s54, v252
v_mfma_f32_16x16x32_bf16 v[216:219], a[180:183], v[104:107], v[216:219]
v_exp_f32 v9, v31
v_mfma_f32_16x16x32_bf16 v[216:219], a[176:179], v[100:103], v[216:219]
buffer_load_dwordx4 v3, s[24:27], s43 offen offset:1024 lds
v_mfma_f32_16x16x32_bf16 v[28:31], a[144:147], a[96:99], v[244:247]
v_exp_f32 v6, v32
v_mfma_f32_16x16x32_bf16 v[28:31], a[148:151], a[100:103], v[28:31]
ds_read_b64_tr_b16 a[164:165], v20 offset:40960
v_cvt_pk_bf16_f32 v51, v8, v9
v_mfma_f32_16x16x32_bf16 v[28:31], a[152:155], a[104:107], v[28:31]
v_exp_f32 v7, v33
v_mfma_f32_16x16x32_bf16 v[28:31], a[156:159], a[108:111], v[28:31]
s_waitcnt lgkmcnt(8)
ds_read_b64_tr_b16 a[166:167], v20 offset:45056
v_cvt_pk_bf16_f32 v58, v6, v7
v_mfma_f32_16x16x32_bf16 v[220:223], a[184:187], v[76:79], v[220:223]
s_waitcnt lgkmcnt(6)
v_exp_f32 v8, v34
v_mfma_f32_16x16x32_bf16 v[220:223], a[188:191], v[80:83], v[220:223]
ds_read_b128 a[140:143], v19 offset:49152
v_mfma_f32_16x16x32_bf16 v[224:227], a[188:191], v[88:91], v[224:227]
v_exp_f32 v9, v35
v_mfma_f32_16x16x32_bf16 v[224:227], a[184:187], v[84:87], v[224:227]
s_cmp_lt_u32 s54, s91
s_cbranch_scc1 L2_wn
L2_wn_r:
v_mfma_f32_16x16x32_bf16 v[32:35], a[144:147], a[112:115], v[248:251]
v_exp_f32 v6, v28
v_mfma_f32_16x16x32_bf16 v[32:35], a[148:151], a[116:119], v[32:35]
ds_read_b64_tr_b16 a[168:169], v21 offset:32768
v_cvt_pk_bf16_f32 v59, v8, v9
v_mfma_f32_16x16x32_bf16 v[32:35], a[152:155], a[120:123], v[32:35]
v_exp_f32 v7, v29
v_mfma_f32_16x16x32_bf16 v[32:35], a[156:159], a[124:127], v[32:35]
ds_read_b64_tr_b16 a[170:171], v21 offset:36864
v_cvt_pk_bf16_f32 v66, v6, v7
v_mfma_f32_16x16x32_bf16 v[228:231], a[184:187], v[92:95], v[228:231]
v_exp_f32 v8, v30
v_mfma_f32_16x16x32_bf16 v[228:231], a[188:191], v[96:99], v[228:231]
ds_read_b128 a[144:147], v16 offset:53248
v_mfma_f32_16x16x32_bf16 v[232:235], a[188:191], v[104:107], v[232:235]
v_exp_f32 v9, v31
v_mfma_f32_16x16x32_bf16 v[232:235], a[184:187], v[100:103], v[232:235]
buffer_load_dwordx4 v4, s[24:27], s43 offen offset:2048 lds
v_smfmac_f32_16x16x64_bf16 a[44:47], a[48:51], v[100:107], v37
v_mfma_f32_16x16x32_bf16 v[28:31], a[128:131], a[64:67], v[236:239]
s_waitcnt lgkmcnt(9)
v_exp_f32 v6, v32
v_mfma_f32_16x16x32_bf16 v[28:31], a[132:135], a[68:71], v[28:31]
s_waitcnt lgkmcnt(6)
ds_read_b64_tr_b16 a[172:173], v21 offset:40960
v_cvt_pk_bf16_f32 v67, v8, v9
v_mfma_f32_16x16x32_bf16 v[28:31], a[136:139], a[72:75], v[28:31]
s_waitcnt lgkmcnt(4)
v_exp_f32 v7, v33
v_mfma_f32_16x16x32_bf16 v[28:31], a[140:143], a[76:79], v[28:31]
ds_read_b64_tr_b16 a[174:175], v21 offset:45056
v_cvt_pk_bf16_f32 v74, v6, v7
v_mfma_f32_16x16x32_bf16 v[108:111], a[160:163], v[44:47], v[108:111]
v_exp_f32 v8, v34
v_mfma_f32_16x16x32_bf16 v[108:111], a[164:167], v[48:51], v[108:111]
ds_read_b128 a[148:151], v17 offset:53248
v_mfma_f32_16x16x32_bf16 v[112:115], a[164:167], v[56:59], v[112:115]
v_exp_f32 v9, v35
v_mfma_f32_16x16x32_bf16 v[112:115], a[160:163], v[52:55], v[112:115]
buffer_load_dwordx4 a[192:195], v36, s[4:7], s44 offen offset:0 sc1
v_mfma_f32_16x16x32_bf16 v[32:35], a[128:131], a[80:83], v[240:243]
v_exp_f32 v6, v28
v_mfma_f32_16x16x32_bf16 v[32:35], a[132:135], a[84:87], v[32:35]
ds_read_b64_tr_b16 a[176:177], v22 offset:32768
v_cvt_pk_bf16_f32 v75, v8, v9
v_mfma_f32_16x16x32_bf16 v[32:35], a[136:139], a[88:91], v[32:35]
v_exp_f32 v7, v29
v_mfma_f32_16x16x32_bf16 v[32:35], a[140:143], a[92:95], v[32:35]
ds_read_b64_tr_b16 a[178:179], v22 offset:36864
v_cvt_pk_bf16_f32 v76, v6, v7
v_mfma_f32_16x16x32_bf16 v[116:119], a[160:163], v[60:63], v[116:119]
v_exp_f32 v8, v30
v_mfma_f32_16x16x32_bf16 v[116:119], a[164:167], v[64:67], v[116:119]
ds_read_b128 a[152:155], v18 offset:53248
v_mfma_f32_16x16x32_bf16 v[120:123], a[164:167], v[72:75], v[120:123]
v_exp_f32 v9, v31
v_mfma_f32_16x16x32_bf16 v[120:123], a[160:163], v[68:71], v[120:123]
buffer_load_dwordx4 v5, s[24:27], s43 offen offset:3072 lds
v_mfma_f32_16x16x32_bf16 v[28:31], a[128:131], a[96:99], v[244:247]
s_add_u32 s43, s43, s73
v_exp_f32 v6, v32
v_mfma_f32_16x16x32_bf16 v[28:31], a[132:135], a[100:103], v[28:31]
ds_read_b64_tr_b16 a[180:181], v22 offset:40960
v_cvt_pk_bf16_f32 v77, v8, v9
v_mfma_f32_16x16x32_bf16 v[28:31], a[136:139], a[104:107], v[28:31]
v_exp_f32 v7, v33
v_mfma_f32_16x16x32_bf16 v[28:31], a[140:143], a[108:111], v[28:31]
s_waitcnt lgkmcnt(8)
ds_read_b64_tr_b16 a[182:183], v22 offset:45056
v_cvt_pk_bf16_f32 v84, v6, v7
v_mfma_f32_16x16x32_bf16 v[124:127], a[168:171], v[44:47], v[124:127]
s_waitcnt lgkmcnt(6)
v_exp_f32 v8, v34
v_mfma_f32_16x16x32_bf16 v[124:127], a[172:175], v[48:51], v[124:127]
ds_read_b128 a[156:159], v19 offset:53248
v_mfma_f32_16x16x32_bf16 v[128:131], a[172:175], v[56:59], v[128:131]
v_exp_f32 v9, v35
v_mfma_f32_16x16x32_bf16 v[128:131], a[168:171], v[52:55], v[128:131]
buffer_load_dwordx4 a[196:199], v36, s[4:7], s44 offen offset:1024 sc1
v_mfma_f32_16x16x32_bf16 v[32:35], a[128:131], a[112:115], v[248:251]
v_exp_f32 v6, v28
v_mfma_f32_16x16x32_bf16 v[32:35], a[132:135], a[116:119], v[32:35]
ds_read_b64_tr_b16 a[184:185], v23 offset:32768
v_cvt_pk_bf16_f32 v85, v8, v9
v_mfma_f32_16x16x32_bf16 v[32:35], a[136:139], a[120:123], v[32:35]
v_exp_f32 v7, v29
v_mfma_f32_16x16x32_bf16 v[32:35], a[140:143], a[124:127], v[32:35]
ds_read_b64_tr_b16 a[186:187], v23 offset:36864
v_cvt_pk_bf16_f32 v92, v6, v7
v_mfma_f32_16x16x32_bf16 v[132:135], a[168:171], v[60:63], v[132:135]
v_exp_f32 v8, v30
v_mfma_f32_16x16x32_bf16 v[132:135], a[172:175], v[64:67], v[132:135]
ds_read_b128 a[128:131], v16 offset:57344
v_mfma_f32_16x16x32_bf16 v[136:139], a[172:175], v[72:75], v[136:139]
v_exp_f32 v9, v31
v_mfma_f32_16x16x32_bf16 v[136:139], a[168:171], v[68:71], v[136:139]
buffer_load_dwordx4 a[208:211], v36, s[4:7], s44 offen offset:2048 sc1
v_smfmac_f32_16x16x64_bf16 a[32:35], a[48:51], v[44:51], v37
buffer_load_dwordx4 a[212:215], v36, s[4:7], s44 offen offset:3072 sc1
v_mfma_f32_16x16x32_bf16 v[28:31], a[144:147], a[64:67], v[236:239]
s_waitcnt lgkmcnt(9)
v_exp_f32 v6, v32
v_mfma_f32_16x16x32_bf16 v[28:31], a[148:151], a[68:71], v[28:31]
s_waitcnt lgkmcnt(6)
ds_read_b64_tr_b16 a[188:189], v23 offset:40960
v_cvt_pk_bf16_f32 v93, v8, v9
v_mfma_f32_16x16x32_bf16 v[28:31], a[152:155], a[72:75], v[28:31]
s_waitcnt lgkmcnt(4)
v_exp_f32 v7, v33
v_mfma_f32_16x16x32_bf16 v[28:31], a[156:159], a[76:79], v[28:31]
ds_read_b64_tr_b16 a[190:191], v23 offset:45056
v_cvt_pk_bf16_f32 v100, v6, v7
v_mfma_f32_16x16x32_bf16 v[140:143], a[176:179], v[44:47], v[140:143]
v_exp_f32 v8, v34
v_mfma_f32_16x16x32_bf16 v[140:143], a[180:183], v[48:51], v[140:143]
ds_read_b128 a[132:135], v17 offset:57344
v_mfma_f32_16x16x32_bf16 v[144:147], a[180:183], v[56:59], v[144:147]
v_exp_f32 v9, v35
v_mfma_f32_16x16x32_bf16 v[144:147], a[176:179], v[52:55], v[144:147]
buffer_load_dwordx4 a[200:203], v253, s[4:7], s44 offen offset:0 sc1
v_mfma_f32_16x16x32_bf16 v[32:35], a[144:147], a[80:83], v[240:243]
v_exp_f32 v6, v28
v_mfma_f32_16x16x32_bf16 v[32:35], a[148:151], a[84:87], v[32:35]
ds_read_b64_tr_b16 a[160:161], v24 offset:32768
v_cvt_pk_bf16_f32 v101, v8, v9
v_mfma_f32_16x16x32_bf16 v[32:35], a[152:155], a[88:91], v[32:35]
v_exp_f32 v7, v29
v_mfma_f32_16x16x32_bf16 v[32:35], a[156:159], a[92:95], v[32:35]
ds_read_b64_tr_b16 a[162:163], v24 offset:36864
v_cvt_pk_bf16_f32 v78, v6, v7
v_mfma_f32_16x16x32_bf16 v[148:151], a[176:179], v[60:63], v[148:151]
v_exp_f32 v8, v30
v_mfma_f32_16x16x32_bf16 v[148:151], a[180:183], v[64:67], v[148:151]
ds_read_b128 a[136:139], v18 offset:57344
v_mfma_f32_16x16x32_bf16 v[152:155], a[180:183], v[72:75], v[152:155]
v_exp_f32 v9, v31
v_mfma_f32_16x16x32_bf16 v[152:155], a[176:179], v[68:71], v[152:155]
buffer_load_dwordx4 a[204:207], v253, s[4:7], s44 offen offset:1024 sc1
v_mfma_f32_16x16x32_bf16 v[28:31], a[144:147], a[96:99], v[244:247]
v_exp_f32 v6, v32
v_mfma_f32_16x16x32_bf16 v[28:31], a[148:151], a[100:103], v[28:31]
ds_read_b64_tr_b16 a[164:165], v24 offset:40960
v_cvt_pk_bf16_f32 v79, v8, v9
v_mfma_f32_16x16x32_bf16 v[28:31], a[152:155], a[104:107], v[28:31]
v_exp_f32 v7, v33
v_mfma_f32_16x16x32_bf16 v[28:31], a[156:159], a[108:111], v[28:31]
s_waitcnt lgkmcnt(8)
ds_read_b64_tr_b16 a[166:167], v24 offset:45056
v_cvt_pk_bf16_f32 v86, v6, v7
v_mfma_f32_16x16x32_bf16 v[156:159], a[184:187], v[44:47], v[156:159]
s_waitcnt lgkmcnt(6)
v_exp_f32 v8, v34
v_mfma_f32_16x16x32_bf16 v[156:159], a[188:191], v[48:51], v[156:159]
ds_read_b128 a[140:143], v19 offset:57344
v_mfma_f32_16x16x32_bf16 v[160:163], a[188:191], v[56:59], v[160:163]
v_exp_f32 v9, v35
v_mfma_f32_16x16x32_bf16 v[160:163], a[184:187], v[52:55], v[160:163]
buffer_load_dwordx4 a[216:219], v253, s[4:7], s44 offen offset:2048 sc1
v_mfma_f32_16x16x32_bf16 v[32:35], a[144:147], a[112:115], v[248:251]
v_exp_f32 v6, v28
v_mfma_f32_16x16x32_bf16 v[32:35], a[148:151], a[116:119], v[32:35]
ds_read_b64_tr_b16 a[168:169], v25 offset:32768
v_cvt_pk_bf16_f32 v87, v8, v9
v_mfma_f32_16x16x32_bf16 v[32:35], a[152:155], a[120:123], v[32:35]
v_exp_f32 v7, v29
v_mfma_f32_16x16x32_bf16 v[32:35], a[156:159], a[124:127], v[32:35]
ds_read_b64_tr_b16 a[170:171], v25 offset:36864
v_cvt_pk_bf16_f32 v94, v6, v7
v_mfma_f32_16x16x32_bf16 v[164:167], a[184:187], v[60:63], v[164:167]
v_exp_f32 v8, v30
v_mfma_f32_16x16x32_bf16 v[164:167], a[188:191], v[64:67], v[164:167]
ds_read_b128 a[144:147], v16 offset:61440
v_mfma_f32_16x16x32_bf16 v[168:171], a[188:191], v[72:75], v[168:171]
v_exp_f32 v9, v31
v_mfma_f32_16x16x32_bf16 v[168:171], a[184:187], v[68:71], v[168:171]
buffer_load_dwordx4 a[220:223], v253, s[4:7], s44 offen offset:3072 sc1
v_smfmac_f32_16x16x64_bf16 a[36:39], a[48:51], v[52:59], v37
s_add_u32 s44, s44, s74
buffer_load_dwordx4 a[224:227], v36, s[4:7], s44 offen offset:0 sc1
v_mfma_f32_16x16x32_bf16 v[28:31], a[128:131], a[64:67], v[236:239]
s_waitcnt lgkmcnt(9)
v_exp_f32 v6, v32
v_mfma_f32_16x16x32_bf16 v[28:31], a[132:135], a[68:71], v[28:31]
s_waitcnt lgkmcnt(6)
ds_read_b64_tr_b16 a[172:173], v25 offset:40960
v_cvt_pk_bf16_f32 v95, v8, v9
v_mfma_f32_16x16x32_bf16 v[28:31], a[136:139], a[72:75], v[28:31]
s_waitcnt lgkmcnt(4)
v_exp_f32 v7, v33
v_mfma_f32_16x16x32_bf16 v[28:31], a[140:143], a[76:79], v[28:31]
ds_read_b64_tr_b16 a[174:175], v25 offset:45056
v_cvt_pk_bf16_f32 v102, v6, v7
v_mfma_f32_16x16x32_bf16 v[172:175], a[160:163], v[44:47], v[172:175]
v_exp_f32 v8, v34
v_mfma_f32_16x16x32_bf16 v[172:175], a[164:167], v[48:51], v[172:175]
ds_read_b128 a[148:151], v17 offset:61440
v_mfma_f32_16x16x32_bf16 v[176:179], a[164:167], v[56:59], v[176:179]
v_exp_f32 v9, v35
v_mfma_f32_16x16x32_bf16 v[176:179], a[160:163], v[52:55], v[176:179]
buffer_load_dwordx4 a[228:231], v36, s[4:7], s44 offen offset:1024 sc1
v_mfma_f32_16x16x32_bf16 v[32:35], a[128:131], a[80:83], v[240:243]
v_exp_f32 v6, v28
v_mfma_f32_16x16x32_bf16 v[32:35], a[132:135], a[84:87], v[32:35]
ds_read_b64_tr_b16 a[176:177], v26 offset:32768
v_cvt_pk_bf16_f32 v103, v8, v9
v_mfma_f32_16x16x32_bf16 v[32:35], a[136:139], a[88:91], v[32:35]
v_exp_f32 v7, v29
v_mfma_f32_16x16x32_bf16 v[32:35], a[140:143], a[92:95], v[32:35]
ds_read_b64_tr_b16 a[178:179], v26 offset:36864
v_cvt_pk_bf16_f32 v80, v6, v7
v_mfma_f32_16x16x32_bf16 v[180:183], a[160:163], v[60:63], v[180:183]
v_exp_f32 v8, v30
v_mfma_f32_16x16x32_bf16 v[180:183], a[164:167], v[64:67], v[180:183]
ds_read_b128 a[152:155], v18 offset:61440
v_mfma_f32_16x16x32_bf16 v[184:187], a[164:167], v[72:75], v[184:187]
v_exp_f32 v9, v31
v_mfma_f32_16x16x32_bf16 v[184:187], a[160:163], v[68:71], v[184:187]
buffer_load_dwordx4 a[240:243], v36, s[4:7], s44 offen offset:2048 sc1
v_mfma_f32_16x16x32_bf16 v[28:31], a[128:131], a[96:99], v[244:247]
v_exp_f32 v6, v32
v_mfma_f32_16x16x32_bf16 v[28:31], a[132:135], a[100:103], v[28:31]
ds_read_b64_tr_b16 a[180:181], v26 offset:40960
v_cvt_pk_bf16_f32 v81, v8, v9
v_mfma_f32_16x16x32_bf16 v[28:31], a[136:139], a[104:107], v[28:31]
v_exp_f32 v7, v33
v_mfma_f32_16x16x32_bf16 v[28:31], a[140:143], a[108:111], v[28:31]
s_waitcnt lgkmcnt(8)
ds_read_b64_tr_b16 a[182:183], v26 offset:45056
v_cvt_pk_bf16_f32 v88, v6, v7
v_mfma_f32_16x16x32_bf16 v[188:191], a[168:171], v[44:47], v[188:191]
s_waitcnt lgkmcnt(6)
v_exp_f32 v8, v34
v_mfma_f32_16x16x32_bf16 v[188:191], a[172:175], v[48:51], v[188:191]
ds_read_b128 a[156:159], v19 offset:61440
v_mfma_f32_16x16x32_bf16 v[192:195], a[172:175], v[56:59], v[192:195]
v_exp_f32 v9, v35
v_mfma_f32_16x16x32_bf16 v[192:195], a[168:171], v[52:55], v[192:195]
s_waitcnt vmcnt(16)
s_barrier
v_mfma_f32_16x16x32_bf16 v[32:35], a[128:131], a[112:115], v[248:251]
v_exp_f32 v6, v28
v_mfma_f32_16x16x32_bf16 v[32:35], a[132:135], a[116:119], v[32:35]
ds_read_b64_tr_b16 a[184:185], v27 offset:32768
v_cvt_pk_bf16_f32 v89, v8, v9
v_mfma_f32_16x16x32_bf16 v[32:35], a[136:139], a[120:123], v[32:35]
v_exp_f32 v7, v29
v_mfma_f32_16x16x32_bf16 v[32:35], a[140:143], a[124:127], v[32:35]
ds_read_b64_tr_b16 a[186:187], v27 offset:36864
v_cvt_pk_bf16_f32 v96, v6, v7
v_mfma_f32_16x16x32_bf16 v[196:199], a[168:171], v[60:63], v[196:199]
v_exp_f32 v8, v30
v_mfma_f32_16x16x32_bf16 v[196:199], a[172:175], v[64:67], v[196:199]
buffer_load_dwordx4 a[244:247], v36, s[4:7], s44 offen offset:3072 sc1
v_mfma_f32_16x16x32_bf16 v[200:203], a[172:175], v[72:75], v[200:203]
s_add_u32 m0, s37, 32768
v_exp_f32 v9, v31
v_mfma_f32_16x16x32_bf16 v[200:203], a[168:171], v[68:71], v[200:203]
buffer_load_dwordx4 v2, s[24:27], s43 offen offset:0 lds
v_smfmac_f32_16x16x64_bf16 a[40:43], a[48:51], v[60:67], v37
v_mfma_f32_16x16x32_bf16 v[28:31], a[144:147], a[64:67], v[236:239]
s_waitcnt lgkmcnt(8)
v_exp_f32 v6, v32
v_mfma_f32_16x16x32_bf16 v[28:31], a[148:151], a[68:71], v[28:31]
s_waitcnt lgkmcnt(5)
ds_read_b64_tr_b16 a[188:189], v27 offset:40960
v_cvt_pk_bf16_f32 v97, v8, v9
v_mfma_f32_16x16x32_bf16 v[28:31], a[152:155], a[72:75], v[28:31]
s_waitcnt lgkmcnt(3)
v_exp_f32 v7, v33
v_mfma_f32_16x16x32_bf16 v[28:31], a[156:159], a[76:79], v[28:31]
ds_read_b64_tr_b16 a[190:191], v27 offset:45056
v_cvt_pk_bf16_f32 v104, v6, v7
v_mfma_f32_16x16x32_bf16 v[204:207], a[176:179], v[44:47], v[204:207]
v_exp_f32 v8, v34
v_mfma_f32_16x16x32_bf16 v[204:207], a[180:183], v[48:51], v[204:207]
v_mfma_f32_16x16x32_bf16 v[208:211], a[180:183], v[56:59], v[208:211]
v_exp_f32 v9, v35
v_mfma_f32_16x16x32_bf16 v[208:211], a[176:179], v[52:55], v[208:211]
v_mfma_f32_16x16x32_bf16 v[32:35], a[144:147], a[80:83], v[240:243]
v_exp_f32 v6, v28
v_mfma_f32_16x16x32_bf16 v[32:35], a[148:151], a[84:87], v[32:35]
ds_read_b64_tr_b16 a[160:161], v20 offset:49152
v_cvt_pk_bf16_f32 v105, v8, v9
v_mfma_f32_16x16x32_bf16 v[32:35], a[152:155], a[88:91], v[32:35]
v_exp_f32 v7, v29
v_mfma_f32_16x16x32_bf16 v[32:35], a[156:159], a[92:95], v[32:35]
ds_read_b64_tr_b16 a[162:163], v20 offset:53248
v_cvt_pk_bf16_f32 v82, v6, v7
v_mfma_f32_16x16x32_bf16 v[212:215], a[176:179], v[60:63], v[212:215]
v_exp_f32 v8, v30
v_mfma_f32_16x16x32_bf16 v[212:215], a[180:183], v[64:67], v[212:215]
v_mfma_f32_16x16x32_bf16 v[216:219], a[180:183], v[72:75], v[216:219]
v_exp_f32 v9, v31
v_mfma_f32_16x16x32_bf16 v[216:219], a[176:179], v[68:71], v[216:219]
buffer_load_dwordx4 v3, s[24:27], s43 offen offset:1024 lds
v_mfma_f32_16x16x32_bf16 v[28:31], a[144:147], a[96:99], v[244:247]
v_exp_f32 v6, v32
v_mfma_f32_16x16x32_bf16 v[28:31], a[148:151], a[100:103], v[28:31]
ds_read_b64_tr_b16 a[164:165], v20 offset:57344
v_cvt_pk_bf16_f32 v83, v8, v9
v_mfma_f32_16x16x32_bf16 v[28:31], a[152:155], a[104:107], v[28:31]
v_exp_f32 v7, v33
v_mfma_f32_16x16x32_bf16 v[28:31], a[156:159], a[108:111], v[28:31]
s_waitcnt lgkmcnt(5)
ds_read_b64_tr_b16 a[166:167], v20 offset:61440
v_cvt_pk_bf16_f32 v90, v6, v7
v_mfma_f32_16x16x32_bf16 v[220:223], a[184:187], v[44:47], v[220:223]
s_waitcnt lgkmcnt(4)
v_exp_f32 v8, v34
v_mfma_f32_16x16x32_bf16 v[220:223], a[188:191], v[48:51], v[220:223]
v_mfma_f32_16x16x32_bf16 v[224:227], a[188:191], v[56:59], v[224:227]
v_exp_f32 v9, v35
v_mfma_f32_16x16x32_bf16 v[224:227], a[184:187], v[52:55], v[224:227]
v_mfma_f32_16x16x32_bf16 v[32:35], a[144:147], a[112:115], v[248:251]
v_exp_f32 v6, v28
v_mfma_f32_16x16x32_bf16 v[32:35], a[148:151], a[116:119], v[32:35]
ds_read_b64_tr_b16 a[168:169], v21 offset:49152
v_cvt_pk_bf16_f32 v91, v8, v9
v_mfma_f32_16x16x32_bf16 v[32:35], a[152:155], a[120:123], v[32:35]
v_exp_f32 v7, v29
v_mfma_f32_16x16x32_bf16 v[32:35], a[156:159], a[124:127], v[32:35]
ds_read_b64_tr_b16 a[170:171], v21 offset:53248
v_cvt_pk_bf16_f32 v98, v6, v7
v_mfma_f32_16x16x32_bf16 v[228:231], a[184:187], v[60:63], v[228:231]
v_exp_f32 v8, v30
v_mfma_f32_16x16x32_bf16 v[228:231], a[188:191], v[64:67], v[228:231]
v_mfma_f32_16x16x32_bf16 v[232:235], a[188:191], v[72:75], v[232:235]
v_exp_f32 v9, v31
v_mfma_f32_16x16x32_bf16 v[232:235], a[184:187], v[68:71], v[232:235]
v_smfmac_f32_16x16x64_bf16 a[44:47], a[48:51], v[68:75], v37
v_smfmac_f32_16x16x64_bf16 a[32:35], a[48:51], v[76:83], v37
v_exp_f32 v6, v32
ds_read_b64_tr_b16 a[172:173], v21 offset:57344
v_cvt_pk_bf16_f32 v99, v8, v9
v_smfmac_f32_16x16x64_bf16 a[36:39], a[48:51], v[84:91], v37
s_waitcnt lgkmcnt(5)
v_exp_f32 v7, v33
ds_read_b64_tr_b16 a[174:175], v21 offset:61440
v_cvt_pk_bf16_f32 v106, v6, v7
v_mfma_f32_16x16x32_bf16 v[108:111], a[160:163], v[76:79], v[108:111]
s_waitcnt lgkmcnt(4)
v_exp_f32 v8, v34
v_mfma_f32_16x16x32_bf16 v[108:111], a[164:167], v[80:83], v[108:111]
v_mfma_f32_16x16x32_bf16 v[112:115], a[164:167], v[88:91], v[112:115]
v_exp_f32 v9, v35
v_mfma_f32_16x16x32_bf16 v[112:115], a[160:163], v[84:87], v[112:115]
v_smfmac_f32_16x16x64_bf16 a[40:43], a[48:51], v[92:99], v37
ds_read_b64_tr_b16 a[176:177], v22 offset:49152
v_cvt_pk_bf16_f32 v107, v8, v9
ds_read_b64_tr_b16 a[178:179], v22 offset:53248
v_mfma_f32_16x16x32_bf16 v[116:119], a[160:163], v[92:95], v[116:119]
v_mfma_f32_16x16x32_bf16 v[116:119], a[164:167], v[96:99], v[116:119]
v_mfma_f32_16x16x32_bf16 v[120:123], a[164:167], v[104:107], v[120:123]
v_mfma_f32_16x16x32_bf16 v[120:123], a[160:163], v[100:103], v[120:123]
buffer_load_dwordx4 a[232:235], v253, s[4:7], s44 offen offset:0 sc1
v_smfmac_f32_16x16x64_bf16 a[44:47], a[48:51], v[100:107], v37
s_waitcnt lgkmcnt(4)
buffer_load_dwordx4 a[236:239], v253, s[4:7], s44 offen offset:1024 sc1
v_mfma_f32_16x16x32_bf16 v[124:127], a[168:171], v[76:79], v[124:127]
s_waitcnt lgkmcnt(2)
ds_read_b64_tr_b16 a[180:181], v22 offset:57344
v_mfma_f32_16x16x32_bf16 v[124:127], a[172:175], v[80:83], v[124:127]
buffer_load_dwordx4 a[248:251], v253, s[4:7], s44 offen offset:2048 sc1
v_mfma_f32_16x16x32_bf16 v[128:131], a[172:175], v[88:91], v[128:131]
ds_read_b64_tr_b16 a[182:183], v22 offset:61440
v_mfma_f32_16x16x32_bf16 v[128:131], a[168:171], v[84:87], v[128:131]
buffer_load_dwordx4 a[252:255], v253, s[4:7], s44 offen offset:3072 sc1
v_mfma_f32_16x16x32_bf16 v[132:135], a[168:171], v[92:95], v[132:135]
s_add_u32 s44, s44, s75
ds_read_b64_tr_b16 a[184:185], v23 offset:49152
v_accvgpr_read_b32 v236, a32
v_mfma_f32_16x16x32_bf16 v[132:135], a[172:175], v[96:99], v[132:135]
v_accvgpr_read_b32 v237, a33
v_accvgpr_read_b32 v238, a36
v_mfma_f32_16x16x32_bf16 v[136:139], a[172:175], v[104:107], v[136:139]
ds_read_b64_tr_b16 a[186:187], v23 offset:53248
v_accvgpr_read_b32 v239, a37
v_mfma_f32_16x16x32_bf16 v[136:139], a[168:171], v[100:103], v[136:139]
s_waitcnt lgkmcnt(4)
v_accvgpr_read_b32 v240, a40
v_accvgpr_read_b32 v241, a41
v_mfma_f32_16x16x32_bf16 v[140:143], a[176:179], v[76:79], v[140:143]
s_waitcnt lgkmcnt(2)
ds_read_b64_tr_b16 a[188:189], v23 offset:57344
v_accvgpr_read_b32 v242, a44
v_mfma_f32_16x16x32_bf16 v[140:143], a[180:183], v[80:83], v[140:143]
v_accvgpr_read_b32 v243, a45
v_add_f32 v236, v236, v237
v_mfma_f32_16x16x32_bf16 v[144:147], a[180:183], v[88:91], v[144:147]
ds_read_b64_tr_b16 a[190:191], v23 offset:61440
v_add_f32 v238, v238, v239
v_mfma_f32_16x16x32_bf16 v[144:147], a[176:179], v[84:87], v[144:147]
v_add_f32 v240, v240, v241
v_add_f32 v242, v242, v243
v_mfma_f32_16x16x32_bf16 v[148:151], a[176:179], v[92:95], v[148:151]
ds_read_b64_tr_b16 a[160:161], v24 offset:49152
v_add_f32 v40, v236, v238
v_mfma_f32_16x16x32_bf16 v[148:151], a[180:183], v[96:99], v[148:151]
v_add_f32 v41, v240, v242
v_add_f32 v40, v40, v41
v_mfma_f32_16x16x32_bf16 v[152:155], a[180:183], v[104:107], v[152:155]
ds_read_b64_tr_b16 a[162:163], v24 offset:53248
v_cmp_nge_f32 vcc, 0x47800000, v40
v_mfma_f32_16x16x32_bf16 v[152:155], a[176:179], v[100:103], v[152:155]
s_waitcnt lgkmcnt(4)
v_rcp_f32 v236, v236
v_mfma_f32_16x16x32_bf16 v[156:159], a[184:187], v[76:79], v[156:159]
s_waitcnt lgkmcnt(2)
ds_read_b64_tr_b16 a[164:165], v24 offset:57344
v_mfma_f32_16x16x32_bf16 v[156:159], a[188:191], v[80:83], v[156:159]
v_rcp_f32 v238, v238
v_mfma_f32_16x16x32_bf16 v[160:163], a[188:191], v[88:91], v[160:163]
s_cbranch_vccnz L2_bad
L2_bad_r:
ds_read_b64_tr_b16 a[166:167], v24 offset:61440
s_barrier
v_mfma_f32_16x16x32_bf16 v[160:163], a[184:187], v[84:87], v[160:163]
ds_read_b32 v38, v39
v_mfma_f32_16x16x32_bf16 v[164:167], a[184:187], v[92:95], v[164:167]
ds_read_b64_tr_b16 a[168:169], v25 offset:49152
v_mfma_f32_16x16x32_bf16 v[164:167], a[188:191], v[96:99], v[164:167]
v_rcp_f32 v240, v240
v_mfma_f32_16x16x32_bf16 v[168:171], a[188:191], v[104:107], v[168:171]
ds_read_b64_tr_b16 a[170:171], v25 offset:53248
v_mfma_f32_16x16x32_bf16 v[168:171], a[184:187], v[100:103], v[168:171]
s_waitcnt lgkmcnt(5)
v_rcp_f32 v242, v242
v_mfma_f32_16x16x32_bf16 v[172:175], a[160:163], v[76:79], v[172:175]
s_waitcnt lgkmcnt(3)
ds_read_b64_tr_b16 a[172:173], v25 offset:57344
v_mfma_f32_16x16x32_bf16 v[172:175], a[164:167], v[80:83], v[172:175]
buffer_load_dwordx4 v4, s[24:27], s43 offen offset:2048 lds
v_mfma_f32_16x16x32_bf16 v[176:179], a[164:167], v[88:91], v[176:179]
ds_read_b64_tr_b16 a[174:175], v25 offset:61440
v_mfma_f32_16x16x32_bf16 v[176:179], a[160:163], v[84:87], v[176:179]
buffer_load_dwordx4 v5, s[24:27], s43 offen offset:3072 lds
v_mfma_f32_16x16x32_bf16 v[180:183], a[160:163], v[92:95], v[180:183]
s_add_u32 s43, s43, s72
ds_read_b64_tr_b16 a[176:177], v26 offset:49152
v_mfma_f32_16x16x32_bf16 v[180:183], a[164:167], v[96:99], v[180:183]
buffer_load_dwordx4 a[128:131], v36, s[4:7], s44 offen offset:0 sc1
v_mfma_f32_16x16x32_bf16 v[184:187], a[164:167], v[104:107], v[184:187]
ds_read_b64_tr_b16 a[178:179], v26 offset:53248
v_mfma_f32_16x16x32_bf16 v[184:187], a[160:163], v[100:103], v[184:187]
s_waitcnt lgkmcnt(4)
buffer_load_dwordx4 a[132:135], v36, s[4:7], s44 offen offset:1024 sc1
v_mfma_f32_16x16x32_bf16 v[188:191], a[168:171], v[76:79], v[188:191]
s_waitcnt lgkmcnt(2)
ds_read_b64_tr_b16 a[180:181], v26 offset:57344
v_mfma_f32_16x16x32_bf16 v[188:191], a[172:175], v[80:83], v[188:191]
buffer_load_dwordx4 a[144:147], v36, s[4:7], s44 offen offset:2048 sc1
v_mfma_f32_16x16x32_bf16 v[192:195], a[172:175], v[88:91], v[192:195]
ds_read_b64_tr_b16 a[182:183], v26 offset:61440
v_mfma_f32_16x16x32_bf16 v[192:195], a[168:171], v[84:87], v[192:195]
buffer_load_dwordx4 a[148:151], v36, s[4:7], s44 offen offset:3072 sc1
v_mfma_f32_16x16x32_bf16 v[196:199], a[168:171], v[92:95], v[196:199]
ds_read_b64_tr_b16 a[184:185], v27 offset:49152
v_mfma_f32_16x16x32_bf16 v[196:199], a[172:175], v[96:99], v[196:199]
buffer_load_dwordx4 a[136:139], v253, s[4:7], s44 offen offset:0 sc1
v_mfma_f32_16x16x32_bf16 v[200:203], a[172:175], v[104:107], v[200:203]
ds_read_b64_tr_b16 a[186:187], v27 offset:53248
v_mfma_f32_16x16x32_bf16 v[200:203], a[168:171], v[100:103], v[200:203]
s_waitcnt lgkmcnt(4)
buffer_load_dwordx4 a[140:143], v253, s[4:7], s44 offen offset:1024 sc1
v_mfma_f32_16x16x32_bf16 v[204:207], a[176:179], v[76:79], v[204:207]
s_waitcnt lgkmcnt(2)
ds_read_b64_tr_b16 a[188:189], v27 offset:57344
v_subrev_u32 v28, 65536, v20
v_mfma_f32_16x16x32_bf16 v[204:207], a[180:183], v[80:83], v[204:207]
v_subrev_u32 v29, 65536, v21
v_subrev_u32 v30, 65536, v22
v_mfma_f32_16x16x32_bf16 v[208:211], a[180:183], v[88:91], v[208:211]
ds_read_b64_tr_b16 a[190:191], v27 offset:61440
v_subrev_u32 v31, 65536, v23
v_mfma_f32_16x16x32_bf16 v[208:211], a[176:179], v[84:87], v[208:211]
v_readfirstlane_b32 s54, v38
v_subrev_u32 v32, 65536, v24
v_mfma_f32_16x16x32_bf16 v[212:215], a[176:179], v[92:95], v[212:215]
v_subrev_u32 v33, 65536, v25
v_subrev_u32 v34, 65536, v26
v_mfma_f32_16x16x32_bf16 v[212:215], a[180:183], v[96:99], v[212:215]
v_subrev_u32 v35, 65536, v27
v_mfma_f32_16x16x32_bf16 v[216:219], a[180:183], v[104:107], v[216:219]
s_cmp_gt_u32 s54, s48
s_cbranch_scc1 L2_redo
s_add_u32 s54, s45, 4096
v_mfma_f32_16x16x32_bf16 v[216:219], a[176:179], v[100:103], v[216:219]
s_waitcnt lgkmcnt(2)
s_add_u32 s55, s45, 262144
s_add_u32 s66, s55, 4096
v_mfma_f32_16x16x32_bf16 v[220:223], a[184:187], v[76:79], v[220:223]
s_waitcnt lgkmcnt(0)
s_lshr_b32 s85, s64, 1
s_lshl_b32 s85, s85, 8
v_mfma_f32_16x16x32_bf16 v[220:223], a[188:191], v[80:83], v[220:223]
s_add_u32 s85, s85, 41943040
ds_read_b64_tr_b16 v[44:45], v28 offset:0
v_accvgpr_read_b32 v244, a52
v_mfma_f32_16x16x32_bf16 v[224:227], a[188:191], v[88:91], v[224:227]
ds_read_b64_tr_b16 v[46:47], v28 offset:4096
v_accvgpr_read_b32 v245, a53
v_mfma_f32_16x16x32_bf16 v[224:227], a[184:187], v[84:87], v[224:227]
ds_read_b64_tr_b16 v[48:49], v28 offset:8192
v_accvgpr_read_b32 v246, a54
v_mfma_f32_16x16x32_bf16 v[228:231], a[184:187], v[92:95], v[228:231]
ds_read_b64_tr_b16 v[50:51], v28 offset:12288
v_accvgpr_read_b32 v247, a55
v_mfma_f32_16x16x32_bf16 v[228:231], a[188:191], v[96:99], v[228:231]
ds_read_b64_tr_b16 v[52:53], v29 offset:0
v_accvgpr_read_b32 v248, a56
v_mfma_f32_16x16x32_bf16 v[232:235], a[188:191], v[104:107], v[232:235]
ds_read_b64_tr_b16 v[54:55], v29 offset:4096
v_accvgpr_read_b32 v249, a57
v_mfma_f32_16x16x32_bf16 v[232:235], a[184:187], v[100:103], v[232:235]
ds_read_b64_tr_b16 v[56:57], v29 offset:8192
v_accvgpr_read_b32 v250, a58
ds_read_b64_tr_b16 v[58:59], v29 offset:12288
s_waitcnt vmcnt(29)
s_nop 0
v_accvgpr_read_b32 v251, a59
v_pk_mul_f32 v[108:109], v[108:109], v[236:237] op_sel_hi:[1,0]
v_pk_mul_f32 v[110:111], v[110:111], v[236:237] op_sel_hi:[1,0]
v_pk_mul_f32 v[124:125], v[124:125], v[236:237] op_sel_hi:[1,0]
v_pk_mul_f32 v[126:127], v[126:127], v[236:237] op_sel_hi:[1,0]
v_cvt_pk_bf16_f32 v108, v108, v109
v_cvt_pk_bf16_f32 v109, v110, v111
v_cvt_pk_bf16_f32 v110, v124, v125
v_cvt_pk_bf16_f32 v111, v126, v127
buffer_store_dwordx4 v[108:111], v1, s[4:7], s45 offen offset:0 sc1
v_pk_mul_f32 v[112:113], v[112:113], v[238:239] op_sel_hi:[1,0]
v_pk_mul_f32 v[114:115], v[114:115], v[238:239] op_sel_hi:[1,0]
v_pk_mul_f32 v[128:129], v[128:129], v[238:239] op_sel_hi:[1,0]
v_pk_mul_f32 v[130:131], v[130:131], v[238:239] op_sel_hi:[1,0]
v_cvt_pk_bf16_f32 v112, v112, v113
v_cvt_pk_bf16_f32 v113, v114, v115
v_cvt_pk_bf16_f32 v114, v128, v129
v_cvt_pk_bf16_f32 v115, v130, v131
buffer_store_dwordx4 v[112:115], v1, s[4:7], s45 offen offset:1024 sc1
v_pk_mul_f32 v[116:117], v[116:117], v[240:241] op_sel_hi:[1,0]
v_pk_mul_f32 v[118:119], v[118:119], v[240:241] op_sel_hi:[1,0]
v_pk_mul_f32 v[132:133], v[132:133], v[240:241] op_sel_hi:[1,0]
v_pk_mul_f32 v[134:135], v[134:135], v[240:241] op_sel_hi:[1,0]
v_cvt_pk_bf16_f32 v116, v116, v117
v_cvt_pk_bf16_f32 v117, v118, v119
v_cvt_pk_bf16_f32 v118, v132, v133
v_cvt_pk_bf16_f32 v119, v134, v135
buffer_store_dwordx4 v[116:119], v1, s[4:7], s55 offen offset:0 sc1
v_pk_mul_f32 v[120:121], v[120:121], v[242:243] op_sel_hi:[1,0]
v_pk_mul_f32 v[122:123], v[122:123], v[242:243] op_sel_hi:[1,0]
v_pk_mul_f32 v[136:137], v[136:137], v[242:243] op_sel_hi:[1,0]
v_pk_mul_f32 v[138:139], v[138:139], v[242:243] op_sel_hi:[1,0]
v_cvt_pk_bf16_f32 v120, v120, v121
v_cvt_pk_bf16_f32 v121, v122, v123
v_cvt_pk_bf16_f32 v122, v136, v137
v_cvt_pk_bf16_f32 v123, v138, v139
buffer_store_dwordx4 v[120:123], v1, s[4:7], s55 offen offset:1024 sc1
v_lshlrev_b32 v124, 16, v245
v_lshlrev_b32 v125, 16, v245
v_mov_b64 v[126:127], v[124:125]
v_mov_b64 v[128:129], v[124:125]
v_mov_b64 v[130:131], v[124:125]
v_mov_b64 v[132:133], 0
v_mov_b64 v[134:135], 0
v_mov_b64 v[136:137], 0
v_mov_b64 v[138:139], 0
v_lshlrev_b32 v108, 16, v244
v_lshlrev_b32 v109, 16, v244
v_mov_b64 v[110:111], v[108:109]
v_mov_b64 v[112:113], v[108:109]
v_mov_b64 v[114:115], v[108:109]
v_mov_b64 v[116:117], 0
v_mov_b64 v[118:119], 0
v_mov_b64 v[120:121], 0
v_mov_b64 v[122:123], 0
v_pk_mul_f32 v[140:141], v[140:141], v[236:237] op_sel_hi:[1,0]
v_pk_mul_f32 v[142:143], v[142:143], v[236:237] op_sel_hi:[1,0]
v_pk_mul_f32 v[156:157], v[156:157], v[236:237] op_sel_hi:[1,0]
v_pk_mul_f32 v[158:159], v[158:159], v[236:237] op_sel_hi:[1,0]
v_cvt_pk_bf16_f32 v140, v140, v141
v_cvt_pk_bf16_f32 v141, v142, v143
v_cvt_pk_bf16_f32 v142, v156, v157
v_cvt_pk_bf16_f32 v143, v158, v159
buffer_store_dwordx4 v[140:143], v1, s[4:7], s45 offen offset:2048 sc1
v_pk_mul_f32 v[144:145], v[144:145], v[238:239] op_sel_hi:[1,0]
v_pk_mul_f32 v[146:147], v[146:147], v[238:239] op_sel_hi:[1,0]
v_pk_mul_f32 v[160:161], v[160:161], v[238:239] op_sel_hi:[1,0]
v_pk_mul_f32 v[162:163], v[162:163], v[238:239] op_sel_hi:[1,0]
v_cvt_pk_bf16_f32 v144, v144, v145
v_cvt_pk_bf16_f32 v145, v146, v147
v_cvt_pk_bf16_f32 v146, v160, v161
v_cvt_pk_bf16_f32 v147, v162, v163
buffer_store_dwordx4 v[144:147], v1, s[4:7], s45 offen offset:3072 sc1
v_pk_mul_f32 v[148:149], v[148:149], v[240:241] op_sel_hi:[1,0]
v_pk_mul_f32 v[150:151], v[150:151], v[240:241] op_sel_hi:[1,0]
v_pk_mul_f32 v[164:165], v[164:165], v[240:241] op_sel_hi:[1,0]
v_pk_mul_f32 v[166:167], v[166:167], v[240:241] op_sel_hi:[1,0]
v_cvt_pk_bf16_f32 v148, v148, v149
v_cvt_pk_bf16_f32 v149, v150, v151
v_cvt_pk_bf16_f32 v150, v164, v165
v_cvt_pk_bf16_f32 v151, v166, v167
buffer_store_dwordx4 v[148:151], v1, s[4:7], s55 offen offset:2048 sc1
v_pk_mul_f32 v[152:153], v[152:153], v[242:243] op_sel_hi:[1,0]
v_pk_mul_f32 v[154:155], v[154:155], v[242:243] op_sel_hi:[1,0]
v_pk_mul_f32 v[168:169], v[168:169], v[242:243] op_sel_hi:[1,0]
v_pk_mul_f32 v[170:171], v[170:171], v[242:243] op_sel_hi:[1,0]
v_cvt_pk_bf16_f32 v152, v152, v153
v_cvt_pk_bf16_f32 v153, v154, v155
v_cvt_pk_bf16_f32 v154, v168, v169
v_cvt_pk_bf16_f32 v155, v170, v171
buffer_store_dwordx4 v[152:155], v1, s[4:7], s55 offen offset:3072 sc1
v_lshlrev_b32 v156, 16, v247
v_lshlrev_b32 v157, 16, v247
v_mov_b64 v[158:159], v[156:157]
v_mov_b64 v[160:161], v[156:157]
v_mov_b64 v[162:163], v[156:157]
v_mov_b64 v[164:165], 0
v_mov_b64 v[166:167], 0
v_mov_b64 v[168:169], 0
v_mov_b64 v[170:171], 0
v_lshlrev_b32 v140, 16, v246
v_lshlrev_b32 v141, 16, v246
v_mov_b64 v[142:143], v[140:141]
v_mov_b64 v[144:145], v[140:141]
v_mov_b64 v[146:147], v[140:141]
v_mov_b64 v[148:149], 0
v_mov_b64 v[150:151], 0
v_mov_b64 v[152:153], 0
v_mov_b64 v[154:155], 0
v_pk_mul_f32 v[172:173], v[172:173], v[236:237] op_sel_hi:[1,0]
v_pk_mul_f32 v[174:175], v[174:175], v[236:237] op_sel_hi:[1,0]
v_pk_mul_f32 v[188:189], v[188:189], v[236:237] op_sel_hi:[1,0]
v_pk_mul_f32 v[190:191], v[190:191], v[236:237] op_sel_hi:[1,0]
v_cvt_pk_bf16_f32 v172, v172, v173
v_cvt_pk_bf16_f32 v173, v174, v175
v_cvt_pk_bf16_f32 v174, v188, v189
v_cvt_pk_bf16_f32 v175, v190, v191
buffer_store_dwordx4 v[172:175], v1, s[4:7], s54 offen offset:0 sc1
v_pk_mul_f32 v[176:177], v[176:177], v[238:239] op_sel_hi:[1,0]
v_pk_mul_f32 v[178:179], v[178:179], v[238:239] op_sel_hi:[1,0]
v_pk_mul_f32 v[192:193], v[192:193], v[238:239] op_sel_hi:[1,0]
v_pk_mul_f32 v[194:195], v[194:195], v[238:239] op_sel_hi:[1,0]
v_cvt_pk_bf16_f32 v176, v176, v177
v_cvt_pk_bf16_f32 v177, v178, v179
v_cvt_pk_bf16_f32 v178, v192, v193
v_cvt_pk_bf16_f32 v179, v194, v195
buffer_store_dwordx4 v[176:179], v1, s[4:7], s54 offen offset:1024 sc1
v_pk_mul_f32 v[180:181], v[180:181], v[240:241] op_sel_hi:[1,0]
v_pk_mul_f32 v[182:183], v[182:183], v[240:241] op_sel_hi:[1,0]
v_pk_mul_f32 v[196:197], v[196:197], v[240:241] op_sel_hi:[1,0]
v_pk_mul_f32 v[198:199], v[198:199], v[240:241] op_sel_hi:[1,0]
v_cvt_pk_bf16_f32 v180, v180, v181
v_cvt_pk_bf16_f32 v181, v182, v183
v_cvt_pk_bf16_f32 v182, v196, v197
v_cvt_pk_bf16_f32 v183, v198, v199
buffer_store_dwordx4 v[180:183], v1, s[4:7], s66 offen offset:0 sc1
v_pk_mul_f32 v[184:185], v[184:185], v[242:243] op_sel_hi:[1,0]
v_pk_mul_f32 v[186:187], v[186:187], v[242:243] op_sel_hi:[1,0]
v_pk_mul_f32 v[200:201], v[200:201], v[242:243] op_sel_hi:[1,0]
v_pk_mul_f32 v[202:203], v[202:203], v[242:243] op_sel_hi:[1,0]
v_cvt_pk_bf16_f32 v184, v184, v185
v_cvt_pk_bf16_f32 v185, v186, v187
v_cvt_pk_bf16_f32 v186, v200, v201
v_cvt_pk_bf16_f32 v187, v202, v203
buffer_store_dwordx4 v[184:187], v1, s[4:7], s66 offen offset:1024 sc1
v_lshlrev_b32 v188, 16, v249
v_lshlrev_b32 v189, 16, v249
v_mov_b64 v[190:191], v[188:189]
v_mov_b64 v[192:193], v[188:189]
v_mov_b64 v[194:195], v[188:189]
v_mov_b64 v[196:197], 0
v_mov_b64 v[198:199], 0
v_mov_b64 v[200:201], 0
v_mov_b64 v[202:203], 0
v_lshlrev_b32 v172, 16, v248
v_lshlrev_b32 v173, 16, v248
v_mov_b64 v[174:175], v[172:173]
v_mov_b64 v[176:177], v[172:173]
v_mov_b64 v[178:179], v[172:173]
v_mov_b64 v[180:181], 0
v_mov_b64 v[182:183], 0
v_mov_b64 v[184:185], 0
v_mov_b64 v[186:187], 0
v_pk_mul_f32 v[204:205], v[204:205], v[236:237] op_sel_hi:[1,0]
v_pk_mul_f32 v[206:207], v[206:207], v[236:237] op_sel_hi:[1,0]
v_pk_mul_f32 v[220:221], v[220:221], v[236:237] op_sel_hi:[1,0]
v_pk_mul_f32 v[222:223], v[222:223], v[236:237] op_sel_hi:[1,0]
v_cvt_pk_bf16_f32 v204, v204, v205
v_cvt_pk_bf16_f32 v205, v206, v207
v_cvt_pk_bf16_f32 v206, v220, v221
v_cvt_pk_bf16_f32 v207, v222, v223
buffer_store_dwordx4 v[204:207], v1, s[4:7], s54 offen offset:2048 sc1
v_pk_mul_f32 v[208:209], v[208:209], v[238:239] op_sel_hi:[1,0]
v_pk_mul_f32 v[210:211], v[210:211], v[238:239] op_sel_hi:[1,0]
v_pk_mul_f32 v[224:225], v[224:225], v[238:239] op_sel_hi:[1,0]
v_pk_mul_f32 v[226:227], v[226:227], v[238:239] op_sel_hi:[1,0]
v_cvt_pk_bf16_f32 v208, v208, v209
v_cvt_pk_bf16_f32 v209, v210, v211
v_cvt_pk_bf16_f32 v210, v224, v225
v_cvt_pk_bf16_f32 v211, v226, v227
buffer_store_dwordx4 v[208:211], v1, s[4:7], s54 offen offset:3072 sc1
v_pk_mul_f32 v[212:213], v[212:213], v[240:241] op_sel_hi:[1,0]
v_pk_mul_f32 v[214:215], v[214:215], v[240:241] op_sel_hi:[1,0]
v_pk_mul_f32 v[228:229], v[228:229], v[240:241] op_sel_hi:[1,0]
v_pk_mul_f32 v[230:231], v[230:231], v[240:241] op_sel_hi:[1,0]
v_cvt_pk_bf16_f32 v212, v212, v213
v_cvt_pk_bf16_f32 v213, v214, v215
v_cvt_pk_bf16_f32 v214, v228, v229
v_cvt_pk_bf16_f32 v215, v230, v231
buffer_store_dwordx4 v[212:215], v1, s[4:7], s66 offen offset:2048 sc1
v_pk_mul_f32 v[216:217], v[216:217], v[242:243] op_sel_hi:[1,0]
v_pk_mul_f32 v[218:219], v[218:219], v[242:243] op_sel_hi:[1,0]
v_pk_mul_f32 v[232:233], v[232:233], v[242:243] op_sel_hi:[1,0]
v_pk_mul_f32 v[234:235], v[234:235], v[242:243] op_sel_hi:[1,0]
v_cvt_pk_bf16_f32 v216, v216, v217
v_cvt_pk_bf16_f32 v217, v218, v219
v_cvt_pk_bf16_f32 v218, v232, v233
v_cvt_pk_bf16_f32 v219, v234, v235
buffer_store_dwordx4 v[216:219], v1, s[4:7], s66 offen offset:3072 sc1
v_lshlrev_b32 v220, 16, v251
v_lshlrev_b32 v221, 16, v251
v_mov_b64 v[222:223], v[220:221]
v_mov_b64 v[224:225], v[220:221]
v_mov_b64 v[226:227], v[220:221]
v_mov_b64 v[228:229], 0
v_mov_b64 v[230:231], 0
v_mov_b64 v[232:233], 0
v_mov_b64 v[234:235], 0
v_lshlrev_b32 v204, 16, v250
v_lshlrev_b32 v205, 16, v250
v_mov_b64 v[206:207], v[204:205]
v_mov_b64 v[208:209], v[204:205]
v_mov_b64 v[210:211], v[204:205]
v_mov_b64 v[212:213], 0
v_mov_b64 v[214:215], 0
v_mov_b64 v[216:217], 0
v_mov_b64 v[218:219], 0
s_cmp_lg_u32 s94, 0
s_cbranch_scc1 L2_Y
s_cmp_eq_u32 s36, 0
s_cselect_b32 s82, -6, 0
s_waitcnt vmcnt(42) lgkmcnt(6)
v_mfma_f32_16x16x32_bf16 v[108:111], a[192:195], v[44:47], v[108:111]
s_waitcnt vmcnt(39) lgkmcnt(4)
ds_read_b64_tr_b16 v[60:61], v30 offset:0
v_mfma_f32_16x16x32_bf16 v[108:111], a[208:211], v[48:51], v[108:111]
s_waitcnt vmcnt(38)
buffer_load_dwordx4 a[152:155], v253, s[4:7], s44 offen offset:2048 sc1
v_mfma_f32_16x16x32_bf16 v[112:115], a[212:215], v[48:51], v[112:115]
ds_read_b64_tr_b16 v[62:63], v30 offset:4096
v_mfma_f32_16x16x32_bf16 v[112:115], a[196:199], v[44:47], v[112:115]
s_waitcnt vmcnt(38)
v_mfma_f32_16x16x32_bf16 v[116:119], a[200:203], v[44:47], v[116:119]
s_waitcnt vmcnt(36)
ds_read_b64_tr_b16 v[64:65], v30 offset:8192
v_mfma_f32_16x16x32_bf16 v[116:119], a[216:219], v[48:51], v[116:119]
s_waitcnt vmcnt(35)
buffer_load_dwordx4 a[156:159], v253, s[4:7], s44 offen offset:3072 sc1
v_mfma_f32_16x16x32_bf16 v[120:123], a[220:223], v[48:51], v[120:123]
s_add_u32 s44, s44, s74
ds_read_b64_tr_b16 v[66:67], v30 offset:12288
v_mfma_f32_16x16x32_bf16 v[120:123], a[204:207], v[44:47], v[120:123]
s_waitcnt lgkmcnt(6)
v_mfma_f32_16x16x32_bf16 v[124:127], a[192:195], v[52:55], v[124:127]
s_waitcnt lgkmcnt(4)
ds_read_b64_tr_b16 v[68:69], v31 offset:0
v_mfma_f32_16x16x32_bf16 v[124:127], a[208:211], v[56:59], v[124:127]
v_mfma_f32_16x16x32_bf16 v[128:131], a[212:215], v[56:59], v[128:131]
ds_read_b64_tr_b16 v[70:71], v31 offset:4096
v_mfma_f32_16x16x32_bf16 v[128:131], a[196:199], v[52:55], v[128:131]
v_mfma_f32_16x16x32_bf16 v[132:135], a[200:203], v[52:55], v[132:135]
ds_read_b64_tr_b16 v[72:73], v31 offset:8192
v_mfma_f32_16x16x32_bf16 v[132:135], a[216:219], v[56:59], v[132:135]
v_mfma_f32_16x16x32_bf16 v[136:139], a[220:223], v[56:59], v[136:139]
ds_read_b64_tr_b16 v[74:75], v31 offset:12288
v_mfma_f32_16x16x32_bf16 v[136:139], a[204:207], v[52:55], v[136:139]
s_waitcnt lgkmcnt(6)
v_mfma_f32_16x16x32_bf16 v[140:143], a[192:195], v[60:63], v[140:143]
s_waitcnt lgkmcnt(4)
ds_read_b64_tr_b16 v[44:45], v32 offset:0
v_mfma_f32_16x16x32_bf16 v[140:143], a[208:211], v[64:67], v[140:143]
v_mfma_f32_16x16x32_bf16 v[144:147], a[212:215], v[64:67], v[144:147]
ds_read_b64_tr_b16 v[46:47], v32 offset:4096
v_mfma_f32_16x16x32_bf16 v[144:147], a[196:199], v[60:63], v[144:147]
v_mfma_f32_16x16x32_bf16 v[148:151], a[200:203], v[60:63], v[148:151]
ds_read_b64_tr_b16 v[48:49], v32 offset:8192
v_mfma_f32_16x16x32_bf16 v[148:151], a[216:219], v[64:67], v[148:151]
v_mfma_f32_16x16x32_bf16 v[152:155], a[220:223], v[64:67], v[152:155]
ds_read_b64_tr_b16 v[50:51], v32 offset:12288
v_mfma_f32_16x16x32_bf16 v[152:155], a[204:207], v[60:63], v[152:155]
s_waitcnt lgkmcnt(6)
s_barrier
v_mfma_f32_16x16x32_bf16 v[156:159], a[192:195], v[68:71], v[156:159]
s_waitcnt lgkmcnt(4)
s_add_u32 m0, s37, 49152
ds_read_b64_tr_b16 v[52:53], v32 offset:16384
v_mfma_f32_16x16x32_bf16 v[156:159], a[208:211], v[72:75], v[156:159]
buffer_load_dwordx4 v2, s[24:27], s43 offen offset:0 lds
v_mfma_f32_16x16x32_bf16 v[160:163], a[212:215], v[72:75], v[160:163]
ds_read_b64_tr_b16 v[54:55], v32 offset:20480
v_mfma_f32_16x16x32_bf16 v[160:163], a[196:199], v[68:71], v[160:163]
ds_read_b64_tr_b16 v[56:57], v32 offset:24576
v_mfma_f32_16x16x32_bf16 v[164:167], a[200:203], v[68:71], v[164:167]
ds_read_b64_tr_b16 v[58:59], v32 offset:28672
v_mfma_f32_16x16x32_bf16 v[164:167], a[216:219], v[72:75], v[164:167]
buffer_load_dwordx4 v3, s[24:27], s43 offen offset:1024 lds
v_mfma_f32_16x16x32_bf16 v[168:171], a[220:223], v[72:75], v[168:171]
v_mfma_f32_16x16x32_bf16 v[168:171], a[204:207], v[68:71], v[168:171]
s_waitcnt lgkmcnt(6)
s_mov_b32 s38, -6
.p2align 3
L2_y:
v_mfma_f32_16x16x32_bf16 v[172:175], a[192:195], v[44:47], v[172:175]
s_waitcnt lgkmcnt(4)
ds_read_b64_tr_b16 v[60:61], v33 offset:0
v_mfma_f32_16x16x32_bf16 v[172:175], a[208:211], v[48:51], v[172:175]
s_waitcnt vmcnt(37) lgkmcnt(3)
buffer_load_dwordx4 v4, s[24:27], s43 offen offset:2048 lds
v_mfma_f32_16x16x32_bf16 v[172:175], a[224:227], v[52:55], v[172:175]
s_waitcnt vmcnt(36) lgkmcnt(1)
ds_read_b64_tr_b16 v[62:63], v33 offset:4096
v_mfma_f32_16x16x32_bf16 v[172:175], a[240:243], v[56:59], v[172:175]
s_waitcnt vmcnt(35)
v_mfma_f32_16x16x32_bf16 v[176:179], a[244:247], v[56:59], v[176:179]
ds_read_b64_tr_b16 v[64:65], v33 offset:8192
v_mfma_f32_16x16x32_bf16 v[176:179], a[228:231], v[52:55], v[176:179]
buffer_load_dwordx4 v5, s[24:27], s43 offen offset:3072 lds
v_mfma_f32_16x16x32_bf16 v[176:179], a[212:215], v[48:51], v[176:179]
s_add_u32 s43, s43, s73
ds_read_b64_tr_b16 v[66:67], v33 offset:12288
v_mfma_f32_16x16x32_bf16 v[176:179], a[196:199], v[44:47], v[176:179]
v_mfma_f32_16x16x32_bf16 v[180:183], a[200:203], v[44:47], v[180:183]
ds_read_b64_tr_b16 v[68:69], v33 offset:16384
v_mfma_f32_16x16x32_bf16 v[180:183], a[216:219], v[48:51], v[180:183]
s_waitcnt vmcnt(33)
buffer_load_dwordx4 a[160:163], v36, s[4:7], s44 offen offset:0 sc1
v_mfma_f32_16x16x32_bf16 v[180:183], a[232:235], v[52:55], v[180:183]
s_waitcnt vmcnt(32)
ds_read_b64_tr_b16 v[70:71], v33 offset:20480
v_mfma_f32_16x16x32_bf16 v[180:183], a[248:251], v[56:59], v[180:183]
s_waitcnt vmcnt(31)
ds_read_b64_tr_b16 v[72:73], v33 offset:24576
v_mfma_f32_16x16x32_bf16 v[184:187], a[252:255], v[56:59], v[184:187]
ds_read_b64_tr_b16 v[74:75], v33 offset:28672
v_mfma_f32_16x16x32_bf16 v[184:187], a[236:239], v[52:55], v[184:187]
buffer_load_dwordx4 a[164:167], v36, s[4:7], s44 offen offset:1024 sc1
v_mfma_f32_16x16x32_bf16 v[184:187], a[220:223], v[48:51], v[184:187]
v_mfma_f32_16x16x32_bf16 v[184:187], a[204:207], v[44:47], v[184:187]
s_waitcnt lgkmcnt(6)
v_mfma_f32_16x16x32_bf16 v[188:191], a[192:195], v[60:63], v[188:191]
s_waitcnt lgkmcnt(4)
ds_read_b64_tr_b16 v[44:45], v34 offset:0
v_mfma_f32_16x16x32_bf16 v[188:191], a[208:211], v[64:67], v[188:191]
s_waitcnt lgkmcnt(3)
buffer_load_dwordx4 a[176:179], v36, s[4:7], s44 offen offset:2048 sc1
v_mfma_f32_16x16x32_bf16 v[188:191], a[224:227], v[68:71], v[188:191]
s_waitcnt lgkmcnt(1)
ds_read_b64_tr_b16 v[46:47], v34 offset:4096
v_mfma_f32_16x16x32_bf16 v[188:191], a[240:243], v[72:75], v[188:191]
v_mfma_f32_16x16x32_bf16 v[192:195], a[244:247], v[72:75], v[192:195]
ds_read_b64_tr_b16 v[48:49], v34 offset:8192
v_mfma_f32_16x16x32_bf16 v[192:195], a[228:231], v[68:71], v[192:195]
buffer_load_dwordx4 a[180:183], v36, s[4:7], s44 offen offset:3072 sc1
v_mfma_f32_16x16x32_bf16 v[192:195], a[212:215], v[64:67], v[192:195]
ds_read_b64_tr_b16 v[50:51], v34 offset:12288
v_mfma_f32_16x16x32_bf16 v[192:195], a[196:199], v[60:63], v[192:195]
v_mfma_f32_16x16x32_bf16 v[196:199], a[200:203], v[60:63], v[196:199]
ds_read_b64_tr_b16 v[52:53], v34 offset:16384
v_mfma_f32_16x16x32_bf16 v[196:199], a[216:219], v[64:67], v[196:199]
buffer_load_dwordx4 a[168:171], v253, s[4:7], s44 offen offset:0 sc1
v_mfma_f32_16x16x32_bf16 v[196:199], a[232:235], v[68:71], v[196:199]
ds_read_b64_tr_b16 v[54:55], v34 offset:20480
v_mfma_f32_16x16x32_bf16 v[196:199], a[248:251], v[72:75], v[196:199]
ds_read_b64_tr_b16 v[56:57], v34 offset:24576
v_mfma_f32_16x16x32_bf16 v[200:203], a[252:255], v[72:75], v[200:203]
ds_read_b64_tr_b16 v[58:59], v34 offset:28672
v_mfma_f32_16x16x32_bf16 v[200:203], a[236:239], v[68:71], v[200:203]
buffer_load_dwordx4 a[172:175], v253, s[4:7], s44 offen offset:1024 sc1
v_mfma_f32_16x16x32_bf16 v[200:203], a[220:223], v[64:67], v[200:203]
v_mfma_f32_16x16x32_bf16 v[200:203], a[204:207], v[60:63], v[200:203]
s_waitcnt lgkmcnt(6)
v_mfma_f32_16x16x32_bf16 v[204:207], a[192:195], v[44:47], v[204:207]
s_waitcnt lgkmcnt(4)
ds_read_b64_tr_b16 v[60:61], v35 offset:0
v_mfma_f32_16x16x32_bf16 v[204:207], a[208:211], v[48:51], v[204:207]
s_waitcnt lgkmcnt(3)
buffer_load_dwordx4 a[184:187], v253, s[4:7], s44 offen offset:2048 sc1
v_mfma_f32_16x16x32_bf16 v[204:207], a[224:227], v[52:55], v[204:207]
s_waitcnt lgkmcnt(1)
ds_read_b64_tr_b16 v[62:63], v35 offset:4096
v_mfma_f32_16x16x32_bf16 v[204:207], a[240:243], v[56:59], v[204:207]
v_mfma_f32_16x16x32_bf16 v[208:211], a[244:247], v[56:59], v[208:211]
ds_read_b64_tr_b16 v[64:65], v35 offset:8192
v_mfma_f32_16x16x32_bf16 v[208:211], a[228:231], v[52:55], v[208:211]
buffer_load_dwordx4 a[188:191], v253, s[4:7], s44 offen offset:3072 sc1
v_mfma_f32_16x16x32_bf16 v[208:211], a[212:215], v[48:51], v[208:211]
s_add_u32 s44, s44, s75
ds_read_b64_tr_b16 v[66:67], v35 offset:12288
v_mfma_f32_16x16x32_bf16 v[208:211], a[196:199], v[44:47], v[208:211]
v_mfma_f32_16x16x32_bf16 v[212:215], a[200:203], v[44:47], v[212:215]
ds_read_b64_tr_b16 v[68:69], v35 offset:16384
v_mfma_f32_16x16x32_bf16 v[212:215], a[216:219], v[48:51], v[212:215]
v_mfma_f32_16x16x32_bf16 v[212:215], a[232:235], v[52:55], v[212:215]
ds_read_b64_tr_b16 v[70:71], v35 offset:20480
v_mfma_f32_16x16x32_bf16 v[212:215], a[248:251], v[56:59], v[212:215]
ds_read_b64_tr_b16 v[72:73], v35 offset:24576
v_mfma_f32_16x16x32_bf16 v[216:219], a[252:255], v[56:59], v[216:219]
ds_read_b64_tr_b16 v[74:75], v35 offset:28672
v_mfma_f32_16x16x32_bf16 v[216:219], a[236:239], v[52:55], v[216:219]
v_mfma_f32_16x16x32_bf16 v[216:219], a[220:223], v[48:51], v[216:219]
v_mfma_f32_16x16x32_bf16 v[216:219], a[204:207], v[44:47], v[216:219]
s_waitcnt lgkmcnt(6)
v_mfma_f32_16x16x32_bf16 v[220:223], a[192:195], v[60:63], v[220:223]
s_waitcnt lgkmcnt(4)
ds_read_b64_tr_b16 v[44:45], v28 offset:16384
v_mfma_f32_16x16x32_bf16 v[220:223], a[208:211], v[64:67], v[220:223]
s_waitcnt lgkmcnt(3)
v_mfma_f32_16x16x32_bf16 v[220:223], a[224:227], v[68:71], v[220:223]
s_waitcnt lgkmcnt(1)
ds_read_b64_tr_b16 v[46:47], v28 offset:20480
v_mfma_f32_16x16x32_bf16 v[220:223], a[240:243], v[72:75], v[220:223]
v_mfma_f32_16x16x32_bf16 v[224:227], a[244:247], v[72:75], v[224:227]
ds_read_b64_tr_b16 v[48:49], v28 offset:24576
v_mfma_f32_16x16x32_bf16 v[224:227], a[228:231], v[68:71], v[224:227]
v_mfma_f32_16x16x32_bf16 v[224:227], a[212:215], v[64:67], v[224:227]
ds_read_b64_tr_b16 v[50:51], v28 offset:28672
v_mfma_f32_16x16x32_bf16 v[224:227], a[196:199], v[60:63], v[224:227]
s_waitcnt vmcnt(14)
s_barrier
v_mfma_f32_16x16x32_bf16 v[228:231], a[200:203], v[60:63], v[228:231]
s_add_u32 m0, s37, 0
ds_read_b64_tr_b16 v[52:53], v28 offset:32768
v_mfma_f32_16x16x32_bf16 v[228:231], a[216:219], v[64:67], v[228:231]
buffer_load_dwordx4 v2, s[24:27], s43 offen offset:0 lds
v_mfma_f32_16x16x32_bf16 v[228:231], a[232:235], v[68:71], v[228:231]
ds_read_b64_tr_b16 v[54:55], v28 offset:36864
v_mfma_f32_16x16x32_bf16 v[228:231], a[248:251], v[72:75], v[228:231]
ds_read_b64_tr_b16 v[56:57], v28 offset:40960
v_mfma_f32_16x16x32_bf16 v[232:235], a[252:255], v[72:75], v[232:235]
ds_read_b64_tr_b16 v[58:59], v28 offset:45056
v_mfma_f32_16x16x32_bf16 v[232:235], a[236:239], v[68:71], v[232:235]
buffer_load_dwordx4 v3, s[24:27], s43 offen offset:1024 lds
v_mfma_f32_16x16x32_bf16 v[232:235], a[220:223], v[64:67], v[232:235]
s_cmp_eq_u32 s38, s82
s_cbranch_scc1 L2_so
L2_so_r:
v_mfma_f32_16x16x32_bf16 v[232:235], a[204:207], v[60:63], v[232:235]
s_waitcnt lgkmcnt(6)
v_mfma_f32_16x16x32_bf16 v[108:111], a[224:227], v[44:47], v[108:111]
s_waitcnt lgkmcnt(4)
ds_read_b64_tr_b16 v[60:61], v29 offset:16384
v_mfma_f32_16x16x32_bf16 v[108:111], a[240:243], v[48:51], v[108:111]
s_waitcnt vmcnt(22) lgkmcnt(3)
buffer_load_dwordx4 v4, s[24:27], s43 offen offset:2048 lds
v_mfma_f32_16x16x32_bf16 v[108:111], a[128:131], v[52:55], v[108:111]
s_waitcnt vmcnt(21) lgkmcnt(1)
ds_read_b64_tr_b16 v[62:63], v29 offset:20480
v_mfma_f32_16x16x32_bf16 v[108:111], a[144:147], v[56:59], v[108:111]
s_waitcnt vmcnt(19)
v_mfma_f32_16x16x32_bf16 v[112:115], a[148:151], v[56:59], v[112:115]
ds_read_b64_tr_b16 v[64:65], v29 offset:24576
v_mfma_f32_16x16x32_bf16 v[112:115], a[132:135], v[52:55], v[112:115]
buffer_load_dwordx4 v5, s[24:27], s43 offen offset:3072 lds
v_mfma_f32_16x16x32_bf16 v[112:115], a[244:247], v[48:51], v[112:115]
s_add_u32 s43, s43, s72
ds_read_b64_tr_b16 v[66:67], v29 offset:28672
v_mfma_f32_16x16x32_bf16 v[112:115], a[228:231], v[44:47], v[112:115]
v_mfma_f32_16x16x32_bf16 v[116:119], a[232:235], v[44:47], v[116:119]
ds_read_b64_tr_b16 v[68:69], v29 offset:32768
v_mfma_f32_16x16x32_bf16 v[116:119], a[248:251], v[48:51], v[116:119]
s_waitcnt vmcnt(19)
buffer_load_dwordx4 a[192:195], v36, s[4:7], s44 offen offset:0 sc1
v_mfma_f32_16x16x32_bf16 v[116:119], a[136:139], v[52:55], v[116:119]
s_waitcnt vmcnt(18)
ds_read_b64_tr_b16 v[70:71], v29 offset:36864
v_mfma_f32_16x16x32_bf16 v[116:119], a[152:155], v[56:59], v[116:119]
s_waitcnt vmcnt(17)
ds_read_b64_tr_b16 v[72:73], v29 offset:40960
v_mfma_f32_16x16x32_bf16 v[120:123], a[156:159], v[56:59], v[120:123]
ds_read_b64_tr_b16 v[74:75], v29 offset:45056
v_mfma_f32_16x16x32_bf16 v[120:123], a[140:143], v[52:55], v[120:123]
buffer_load_dwordx4 a[196:199], v36, s[4:7], s44 offen offset:1024 sc1
v_mfma_f32_16x16x32_bf16 v[120:123], a[252:255], v[48:51], v[120:123]
v_mfma_f32_16x16x32_bf16 v[120:123], a[236:239], v[44:47], v[120:123]
s_waitcnt lgkmcnt(6)
v_mfma_f32_16x16x32_bf16 v[124:127], a[224:227], v[60:63], v[124:127]
s_waitcnt lgkmcnt(4)
ds_read_b64_tr_b16 v[44:45], v30 offset:16384
v_mfma_f32_16x16x32_bf16 v[124:127], a[240:243], v[64:67], v[124:127]
s_waitcnt lgkmcnt(3)
buffer_load_dwordx4 a[208:211], v36, s[4:7], s44 offen offset:2048 sc1
v_mfma_f32_16x16x32_bf16 v[124:127], a[128:131], v[68:71], v[124:127]
s_waitcnt lgkmcnt(1)
ds_read_b64_tr_b16 v[46:47], v30 offset:20480
v_mfma_f32_16x16x32_bf16 v[124:127], a[144:147], v[72:75], v[124:127]
v_mfma_f32_16x16x32_bf16 v[128:131], a[148:151], v[72:75], v[128:131]
ds_read_b64_tr_b16 v[48:49], v30 offset:24576
v_mfma_f32_16x16x32_bf16 v[128:131], a[132:135], v[68:71], v[128:131]
buffer_load_dwordx4 a[212:215], v36, s[4:7], s44 offen offset:3072 sc1
v_mfma_f32_16x16x32_bf16 v[128:131], a[244:247], v[64:67], v[128:131]
ds_read_b64_tr_b16 v[50:51], v30 offset:28672
v_mfma_f32_16x16x32_bf16 v[128:131], a[228:231], v[60:63], v[128:131]
v_mfma_f32_16x16x32_bf16 v[132:135], a[232:235], v[60:63], v[132:135]
ds_read_b64_tr_b16 v[52:53], v30 offset:32768
v_mfma_f32_16x16x32_bf16 v[132:135], a[248:251], v[64:67], v[132:135]
buffer_load_dwordx4 a[200:203], v253, s[4:7], s44 offen offset:0 sc1
v_mfma_f32_16x16x32_bf16 v[132:135], a[136:139], v[68:71], v[132:135]
ds_read_b64_tr_b16 v[54:55], v30 offset:36864
v_mfma_f32_16x16x32_bf16 v[132:135], a[152:155], v[72:75], v[132:135]
ds_read_b64_tr_b16 v[56:57], v30 offset:40960
v_mfma_f32_16x16x32_bf16 v[136:139], a[156:159], v[72:75], v[136:139]
ds_read_b64_tr_b16 v[58:59], v30 offset:45056
v_mfma_f32_16x16x32_bf16 v[136:139], a[140:143], v[68:71], v[136:139]
buffer_load_dwordx4 a[204:207], v253, s[4:7], s44 offen offset:1024 sc1
v_mfma_f32_16x16x32_bf16 v[136:139], a[252:255], v[64:67], v[136:139]
v_mfma_f32_16x16x32_bf16 v[136:139], a[236:239], v[60:63], v[136:139]
s_waitcnt lgkmcnt(6)
v_mfma_f32_16x16x32_bf16 v[140:143], a[224:227], v[44:47], v[140:143]
s_waitcnt lgkmcnt(4)
ds_read_b64_tr_b16 v[60:61], v31 offset:16384
v_mfma_f32_16x16x32_bf16 v[140:143], a[240:243], v[48:51], v[140:143]
s_waitcnt lgkmcnt(3)
buffer_load_dwordx4 a[216:219], v253, s[4:7], s44 offen offset:2048 sc1
v_mfma_f32_16x16x32_bf16 v[140:143], a[128:131], v[52:55], v[140:143]
s_waitcnt lgkmcnt(1)
ds_read_b64_tr_b16 v[62:63], v31 offset:20480
v_mfma_f32_16x16x32_bf16 v[140:143], a[144:147], v[56:59], v[140:143]
v_mfma_f32_16x16x32_bf16 v[144:147], a[148:151], v[56:59], v[144:147]
ds_read_b64_tr_b16 v[64:65], v31 offset:24576
v_mfma_f32_16x16x32_bf16 v[144:147], a[132:135], v[52:55], v[144:147]
buffer_load_dwordx4 a[220:223], v253, s[4:7], s44 offen offset:3072 sc1
v_mfma_f32_16x16x32_bf16 v[144:147], a[244:247], v[48:51], v[144:147]
s_add_u32 s44, s44, s74
ds_read_b64_tr_b16 v[66:67], v31 offset:28672
v_mfma_f32_16x16x32_bf16 v[144:147], a[228:231], v[44:47], v[144:147]
v_mfma_f32_16x16x32_bf16 v[148:151], a[232:235], v[44:47], v[148:151]
ds_read_b64_tr_b16 v[68:69], v31 offset:32768
v_mfma_f32_16x16x32_bf16 v[148:151], a[248:251], v[48:51], v[148:151]
v_mfma_f32_16x16x32_bf16 v[148:151], a[136:139], v[52:55], v[148:151]
ds_read_b64_tr_b16 v[70:71], v31 offset:36864
v_mfma_f32_16x16x32_bf16 v[148:151], a[152:155], v[56:59], v[148:151]
ds_read_b64_tr_b16 v[72:73], v31 offset:40960
v_mfma_f32_16x16x32_bf16 v[152:155], a[156:159], v[56:59], v[152:155]
ds_read_b64_tr_b16 v[74:75], v31 offset:45056
v_mfma_f32_16x16x32_bf16 v[152:155], a[140:143], v[52:55], v[152:155]
v_mfma_f32_16x16x32_bf16 v[152:155], a[252:255], v[48:51], v[152:155]
v_mfma_f32_16x16x32_bf16 v[152:155], a[236:239], v[44:47], v[152:155]
s_waitcnt lgkmcnt(6)
v_mfma_f32_16x16x32_bf16 v[156:159], a[224:227], v[60:63], v[156:159]
s_waitcnt lgkmcnt(4)
ds_read_b64_tr_b16 v[44:45], v32 offset:32768
v_mfma_f32_16x16x32_bf16 v[156:159], a[240:243], v[64:67], v[156:159]
s_waitcnt lgkmcnt(3)
v_mfma_f32_16x16x32_bf16 v[156:159], a[128:131], v[68:71], v[156:159]
s_waitcnt lgkmcnt(1)
ds_read_b64_tr_b16 v[46:47], v32 offset:36864
v_mfma_f32_16x16x32_bf16 v[156:159], a[144:147], v[72:75], v[156:159]
v_mfma_f32_16x16x32_bf16 v[160:163], a[148:151], v[72:75], v[160:163]
ds_read_b64_tr_b16 v[48:49], v32 offset:40960
v_mfma_f32_16x16x32_bf16 v[160:163], a[132:135], v[68:71], v[160:163]
v_mfma_f32_16x16x32_bf16 v[160:163], a[244:247], v[64:67], v[160:163]
ds_read_b64_tr_b16 v[50:51], v32 offset:45056
v_mfma_f32_16x16x32_bf16 v[160:163], a[228:231], v[60:63], v[160:163]
s_waitcnt vmcnt(20)
s_barrier
v_mfma_f32_16x16x32_bf16 v[164:167], a[232:235], v[60:63], v[164:167]
s_add_u32 m0, s37, 16384
ds_read_b64_tr_b16 v[52:53], v32 offset:49152
v_mfma_f32_16x16x32_bf16 v[164:167], a[248:251], v[64:67], v[164:167]
buffer_load_dwordx4 v2, s[24:27], s43 offen offset:0 lds
v_mfma_f32_16x16x32_bf16 v[164:167], a[136:139], v[68:71], v[164:167]
ds_read_b64_tr_b16 v[54:55], v32 offset:53248
v_mfma_f32_16x16x32_bf16 v[164:167], a[152:155], v[72:75], v[164:167]
ds_read_b64_tr_b16 v[56:57], v32 offset:57344
v_mfma_f32_16x16x32_bf16 v[168:171], a[156:159], v[72:75], v[168:171]
ds_read_b64_tr_b16 v[58:59], v32 offset:61440
v_mfma_f32_16x16x32_bf16 v[168:171], a[140:143], v[68:71], v[168:171]
buffer_load_dwordx4 v3, s[24:27], s43 offen offset:1024 lds
v_mfma_f32_16x16x32_bf16 v[168:171], a[252:255], v[64:67], v[168:171]
v_mfma_f32_16x16x32_bf16 v[168:171], a[236:239], v[60:63], v[168:171]
s_waitcnt lgkmcnt(6)
v_mfma_f32_16x16x32_bf16 v[172:175], a[128:131], v[44:47], v[172:175]
s_waitcnt lgkmcnt(4)
ds_read_b64_tr_b16 v[60:61], v33 offset:32768
v_mfma_f32_16x16x32_bf16 v[172:175], a[144:147], v[48:51], v[172:175]
s_waitcnt vmcnt(21) lgkmcnt(3)
buffer_load_dwordx4 v4, s[24:27], s43 offen offset:2048 lds
v_mfma_f32_16x16x32_bf16 v[172:175], a[160:163], v[52:55], v[172:175]
s_waitcnt vmcnt(20) lgkmcnt(1)
ds_read_b64_tr_b16 v[62:63], v33 offset:36864
v_mfma_f32_16x16x32_bf16 v[172:175], a[176:179], v[56:59], v[172:175]
s_waitcnt vmcnt(19)
v_mfma_f32_16x16x32_bf16 v[176:179], a[180:183], v[56:59], v[176:179]
ds_read_b64_tr_b16 v[64:65], v33 offset:40960
v_mfma_f32_16x16x32_bf16 v[176:179], a[164:167], v[52:55], v[176:179]
buffer_load_dwordx4 v5, s[24:27], s43 offen offset:3072 lds
v_mfma_f32_16x16x32_bf16 v[176:179], a[148:151], v[48:51], v[176:179]
s_add_u32 s43, s43, s73
ds_read_b64_tr_b16 v[66:67], v33 offset:45056
v_mfma_f32_16x16x32_bf16 v[176:179], a[132:135], v[44:47], v[176:179]
v_mfma_f32_16x16x32_bf16 v[180:183], a[136:139], v[44:47], v[180:183]
ds_read_b64_tr_b16 v[68:69], v33 offset:49152
v_mfma_f32_16x16x32_bf16 v[180:183], a[152:155], v[48:51], v[180:183]
s_waitcnt vmcnt(19)
buffer_load_dwordx4 a[224:227], v36, s[4:7], s44 offen offset:0 sc1
v_mfma_f32_16x16x32_bf16 v[180:183], a[168:171], v[52:55], v[180:183]
s_waitcnt vmcnt(18)
ds_read_b64_tr_b16 v[70:71], v33 offset:53248
v_mfma_f32_16x16x32_bf16 v[180:183], a[184:187], v[56:59], v[180:183]
s_waitcnt vmcnt(17)
ds_read_b64_tr_b16 v[72:73], v33 offset:57344
v_mfma_f32_16x16x32_bf16 v[184:187], a[188:191], v[56:59], v[184:187]
ds_read_b64_tr_b16 v[74:75], v33 offset:61440
v_mfma_f32_16x16x32_bf16 v[184:187], a[172:175], v[52:55], v[184:187]
buffer_load_dwordx4 a[228:231], v36, s[4:7], s44 offen offset:1024 sc1
v_mfma_f32_16x16x32_bf16 v[184:187], a[156:159], v[48:51], v[184:187]
v_mfma_f32_16x16x32_bf16 v[184:187], a[140:143], v[44:47], v[184:187]
s_waitcnt lgkmcnt(6)
v_mfma_f32_16x16x32_bf16 v[188:191], a[128:131], v[60:63], v[188:191]
s_waitcnt lgkmcnt(4)
ds_read_b64_tr_b16 v[44:45], v34 offset:32768
v_mfma_f32_16x16x32_bf16 v[188:191], a[144:147], v[64:67], v[188:191]
s_waitcnt lgkmcnt(3)
buffer_load_dwordx4 a[240:243], v36, s[4:7], s44 offen offset:2048 sc1
v_mfma_f32_16x16x32_bf16 v[188:191], a[160:163], v[68:71], v[188:191]
s_waitcnt lgkmcnt(1)
ds_read_b64_tr_b16 v[46:47], v34 offset:36864
v_mfma_f32_16x16x32_bf16 v[188:191], a[176:179], v[72:75], v[188:191]
v_mfma_f32_16x16x32_bf16 v[192:195], a[180:183], v[72:75], v[192:195]
ds_read_b64_tr_b16 v[48:49], v34 offset:40960
v_mfma_f32_16x16x32_bf16 v[192:195], a[164:167], v[68:71], v[192:195]
buffer_load_dwordx4 a[244:247], v36, s[4:7], s44 offen offset:3072 sc1
v_mfma_f32_16x16x32_bf16 v[192:195], a[148:151], v[64:67], v[192:195]
ds_read_b64_tr_b16 v[50:51], v34 offset:45056
v_mfma_f32_16x16x32_bf16 v[192:195], a[132:135], v[60:63], v[192:195]
v_mfma_f32_16x16x32_bf16 v[196:199], a[136:139], v[60:63], v[196:199]
ds_read_b64_tr_b16 v[52:53], v34 offset:49152
v_mfma_f32_16x16x32_bf16 v[196:199], a[152:155], v[64:67], v[196:199]
buffer_load_dwordx4 a[232:235], v253, s[4:7], s44 offen offset:0 sc1
v_mfma_f32_16x16x32_bf16 v[196:199], a[168:171], v[68:71], v[196:199]
ds_read_b64_tr_b16 v[54:55], v34 offset:53248
v_mfma_f32_16x16x32_bf16 v[196:199], a[184:187], v[72:75], v[196:199]
ds_read_b64_tr_b16 v[56:57], v34 offset:57344
v_mfma_f32_16x16x32_bf16 v[200:203], a[188:191], v[72:75], v[200:203]
ds_read_b64_tr_b16 v[58:59], v34 offset:61440
v_mfma_f32_16x16x32_bf16 v[200:203], a[172:175], v[68:71], v[200:203]
buffer_load_dwordx4 a[236:239], v253, s[4:7], s44 offen offset:1024 sc1
v_mfma_f32_16x16x32_bf16 v[200:203], a[156:159], v[64:67], v[200:203]
v_mfma_f32_16x16x32_bf16 v[200:203], a[140:143], v[60:63], v[200:203]
s_waitcnt lgkmcnt(6)
v_mfma_f32_16x16x32_bf16 v[204:207], a[128:131], v[44:47], v[204:207]
s_waitcnt lgkmcnt(4)
ds_read_b64_tr_b16 v[60:61], v35 offset:32768
v_mfma_f32_16x16x32_bf16 v[204:207], a[144:147], v[48:51], v[204:207]
s_waitcnt lgkmcnt(3)
buffer_load_dwordx4 a[248:251], v253, s[4:7], s44 offen offset:2048 sc1
v_mfma_f32_16x16x32_bf16 v[204:207], a[160:163], v[52:55], v[204:207]
s_waitcnt lgkmcnt(1)
ds_read_b64_tr_b16 v[62:63], v35 offset:36864
v_mfma_f32_16x16x32_bf16 v[204:207], a[176:179], v[56:59], v[204:207]
v_mfma_f32_16x16x32_bf16 v[208:211], a[180:183], v[56:59], v[208:211]
ds_read_b64_tr_b16 v[64:65], v35 offset:40960
v_mfma_f32_16x16x32_bf16 v[208:211], a[164:167], v[52:55], v[208:211]
buffer_load_dwordx4 a[252:255], v253, s[4:7], s44 offen offset:3072 sc1
v_mfma_f32_16x16x32_bf16 v[208:211], a[148:151], v[48:51], v[208:211]
s_add_u32 s44, s44, s75
ds_read_b64_tr_b16 v[66:67], v35 offset:45056
v_mfma_f32_16x16x32_bf16 v[208:211], a[132:135], v[44:47], v[208:211]
v_mfma_f32_16x16x32_bf16 v[212:215], a[136:139], v[44:47], v[212:215]
ds_read_b64_tr_b16 v[68:69], v35 offset:49152
v_mfma_f32_16x16x32_bf16 v[212:215], a[152:155], v[48:51], v[212:215]
v_mfma_f32_16x16x32_bf16 v[212:215], a[168:171], v[52:55], v[212:215]
ds_read_b64_tr_b16 v[70:71], v35 offset:53248
v_mfma_f32_16x16x32_bf16 v[212:215], a[184:187], v[56:59], v[212:215]
ds_read_b64_tr_b16 v[72:73], v35 offset:57344
v_mfma_f32_16x16x32_bf16 v[216:219], a[188:191], v[56:59], v[216:219]
ds_read_b64_tr_b16 v[74:75], v35 offset:61440
v_mfma_f32_16x16x32_bf16 v[216:219], a[172:175], v[52:55], v[216:219]
v_mfma_f32_16x16x32_bf16 v[216:219], a[156:159], v[48:51], v[216:219]
v_mfma_f32_16x16x32_bf16 v[216:219], a[140:143], v[44:47], v[216:219]
s_waitcnt lgkmcnt(6)
v_mfma_f32_16x16x32_bf16 v[220:223], a[128:131], v[60:63], v[220:223]
s_waitcnt lgkmcnt(4)
ds_read_b64_tr_b16 v[44:45], v28 offset:49152
v_mfma_f32_16x16x32_bf16 v[220:223], a[144:147], v[64:67], v[220:223]
s_waitcnt lgkmcnt(3)
v_mfma_f32_16x16x32_bf16 v[220:223], a[160:163], v[68:71], v[220:223]
s_waitcnt lgkmcnt(1)
ds_read_b64_tr_b16 v[46:47], v28 offset:53248
v_mfma_f32_16x16x32_bf16 v[220:223], a[176:179], v[72:75], v[220:223]
v_mfma_f32_16x16x32_bf16 v[224:227], a[180:183], v[72:75], v[224:227]
ds_read_b64_tr_b16 v[48:49], v28 offset:57344
v_mfma_f32_16x16x32_bf16 v[224:227], a[164:167], v[68:71], v[224:227]
v_mfma_f32_16x16x32_bf16 v[224:227], a[148:151], v[64:67], v[224:227]
ds_read_b64_tr_b16 v[50:51], v28 offset:61440
v_mfma_f32_16x16x32_bf16 v[224:227], a[132:135], v[60:63], v[224:227]
s_waitcnt vmcnt(20)
s_barrier
v_mfma_f32_16x16x32_bf16 v[228:231], a[136:139], v[60:63], v[228:231]
s_add_u32 m0, s37, 32768
ds_read_b64_tr_b16 v[52:53], v28 offset:0
v_mfma_f32_16x16x32_bf16 v[228:231], a[152:155], v[64:67], v[228:231]
buffer_load_dwordx4 v2, s[24:27], s43 offen offset:0 lds
v_mfma_f32_16x16x32_bf16 v[228:231], a[168:171], v[68:71], v[228:231]
ds_read_b64_tr_b16 v[54:55], v28 offset:4096
v_mfma_f32_16x16x32_bf16 v[228:231], a[184:187], v[72:75], v[228:231]
ds_read_b64_tr_b16 v[56:57], v28 offset:8192
v_mfma_f32_16x16x32_bf16 v[232:235], a[188:191], v[72:75], v[232:235]
ds_read_b64_tr_b16 v[58:59], v28 offset:12288
v_mfma_f32_16x16x32_bf16 v[232:235], a[172:175], v[68:71], v[232:235]
buffer_load_dwordx4 v3, s[24:27], s43 offen offset:1024 lds
v_mfma_f32_16x16x32_bf16 v[232:235], a[156:159], v[64:67], v[232:235]
v_mfma_f32_16x16x32_bf16 v[232:235], a[140:143], v[60:63], v[232:235]
s_waitcnt lgkmcnt(6)
v_mfma_f32_16x16x32_bf16 v[108:111], a[160:163], v[44:47], v[108:111]
s_waitcnt lgkmcnt(4)
ds_read_b64_tr_b16 v[60:61], v29 offset:49152
v_mfma_f32_16x16x32_bf16 v[108:111], a[176:179], v[48:51], v[108:111]
s_waitcnt vmcnt(21) lgkmcnt(3)
buffer_load_dwordx4 v4, s[24:27], s43 offen offset:2048 lds
v_mfma_f32_16x16x32_bf16 v[108:111], a[192:195], v[52:55], v[108:111]
s_waitcnt vmcnt(20) lgkmcnt(1)
ds_read_b64_tr_b16 v[62:63], v29 offset:53248
v_mfma_f32_16x16x32_bf16 v[108:111], a[208:211], v[56:59], v[108:111]
s_waitcnt vmcnt(19)
buffer_load_dword v252, off, s[4:7], s85 sc1
v_mfma_f32_16x16x32_bf16 v[112:115], a[212:215], v[56:59], v[112:115]
ds_read_b64_tr_b16 v[64:65], v29 offset:57344
v_mfma_f32_16x16x32_bf16 v[112:115], a[196:199], v[52:55], v[112:115]
buffer_load_dwordx4 v5, s[24:27], s43 offen offset:3072 lds
v_mfma_f32_16x16x32_bf16 v[112:115], a[180:183], v[48:51], v[112:115]
s_add_u32 s43, s43, s72
ds_read_b64_tr_b16 v[66:67], v29 offset:61440
v_mfma_f32_16x16x32_bf16 v[112:115], a[164:167], v[44:47], v[112:115]
v_mfma_f32_16x16x32_bf16 v[116:119], a[168:171], v[44:47], v[116:119]
ds_read_b64_tr_b16 v[68:69], v29 offset:0
v_mfma_f32_16x16x32_bf16 v[116:119], a[184:187], v[48:51], v[116:119]
s_waitcnt vmcnt(20)
buffer_load_dwordx4 a[128:131], v36, s[4:7], s44 offen offset:0 sc1
v_mfma_f32_16x16x32_bf16 v[116:119], a[200:203], v[52:55], v[116:119]
s_waitcnt vmcnt(19)
ds_read_b64_tr_b16 v[70:71], v29 offset:4096
v_mfma_f32_16x16x32_bf16 v[116:119], a[216:219], v[56:59], v[116:119]
s_waitcnt vmcnt(18)
ds_read_b64_tr_b16 v[72:73], v29 offset:8192
v_mfma_f32_16x16x32_bf16 v[120:123], a[220:223], v[56:59], v[120:123]
ds_read_b64_tr_b16 v[74:75], v29 offset:12288
v_mfma_f32_16x16x32_bf16 v[120:123], a[204:207], v[52:55], v[120:123]
buffer_load_dwordx4 a[132:135], v36, s[4:7], s44 offen offset:1024 sc1
v_mfma_f32_16x16x32_bf16 v[120:123], a[188:191], v[48:51], v[120:123]
v_mfma_f32_16x16x32_bf16 v[120:123], a[172:175], v[44:47], v[120:123]
s_waitcnt lgkmcnt(6)
v_mfma_f32_16x16x32_bf16 v[124:127], a[160:163], v[60:63], v[124:127]
s_waitcnt lgkmcnt(4)
ds_read_b64_tr_b16 v[44:45], v30 offset:49152
v_mfma_f32_16x16x32_bf16 v[124:127], a[176:179], v[64:67], v[124:127]
s_waitcnt lgkmcnt(3)
buffer_load_dwordx4 a[144:147], v36, s[4:7], s44 offen offset:2048 sc1
v_mfma_f32_16x16x32_bf16 v[124:127], a[192:195], v[68:71], v[124:127]
s_waitcnt lgkmcnt(1)
ds_read_b64_tr_b16 v[46:47], v30 offset:53248
v_mfma_f32_16x16x32_bf16 v[124:127], a[208:211], v[72:75], v[124:127]
global_load_dword a60, v42, s[56:57]
v_mfma_f32_16x16x32_bf16 v[128:131], a[212:215], v[72:75], v[128:131]
ds_read_b64_tr_b16 v[48:49], v30 offset:57344
v_mfma_f32_16x16x32_bf16 v[128:131], a[196:199], v[68:71], v[128:131]
buffer_load_dwordx4 a[148:151], v36, s[4:7], s44 offen offset:3072 sc1
v_mfma_f32_16x16x32_bf16 v[128:131], a[180:183], v[64:67], v[128:131]
ds_read_b64_tr_b16 v[50:51], v30 offset:61440
v_mfma_f32_16x16x32_bf16 v[128:131], a[164:167], v[60:63], v[128:131]
v_mfma_f32_16x16x32_bf16 v[132:135], a[168:171], v[60:63], v[132:135]
ds_read_b64_tr_b16 v[52:53], v30 offset:0
v_mfma_f32_16x16x32_bf16 v[132:135], a[184:187], v[64:67], v[132:135]
buffer_load_dwordx4 a[136:139], v253, s[4:7], s44 offen offset:0 sc1
v_mfma_f32_16x16x32_bf16 v[132:135], a[200:203], v[68:71], v[132:135]
ds_read_b64_tr_b16 v[54:55], v30 offset:4096
v_mfma_f32_16x16x32_bf16 v[132:135], a[216:219], v[72:75], v[132:135]
ds_read_b64_tr_b16 v[56:57], v30 offset:8192
v_mfma_f32_16x16x32_bf16 v[136:139], a[220:223], v[72:75], v[136:139]
ds_read_b64_tr_b16 v[58:59], v30 offset:12288
v_mfma_f32_16x16x32_bf16 v[136:139], a[204:207], v[68:71], v[136:139]
buffer_load_dwordx4 a[140:143], v253, s[4:7], s44 offen offset:1024 sc1
v_mfma_f32_16x16x32_bf16 v[136:139], a[188:191], v[64:67], v[136:139]
v_mfma_f32_16x16x32_bf16 v[136:139], a[172:175], v[60:63], v[136:139]
s_waitcnt lgkmcnt(6)
v_mfma_f32_16x16x32_bf16 v[140:143], a[160:163], v[44:47], v[140:143]
s_waitcnt lgkmcnt(4)
ds_read_b64_tr_b16 v[60:61], v31 offset:49152
v_mfma_f32_16x16x32_bf16 v[140:143], a[176:179], v[48:51], v[140:143]
s_waitcnt lgkmcnt(3)
buffer_load_dwordx4 a[152:155], v253, s[4:7], s44 offen offset:2048 sc1
v_mfma_f32_16x16x32_bf16 v[140:143], a[192:195], v[52:55], v[140:143]
s_waitcnt lgkmcnt(1)
ds_read_b64_tr_b16 v[62:63], v31 offset:53248
v_mfma_f32_16x16x32_bf16 v[140:143], a[208:211], v[56:59], v[140:143]
v_mfma_f32_16x16x32_bf16 v[144:147], a[212:215], v[56:59], v[144:147]
ds_read_b64_tr_b16 v[64:65], v31 offset:57344
v_mfma_f32_16x16x32_bf16 v[144:147], a[196:199], v[52:55], v[144:147]
buffer_load_dwordx4 a[156:159], v253, s[4:7], s44 offen offset:3072 sc1
v_mfma_f32_16x16x32_bf16 v[144:147], a[180:183], v[48:51], v[144:147]
s_add_u32 s44, s44, s74
ds_read_b64_tr_b16 v[66:67], v31 offset:61440
v_mfma_f32_16x16x32_bf16 v[144:147], a[164:167], v[44:47], v[144:147]
v_mfma_f32_16x16x32_bf16 v[148:151], a[168:171], v[44:47], v[148:151]
ds_read_b64_tr_b16 v[68:69], v31 offset:0
v_mfma_f32_16x16x32_bf16 v[148:151], a[184:187], v[48:51], v[148:151]
v_mfma_f32_16x16x32_bf16 v[148:151], a[200:203], v[52:55], v[148:151]
ds_read_b64_tr_b16 v[70:71], v31 offset:4096
v_mfma_f32_16x16x32_bf16 v[148:151], a[216:219], v[56:59], v[148:151]
ds_read_b64_tr_b16 v[72:73], v31 offset:8192
v_mfma_f32_16x16x32_bf16 v[152:155], a[220:223], v[56:59], v[152:155]
ds_read_b64_tr_b16 v[74:75], v31 offset:12288
v_mfma_f32_16x16x32_bf16 v[152:155], a[204:207], v[52:55], v[152:155]
v_mfma_f32_16x16x32_bf16 v[152:155], a[188:191], v[48:51], v[152:155]
v_mfma_f32_16x16x32_bf16 v[152:155], a[172:175], v[44:47], v[152:155]
s_waitcnt lgkmcnt(6)
v_mfma_f32_16x16x32_bf16 v[156:159], a[160:163], v[60:63], v[156:159]
s_waitcnt lgkmcnt(4)
ds_read_b64_tr_b16 v[44:45], v32 offset:0
v_mfma_f32_16x16x32_bf16 v[156:159], a[176:179], v[64:67], v[156:159]
s_waitcnt lgkmcnt(3)
v_mfma_f32_16x16x32_bf16 v[156:159], a[192:195], v[68:71], v[156:159]
s_waitcnt lgkmcnt(1)
ds_read_b64_tr_b16 v[46:47], v32 offset:4096
v_mfma_f32_16x16x32_bf16 v[156:159], a[208:211], v[72:75], v[156:159]
v_mfma_f32_16x16x32_bf16 v[160:163], a[212:215], v[72:75], v[160:163]
ds_read_b64_tr_b16 v[48:49], v32 offset:8192
v_mfma_f32_16x16x32_bf16 v[160:163], a[196:199], v[68:71], v[160:163]
v_mfma_f32_16x16x32_bf16 v[160:163], a[180:183], v[64:67], v[160:163]
ds_read_b64_tr_b16 v[50:51], v32 offset:12288
v_mfma_f32_16x16x32_bf16 v[160:163], a[164:167], v[60:63], v[160:163]
s_waitcnt vmcnt(22)
s_barrier
v_mfma_f32_16x16x32_bf16 v[164:167], a[168:171], v[60:63], v[164:167]
s_add_u32 m0, s37, 49152
ds_read_b64_tr_b16 v[52:53], v32 offset:16384
v_mfma_f32_16x16x32_bf16 v[164:167], a[184:187], v[64:67], v[164:167]
buffer_load_dwordx4 v2, s[24:27], s43 offen offset:0 lds
v_mfma_f32_16x16x32_bf16 v[164:167], a[200:203], v[68:71], v[164:167]
ds_read_b64_tr_b16 v[54:55], v32 offset:20480
v_mfma_f32_16x16x32_bf16 v[164:167], a[216:219], v[72:75], v[164:167]
s_waitcnt vmcnt(11)
ds_read_b64_tr_b16 v[56:57], v32 offset:24576
v_readfirstlane_b32 s54, v252
v_mfma_f32_16x16x32_bf16 v[168:171], a[220:223], v[72:75], v[168:171]
ds_read_b64_tr_b16 v[58:59], v32 offset:28672
v_mfma_f32_16x16x32_bf16 v[168:171], a[204:207], v[68:71], v[168:171]
buffer_load_dwordx4 v3, s[24:27], s43 offen offset:1024 lds
v_mfma_f32_16x16x32_bf16 v[168:171], a[188:191], v[64:67], v[168:171]
v_mfma_f32_16x16x32_bf16 v[168:171], a[172:175], v[60:63], v[168:171]
s_waitcnt lgkmcnt(6)
s_add_u32 s38, s38, 1
s_cbranch_scc0 L2_y
v_mfma_f32_16x16x32_bf16 v[172:175], a[192:195], v[44:47], v[172:175]
s_waitcnt lgkmcnt(4)
ds_read_b64_tr_b16 v[60:61], v33 offset:0
v_mfma_f32_16x16x32_bf16 v[172:175], a[208:211], v[48:51], v[172:175]
s_waitcnt lgkmcnt(3)
buffer_load_dwordx4 v4, s[24:27], s43 offen offset:2048 lds
v_mfma_f32_16x16x32_bf16 v[172:175], a[224:227], v[52:55], v[172:175]
s_waitcnt lgkmcnt(1)
ds_read_b64_tr_b16 v[62:63], v33 offset:4096
v_mfma_f32_16x16x32_bf16 v[172:175], a[240:243], v[56:59], v[172:175]
s_branch L2_h4o
L2_h4o_r:
v_mfma_f32_16x16x32_bf16 v[176:179], a[244:247], v[56:59], v[176:179]
ds_read_b64_tr_b16 v[64:65], v33 offset:8192
v_mfma_f32_16x16x32_bf16 v[176:179], a[228:231], v[52:55], v[176:179]
buffer_load_dwordx4 v5, s[24:27], s43 offen offset:3072 lds
v_mfma_f32_16x16x32_bf16 v[176:179], a[212:215], v[48:51], v[176:179]
s_add_u32 s43, s43, s73
ds_read_b64_tr_b16 v[66:67], v33 offset:12288
v_mfma_f32_16x16x32_bf16 v[176:179], a[196:199], v[44:47], v[176:179]
v_mfma_f32_16x16x32_bf16 v[180:183], a[200:203], v[44:47], v[180:183]
s_lshl_b32 s80, s65, 8
ds_read_b64_tr_b16 v[68:69], v33 offset:16384
s_add_u32 s80, s80, 3145728
v_mfma_f32_16x16x32_bf16 v[180:183], a[216:219], v[48:51], v[180:183]
s_lshl_b32 s67, s64, 2
buffer_load_dwordx4 a[160:163], v36, s[4:7], s44 offen offset:0 sc1
v_mfma_f32_16x16x32_bf16 v[180:183], a[232:235], v[52:55], v[180:183]
s_add_u32 s67, s67, s36
ds_read_b64_tr_b16 v[70:71], v33 offset:20480
s_lshl_b32 s81, s67, 18
v_mfma_f32_16x16x32_bf16 v[180:183], a[248:251], v[56:59], v[180:183]
s_add_u32 s81, s81, 16875520
ds_read_b64_tr_b16 v[72:73], v33 offset:24576
s_add_u32 s66, s64, s65
v_mfma_f32_16x16x32_bf16 v[184:187], a[252:255], v[56:59], v[184:187]
s_and_b32 s66, s66, 1
ds_read_b64_tr_b16 v[74:75], v33 offset:28672
v_mfma_f32_16x16x32_bf16 v[184:187], a[236:239], v[52:55], v[184:187]
buffer_load_dwordx4 a[164:167], v36, s[4:7], s44 offen offset:1024 sc1
v_mfma_f32_16x16x32_bf16 v[184:187], a[220:223], v[48:51], v[184:187]
s_cmp_lg_u32 s66, 0
s_cselect_b32 s67, -1, 1
s_cselect_b32 s55, 3, 1
v_mfma_f32_16x16x32_bf16 v[184:187], a[204:207], v[44:47], v[184:187]
s_waitcnt lgkmcnt(6)
s_mul_i32 s76, s67, 131072
s_mul_i32 s77, s55, 131072
v_mfma_f32_16x16x32_bf16 v[188:191], a[192:195], v[60:63], v[188:191]
s_waitcnt lgkmcnt(4)
s_mul_i32 s78, s67, 4096
ds_read_b64_tr_b16 v[44:45], v34 offset:0
v_mfma_f32_16x16x32_bf16 v[188:191], a[208:211], v[64:67], v[188:191]
s_waitcnt lgkmcnt(3)
buffer_load_dwordx4 a[176:179], v36, s[4:7], s44 offen offset:2048 sc1
v_mfma_f32_16x16x32_bf16 v[188:191], a[224:227], v[68:71], v[188:191]
s_waitcnt lgkmcnt(1)
s_mul_i32 s79, s55, 4096
ds_read_b64_tr_b16 v[46:47], v34 offset:4096
v_mfma_f32_16x16x32_bf16 v[188:191], a[240:243], v[72:75], v[188:191]
s_mul_i32 s67, s66, 131072
s_add_u32 s80, s80, s67
s_mul_i32 s67, s66, 4096
v_mfma_f32_16x16x32_bf16 v[192:195], a[244:247], v[72:75], v[192:195]
s_add_u32 s81, s81, s67
ds_read_b64_tr_b16 v[48:49], v34 offset:8192
v_bfe_u32 v40, v0, 4, 2
v_mfma_f32_16x16x32_bf16 v[192:195], a[228:231], v[68:71], v[192:195]
buffer_load_dwordx4 a[180:183], v36, s[4:7], s44 offen offset:3072 sc1
v_mfma_f32_16x16x32_bf16 v[192:195], a[212:215], v[64:67], v[192:195]
ds_read_b64_tr_b16 v[50:51], v34 offset:12288
v_lshrrev_b32 v41, 6, v0
v_mfma_f32_16x16x32_bf16 v[192:195], a[196:199], v[60:63], v[192:195]
v_lshl_add_u32 v40, v41, 4, v40
v_lshlrev_b32 v40, 11, v40
v_mfma_f32_16x16x32_bf16 v[196:199], a[200:203], v[60:63], v[196:199]
ds_read_b64_tr_b16 v[52:53], v34 offset:16384
v_sub_u32 v6, v2, v40
v_mfma_f32_16x16x32_bf16 v[196:199], a[216:219], v[64:67], v[196:199]
buffer_load_dwordx4 a[168:171], v253, s[4:7], s44 offen offset:0 sc1
v_mfma_f32_16x16x32_bf16 v[196:199], a[232:235], v[68:71], v[196:199]
ds_read_b64_tr_b16 v[54:55], v34 offset:20480
v_sub_u32 v7, v3, v40
v_mfma_f32_16x16x32_bf16 v[196:199], a[248:251], v[72:75], v[196:199]
ds_read_b64_tr_b16 v[56:57], v34 offset:24576
v_subrev_u32 v7, 8192, v7
v_mfma_f32_16x16x32_bf16 v[200:203], a[252:255], v[72:75], v[200:203]
ds_read_b64_tr_b16 v[58:59], v34 offset:28672
v_sub_u32 v8, v4, v40
v_mfma_f32_16x16x32_bf16 v[200:203], a[236:239], v[68:71], v[200:203]
buffer_load_dwordx4 a[172:175], v253, s[4:7], s44 offen offset:1024 sc1
v_mfma_f32_16x16x32_bf16 v[200:203], a[220:223], v[64:67], v[200:203]
v_subrev_u32 v8, 16384, v8
v_sub_u32 v9, v5, v40
v_mfma_f32_16x16x32_bf16 v[200:203], a[204:207], v[60:63], v[200:203]
s_waitcnt lgkmcnt(6)
v_subrev_u32 v9, 24576, v9
s_mov_b32 s58, 0xbfb8aa3b
v_mfma_f32_16x16x32_bf16 v[204:207], a[192:195], v[44:47], v[204:207]
s_waitcnt lgkmcnt(4)
s_mov_b32 s59, 0xbfb8aa3b
ds_read_b64_tr_b16 v[60:61], v35 offset:0
v_mfma_f32_16x16x32_bf16 v[204:207], a[208:211], v[48:51], v[204:207]
s_waitcnt lgkmcnt(3)
buffer_load_dwordx4 a[184:187], v253, s[4:7], s44 offen offset:2048 sc1
v_mfma_f32_16x16x32_bf16 v[204:207], a[224:227], v[52:55], v[204:207]
s_waitcnt lgkmcnt(1)
s_xor_b32 s66, s87, 4
ds_read_b64_tr_b16 v[62:63], v35 offset:4096
v_mfma_f32_16x16x32_bf16 v[204:207], a[240:243], v[56:59], v[204:207]
s_lshl_b32 s93, s66, 13
s_add_u32 s93, s93, 46137344
s_add_u32 s100, s93, 4096
v_mfma_f32_16x16x32_bf16 v[208:211], a[244:247], v[56:59], v[208:211]
s_lshl_b32 s66, s66, 7
ds_read_b64_tr_b16 v[64:65], v35 offset:8192
s_add_u32 s83, s66, 41959488
v_mfma_f32_16x16x32_bf16 v[208:211], a[228:231], v[52:55], v[208:211]
s_lshl_b32 s66, s87, 7
buffer_load_dwordx4 a[188:191], v253, s[4:7], s44 offen offset:3072 sc1
v_mfma_f32_16x16x32_bf16 v[208:211], a[212:215], v[48:51], v[208:211]
s_add_u32 s86, s66, 41959424
s_add_u32 s44, s44, s75
ds_read_b64_tr_b16 v[66:67], v35 offset:12288
v_mfma_f32_16x16x32_bf16 v[208:211], a[196:199], v[44:47], v[208:211]
s_add_u32 s84, s85, 6144
s_add_u32 s85, s86, 64
s_mov_b32 s82, -9
v_mfma_f32_16x16x32_bf16 v[212:215], a[200:203], v[44:47], v[212:215]
s_lshl_b32 s66, s36, 14
ds_read_b64_tr_b16 v[68:69], v35 offset:16384
s_lshl_b32 s67, s36, 11
v_mfma_f32_16x16x32_bf16 v[212:215], a[216:219], v[48:51], v[212:215]
v_and_b32 v39, 63, v0
v_lshlrev_b32 v39, 4, v39
v_mfma_f32_16x16x32_bf16 v[212:215], a[232:235], v[52:55], v[212:215]
ds_read_b64_tr_b16 v[70:71], v35 offset:20480
v_add_u32 v38, s67, v39
v_mfma_f32_16x16x32_bf16 v[212:215], a[248:251], v[56:59], v[212:215]
ds_read_b64_tr_b16 v[72:73], v35 offset:24576
v_add_u32 v39, s66, v39
v_mfma_f32_16x16x32_bf16 v[216:219], a[252:255], v[56:59], v[216:219]
ds_read_b64_tr_b16 v[74:75], v35 offset:28672
v_bfe_u32 v40, v0, 4, 2
v_mfma_f32_16x16x32_bf16 v[216:219], a[236:239], v[52:55], v[216:219]
v_and_b32 v41, 15, v0
v_lshlrev_b32 v40, 2, v40
v_mfma_f32_16x16x32_bf16 v[216:219], a[220:223], v[48:51], v[216:219]
v_sub_u32 v40, v41, v40
v_and_b32 v41, 1, v0
v_mfma_f32_16x16x32_bf16 v[216:219], a[204:207], v[44:47], v[216:219]
s_waitcnt lgkmcnt(6)
v_lshlrev_b32 v41, 4, v41
v_mov_b32 v10, 0x3f80
v_mfma_f32_16x16x32_bf16 v[220:223], a[192:195], v[60:63], v[220:223]
s_waitcnt lgkmcnt(4)
ds_read_b64_tr_b16 v[44:45], v28 offset:16384
v_lshlrev_b32 v41, v41, v10
v_mfma_f32_16x16x32_bf16 v[220:223], a[208:211], v[64:67], v[220:223]
s_waitcnt lgkmcnt(3)
v_lshrrev_b32 v40, 1, v40
v_cmp_eq_u32 vcc, 0, v40
v_mfma_f32_16x16x32_bf16 v[220:223], a[224:227], v[68:71], v[220:223]
s_waitcnt lgkmcnt(1)
ds_read_b64_tr_b16 v[46:47], v28 offset:20480
v_mov_b32 v10, 0
v_mfma_f32_16x16x32_bf16 v[220:223], a[240:243], v[72:75], v[220:223]
v_mov_b32 v11, 0
v_cndmask_b32 v12, 0, v41, vcc
v_mfma_f32_16x16x32_bf16 v[224:227], a[244:247], v[72:75], v[224:227]
ds_read_b64_tr_b16 v[48:49], v28 offset:24576
v_cmp_eq_u32 vcc, 1, v40
v_mfma_f32_16x16x32_bf16 v[224:227], a[228:231], v[68:71], v[224:227]
v_mov_b32 v14, 0
v_mov_b32 v15, 0
v_mfma_f32_16x16x32_bf16 v[224:227], a[212:215], v[64:67], v[224:227]
ds_read_b64_tr_b16 v[50:51], v28 offset:28672
v_cndmask_b32 v13, 0, v41, vcc
v_mfma_f32_16x16x32_bf16 v[224:227], a[196:199], v[60:63], v[224:227]
s_waitcnt vmcnt(21)
s_barrier
v_mfma_f32_16x16x32_bf16 v[228:231], a[200:203], v[60:63], v[228:231]
s_add_u32 m0, s37, 65536
ds_read_b64_tr_b16 v[52:53], v28 offset:32768
v_mfma_f32_16x16x32_bf16 v[228:231], a[216:219], v[64:67], v[228:231]
buffer_load_dwordx4 v6, s[28:31], s80 offen offset:0 lds
v_mfma_f32_16x16x32_bf16 v[228:231], a[232:235], v[68:71], v[228:231]
ds_read_b64_tr_b16 v[54:55], v28 offset:36864
v_mfma_f32_16x16x32_bf16 v[228:231], a[248:251], v[72:75], v[228:231]
ds_read_b64_tr_b16 v[56:57], v28 offset:40960
v_mfma_f32_16x16x32_bf16 v[232:235], a[252:255], v[72:75], v[232:235]
ds_read_b64_tr_b16 v[58:59], v28 offset:45056
v_mfma_f32_16x16x32_bf16 v[232:235], a[236:239], v[68:71], v[232:235]
buffer_load_dwordx4 v7, s[28:31], s80 offen offset:1024 lds
v_mfma_f32_16x16x32_bf16 v[232:235], a[220:223], v[64:67], v[232:235]
v_mfma_f32_16x16x32_bf16 v[232:235], a[204:207], v[60:63], v[232:235]
s_waitcnt lgkmcnt(6)
v_mfma_f32_16x16x32_bf16 v[108:111], a[224:227], v[44:47], v[108:111]
s_waitcnt lgkmcnt(4)
ds_read_b64_tr_b16 v[60:61], v29 offset:16384
v_mfma_f32_16x16x32_bf16 v[108:111], a[240:243], v[48:51], v[108:111]
s_waitcnt vmcnt(22) lgkmcnt(3)
buffer_load_dwordx4 v8, s[28:31], s80 offen offset:2048 lds
v_mfma_f32_16x16x32_bf16 v[108:111], a[128:131], v[52:55], v[108:111]
s_waitcnt vmcnt(21) lgkmcnt(1)
ds_read_b64_tr_b16 v[62:63], v29 offset:20480
v_mfma_f32_16x16x32_bf16 v[108:111], a[144:147], v[56:59], v[108:111]
s_waitcnt vmcnt(19)
v_mfma_f32_16x16x32_bf16 v[112:115], a[148:151], v[56:59], v[112:115]
ds_read_b64_tr_b16 v[64:65], v29 offset:24576
v_mfma_f32_16x16x32_bf16 v[112:115], a[132:135], v[52:55], v[112:115]
buffer_load_dwordx4 v9, s[28:31], s80 offen offset:3072 lds
v_mfma_f32_16x16x32_bf16 v[112:115], a[244:247], v[48:51], v[112:115]
s_add_u32 s80, s80, s76
ds_read_b64_tr_b16 v[66:67], v29 offset:28672
v_mfma_f32_16x16x32_bf16 v[112:115], a[228:231], v[44:47], v[112:115]
v_mfma_f32_16x16x32_bf16 v[116:119], a[232:235], v[44:47], v[116:119]
ds_read_b64_tr_b16 v[68:69], v29 offset:32768
v_mfma_f32_16x16x32_bf16 v[116:119], a[248:251], v[48:51], v[116:119]
s_waitcnt vmcnt(19)
buffer_load_dwordx4 a[0:3], v1, s[4:7], s81 offen offset:0 sc1
v_mfma_f32_16x16x32_bf16 v[116:119], a[136:139], v[52:55], v[116:119]
s_waitcnt vmcnt(18)
ds_read_b64_tr_b16 v[70:71], v29 offset:36864
v_mfma_f32_16x16x32_bf16 v[116:119], a[152:155], v[56:59], v[116:119]
s_waitcnt vmcnt(17)
ds_read_b64_tr_b16 v[72:73], v29 offset:40960
v_mfma_f32_16x16x32_bf16 v[120:123], a[156:159], v[56:59], v[120:123]
ds_read_b64_tr_b16 v[74:75], v29 offset:45056
v_mfma_f32_16x16x32_bf16 v[120:123], a[140:143], v[52:55], v[120:123]
buffer_load_dwordx4 a[4:7], v1, s[4:7], s81 offen offset:1024 sc1
v_mfma_f32_16x16x32_bf16 v[120:123], a[252:255], v[48:51], v[120:123]
v_mfma_f32_16x16x32_bf16 v[120:123], a[236:239], v[44:47], v[120:123]
s_waitcnt lgkmcnt(6)
v_mfma_f32_16x16x32_bf16 v[124:127], a[224:227], v[60:63], v[124:127]
s_waitcnt lgkmcnt(4)
ds_read_b64_tr_b16 v[44:45], v30 offset:16384
v_mfma_f32_16x16x32_bf16 v[124:127], a[240:243], v[64:67], v[124:127]
s_waitcnt lgkmcnt(3)
buffer_load_dwordx4 a[8:11], v1, s[4:7], s81 offen offset:2048 sc1
v_mfma_f32_16x16x32_bf16 v[124:127], a[128:131], v[68:71], v[124:127]
s_waitcnt lgkmcnt(1)
ds_read_b64_tr_b16 v[46:47], v30 offset:20480
v_mfma_f32_16x16x32_bf16 v[124:127], a[144:147], v[72:75], v[124:127]
v_mfma_f32_16x16x32_bf16 v[128:131], a[148:151], v[72:75], v[128:131]
ds_read_b64_tr_b16 v[48:49], v30 offset:24576
v_mfma_f32_16x16x32_bf16 v[128:131], a[132:135], v[68:71], v[128:131]
buffer_load_dwordx4 a[12:15], v1, s[4:7], s81 offen offset:3072 sc1
v_mfma_f32_16x16x32_bf16 v[128:131], a[244:247], v[64:67], v[128:131]
s_add_u32 s81, s81, s78
ds_read_b64_tr_b16 v[50:51], v30 offset:28672
v_mfma_f32_16x16x32_bf16 v[128:131], a[228:231], v[60:63], v[128:131]
v_mfma_f32_16x16x32_bf16 v[132:135], a[232:235], v[60:63], v[132:135]
s_add_u32 m0, s37, 81920
ds_read_b64_tr_b16 v[52:53], v30 offset:32768
v_mfma_f32_16x16x32_bf16 v[132:135], a[248:251], v[64:67], v[132:135]
buffer_load_dwordx4 v6, s[28:31], s80 offen offset:0 lds
v_mfma_f32_16x16x32_bf16 v[132:135], a[136:139], v[68:71], v[132:135]
ds_read_b64_tr_b16 v[54:55], v30 offset:36864
v_mfma_f32_16x16x32_bf16 v[132:135], a[152:155], v[72:75], v[132:135]
ds_read_b64_tr_b16 v[56:57], v30 offset:40960
v_mfma_f32_16x16x32_bf16 v[136:139], a[156:159], v[72:75], v[136:139]
ds_read_b64_tr_b16 v[58:59], v30 offset:45056
v_mfma_f32_16x16x32_bf16 v[136:139], a[140:143], v[68:71], v[136:139]
buffer_load_dwordx4 v7, s[28:31], s80 offen offset:1024 lds
v_mfma_f32_16x16x32_bf16 v[136:139], a[252:255], v[64:67], v[136:139]
v_mfma_f32_16x16x32_bf16 v[136:139], a[236:239], v[60:63], v[136:139]
s_waitcnt lgkmcnt(6)
v_mfma_f32_16x16x32_bf16 v[140:143], a[224:227], v[44:47], v[140:143]
s_waitcnt lgkmcnt(4)
ds_read_b64_tr_b16 v[60:61], v31 offset:16384
v_mfma_f32_16x16x32_bf16 v[140:143], a[240:243], v[48:51], v[140:143]
s_waitcnt lgkmcnt(3)
buffer_load_dwordx4 v8, s[28:31], s80 offen offset:2048 lds
v_mfma_f32_16x16x32_bf16 v[140:143], a[128:131], v[52:55], v[140:143]
s_waitcnt lgkmcnt(1)
ds_read_b64_tr_b16 v[62:63], v31 offset:20480
v_mfma_f32_16x16x32_bf16 v[140:143], a[144:147], v[56:59], v[140:143]
v_mfma_f32_16x16x32_bf16 v[144:147], a[148:151], v[56:59], v[144:147]
ds_read_b64_tr_b16 v[64:65], v31 offset:24576
v_mfma_f32_16x16x32_bf16 v[144:147], a[132:135], v[52:55], v[144:147]
buffer_load_dwordx4 v9, s[28:31], s80 offen offset:3072 lds
v_mfma_f32_16x16x32_bf16 v[144:147], a[244:247], v[48:51], v[144:147]
s_add_u32 s80, s80, s77
ds_read_b64_tr_b16 v[66:67], v31 offset:28672
v_mfma_f32_16x16x32_bf16 v[144:147], a[228:231], v[44:47], v[144:147]
v_mfma_f32_16x16x32_bf16 v[148:151], a[232:235], v[44:47], v[148:151]
ds_read_b64_tr_b16 v[68:69], v31 offset:32768
v_mfma_f32_16x16x32_bf16 v[148:151], a[248:251], v[48:51], v[148:151]
v_mfma_f32_16x16x32_bf16 v[148:151], a[136:139], v[52:55], v[148:151]
ds_read_b64_tr_b16 v[70:71], v31 offset:36864
v_mfma_f32_16x16x32_bf16 v[148:151], a[152:155], v[56:59], v[148:151]
ds_read_b64_tr_b16 v[72:73], v31 offset:40960
v_mfma_f32_16x16x32_bf16 v[152:155], a[156:159], v[56:59], v[152:155]
ds_read_b64_tr_b16 v[74:75], v31 offset:45056
v_mfma_f32_16x16x32_bf16 v[152:155], a[140:143], v[52:55], v[152:155]
v_mfma_f32_16x16x32_bf16 v[152:155], a[252:255], v[48:51], v[152:155]
v_mfma_f32_16x16x32_bf16 v[152:155], a[236:239], v[44:47], v[152:155]
s_waitcnt lgkmcnt(6)
v_mfma_f32_16x16x32_bf16 v[156:159], a[224:227], v[60:63], v[156:159]
s_waitcnt lgkmcnt(4)
ds_read_b64_tr_b16 v[44:45], v32 offset:32768
v_mfma_f32_16x16x32_bf16 v[156:159], a[240:243], v[64:67], v[156:159]
s_waitcnt lgkmcnt(3)
v_mfma_f32_16x16x32_bf16 v[156:159], a[128:131], v[68:71], v[156:159]
s_waitcnt lgkmcnt(1)
ds_read_b64_tr_b16 v[46:47], v32 offset:36864
v_mfma_f32_16x16x32_bf16 v[156:159], a[144:147], v[72:75], v[156:159]
v_mfma_f32_16x16x32_bf16 v[160:163], a[148:151], v[72:75], v[160:163]
ds_read_b64_tr_b16 v[48:49], v32 offset:40960
v_mfma_f32_16x16x32_bf16 v[160:163], a[132:135], v[68:71], v[160:163]
v_mfma_f32_16x16x32_bf16 v[160:163], a[244:247], v[64:67], v[160:163]
ds_read_b64_tr_b16 v[50:51], v32 offset:45056
v_mfma_f32_16x16x32_bf16 v[160:163], a[228:231], v[60:63], v[160:163]
s_waitcnt vmcnt(20)
s_barrier
v_mfma_f32_16x16x32_bf16 v[164:167], a[232:235], v[60:63], v[164:167]
ds_read_b64_tr_b16 v[52:53], v32 offset:49152
v_mfma_f32_16x16x32_bf16 v[164:167], a[248:251], v[64:67], v[164:167]
buffer_load_dwordx4 a[16:19], v1, s[4:7], s81 offen offset:0 sc1
v_mfma_f32_16x16x32_bf16 v[164:167], a[136:139], v[68:71], v[164:167]
ds_read_b64_tr_b16 v[54:55], v32 offset:53248
v_mfma_f32_16x16x32_bf16 v[164:167], a[152:155], v[72:75], v[164:167]
ds_read_b64_tr_b16 v[56:57], v32 offset:57344
v_mfma_f32_16x16x32_bf16 v[168:171], a[156:159], v[72:75], v[168:171]
ds_read_b64_tr_b16 v[58:59], v32 offset:61440
v_mfma_f32_16x16x32_bf16 v[168:171], a[140:143], v[68:71], v[168:171]
buffer_load_dwordx4 a[20:23], v1, s[4:7], s81 offen offset:1024 sc1
v_mfma_f32_16x16x32_bf16 v[168:171], a[252:255], v[64:67], v[168:171]
v_mfma_f32_16x16x32_bf16 v[168:171], a[236:239], v[60:63], v[168:171]
s_waitcnt lgkmcnt(6)
v_mfma_f32_16x16x32_bf16 v[172:175], a[128:131], v[44:47], v[172:175]
s_waitcnt lgkmcnt(4)
ds_read_b64_tr_b16 v[60:61], v33 offset:32768
v_mfma_f32_16x16x32_bf16 v[172:175], a[144:147], v[48:51], v[172:175]
s_waitcnt vmcnt(21) lgkmcnt(3)
buffer_load_dwordx4 a[24:27], v1, s[4:7], s81 offen offset:2048 sc1
v_mfma_f32_16x16x32_bf16 v[172:175], a[160:163], v[52:55], v[172:175]
s_waitcnt vmcnt(20) lgkmcnt(1)
ds_read_b64_tr_b16 v[62:63], v33 offset:36864
v_mfma_f32_16x16x32_bf16 v[172:175], a[176:179], v[56:59], v[172:175]
s_waitcnt vmcnt(19)
v_mfma_f32_16x16x32_bf16 v[176:179], a[180:183], v[56:59], v[176:179]
ds_read_b64_tr_b16 v[64:65], v33 offset:40960
v_mfma_f32_16x16x32_bf16 v[176:179], a[164:167], v[52:55], v[176:179]
buffer_load_dwordx4 a[28:31], v1, s[4:7], s81 offen offset:3072 sc1
v_mfma_f32_16x16x32_bf16 v[176:179], a[148:151], v[48:51], v[176:179]
s_add_u32 s81, s81, s79
ds_read_b64_tr_b16 v[66:67], v33 offset:45056
v_mfma_f32_16x16x32_bf16 v[176:179], a[132:135], v[44:47], v[176:179]
v_mfma_f32_16x16x32_bf16 v[180:183], a[136:139], v[44:47], v[180:183]
s_add_u32 m0, s37, 98304
ds_read_b64_tr_b16 v[68:69], v33 offset:49152
v_mfma_f32_16x16x32_bf16 v[180:183], a[152:155], v[48:51], v[180:183]
s_waitcnt vmcnt(19)
buffer_load_dwordx4 v6, s[28:31], s80 offen offset:0 lds
v_mfma_f32_16x16x32_bf16 v[180:183], a[168:171], v[52:55], v[180:183]
s_waitcnt vmcnt(18)
ds_read_b64_tr_b16 v[70:71], v33 offset:53248
v_mfma_f32_16x16x32_bf16 v[180:183], a[184:187], v[56:59], v[180:183]
s_waitcnt vmcnt(17)
ds_read_b64_tr_b16 v[72:73], v33 offset:57344
v_mfma_f32_16x16x32_bf16 v[184:187], a[188:191], v[56:59], v[184:187]
ds_read_b64_tr_b16 v[74:75], v33 offset:61440
v_mfma_f32_16x16x32_bf16 v[184:187], a[172:175], v[52:55], v[184:187]
buffer_load_dwordx4 v7, s[28:31], s80 offen offset:1024 lds
v_mfma_f32_16x16x32_bf16 v[184:187], a[156:159], v[48:51], v[184:187]
v_mfma_f32_16x16x32_bf16 v[184:187], a[140:143], v[44:47], v[184:187]
s_waitcnt lgkmcnt(6)
v_mfma_f32_16x16x32_bf16 v[188:191], a[128:131], v[60:63], v[188:191]
s_waitcnt lgkmcnt(4)
ds_read_b64_tr_b16 v[44:45], v34 offset:32768
v_mfma_f32_16x16x32_bf16 v[188:191], a[144:147], v[64:67], v[188:191]
s_waitcnt lgkmcnt(3)
buffer_load_dwordx4 v8, s[28:31], s80 offen offset:2048 lds
v_mfma_f32_16x16x32_bf16 v[188:191], a[160:163], v[68:71], v[188:191]
s_waitcnt lgkmcnt(1)
ds_read_b64_tr_b16 v[46:47], v34 offset:36864
v_mfma_f32_16x16x32_bf16 v[188:191], a[176:179], v[72:75], v[188:191]
v_mfma_f32_16x16x32_bf16 v[192:195], a[180:183], v[72:75], v[192:195]
ds_read_b64_tr_b16 v[48:49], v34 offset:40960
v_mfma_f32_16x16x32_bf16 v[192:195], a[164:167], v[68:71], v[192:195]
buffer_load_dwordx4 v9, s[28:31], s80 offen offset:3072 lds
v_mfma_f32_16x16x32_bf16 v[192:195], a[148:151], v[64:67], v[192:195]
s_add_u32 s80, s80, s76
ds_read_b64_tr_b16 v[50:51], v34 offset:45056
v_mfma_f32_16x16x32_bf16 v[192:195], a[132:135], v[60:63], v[192:195]
v_mfma_f32_16x16x32_bf16 v[196:199], a[136:139], v[60:63], v[196:199]
ds_read_b64_tr_b16 v[52:53], v34 offset:49152
v_cvt_pk_bf16_f32 v180, v180, v181
v_mfma_f32_16x16x32_bf16 v[196:199], a[152:155], v[64:67], v[196:199]
buffer_load_dwordx4 a[32:35], v1, s[4:7], s81 offen offset:0 sc1
v_mfma_f32_16x16x32_bf16 v[196:199], a[168:171], v[68:71], v[196:199]
ds_read_b64_tr_b16 v[54:55], v34 offset:53248
v_cvt_pk_bf16_f32 v181, v182, v183
v_mfma_f32_16x16x32_bf16 v[196:199], a[184:187], v[72:75], v[196:199]
ds_read_b64_tr_b16 v[56:57], v34 offset:57344
v_cvt_pk_bf16_f32 v182, v184, v185
v_mfma_f32_16x16x32_bf16 v[200:203], a[188:191], v[72:75], v[200:203]
ds_read_b64_tr_b16 v[58:59], v34 offset:61440
v_cvt_pk_bf16_f32 v183, v186, v187
v_mfma_f32_16x16x32_bf16 v[200:203], a[172:175], v[68:71], v[200:203]
buffer_load_dwordx4 a[36:39], v1, s[4:7], s81 offen offset:1024 sc1
v_mfma_f32_16x16x32_bf16 v[200:203], a[156:159], v[64:67], v[200:203]
buffer_store_dwordx4 v[180:183], v1, s[4:7], s100 offen offset:0 sc1
v_mfma_f32_16x16x32_bf16 v[200:203], a[140:143], v[60:63], v[200:203]
s_waitcnt lgkmcnt(6)
v_mov_b64 v[184:185], 0
v_mov_b64 v[186:187], 0
v_mfma_f32_16x16x32_bf16 v[204:207], a[128:131], v[44:47], v[204:207]
s_waitcnt lgkmcnt(4)
ds_read_b64_tr_b16 v[60:61], v35 offset:32768
v_mov_b64 v[180:181], 0
v_mfma_f32_16x16x32_bf16 v[204:207], a[144:147], v[48:51], v[204:207]
s_waitcnt lgkmcnt(3)
buffer_load_dwordx4 a[40:43], v1, s[4:7], s81 offen offset:2048 sc1
v_mfma_f32_16x16x32_bf16 v[204:207], a[160:163], v[52:55], v[204:207]
s_waitcnt lgkmcnt(1)
ds_read_b64_tr_b16 v[62:63], v35 offset:36864
v_mov_b64 v[182:183], 0
v_mfma_f32_16x16x32_bf16 v[204:207], a[176:179], v[56:59], v[204:207]
v_mfma_f32_16x16x32_bf16 v[208:211], a[180:183], v[56:59], v[208:211]
ds_read_b64_tr_b16 v[64:65], v35 offset:40960
v_mfma_f32_16x16x32_bf16 v[208:211], a[164:167], v[52:55], v[208:211]
buffer_load_dwordx4 a[44:47], v1, s[4:7], s81 offen offset:3072 sc1
v_mfma_f32_16x16x32_bf16 v[208:211], a[148:151], v[48:51], v[208:211]
s_add_u32 s81, s81, s78
ds_read_b64_tr_b16 v[66:67], v35 offset:45056
v_mfma_f32_16x16x32_bf16 v[208:211], a[132:135], v[44:47], v[208:211]
v_mfma_f32_16x16x32_bf16 v[212:215], a[136:139], v[44:47], v[212:215]
ds_read_b64_tr_b16 v[68:69], v35 offset:49152
v_cvt_pk_bf16_f32 v196, v196, v197
v_mfma_f32_16x16x32_bf16 v[212:215], a[152:155], v[48:51], v[212:215]
v_cvt_pk_bf16_f32 v197, v198, v199
v_cvt_pk_bf16_f32 v198, v200, v201
v_mfma_f32_16x16x32_bf16 v[212:215], a[168:171], v[52:55], v[212:215]
ds_read_b64_tr_b16 v[70:71], v35 offset:53248
v_cvt_pk_bf16_f32 v199, v202, v203
v_mfma_f32_16x16x32_bf16 v[212:215], a[184:187], v[56:59], v[212:215]
ds_read_b64_tr_b16 v[72:73], v35 offset:57344
v_mfma_f32_16x16x32_bf16 v[216:219], a[188:191], v[56:59], v[216:219]
ds_read_b64_tr_b16 v[74:75], v35 offset:61440
v_mfma_f32_16x16x32_bf16 v[216:219], a[172:175], v[52:55], v[216:219]
buffer_store_dwordx4 v[196:199], v1, s[4:7], s100 offen offset:1024 sc1
v_mfma_f32_16x16x32_bf16 v[216:219], a[156:159], v[48:51], v[216:219]
v_mov_b64 v[200:201], 0
v_mov_b64 v[202:203], 0
v_mfma_f32_16x16x32_bf16 v[216:219], a[140:143], v[44:47], v[216:219]
s_waitcnt lgkmcnt(6)
v_mov_b64 v[196:197], 0
v_mov_b64 v[198:199], 0
v_mfma_f32_16x16x32_bf16 v[220:223], a[128:131], v[60:63], v[220:223]
s_waitcnt lgkmcnt(4)
ds_read_b64_tr_b16 v[44:45], v28 offset:49152
v_mfma_f32_16x16x32_bf16 v[220:223], a[144:147], v[64:67], v[220:223]
s_waitcnt lgkmcnt(3)
v_mfma_f32_16x16x32_bf16 v[220:223], a[160:163], v[68:71], v[220:223]
s_waitcnt lgkmcnt(1)
ds_read_b64_tr_b16 v[46:47], v28 offset:53248
v_mfma_f32_16x16x32_bf16 v[220:223], a[176:179], v[72:75], v[220:223]
v_mfma_f32_16x16x32_bf16 v[224:227], a[180:183], v[72:75], v[224:227]
ds_read_b64_tr_b16 v[48:49], v28 offset:57344
v_mfma_f32_16x16x32_bf16 v[224:227], a[164:167], v[68:71], v[224:227]
v_mfma_f32_16x16x32_bf16 v[224:227], a[148:151], v[64:67], v[224:227]
ds_read_b64_tr_b16 v[50:51], v28 offset:61440
v_mfma_f32_16x16x32_bf16 v[224:227], a[132:135], v[60:63], v[224:227]
s_waitcnt vmcnt(22)
s_barrier
v_mfma_f32_16x16x32_bf16 v[228:231], a[136:139], v[60:63], v[228:231]
s_add_u32 m0, s37, 114688
ds_read_b64_tr_b16 v[52:53], v29 offset:49152
v_cvt_pk_bf16_f32 v212, v212, v213
v_mfma_f32_16x16x32_bf16 v[228:231], a[152:155], v[64:67], v[228:231]
buffer_load_dwordx4 v6, s[28:31], s80 offen offset:0 lds
v_mfma_f32_16x16x32_bf16 v[228:231], a[168:171], v[68:71], v[228:231]
ds_read_b64_tr_b16 v[54:55], v29 offset:53248
v_cvt_pk_bf16_f32 v213, v214, v215
v_mfma_f32_16x16x32_bf16 v[228:231], a[184:187], v[72:75], v[228:231]
v_cvt_pk_bf16_f32 v214, v216, v217
v_cvt_pk_bf16_f32 v215, v218, v219
v_mfma_f32_16x16x32_bf16 v[232:235], a[188:191], v[72:75], v[232:235]
ds_read_b64_tr_b16 v[56:57], v29 offset:57344
v_mfma_f32_16x16x32_bf16 v[232:235], a[172:175], v[68:71], v[232:235]
buffer_load_dwordx4 v7, s[28:31], s80 offen offset:1024 lds
v_mfma_f32_16x16x32_bf16 v[232:235], a[156:159], v[64:67], v[232:235]
ds_read_b64_tr_b16 v[58:59], v29 offset:61440
v_mfma_f32_16x16x32_bf16 v[232:235], a[140:143], v[60:63], v[232:235]
s_waitcnt lgkmcnt(6)
buffer_store_dwordx4 v[212:215], v1, s[4:7], s100 offen offset:2048 sc1
v_mfma_f32_16x16x32_bf16 v[108:111], a[160:163], v[44:47], v[108:111]
s_waitcnt lgkmcnt(4)
ds_read_b64_tr_b16 v[60:61], v30 offset:49152
v_mov_b64 v[216:217], 0
v_mfma_f32_16x16x32_bf16 v[108:111], a[176:179], v[48:51], v[108:111]
v_mov_b64 v[218:219], 0
v_mov_b64 v[212:213], 0
v_mfma_f32_16x16x32_bf16 v[112:115], a[180:183], v[48:51], v[112:115]
ds_read_b64_tr_b16 v[62:63], v30 offset:53248
v_mov_b64 v[214:215], 0
v_mfma_f32_16x16x32_bf16 v[112:115], a[164:167], v[44:47], v[112:115]
v_mfma_f32_16x16x32_bf16 v[116:119], a[168:171], v[44:47], v[116:119]
ds_read_b64_tr_b16 v[64:65], v30 offset:57344
v_mfma_f32_16x16x32_bf16 v[116:119], a[184:187], v[48:51], v[116:119]
v_mfma_f32_16x16x32_bf16 v[120:123], a[188:191], v[48:51], v[120:123]
ds_read_b64_tr_b16 v[66:67], v30 offset:61440
v_mfma_f32_16x16x32_bf16 v[120:123], a[172:175], v[44:47], v[120:123]
s_waitcnt lgkmcnt(6)
v_mfma_f32_16x16x32_bf16 v[124:127], a[160:163], v[52:55], v[124:127]
s_waitcnt lgkmcnt(4)
ds_read_b64_tr_b16 v[68:69], v31 offset:49152
v_cvt_pk_bf16_f32 v228, v228, v229
v_mfma_f32_16x16x32_bf16 v[124:127], a[176:179], v[56:59], v[124:127]
v_cvt_pk_bf16_f32 v229, v230, v231
v_cvt_pk_bf16_f32 v230, v232, v233
v_mfma_f32_16x16x32_bf16 v[128:131], a[180:183], v[56:59], v[128:131]
ds_read_b64_tr_b16 v[70:71], v31 offset:53248
v_cvt_pk_bf16_f32 v231, v234, v235
v_mfma_f32_16x16x32_bf16 v[128:131], a[164:167], v[52:55], v[128:131]
buffer_store_dwordx4 v[228:231], v1, s[4:7], s100 offen offset:3072 sc1
v_mfma_f32_16x16x32_bf16 v[132:135], a[168:171], v[52:55], v[132:135]
ds_read_b64_tr_b16 v[72:73], v31 offset:57344
v_mov_b64 v[232:233], 0
v_mfma_f32_16x16x32_bf16 v[132:135], a[184:187], v[56:59], v[132:135]
v_mov_b64 v[234:235], 0
v_mov_b64 v[228:229], 0
v_mfma_f32_16x16x32_bf16 v[136:139], a[188:191], v[56:59], v[136:139]
ds_read_b64_tr_b16 v[74:75], v31 offset:61440
v_mov_b64 v[230:231], 0
v_mfma_f32_16x16x32_bf16 v[136:139], a[172:175], v[52:55], v[136:139]
s_waitcnt lgkmcnt(6)
v_mfma_f32_16x16x32_bf16 v[140:143], a[160:163], v[60:63], v[140:143]
s_waitcnt lgkmcnt(4)
ds_read_b64_tr_b16 a[64:65], v20 offset:0
v_cvt_pk_bf16_f32 v116, v116, v117
v_mfma_f32_16x16x32_bf16 v[140:143], a[176:179], v[64:67], v[140:143]
v_cvt_pk_bf16_f32 v117, v118, v119
v_cvt_pk_bf16_f32 v118, v120, v121
v_mfma_f32_16x16x32_bf16 v[144:147], a[180:183], v[64:67], v[144:147]
ds_read_b64_tr_b16 a[66:67], v20 offset:4096
v_cvt_pk_bf16_f32 v119, v122, v123
v_mfma_f32_16x16x32_bf16 v[144:147], a[164:167], v[60:63], v[144:147]
buffer_store_dwordx4 v[116:119], v1, s[4:7], s93 offen offset:0 sc1
v_mfma_f32_16x16x32_bf16 v[148:151], a[168:171], v[60:63], v[148:151]
ds_read_b64_tr_b16 a[68:69], v20 offset:8192
v_mov_b64 v[120:121], 0
v_mfma_f32_16x16x32_bf16 v[148:151], a[184:187], v[64:67], v[148:151]
v_mov_b64 v[122:123], 0
v_mov_b64 v[116:117], 0
v_mfma_f32_16x16x32_bf16 v[152:155], a[188:191], v[64:67], v[152:155]
ds_read_b64_tr_b16 a[70:71], v20 offset:12288
v_mov_b64 v[118:119], 0
v_mfma_f32_16x16x32_bf16 v[152:155], a[172:175], v[60:63], v[152:155]
s_waitcnt lgkmcnt(6)
v_mfma_f32_16x16x32_bf16 v[156:159], a[160:163], v[68:71], v[156:159]
s_waitcnt lgkmcnt(4)
ds_read_b64_tr_b16 a[72:73], v21 offset:0
v_cvt_pk_bf16_f32 v132, v132, v133
v_mfma_f32_16x16x32_bf16 v[156:159], a[176:179], v[72:75], v[156:159]
v_cvt_pk_bf16_f32 v133, v134, v135
v_cvt_pk_bf16_f32 v134, v136, v137
v_mfma_f32_16x16x32_bf16 v[160:163], a[180:183], v[72:75], v[160:163]
ds_read_b64_tr_b16 a[74:75], v21 offset:4096
v_cvt_pk_bf16_f32 v135, v138, v139
v_mfma_f32_16x16x32_bf16 v[160:163], a[164:167], v[68:71], v[160:163]
buffer_store_dwordx4 v[132:135], v1, s[4:7], s93 offen offset:1024 sc1
v_mfma_f32_16x16x32_bf16 v[164:167], a[168:171], v[68:71], v[164:167]
ds_read_b64_tr_b16 a[76:77], v21 offset:8192
v_mov_b64 v[136:137], 0
v_mfma_f32_16x16x32_bf16 v[164:167], a[184:187], v[72:75], v[164:167]
v_mov_b64 v[138:139], 0
v_mov_b64 v[132:133], 0
v_mfma_f32_16x16x32_bf16 v[168:171], a[188:191], v[72:75], v[168:171]
ds_read_b64_tr_b16 a[78:79], v21 offset:12288
v_mov_b64 v[134:135], 0
v_mfma_f32_16x16x32_bf16 v[168:171], a[172:175], v[68:71], v[168:171]
s_nop 0
ds_read_b64_tr_b16 a[80:81], v22 offset:0
ds_read_b64_tr_b16 a[82:83], v22 offset:4096
ds_read_b64_tr_b16 a[84:85], v22 offset:8192
ds_read_b64_tr_b16 a[86:87], v22 offset:12288
v_cvt_pk_bf16_f32 v148, v148, v149
v_cvt_pk_bf16_f32 v149, v150, v151
v_cvt_pk_bf16_f32 v150, v152, v153
v_cvt_pk_bf16_f32 v151, v154, v155
buffer_store_dwordx4 v[148:151], v1, s[4:7], s93 offen offset:2048 sc1
v_mov_b64 v[152:153], 0
v_mov_b64 v[154:155], 0
v_mov_b64 v[148:149], 0
v_mov_b64 v[150:151], 0
v_cvt_pk_bf16_f32 v164, v164, v165
v_cvt_pk_bf16_f32 v165, v166, v167
v_cvt_pk_bf16_f32 v166, v168, v169
v_cvt_pk_bf16_f32 v167, v170, v171
buffer_store_dwordx4 v[164:167], v1, s[4:7], s93 offen offset:3072 sc1
v_mov_b64 v[168:169], 0
v_mov_b64 v[170:171], 0
v_mov_b64 v[164:165], 0
v_mov_b64 v[166:167], 0
s_mov_b32 s38, -9
.p2align 3
L2_s:
s_waitcnt vmcnt(29) lgkmcnt(10)
v_mfma_f32_16x16x32_bf16 v[116:119], a[64:67], a[0:3], v[116:119]
s_waitcnt vmcnt(20) lgkmcnt(8)
ds_read_b64_tr_b16 a[88:89], v23 offset:0
ds_read_b64_tr_b16 a[90:91], v23 offset:4096
v_mfma_f32_16x16x32_bf16 v[116:119], a[68:71], a[8:11], v[116:119]
s_waitcnt vmcnt(19)
buffer_load_dwordx4 v8, s[28:31], s80 offen offset:2048 lds
v_mfma_f32_16x16x32_bf16 v[120:123], a[68:71], a[12:15], v[120:123]
ds_read_b64_tr_b16 a[92:93], v23 offset:8192
ds_read_b64_tr_b16 a[94:95], v23 offset:12288
v_mfma_f32_16x16x32_bf16 v[120:123], a[64:67], a[4:7], v[120:123]
s_waitcnt lgkmcnt(10)
v_mfma_f32_16x16x32_bf16 v[132:135], a[72:75], a[0:3], v[132:135]
s_waitcnt lgkmcnt(8)
ds_read_b64_tr_b16 a[64:65], v24 offset:0
ds_read_b64_tr_b16 a[66:67], v24 offset:4096
v_mfma_f32_16x16x32_bf16 v[132:135], a[76:79], a[8:11], v[132:135]
buffer_load_dwordx4 v9, s[28:31], s80 offen offset:3072 lds
v_mfma_f32_16x16x32_bf16 v[136:139], a[76:79], a[12:15], v[136:139]
s_add_u32 s80, s80, s77
ds_read_b64_tr_b16 a[68:69], v24 offset:8192
ds_read_b64_tr_b16 a[70:71], v24 offset:12288
v_mfma_f32_16x16x32_bf16 v[136:139], a[72:75], a[4:7], v[136:139]
s_waitcnt lgkmcnt(10)
v_mfma_f32_16x16x32_bf16 v[148:151], a[80:83], a[0:3], v[148:151]
s_waitcnt lgkmcnt(8)
ds_read_b64_tr_b16 a[72:73], v25 offset:0
ds_read_b64_tr_b16 a[74:75], v25 offset:4096
v_mfma_f32_16x16x32_bf16 v[148:151], a[84:87], a[8:11], v[148:151]
buffer_load_dwordx4 a[48:51], v1, s[4:7], s81 offen offset:0 sc1
v_mfma_f32_16x16x32_bf16 v[152:155], a[84:87], a[12:15], v[152:155]
ds_read_b64_tr_b16 a[76:77], v25 offset:8192
ds_read_b64_tr_b16 a[78:79], v25 offset:12288
v_mfma_f32_16x16x32_bf16 v[152:155], a[80:83], a[4:7], v[152:155]
s_waitcnt lgkmcnt(10)
v_mfma_f32_16x16x32_bf16 v[164:167], a[88:91], a[0:3], v[164:167]
s_waitcnt lgkmcnt(8)
ds_read_b64_tr_b16 a[80:81], v26 offset:0
ds_read_b64_tr_b16 a[82:83], v26 offset:4096
v_mfma_f32_16x16x32_bf16 v[164:167], a[92:95], a[8:11], v[164:167]
buffer_load_dwordx4 a[52:55], v1, s[4:7], s81 offen offset:1024 sc1
v_mfma_f32_16x16x32_bf16 v[168:171], a[92:95], a[12:15], v[168:171]
ds_read_b64_tr_b16 a[84:85], v26 offset:8192
ds_read_b64_tr_b16 a[86:87], v26 offset:12288
v_mfma_f32_16x16x32_bf16 v[168:171], a[88:91], a[4:7], v[168:171]
s_waitcnt lgkmcnt(10)
v_mfma_f32_16x16x32_bf16 v[180:183], a[64:67], a[0:3], v[180:183]
s_waitcnt lgkmcnt(8)
ds_read_b64_tr_b16 a[88:89], v27 offset:0
ds_read_b64_tr_b16 a[90:91], v27 offset:4096
v_mfma_f32_16x16x32_bf16 v[180:183], a[68:71], a[8:11], v[180:183]
buffer_load_dwordx4 a[56:59], v1, s[4:7], s81 offen offset:2048 sc1
v_mfma_f32_16x16x32_bf16 v[184:187], a[68:71], a[12:15], v[184:187]
ds_read_b64_tr_b16 a[92:93], v27 offset:8192
ds_read_b64_tr_b16 a[94:95], v27 offset:12288
v_mfma_f32_16x16x32_bf16 v[184:187], a[64:67], a[4:7], v[184:187]
s_waitcnt lgkmcnt(10)
v_mfma_f32_16x16x32_bf16 v[196:199], a[72:75], a[0:3], v[196:199]
s_waitcnt lgkmcnt(8)
v_mfma_f32_16x16x32_bf16 v[196:199], a[76:79], a[8:11], v[196:199]
buffer_load_dwordx4 a[60:63], v1, s[4:7], s81 offen offset:3072 sc1
v_mfma_f32_16x16x32_bf16 v[200:203], a[76:79], a[12:15], v[200:203]
s_add_u32 s81, s81, s79
v_mfma_f32_16x16x32_bf16 v[200:203], a[72:75], a[4:7], v[200:203]
s_waitcnt vmcnt(21) lgkmcnt(0)
s_barrier
v_mfma_f32_16x16x32_bf16 v[212:215], a[80:83], a[0:3], v[212:215]
ds_read_b64_tr_b16 a[64:65], v20 offset:16384
ds_read_b64_tr_b16 a[66:67], v20 offset:20480
v_mfma_f32_16x16x32_bf16 v[212:215], a[84:87], a[8:11], v[212:215]
ds_read_b64_tr_b16 a[68:69], v20 offset:24576
ds_read_b64_tr_b16 a[70:71], v20 offset:28672
v_mfma_f32_16x16x32_bf16 v[216:219], a[84:87], a[12:15], v[216:219]
ds_read_b64_tr_b16 a[72:73], v21 offset:16384
ds_read_b64_tr_b16 a[74:75], v21 offset:20480
v_mfma_f32_16x16x32_bf16 v[216:219], a[80:83], a[4:7], v[216:219]
ds_read_b64_tr_b16 a[76:77], v21 offset:24576
ds_read_b64_tr_b16 a[78:79], v21 offset:28672
v_mfma_f32_16x16x32_bf16 v[228:231], a[88:91], a[0:3], v[228:231]
s_add_u32 m0, s37, 65536
ds_read_b64_tr_b16 a[80:81], v22 offset:16384
ds_read_b64_tr_b16 a[82:83], v22 offset:20480
v_mfma_f32_16x16x32_bf16 v[228:231], a[92:95], a[8:11], v[228:231]
buffer_load_dwordx4 v6, s[28:31], s80 offen offset:0 lds
v_mfma_f32_16x16x32_bf16 v[232:235], a[92:95], a[12:15], v[232:235]
ds_read_b64_tr_b16 a[84:85], v22 offset:24576
ds_read_b64_tr_b16 a[86:87], v22 offset:28672
v_mfma_f32_16x16x32_bf16 v[232:235], a[88:91], a[4:7], v[232:235]
s_waitcnt vmcnt(14) lgkmcnt(10)
buffer_load_dwordx4 v7, s[28:31], s80 offen offset:1024 lds
v_readfirstlane_b32 s54, v252
v_mfma_f32_16x16x32_bf16 v[116:119], a[64:67], a[16:19], v[116:119]
s_waitcnt vmcnt(27) lgkmcnt(8)
ds_read_b64_tr_b16 a[88:89], v23 offset:16384
ds_read_b64_tr_b16 a[90:91], v23 offset:20480
v_mfma_f32_16x16x32_bf16 v[116:119], a[68:71], a[24:27], v[116:119]
s_waitcnt vmcnt(26)
buffer_load_dwordx4 v8, s[28:31], s80 offen offset:2048 lds
v_mfma_f32_16x16x32_bf16 v[120:123], a[68:71], a[28:31], v[120:123]
ds_read_b64_tr_b16 a[92:93], v23 offset:24576
ds_read_b64_tr_b16 a[94:95], v23 offset:28672
v_mfma_f32_16x16x32_bf16 v[120:123], a[64:67], a[20:23], v[120:123]
s_waitcnt lgkmcnt(10)
s_bitcmp1_b32 234881024, s38
s_cbranch_scc1 L2_h3
L2_h3_r:
v_mfma_f32_16x16x32_bf16 v[132:135], a[72:75], a[16:19], v[132:135]
s_waitcnt lgkmcnt(8)
ds_read_b64_tr_b16 a[64:65], v24 offset:16384
ds_read_b64_tr_b16 a[66:67], v24 offset:20480
v_mfma_f32_16x16x32_bf16 v[132:135], a[76:79], a[24:27], v[132:135]
buffer_load_dwordx4 v9, s[28:31], s80 offen offset:3072 lds
v_mfma_f32_16x16x32_bf16 v[136:139], a[76:79], a[28:31], v[136:139]
s_add_u32 s80, s80, s76
ds_read_b64_tr_b16 a[68:69], v24 offset:24576
ds_read_b64_tr_b16 a[70:71], v24 offset:28672
v_mfma_f32_16x16x32_bf16 v[136:139], a[72:75], a[20:23], v[136:139]
s_waitcnt lgkmcnt(10)
v_mfma_f32_16x16x32_bf16 v[148:151], a[80:83], a[16:19], v[148:151]
s_waitcnt lgkmcnt(8)
ds_read_b64_tr_b16 a[72:73], v25 offset:16384
ds_read_b64_tr_b16 a[74:75], v25 offset:20480
v_mfma_f32_16x16x32_bf16 v[148:151], a[84:87], a[24:27], v[148:151]
buffer_load_dwordx4 a[0:3], v1, s[4:7], s81 offen offset:0 sc1
v_mfma_f32_16x16x32_bf16 v[152:155], a[84:87], a[28:31], v[152:155]
ds_read_b64_tr_b16 a[76:77], v25 offset:24576
ds_read_b64_tr_b16 a[78:79], v25 offset:28672
v_mfma_f32_16x16x32_bf16 v[152:155], a[80:83], a[20:23], v[152:155]
s_waitcnt lgkmcnt(10)
v_mfma_f32_16x16x32_bf16 v[164:167], a[88:91], a[16:19], v[164:167]
s_waitcnt lgkmcnt(8)
ds_read_b64_tr_b16 a[80:81], v26 offset:16384
ds_read_b64_tr_b16 a[82:83], v26 offset:20480
v_mfma_f32_16x16x32_bf16 v[164:167], a[92:95], a[24:27], v[164:167]
buffer_load_dwordx4 a[4:7], v1, s[4:7], s81 offen offset:1024 sc1
v_mfma_f32_16x16x32_bf16 v[168:171], a[92:95], a[28:31], v[168:171]
ds_read_b64_tr_b16 a[84:85], v26 offset:24576
ds_read_b64_tr_b16 a[86:87], v26 offset:28672
v_mfma_f32_16x16x32_bf16 v[168:171], a[88:91], a[20:23], v[168:171]
s_waitcnt lgkmcnt(10)
v_mfma_f32_16x16x32_bf16 v[180:183], a[64:67], a[16:19], v[180:183]
s_waitcnt lgkmcnt(8)
ds_read_b64_tr_b16 a[88:89], v27 offset:16384
ds_read_b64_tr_b16 a[90:91], v27 offset:20480
v_mfma_f32_16x16x32_bf16 v[180:183], a[68:71], a[24:27], v[180:183]
buffer_load_dwordx4 a[8:11], v1, s[4:7], s81 offen offset:2048 sc1
v_mfma_f32_16x16x32_bf16 v[184:187], a[68:71], a[28:31], v[184:187]
ds_read_b64_tr_b16 a[92:93], v27 offset:24576
ds_read_b64_tr_b16 a[94:95], v27 offset:28672
v_mfma_f32_16x16x32_bf16 v[184:187], a[64:67], a[20:23], v[184:187]
s_waitcnt lgkmcnt(10)
v_mfma_f32_16x16x32_bf16 v[196:199], a[72:75], a[16:19], v[196:199]
s_waitcnt lgkmcnt(8)
v_mfma_f32_16x16x32_bf16 v[196:199], a[76:79], a[24:27], v[196:199]
buffer_load_dwordx4 a[12:15], v1, s[4:7], s81 offen offset:3072 sc1
v_mfma_f32_16x16x32_bf16 v[200:203], a[76:79], a[28:31], v[200:203]
s_add_u32 s81, s81, s78
v_mfma_f32_16x16x32_bf16 v[200:203], a[72:75], a[20:23], v[200:203]
s_waitcnt vmcnt(20) lgkmcnt(0)
s_barrier
v_mfma_f32_16x16x32_bf16 v[212:215], a[80:83], a[16:19], v[212:215]
ds_read_b64_tr_b16 a[64:65], v20 offset:32768
ds_read_b64_tr_b16 a[66:67], v20 offset:36864
v_mfma_f32_16x16x32_bf16 v[212:215], a[84:87], a[24:27], v[212:215]
ds_read_b64_tr_b16 a[68:69], v20 offset:40960
ds_read_b64_tr_b16 a[70:71], v20 offset:45056
v_mfma_f32_16x16x32_bf16 v[216:219], a[84:87], a[28:31], v[216:219]
ds_read_b64_tr_b16 a[72:73], v21 offset:32768
ds_read_b64_tr_b16 a[74:75], v21 offset:36864
v_mfma_f32_16x16x32_bf16 v[216:219], a[80:83], a[20:23], v[216:219]
ds_read_b64_tr_b16 a[76:77], v21 offset:40960
ds_read_b64_tr_b16 a[78:79], v21 offset:45056
v_mfma_f32_16x16x32_bf16 v[228:231], a[88:91], a[16:19], v[228:231]
s_add_u32 m0, s37, 81920
ds_read_b64_tr_b16 a[80:81], v22 offset:32768
ds_read_b64_tr_b16 a[82:83], v22 offset:36864
v_mfma_f32_16x16x32_bf16 v[228:231], a[92:95], a[24:27], v[228:231]
buffer_load_dwordx4 v6, s[28:31], s80 offen offset:0 lds
v_mfma_f32_16x16x32_bf16 v[232:235], a[92:95], a[28:31], v[232:235]
ds_read_b64_tr_b16 a[84:85], v22 offset:40960
ds_read_b64_tr_b16 a[86:87], v22 offset:45056
v_mfma_f32_16x16x32_bf16 v[232:235], a[88:91], a[20:23], v[232:235]
s_waitcnt vmcnt(20) lgkmcnt(10)
buffer_load_dwordx4 v7, s[28:31], s80 offen offset:1024 lds
v_mfma_f32_16x16x32_bf16 v[116:119], a[64:67], a[32:35], v[116:119]
s_waitcnt vmcnt(19) lgkmcnt(8)
ds_read_b64_tr_b16 a[88:89], v23 offset:32768
ds_read_b64_tr_b16 a[90:91], v23 offset:36864
v_mfma_f32_16x16x32_bf16 v[116:119], a[68:71], a[40:43], v[116:119]
s_waitcnt vmcnt(18)
buffer_load_dwordx4 v8, s[28:31], s80 offen offset:2048 lds
v_mfma_f32_16x16x32_bf16 v[120:123], a[68:71], a[44:47], v[120:123]
ds_read_b64_tr_b16 a[92:93], v23 offset:40960
ds_read_b64_tr_b16 a[94:95], v23 offset:45056
v_mfma_f32_16x16x32_bf16 v[120:123], a[64:67], a[36:39], v[120:123]
s_waitcnt lgkmcnt(10)
v_mfma_f32_16x16x32_bf16 v[132:135], a[72:75], a[32:35], v[132:135]
s_waitcnt lgkmcnt(8)
ds_read_b64_tr_b16 a[64:65], v24 offset:32768
ds_read_b64_tr_b16 a[66:67], v24 offset:36864
v_mfma_f32_16x16x32_bf16 v[132:135], a[76:79], a[40:43], v[132:135]
buffer_load_dwordx4 v9, s[28:31], s80 offen offset:3072 lds
v_mfma_f32_16x16x32_bf16 v[136:139], a[76:79], a[44:47], v[136:139]
s_add_u32 s80, s80, s77
ds_read_b64_tr_b16 a[68:69], v24 offset:40960
ds_read_b64_tr_b16 a[70:71], v24 offset:45056
v_mfma_f32_16x16x32_bf16 v[136:139], a[72:75], a[36:39], v[136:139]
s_waitcnt lgkmcnt(10)
v_mfma_f32_16x16x32_bf16 v[148:151], a[80:83], a[32:35], v[148:151]
s_waitcnt lgkmcnt(8)
ds_read_b64_tr_b16 a[72:73], v25 offset:32768
ds_read_b64_tr_b16 a[74:75], v25 offset:36864
v_mfma_f32_16x16x32_bf16 v[148:151], a[84:87], a[40:43], v[148:151]
buffer_load_dwordx4 a[16:19], v1, s[4:7], s81 offen offset:0 sc1
v_mfma_f32_16x16x32_bf16 v[152:155], a[84:87], a[44:47], v[152:155]
ds_read_b64_tr_b16 a[76:77], v25 offset:40960
ds_read_b64_tr_b16 a[78:79], v25 offset:45056
v_mfma_f32_16x16x32_bf16 v[152:155], a[80:83], a[36:39], v[152:155]
s_waitcnt lgkmcnt(10)
v_mfma_f32_16x16x32_bf16 v[164:167], a[88:91], a[32:35], v[164:167]
s_waitcnt lgkmcnt(8)
ds_read_b64_tr_b16 a[80:81], v26 offset:32768
ds_read_b64_tr_b16 a[82:83], v26 offset:36864
v_mfma_f32_16x16x32_bf16 v[164:167], a[92:95], a[40:43], v[164:167]
buffer_load_dwordx4 a[20:23], v1, s[4:7], s81 offen offset:1024 sc1
v_mfma_f32_16x16x32_bf16 v[168:171], a[92:95], a[44:47], v[168:171]
ds_read_b64_tr_b16 a[84:85], v26 offset:40960
ds_read_b64_tr_b16 a[86:87], v26 offset:45056
v_mfma_f32_16x16x32_bf16 v[168:171], a[88:91], a[36:39], v[168:171]
s_waitcnt lgkmcnt(10)
v_mfma_f32_16x16x32_bf16 v[180:183], a[64:67], a[32:35], v[180:183]
s_waitcnt lgkmcnt(8)
ds_read_b64_tr_b16 a[88:89], v27 offset:32768
ds_read_b64_tr_b16 a[90:91], v27 offset:36864
v_mfma_f32_16x16x32_bf16 v[180:183], a[68:71], a[40:43], v[180:183]
buffer_load_dwordx4 a[24:27], v1, s[4:7], s81 offen offset:2048 sc1
v_mfma_f32_16x16x32_bf16 v[184:187], a[68:71], a[44:47], v[184:187]
ds_read_b64_tr_b16 a[92:93], v27 offset:40960
ds_read_b64_tr_b16 a[94:95], v27 offset:45056
v_mfma_f32_16x16x32_bf16 v[184:187], a[64:67], a[36:39], v[184:187]
s_waitcnt lgkmcnt(10)
v_mfma_f32_16x16x32_bf16 v[196:199], a[72:75], a[32:35], v[196:199]
s_waitcnt lgkmcnt(8)
v_mfma_f32_16x16x32_bf16 v[196:199], a[76:79], a[40:43], v[196:199]
buffer_load_dwordx4 a[28:31], v1, s[4:7], s81 offen offset:3072 sc1
v_mfma_f32_16x16x32_bf16 v[200:203], a[76:79], a[44:47], v[200:203]
s_add_u32 s81, s81, s79
v_mfma_f32_16x16x32_bf16 v[200:203], a[72:75], a[36:39], v[200:203]
s_waitcnt vmcnt(20) lgkmcnt(0)
s_barrier
v_mfma_f32_16x16x32_bf16 v[212:215], a[80:83], a[32:35], v[212:215]
ds_read_b64_tr_b16 a[64:65], v20 offset:49152
ds_read_b64_tr_b16 a[66:67], v20 offset:53248
v_mfma_f32_16x16x32_bf16 v[212:215], a[84:87], a[40:43], v[212:215]
ds_read_b64_tr_b16 a[68:69], v20 offset:57344
ds_read_b64_tr_b16 a[70:71], v20 offset:61440
v_mfma_f32_16x16x32_bf16 v[216:219], a[84:87], a[44:47], v[216:219]
ds_read_b64_tr_b16 a[72:73], v21 offset:49152
ds_read_b64_tr_b16 a[74:75], v21 offset:53248
v_mfma_f32_16x16x32_bf16 v[216:219], a[80:83], a[36:39], v[216:219]
ds_read_b64_tr_b16 a[76:77], v21 offset:57344
ds_read_b64_tr_b16 a[78:79], v21 offset:61440
v_mfma_f32_16x16x32_bf16 v[228:231], a[88:91], a[32:35], v[228:231]
s_add_u32 m0, s37, 98304
ds_read_b64_tr_b16 a[80:81], v22 offset:49152
ds_read_b64_tr_b16 a[82:83], v22 offset:53248
v_mfma_f32_16x16x32_bf16 v[228:231], a[92:95], a[40:43], v[228:231]
buffer_load_dwordx4 v6, s[28:31], s80 offen offset:0 lds
v_mfma_f32_16x16x32_bf16 v[232:235], a[92:95], a[44:47], v[232:235]
ds_read_b64_tr_b16 a[84:85], v22 offset:57344
ds_read_b64_tr_b16 a[86:87], v22 offset:61440
v_mfma_f32_16x16x32_bf16 v[232:235], a[88:91], a[36:39], v[232:235]
s_waitcnt vmcnt(20) lgkmcnt(10)
buffer_load_dwordx4 v7, s[28:31], s80 offen offset:1024 lds
v_mfma_f32_16x16x32_bf16 v[116:119], a[64:67], a[48:51], v[116:119]
s_waitcnt vmcnt(19) lgkmcnt(8)
ds_read_b64_tr_b16 a[88:89], v23 offset:49152
ds_read_b64_tr_b16 a[90:91], v23 offset:53248
v_mfma_f32_16x16x32_bf16 v[116:119], a[68:71], a[56:59], v[116:119]
s_waitcnt vmcnt(18)
buffer_load_dwordx4 v8, s[28:31], s80 offen offset:2048 lds
v_mfma_f32_16x16x32_bf16 v[120:123], a[68:71], a[60:63], v[120:123]
ds_read_b64_tr_b16 a[92:93], v23 offset:57344
ds_read_b64_tr_b16 a[94:95], v23 offset:61440
v_mfma_f32_16x16x32_bf16 v[120:123], a[64:67], a[52:55], v[120:123]
s_waitcnt lgkmcnt(10)
buffer_load_dword v252, off, s[4:7], s85 sc1
v_mfma_f32_16x16x32_bf16 v[132:135], a[72:75], a[48:51], v[132:135]
s_waitcnt lgkmcnt(8)
ds_read_b64_tr_b16 a[64:65], v24 offset:49152
ds_read_b64_tr_b16 a[66:67], v24 offset:53248
v_mfma_f32_16x16x32_bf16 v[132:135], a[76:79], a[56:59], v[132:135]
buffer_load_dwordx4 v9, s[28:31], s80 offen offset:3072 lds
v_mfma_f32_16x16x32_bf16 v[136:139], a[76:79], a[60:63], v[136:139]
s_add_u32 s80, s80, s76
ds_read_b64_tr_b16 a[68:69], v24 offset:57344
ds_read_b64_tr_b16 a[70:71], v24 offset:61440
v_mfma_f32_16x16x32_bf16 v[136:139], a[72:75], a[52:55], v[136:139]
s_waitcnt lgkmcnt(10)
s_cmp_eq_u32 s38, s82
s_cbranch_scc1 L2_sy1
L2_sy1_r:
v_mfma_f32_16x16x32_bf16 v[148:151], a[80:83], a[48:51], v[148:151]
s_waitcnt lgkmcnt(8)
ds_read_b64_tr_b16 a[72:73], v25 offset:49152
ds_read_b64_tr_b16 a[74:75], v25 offset:53248
v_mfma_f32_16x16x32_bf16 v[148:151], a[84:87], a[56:59], v[148:151]
buffer_load_dwordx4 a[32:35], v1, s[4:7], s81 offen offset:0 sc1
v_mfma_f32_16x16x32_bf16 v[152:155], a[84:87], a[60:63], v[152:155]
ds_read_b64_tr_b16 a[76:77], v25 offset:57344
ds_read_b64_tr_b16 a[78:79], v25 offset:61440
v_mfma_f32_16x16x32_bf16 v[152:155], a[80:83], a[52:55], v[152:155]
s_waitcnt lgkmcnt(10)
v_mfma_f32_16x16x32_bf16 v[164:167], a[88:91], a[48:51], v[164:167]
s_waitcnt lgkmcnt(8)
ds_read_b64_tr_b16 a[80:81], v26 offset:49152
ds_read_b64_tr_b16 a[82:83], v26 offset:53248
v_mfma_f32_16x16x32_bf16 v[164:167], a[92:95], a[56:59], v[164:167]
buffer_load_dwordx4 a[36:39], v1, s[4:7], s81 offen offset:1024 sc1
v_mfma_f32_16x16x32_bf16 v[168:171], a[92:95], a[60:63], v[168:171]
ds_read_b64_tr_b16 a[84:85], v26 offset:57344
ds_read_b64_tr_b16 a[86:87], v26 offset:61440
v_mfma_f32_16x16x32_bf16 v[168:171], a[88:91], a[52:55], v[168:171]
s_waitcnt lgkmcnt(10)
v_mfma_f32_16x16x32_bf16 v[180:183], a[64:67], a[48:51], v[180:183]
s_waitcnt lgkmcnt(8)
ds_read_b64_tr_b16 a[88:89], v27 offset:49152
ds_read_b64_tr_b16 a[90:91], v27 offset:53248
v_mfma_f32_16x16x32_bf16 v[180:183], a[68:71], a[56:59], v[180:183]
buffer_load_dwordx4 a[40:43], v1, s[4:7], s81 offen offset:2048 sc1
v_mfma_f32_16x16x32_bf16 v[184:187], a[68:71], a[60:63], v[184:187]
ds_read_b64_tr_b16 a[92:93], v27 offset:57344
ds_read_b64_tr_b16 a[94:95], v27 offset:61440
v_mfma_f32_16x16x32_bf16 v[184:187], a[64:67], a[52:55], v[184:187]
s_waitcnt lgkmcnt(10)
v_mfma_f32_16x16x32_bf16 v[196:199], a[72:75], a[48:51], v[196:199]
s_waitcnt lgkmcnt(8)
v_mfma_f32_16x16x32_bf16 v[196:199], a[76:79], a[56:59], v[196:199]
buffer_load_dwordx4 a[44:47], v1, s[4:7], s81 offen offset:3072 sc1
v_mfma_f32_16x16x32_bf16 v[200:203], a[76:79], a[60:63], v[200:203]
s_add_u32 s81, s81, s78
v_mfma_f32_16x16x32_bf16 v[200:203], a[72:75], a[52:55], v[200:203]
s_waitcnt vmcnt(21) lgkmcnt(0)
s_barrier
v_mfma_f32_16x16x32_bf16 v[212:215], a[80:83], a[48:51], v[212:215]
ds_read_b64_tr_b16 a[64:65], v20 offset:0
ds_read_b64_tr_b16 a[66:67], v20 offset:4096
v_mfma_f32_16x16x32_bf16 v[212:215], a[84:87], a[56:59], v[212:215]
ds_read_b64_tr_b16 a[68:69], v20 offset:8192
ds_read_b64_tr_b16 a[70:71], v20 offset:12288
v_mfma_f32_16x16x32_bf16 v[216:219], a[84:87], a[60:63], v[216:219]
ds_read_b64_tr_b16 a[72:73], v21 offset:0
ds_read_b64_tr_b16 a[74:75], v21 offset:4096
v_mfma_f32_16x16x32_bf16 v[216:219], a[80:83], a[52:55], v[216:219]
ds_read_b64_tr_b16 a[76:77], v21 offset:8192
ds_read_b64_tr_b16 a[78:79], v21 offset:12288
v_mfma_f32_16x16x32_bf16 v[228:231], a[88:91], a[48:51], v[228:231]
s_add_u32 m0, s37, 114688
ds_read_b64_tr_b16 a[80:81], v22 offset:0
ds_read_b64_tr_b16 a[82:83], v22 offset:4096
v_mfma_f32_16x16x32_bf16 v[228:231], a[92:95], a[56:59], v[228:231]
buffer_load_dwordx4 v6, s[28:31], s80 offen offset:0 lds
v_mfma_f32_16x16x32_bf16 v[232:235], a[92:95], a[60:63], v[232:235]
ds_read_b64_tr_b16 a[84:85], v22 offset:8192
ds_read_b64_tr_b16 a[86:87], v22 offset:12288
v_mfma_f32_16x16x32_bf16 v[232:235], a[88:91], a[52:55], v[232:235]
s_waitcnt vmcnt(21) lgkmcnt(10)
buffer_load_dwordx4 v7, s[28:31], s80 offen offset:1024 lds
s_add_u32 s38, s38, 1
s_cbranch_scc0 L2_s
v_bfe_u32 v40, v0, 4, 2
v_and_b32 v41, 15, v0
v_xor_b32 v2, v40, v41
v_lshlrev_b32 v2, 4, v2
v_lshl_add_u32 v2, v40, 11, v2
v_xor_b32 v3, 64, v2
v_add_u32 v3, 7168, v3
v_xor_b32 v4, 128, v2
v_add_u32 v4, 14336, v4
v_xor_b32 v5, 192, v2
v_add_u32 v5, 21504, v5
s_lshl_b32 s66, s36, 13
s_add_u32 s66, s66, 131072
s_lshl_b32 s87, s87, 14
s_add_u32 s87, s87, 33554432
v_mfma_f32_16x16x32_bf16 v[116:119], a[64:67], a[0:3], v[116:119]
s_waitcnt vmcnt(20) lgkmcnt(8)
ds_read_b64_tr_b16 a[88:89], v23 offset:0
ds_read_b64_tr_b16 a[90:91], v23 offset:4096
v_mfma_f32_16x16x32_bf16 v[116:119], a[68:71], a[8:11], v[116:119]
s_waitcnt vmcnt(19)
buffer_load_dwordx4 v8, s[28:31], s80 offen offset:2048 lds
v_mfma_f32_16x16x32_bf16 v[120:123], a[68:71], a[12:15], v[120:123]
ds_read_b64_tr_b16 a[92:93], v23 offset:8192
ds_read_b64_tr_b16 a[94:95], v23 offset:12288
v_mfma_f32_16x16x32_bf16 v[120:123], a[64:67], a[4:7], v[120:123]
s_waitcnt lgkmcnt(10)
ds_read_b128 v[108:111], v39 offset:0
v_lshrrev_b32 v38, 1, v40
v_mfma_f32_16x16x32_bf16 v[132:135], a[72:75], a[0:3], v[132:135]
s_waitcnt lgkmcnt(9)
ds_read_b64_tr_b16 a[64:65], v24 offset:0
ds_read_b64_tr_b16 a[66:67], v24 offset:4096
v_mfma_f32_16x16x32_bf16 v[132:135], a[76:79], a[8:11], v[132:135]
buffer_load_dwordx4 v9, s[28:31], s80 offen offset:3072 lds
v_mfma_f32_16x16x32_bf16 v[136:139], a[76:79], a[12:15], v[136:139]
s_add_u32 s80, s80, s77
ds_read_b64_tr_b16 a[68:69], v24 offset:8192
ds_read_b64_tr_b16 a[70:71], v24 offset:12288
v_mfma_f32_16x16x32_bf16 v[136:139], a[72:75], a[4:7], v[136:139]
s_waitcnt lgkmcnt(11)
ds_read_b128 v[112:115], v39 offset:8192
v_xor_b32 v38, v38, v41
v_mfma_f32_16x16x32_bf16 v[148:151], a[80:83], a[0:3], v[148:151]
s_waitcnt lgkmcnt(10)
ds_read_b64_tr_b16 a[72:73], v25 offset:0
ds_read_b64_tr_b16 a[74:75], v25 offset:4096
v_mfma_f32_16x16x32_bf16 v[148:151], a[84:87], a[8:11], v[148:151]
buffer_load_dwordx4 a[48:51], v1, s[4:7], s81 offen offset:0 sc1
v_mfma_f32_16x16x32_bf16 v[152:155], a[84:87], a[12:15], v[152:155]
ds_read_b64_tr_b16 a[76:77], v25 offset:8192
ds_read_b64_tr_b16 a[78:79], v25 offset:12288
v_mfma_f32_16x16x32_bf16 v[152:155], a[80:83], a[4:7], v[152:155]
s_waitcnt lgkmcnt(12)
ds_read_b128 v[124:127], v39 offset:1024
v_lshlrev_b32 v38, 4, v38
v_mfma_f32_16x16x32_bf16 v[164:167], a[88:91], a[0:3], v[164:167]
s_waitcnt lgkmcnt(11)
ds_read_b64_tr_b16 a[80:81], v26 offset:0
ds_read_b64_tr_b16 a[82:83], v26 offset:4096
v_mfma_f32_16x16x32_bf16 v[164:167], a[92:95], a[8:11], v[164:167]
buffer_load_dwordx4 a[52:55], v1, s[4:7], s81 offen offset:1024 sc1
v_mfma_f32_16x16x32_bf16 v[168:171], a[92:95], a[12:15], v[168:171]
ds_read_b64_tr_b16 a[84:85], v26 offset:8192
ds_read_b64_tr_b16 a[86:87], v26 offset:12288
v_mfma_f32_16x16x32_bf16 v[168:171], a[88:91], a[4:7], v[168:171]
s_waitcnt lgkmcnt(12)
ds_read_b128 v[128:131], v39 offset:9216
v_lshl_add_u32 v38, v41, 8, v38
v_mfma_f32_16x16x32_bf16 v[180:183], a[64:67], a[0:3], v[180:183]
s_waitcnt lgkmcnt(11)
ds_read_b64_tr_b16 a[88:89], v27 offset:0
ds_read_b64_tr_b16 a[90:91], v27 offset:4096
v_mfma_f32_16x16x32_bf16 v[180:183], a[68:71], a[8:11], v[180:183]
buffer_load_dwordx4 a[56:59], v1, s[4:7], s81 offen offset:2048 sc1
v_mfma_f32_16x16x32_bf16 v[184:187], a[68:71], a[12:15], v[184:187]
ds_read_b64_tr_b16 a[92:93], v27 offset:8192
ds_read_b64_tr_b16 a[94:95], v27 offset:12288
v_mfma_f32_16x16x32_bf16 v[184:187], a[64:67], a[4:7], v[184:187]
s_waitcnt lgkmcnt(12)
ds_read_b128 v[140:143], v39 offset:2048
v_and_b32 v253, 1, v40
v_mfma_f32_16x16x32_bf16 v[196:199], a[72:75], a[0:3], v[196:199]
s_waitcnt lgkmcnt(11)
ds_read_b128 v[144:147], v39 offset:10240
v_lshl_add_u32 v38, v253, 3, v38
v_mfma_f32_16x16x32_bf16 v[196:199], a[76:79], a[8:11], v[196:199]
buffer_load_dwordx4 a[60:63], v1, s[4:7], s81 offen offset:3072 sc1
v_mfma_f32_16x16x32_bf16 v[200:203], a[76:79], a[12:15], v[200:203]
s_add_u32 s81, s81, s79
ds_read_b128 v[156:159], v39 offset:3072
v_add_u32 v28, s66, v38
v_mfma_f32_16x16x32_bf16 v[200:203], a[72:75], a[4:7], v[200:203]
s_waitcnt vmcnt(21) lgkmcnt(0)
s_barrier
ds_read_b128 v[160:163], v39 offset:11264
v_mfma_f32_16x16x32_bf16 v[212:215], a[80:83], a[0:3], v[212:215]
ds_read_b64_tr_b16 a[64:65], v20 offset:16384
ds_read_b64_tr_b16 a[66:67], v20 offset:20480
v_mfma_f32_16x16x32_bf16 v[212:215], a[84:87], a[8:11], v[212:215]
ds_read_b64_tr_b16 a[68:69], v20 offset:24576
ds_read_b64_tr_b16 a[70:71], v20 offset:28672
v_mfma_f32_16x16x32_bf16 v[216:219], a[84:87], a[12:15], v[216:219]
ds_read_b64_tr_b16 a[72:73], v21 offset:16384
ds_read_b64_tr_b16 a[74:75], v21 offset:20480
v_mfma_f32_16x16x32_bf16 v[216:219], a[80:83], a[4:7], v[216:219]
ds_read_b64_tr_b16 a[76:77], v21 offset:24576
ds_read_b64_tr_b16 a[78:79], v21 offset:28672
v_mfma_f32_16x16x32_bf16 v[228:231], a[88:91], a[0:3], v[228:231]
s_add_u32 m0, s66, 0
ds_read_b64_tr_b16 a[80:81], v22 offset:16384
ds_read_b64_tr_b16 a[82:83], v22 offset:20480
v_mfma_f32_16x16x32_bf16 v[228:231], a[92:95], a[8:11], v[228:231]
buffer_load_dwordx4 v2, s[68:71], s88 offen offset:0 lds
v_mfma_f32_16x16x32_bf16 v[232:235], a[92:95], a[12:15], v[232:235]
ds_read_b64_tr_b16 a[84:85], v22 offset:24576
ds_read_b64_tr_b16 a[86:87], v22 offset:28672
v_mfma_f32_16x16x32_bf16 v[232:235], a[88:91], a[4:7], v[232:235]
s_waitcnt vmcnt(21) lgkmcnt(10)
buffer_load_dwordx4 v3, s[68:71], s88 offen offset:1024 lds
v_mfma_f32_16x16x32_bf16 v[116:119], a[64:67], a[16:19], v[116:119]
s_waitcnt vmcnt(20) lgkmcnt(8)
ds_read_b64_tr_b16 a[88:89], v23 offset:16384
ds_read_b64_tr_b16 a[90:91], v23 offset:20480
v_mfma_f32_16x16x32_bf16 v[116:119], a[68:71], a[24:27], v[116:119]
s_waitcnt vmcnt(19)
buffer_load_dwordx4 v4, s[68:71], s88 offen offset:2048 lds
v_mfma_f32_16x16x32_bf16 v[120:123], a[68:71], a[28:31], v[120:123]
ds_read_b64_tr_b16 a[92:93], v23 offset:24576
ds_read_b64_tr_b16 a[94:95], v23 offset:28672
v_mfma_f32_16x16x32_bf16 v[120:123], a[64:67], a[20:23], v[120:123]
s_waitcnt vmcnt(16) lgkmcnt(10)
buffer_load_dword v252, off, s[4:7], s86 sc1
v_mfma_f32_16x16x32_bf16 v[132:135], a[72:75], a[16:19], v[132:135]
s_waitcnt lgkmcnt(8)
ds_read_b64_tr_b16 a[64:65], v24 offset:16384
ds_read_b64_tr_b16 a[66:67], v24 offset:20480
v_mfma_f32_16x16x32_bf16 v[132:135], a[76:79], a[24:27], v[132:135]
buffer_load_dwordx4 v5, s[68:71], s88 offen offset:3072 lds
v_mfma_f32_16x16x32_bf16 v[136:139], a[76:79], a[28:31], v[136:139]
ds_read_b64_tr_b16 a[68:69], v24 offset:24576
ds_read_b64_tr_b16 a[70:71], v24 offset:28672
v_mfma_f32_16x16x32_bf16 v[136:139], a[72:75], a[20:23], v[136:139]
s_waitcnt lgkmcnt(10)
v_xor_b32 v29, 32, v28
v_mfma_f32_16x16x32_bf16 v[148:151], a[80:83], a[16:19], v[148:151]
s_waitcnt lgkmcnt(8)
s_add_u32 m0, s66, 4096
ds_read_b64_tr_b16 a[72:73], v25 offset:16384
ds_read_b64_tr_b16 a[74:75], v25 offset:20480
v_mfma_f32_16x16x32_bf16 v[148:151], a[84:87], a[24:27], v[148:151]
buffer_load_dwordx4 v2, s[68:71], s89 offen offset:0 lds
v_mfma_f32_16x16x32_bf16 v[152:155], a[84:87], a[28:31], v[152:155]
ds_read_b64_tr_b16 a[76:77], v25 offset:24576
ds_read_b64_tr_b16 a[78:79], v25 offset:28672
v_mfma_f32_16x16x32_bf16 v[152:155], a[80:83], a[20:23], v[152:155]
s_waitcnt lgkmcnt(10)
ds_read_b128 v[172:175], v39 offset:4096
v_xor_b32 v30, 64, v28
v_mfma_f32_16x16x32_bf16 v[164:167], a[88:91], a[16:19], v[164:167]
s_waitcnt lgkmcnt(9)
ds_read_b64_tr_b16 a[80:81], v26 offset:16384
ds_read_b64_tr_b16 a[82:83], v26 offset:20480
v_mfma_f32_16x16x32_bf16 v[164:167], a[92:95], a[24:27], v[164:167]
buffer_load_dwordx4 v3, s[68:71], s89 offen offset:1024 lds
v_mfma_f32_16x16x32_bf16 v[168:171], a[92:95], a[28:31], v[168:171]
ds_read_b64_tr_b16 a[84:85], v26 offset:24576
ds_read_b64_tr_b16 a[86:87], v26 offset:28672
v_mfma_f32_16x16x32_bf16 v[168:171], a[88:91], a[20:23], v[168:171]
s_waitcnt lgkmcnt(11)
ds_read_b128 v[176:179], v39 offset:12288
v_xor_b32 v31, 96, v28
v_mfma_f32_16x16x32_bf16 v[180:183], a[64:67], a[16:19], v[180:183]
s_waitcnt lgkmcnt(10)
ds_read_b64_tr_b16 a[88:89], v27 offset:16384
ds_read_b64_tr_b16 a[90:91], v27 offset:20480
v_mfma_f32_16x16x32_bf16 v[180:183], a[68:71], a[24:27], v[180:183]
buffer_load_dwordx4 v4, s[68:71], s89 offen offset:2048 lds
v_mfma_f32_16x16x32_bf16 v[184:187], a[68:71], a[28:31], v[184:187]
ds_read_b64_tr_b16 a[92:93], v27 offset:24576
ds_read_b64_tr_b16 a[94:95], v27 offset:28672
v_mfma_f32_16x16x32_bf16 v[184:187], a[64:67], a[20:23], v[184:187]
s_waitcnt lgkmcnt(12)
ds_read_b128 v[188:191], v39 offset:5120
v_xor_b32 v32, 128, v28
v_mfma_f32_16x16x32_bf16 v[196:199], a[72:75], a[16:19], v[196:199]
s_waitcnt lgkmcnt(11)
ds_read_b128 v[192:195], v39 offset:13312
v_xor_b32 v33, 160, v28
v_mfma_f32_16x16x32_bf16 v[196:199], a[76:79], a[24:27], v[196:199]
buffer_load_dwordx4 v5, s[68:71], s89 offen offset:3072 lds
v_mfma_f32_16x16x32_bf16 v[200:203], a[76:79], a[28:31], v[200:203]
ds_read_b128 v[204:207], v39 offset:6144
v_xor_b32 v34, 192, v28
v_mfma_f32_16x16x32_bf16 v[200:203], a[72:75], a[20:23], v[200:203]
s_waitcnt vmcnt(21) lgkmcnt(0)
s_barrier
ds_read_b128 v[208:211], v39 offset:14336
v_mfma_f32_16x16x32_bf16 v[212:215], a[80:83], a[16:19], v[212:215]
ds_read_b64_tr_b16 a[64:65], v20 offset:32768
ds_read_b64_tr_b16 a[66:67], v20 offset:36864
v_mfma_f32_16x16x32_bf16 v[212:215], a[84:87], a[24:27], v[212:215]
ds_read_b64_tr_b16 a[68:69], v20 offset:40960
ds_read_b64_tr_b16 a[70:71], v20 offset:45056
v_mfma_f32_16x16x32_bf16 v[216:219], a[84:87], a[28:31], v[216:219]
ds_read_b64_tr_b16 a[72:73], v21 offset:32768
ds_read_b64_tr_b16 a[74:75], v21 offset:36864
v_mfma_f32_16x16x32_bf16 v[216:219], a[80:83], a[20:23], v[216:219]
ds_read_b64_tr_b16 a[76:77], v21 offset:40960
ds_read_b64_tr_b16 a[78:79], v21 offset:45056
v_mfma_f32_16x16x32_bf16 v[228:231], a[88:91], a[16:19], v[228:231]
ds_read_b64_tr_b16 a[80:81], v22 offset:32768
ds_read_b64_tr_b16 a[82:83], v22 offset:36864
v_mfma_f32_16x16x32_bf16 v[228:231], a[92:95], a[24:27], v[228:231]
v_xor_b32 v35, 224, v28
v_mfma_f32_16x16x32_bf16 v[232:235], a[92:95], a[28:31], v[232:235]
ds_read_b64_tr_b16 a[84:85], v22 offset:40960
ds_read_b64_tr_b16 a[86:87], v22 offset:45056
v_mfma_f32_16x16x32_bf16 v[232:235], a[88:91], a[20:23], v[232:235]
s_waitcnt vmcnt(20) lgkmcnt(10)
ds_read_b128 v[220:223], v39 offset:7168
v_and_b32 v253, 63, v0
v_mfma_f32_16x16x32_bf16 v[116:119], a[64:67], a[32:35], v[116:119]
s_waitcnt vmcnt(18) lgkmcnt(9)
ds_read_b64_tr_b16 a[88:89], v23 offset:32768
ds_read_b64_tr_b16 a[90:91], v23 offset:36864
v_mfma_f32_16x16x32_bf16 v[116:119], a[68:71], a[40:43], v[116:119]
s_waitcnt vmcnt(5)
v_readfirstlane_b32 s101, v252
v_mfma_f32_16x16x32_bf16 v[120:123], a[68:71], a[44:47], v[120:123]
ds_read_b64_tr_b16 a[92:93], v23 offset:40960
ds_read_b64_tr_b16 a[94:95], v23 offset:45056
v_mfma_f32_16x16x32_bf16 v[120:123], a[64:67], a[36:39], v[120:123]
s_waitcnt lgkmcnt(11)
s_cmp_ge_u32 s101, 2
s_cselect_b32 s93, s87, 0x40000000
v_mfma_f32_16x16x32_bf16 v[132:135], a[72:75], a[32:35], v[132:135]
s_waitcnt lgkmcnt(9)
ds_read_b64_tr_b16 a[64:65], v24 offset:32768
ds_read_b64_tr_b16 a[66:67], v24 offset:36864
v_mfma_f32_16x16x32_bf16 v[132:135], a[76:79], a[40:43], v[132:135]
s_add_u32 s100, s93, 4096
s_add_u32 s67, s93, 8192
s_add_u32 s84, s93, 12288
v_mfma_f32_16x16x32_bf16 v[136:139], a[76:79], a[44:47], v[136:139]
ds_read_b64_tr_b16 a[68:69], v24 offset:40960
ds_read_b64_tr_b16 a[70:71], v24 offset:45056
v_mfma_f32_16x16x32_bf16 v[136:139], a[72:75], a[36:39], v[136:139]
s_waitcnt lgkmcnt(11)
buffer_load_dwordx4 a[128:131], v1, s[4:7], s93 offen offset:0 sc1
v_mfma_f32_16x16x32_bf16 v[148:151], a[80:83], a[32:35], v[148:151]
s_waitcnt lgkmcnt(9)
ds_read_b64_tr_b16 a[72:73], v25 offset:32768
ds_read_b64_tr_b16 a[74:75], v25 offset:36864
v_mfma_f32_16x16x32_bf16 v[148:151], a[84:87], a[40:43], v[148:151]
buffer_load_dwordx4 a[132:135], v1, s[4:7], s93 offen offset:1024 sc1
v_mfma_f32_16x16x32_bf16 v[152:155], a[84:87], a[44:47], v[152:155]
ds_read_b64_tr_b16 a[76:77], v25 offset:40960
ds_read_b64_tr_b16 a[78:79], v25 offset:45056
v_mfma_f32_16x16x32_bf16 v[152:155], a[80:83], a[36:39], v[152:155]
s_waitcnt lgkmcnt(10)
buffer_load_dwordx4 a[136:139], v1, s[4:7], s93 offen offset:2048 sc1
v_mfma_f32_16x16x32_bf16 v[164:167], a[88:91], a[32:35], v[164:167]
s_waitcnt lgkmcnt(8)
ds_read_b64_tr_b16 a[80:81], v26 offset:32768
ds_read_b64_tr_b16 a[82:83], v26 offset:36864
v_mfma_f32_16x16x32_bf16 v[164:167], a[92:95], a[40:43], v[164:167]
buffer_load_dwordx4 a[140:143], v1, s[4:7], s93 offen offset:3072 sc1
v_mfma_f32_16x16x32_bf16 v[168:171], a[92:95], a[44:47], v[168:171]
ds_read_b64_tr_b16 a[84:85], v26 offset:40960
ds_read_b64_tr_b16 a[86:87], v26 offset:45056
v_mfma_f32_16x16x32_bf16 v[168:171], a[88:91], a[36:39], v[168:171]
s_waitcnt lgkmcnt(10)
buffer_load_dwordx4 a[144:147], v1, s[4:7], s100 offen offset:0 sc1
v_mfma_f32_16x16x32_bf16 v[180:183], a[64:67], a[32:35], v[180:183]
s_waitcnt lgkmcnt(8)
ds_read_b64_tr_b16 a[88:89], v27 offset:32768
ds_read_b64_tr_b16 a[90:91], v27 offset:36864
v_mfma_f32_16x16x32_bf16 v[180:183], a[68:71], a[40:43], v[180:183]
buffer_load_dwordx4 a[148:151], v1, s[4:7], s100 offen offset:1024 sc1
v_mfma_f32_16x16x32_bf16 v[184:187], a[68:71], a[44:47], v[184:187]
ds_read_b64_tr_b16 a[92:93], v27 offset:40960
ds_read_b64_tr_b16 a[94:95], v27 offset:45056
v_mfma_f32_16x16x32_bf16 v[184:187], a[64:67], a[36:39], v[184:187]
s_waitcnt lgkmcnt(10)
buffer_load_dwordx4 a[152:155], v1, s[4:7], s100 offen offset:2048 sc1
v_mfma_f32_16x16x32_bf16 v[196:199], a[72:75], a[32:35], v[196:199]
s_waitcnt lgkmcnt(8)
buffer_load_dwordx4 a[156:159], v1, s[4:7], s100 offen offset:3072 sc1
v_mfma_f32_16x16x32_bf16 v[196:199], a[76:79], a[40:43], v[196:199]
buffer_load_dwordx4 a[160:163], v1, s[4:7], s67 offen offset:0 sc1
v_mfma_f32_16x16x32_bf16 v[200:203], a[76:79], a[44:47], v[200:203]
buffer_load_dwordx4 a[164:167], v1, s[4:7], s67 offen offset:1024 sc1
v_mfma_f32_16x16x32_bf16 v[200:203], a[72:75], a[36:39], v[200:203]
s_waitcnt lgkmcnt(0)
s_barrier
v_mfma_f32_16x16x32_bf16 v[212:215], a[80:83], a[32:35], v[212:215]
ds_read_b64_tr_b16 a[64:65], v20 offset:49152
ds_read_b64_tr_b16 a[66:67], v20 offset:53248
v_mfma_f32_16x16x32_bf16 v[212:215], a[84:87], a[40:43], v[212:215]
ds_read_b64_tr_b16 a[68:69], v20 offset:57344
ds_read_b64_tr_b16 a[70:71], v20 offset:61440
v_mfma_f32_16x16x32_bf16 v[216:219], a[84:87], a[44:47], v[216:219]
ds_read_b64_tr_b16 a[72:73], v21 offset:49152
ds_read_b64_tr_b16 a[74:75], v21 offset:53248
v_mfma_f32_16x16x32_bf16 v[216:219], a[80:83], a[36:39], v[216:219]
ds_read_b64_tr_b16 a[76:77], v21 offset:57344
ds_read_b64_tr_b16 a[78:79], v21 offset:61440
v_mfma_f32_16x16x32_bf16 v[228:231], a[88:91], a[32:35], v[228:231]
ds_read_b64_tr_b16 a[80:81], v22 offset:49152
ds_read_b64_tr_b16 a[82:83], v22 offset:53248
v_mfma_f32_16x16x32_bf16 v[228:231], a[92:95], a[40:43], v[228:231]
buffer_load_dwordx4 a[168:171], v1, s[4:7], s67 offen offset:2048 sc1
v_mfma_f32_16x16x32_bf16 v[232:235], a[92:95], a[44:47], v[232:235]
ds_read_b64_tr_b16 a[84:85], v22 offset:57344
ds_read_b64_tr_b16 a[86:87], v22 offset:61440
v_mfma_f32_16x16x32_bf16 v[232:235], a[88:91], a[36:39], v[232:235]
s_waitcnt lgkmcnt(10)
buffer_load_dwordx4 a[172:175], v1, s[4:7], s67 offen offset:3072 sc1
v_mfma_f32_16x16x32_bf16 v[116:119], a[64:67], a[48:51], v[116:119]
s_waitcnt lgkmcnt(8)
ds_read_b64_tr_b16 a[88:89], v23 offset:49152
ds_read_b64_tr_b16 a[90:91], v23 offset:53248
v_mfma_f32_16x16x32_bf16 v[116:119], a[68:71], a[56:59], v[116:119]
buffer_load_dwordx4 a[176:179], v1, s[4:7], s84 offen offset:0 sc1
v_mfma_f32_16x16x32_bf16 v[120:123], a[68:71], a[60:63], v[120:123]
ds_read_b64_tr_b16 a[92:93], v23 offset:57344
ds_read_b64_tr_b16 a[94:95], v23 offset:61440
v_mfma_f32_16x16x32_bf16 v[120:123], a[64:67], a[52:55], v[120:123]
s_waitcnt lgkmcnt(10)
buffer_load_dwordx4 a[180:183], v1, s[4:7], s84 offen offset:1024 sc1
v_mfma_f32_16x16x32_bf16 v[132:135], a[72:75], a[48:51], v[132:135]
s_waitcnt lgkmcnt(8)
ds_read_b64_tr_b16 a[64:65], v24 offset:49152
ds_read_b64_tr_b16 a[66:67], v24 offset:53248
v_mfma_f32_16x16x32_bf16 v[132:135], a[76:79], a[56:59], v[132:135]
buffer_load_dwordx4 a[184:187], v1, s[4:7], s84 offen offset:2048 sc1
v_mfma_f32_16x16x32_bf16 v[136:139], a[76:79], a[60:63], v[136:139]
ds_read_b64_tr_b16 a[68:69], v24 offset:57344
ds_read_b64_tr_b16 a[70:71], v24 offset:61440
v_mfma_f32_16x16x32_bf16 v[136:139], a[72:75], a[52:55], v[136:139]
s_waitcnt lgkmcnt(10)
buffer_load_dwordx4 a[188:191], v1, s[4:7], s84 offen offset:3072 sc1
v_mfma_f32_16x16x32_bf16 v[148:151], a[80:83], a[48:51], v[148:151]
s_waitcnt lgkmcnt(8)
ds_read_b64_tr_b16 a[72:73], v25 offset:49152
ds_read_b64_tr_b16 a[74:75], v25 offset:53248
v_mfma_f32_16x16x32_bf16 v[148:151], a[84:87], a[56:59], v[148:151]
ds_read_b128 v[224:227], v39 offset:15360
v_lshl_add_u32 v253, v253, 4, s66
v_mfma_f32_16x16x32_bf16 v[152:155], a[84:87], a[60:63], v[152:155]
ds_read_b64_tr_b16 a[76:77], v25 offset:57344
ds_read_b64_tr_b16 a[78:79], v25 offset:61440
v_mfma_f32_16x16x32_bf16 v[152:155], a[80:83], a[52:55], v[152:155]
s_waitcnt vmcnt(20) lgkmcnt(11)
ds_read_b64 v[46:47], v28 offset:0
v_mfma_f32_16x16x32_bf16 v[164:167], a[88:91], a[48:51], v[164:167]
s_waitcnt lgkmcnt(10)
ds_read_b64_tr_b16 a[80:81], v26 offset:49152
ds_read_b64_tr_b16 a[82:83], v26 offset:53248
v_mfma_f32_16x16x32_bf16 v[164:167], a[92:95], a[56:59], v[164:167]
ds_read_b64 v[54:55], v29 offset:0
v_mfma_f32_16x16x32_bf16 v[168:171], a[92:95], a[60:63], v[168:171]
ds_read_b64_tr_b16 a[84:85], v26 offset:57344
ds_read_b64_tr_b16 a[86:87], v26 offset:61440
v_mfma_f32_16x16x32_bf16 v[168:171], a[88:91], a[52:55], v[168:171]
s_waitcnt lgkmcnt(13)
ds_read_b64 v[62:63], v30 offset:0
v_mfma_f32_16x16x32_bf16 v[180:183], a[64:67], a[48:51], v[180:183]
s_waitcnt lgkmcnt(12)
ds_read_b64_tr_b16 a[88:89], v27 offset:49152
ds_read_b64_tr_b16 a[90:91], v27 offset:53248
v_mfma_f32_16x16x32_bf16 v[180:183], a[68:71], a[56:59], v[180:183]
ds_read_b64 v[70:71], v31 offset:0
v_mfma_f32_16x16x32_bf16 v[184:187], a[68:71], a[60:63], v[184:187]
s_waitcnt lgkmcnt(14)
ds_read_b64_tr_b16 a[92:93], v27 offset:57344
s_waitcnt lgkmcnt(14)
ds_read_b64_tr_b16 a[94:95], v27 offset:61440
v_mfma_f32_16x16x32_bf16 v[184:187], a[64:67], a[52:55], v[184:187]
s_waitcnt lgkmcnt(11)
ds_read_b64 v[78:79], v32 offset:0
v_lshlrev_b32 v44, 16, v46
v_mfma_f32_16x16x32_bf16 v[196:199], a[72:75], a[48:51], v[196:199]
ds_read_b64 v[86:87], v33 offset:0
v_and_b32 v45, 0xffff0000, v46
v_mfma_f32_16x16x32_bf16 v[196:199], a[76:79], a[56:59], v[196:199]
ds_read_b64 v[94:95], v34 offset:0
v_lshlrev_b32 v46, 16, v47
v_mfma_f32_16x16x32_bf16 v[200:203], a[76:79], a[60:63], v[200:203]
ds_read_b64 v[102:103], v35 offset:0
v_and_b32 v47, 0xffff0000, v47
v_mfma_f32_16x16x32_bf16 v[200:203], a[72:75], a[52:55], v[200:203]
s_waitcnt vmcnt(16) lgkmcnt(12)
ds_read_b64 v[50:51], v28 offset:4096
v_lshlrev_b32 v52, 16, v54
v_mfma_f32_16x16x32_bf16 v[212:215], a[80:83], a[48:51], v[212:215]
s_waitcnt lgkmcnt(11)
ds_read_b64 v[58:59], v29 offset:4096
v_and_b32 v53, 0xffff0000, v54
v_mfma_f32_16x16x32_bf16 v[212:215], a[84:87], a[56:59], v[212:215]
ds_read_b64 v[66:67], v30 offset:4096
v_lshlrev_b32 v54, 16, v55
v_mfma_f32_16x16x32_bf16 v[216:219], a[84:87], a[60:63], v[216:219]
ds_read_b64 v[74:75], v31 offset:4096
v_and_b32 v55, 0xffff0000, v55
v_mfma_f32_16x16x32_bf16 v[216:219], a[80:83], a[52:55], v[216:219]
s_waitcnt lgkmcnt(11)
ds_read_b64 v[82:83], v32 offset:4096
v_lshlrev_b32 v60, 16, v62
v_mfma_f32_16x16x32_bf16 v[228:231], a[88:91], a[48:51], v[228:231]
s_waitcnt lgkmcnt(9)
ds_read_b64 v[90:91], v33 offset:4096
v_and_b32 v61, 0xffff0000, v62
v_mfma_f32_16x16x32_bf16 v[228:231], a[92:95], a[56:59], v[228:231]
ds_read_b64 v[98:99], v34 offset:4096
v_lshlrev_b32 v62, 16, v63
v_mfma_f32_16x16x32_bf16 v[232:235], a[92:95], a[60:63], v[232:235]
ds_read_b64 v[106:107], v35 offset:4096
v_and_b32 v63, 0xffff0000, v63
v_mfma_f32_16x16x32_bf16 v[232:235], a[88:91], a[52:55], v[232:235]
v_lshlrev_b32 v68, 16, v70
v_and_b32 v69, 0xffff0000, v70
v_lshlrev_b32 v70, 16, v71
v_and_b32 v71, 0xffff0000, v71
s_waitcnt lgkmcnt(11)
v_lshlrev_b32 v76, 16, v78
v_and_b32 v77, 0xffff0000, v78
v_lshlrev_b32 v78, 16, v79
v_and_b32 v79, 0xffff0000, v79
s_waitcnt lgkmcnt(10)
v_lshlrev_b32 v84, 16, v86
v_and_b32 v85, 0xffff0000, v86
v_lshlrev_b32 v86, 16, v87
v_and_b32 v87, 0xffff0000, v87
s_waitcnt lgkmcnt(9)
v_lshlrev_b32 v92, 16, v94
v_and_b32 v93, 0xffff0000, v94
v_lshlrev_b32 v94, 16, v95
v_and_b32 v95, 0xffff0000, v95
s_waitcnt lgkmcnt(8)
v_lshlrev_b32 v100, 16, v102
v_and_b32 v101, 0xffff0000, v102
v_lshlrev_b32 v102, 16, v103
v_and_b32 v103, 0xffff0000, v103
s_cmp_lt_u32 s101, 2
s_cbranch_scc1 L2_wg
L2_wg_r:
s_waitcnt vmcnt(15)
v_mfma_f32_16x16x32_bf16 v[116:119], v[12:15], a[128:131], v[116:119]
s_waitcnt lgkmcnt(7)
v_lshlrev_b32 v48, 16, v50
v_and_b32 v49, 0xffff0000, v50
v_mfma_f32_16x16x32_bf16 v[132:135], v[10:13], a[128:131], v[132:135]
s_waitcnt vmcnt(14)
v_lshlrev_b32 v50, 16, v51
v_and_b32 v51, 0xffff0000, v51
v_mfma_f32_16x16x32_bf16 v[148:151], v[12:15], a[132:135], v[148:151]
s_waitcnt lgkmcnt(6)
v_lshlrev_b32 v56, 16, v58
v_and_b32 v57, 0xffff0000, v58
v_mfma_f32_16x16x32_bf16 v[164:167], v[10:13], a[132:135], v[164:167]
s_waitcnt vmcnt(13)
v_lshlrev_b32 v58, 16, v59
v_and_b32 v59, 0xffff0000, v59
v_mfma_f32_16x16x32_bf16 v[180:183], v[12:15], a[136:139], v[180:183]
s_waitcnt lgkmcnt(5)
v_lshlrev_b32 v64, 16, v66
v_and_b32 v65, 0xffff0000, v66
v_mfma_f32_16x16x32_bf16 v[196:199], v[10:13], a[136:139], v[196:199]
s_waitcnt vmcnt(12)
v_lshlrev_b32 v66, 16, v67
v_and_b32 v67, 0xffff0000, v67
v_mfma_f32_16x16x32_bf16 v[212:215], v[12:15], a[140:143], v[212:215]
s_waitcnt lgkmcnt(4)
v_lshlrev_b32 v72, 16, v74
v_and_b32 v73, 0xffff0000, v74
v_mfma_f32_16x16x32_bf16 v[228:231], v[10:13], a[140:143], v[228:231]
s_waitcnt vmcnt(11)
v_lshlrev_b32 v74, 16, v75
v_and_b32 v75, 0xffff0000, v75
v_mfma_f32_16x16x32_bf16 v[120:123], v[12:15], a[144:147], v[120:123]
s_waitcnt lgkmcnt(3)
v_lshlrev_b32 v80, 16, v82
v_and_b32 v81, 0xffff0000, v82
v_mfma_f32_16x16x32_bf16 v[136:139], v[10:13], a[144:147], v[136:139]
s_waitcnt vmcnt(10)
v_lshlrev_b32 v82, 16, v83
v_and_b32 v83, 0xffff0000, v83
v_mfma_f32_16x16x32_bf16 v[152:155], v[12:15], a[148:151], v[152:155]
s_waitcnt lgkmcnt(2)
v_lshlrev_b32 v88, 16, v90
v_and_b32 v89, 0xffff0000, v90
v_mfma_f32_16x16x32_bf16 v[168:171], v[10:13], a[148:151], v[168:171]
s_waitcnt vmcnt(9)
v_lshlrev_b32 v90, 16, v91
v_and_b32 v91, 0xffff0000, v91
v_mfma_f32_16x16x32_bf16 v[184:187], v[12:15], a[152:155], v[184:187]
s_waitcnt lgkmcnt(1)
v_lshlrev_b32 v96, 16, v98
v_and_b32 v97, 0xffff0000, v98
v_mfma_f32_16x16x32_bf16 v[200:203], v[10:13], a[152:155], v[200:203]
s_waitcnt vmcnt(8)
v_lshlrev_b32 v98, 16, v99
v_and_b32 v99, 0xffff0000, v99
v_mfma_f32_16x16x32_bf16 v[216:219], v[12:15], a[156:159], v[216:219]
s_waitcnt lgkmcnt(0)
v_lshlrev_b32 v104, 16, v106
v_and_b32 v105, 0xffff0000, v106
v_mfma_f32_16x16x32_bf16 v[232:235], v[10:13], a[156:159], v[232:235]
s_waitcnt vmcnt(7)
v_lshlrev_b32 v106, 16, v107
v_and_b32 v107, 0xffff0000, v107
v_mfma_f32_16x16x32_bf16 v[116:119], v[12:15], a[160:163], v[116:119]
v_mfma_f32_16x16x32_bf16 v[132:135], v[10:13], a[160:163], v[132:135]
s_waitcnt vmcnt(6)
v_mfma_f32_16x16x32_bf16 v[148:151], v[12:15], a[164:167], v[148:151]
v_mfma_f32_16x16x32_bf16 v[164:167], v[10:13], a[164:167], v[164:167]
s_waitcnt vmcnt(5)
v_mfma_f32_16x16x32_bf16 v[180:183], v[12:15], a[168:171], v[180:183]
v_mfma_f32_16x16x32_bf16 v[196:199], v[10:13], a[168:171], v[196:199]
s_waitcnt vmcnt(4)
v_mfma_f32_16x16x32_bf16 v[212:215], v[12:15], a[172:175], v[212:215]
v_mfma_f32_16x16x32_bf16 v[228:231], v[10:13], a[172:175], v[228:231]
s_waitcnt vmcnt(3)
v_mfma_f32_16x16x32_bf16 v[120:123], v[12:15], a[176:179], v[120:123]
v_mfma_f32_16x16x32_bf16 v[136:139], v[10:13], a[176:179], v[136:139]
s_waitcnt vmcnt(2)
v_mfma_f32_16x16x32_bf16 v[152:155], v[12:15], a[180:183], v[152:155]
v_mfma_f32_16x16x32_bf16 v[168:171], v[10:13], a[180:183], v[168:171]
s_waitcnt vmcnt(1)
v_mfma_f32_16x16x32_bf16 v[184:187], v[12:15], a[184:187], v[184:187]
v_mfma_f32_16x16x32_bf16 v[200:203], v[10:13], a[184:187], v[200:203]
s_waitcnt vmcnt(0)
v_mfma_f32_16x16x32_bf16 v[216:219], v[12:15], a[188:191], v[216:219]
v_mfma_f32_16x16x32_bf16 v[232:235], v[10:13], a[188:191], v[232:235]
v_pk_fma_f32 v[44:45], v[116:117], v[108:109], v[44:45]
v_pk_fma_f32 v[46:47], v[118:119], v[110:111], v[46:47]
v_cvt_pk_bf16_f32 v44, v44, v45
v_cvt_pk_bf16_f32 v45, v46, v47
ds_write_b64 v28, v[44:45] offset:0
v_pk_fma_f32 v[52:53], v[132:133], v[124:125], v[52:53]
v_pk_fma_f32 v[54:55], v[134:135], v[126:127], v[54:55]
v_cvt_pk_bf16_f32 v52, v52, v53
v_cvt_pk_bf16_f32 v53, v54, v55
ds_write_b64 v29, v[52:53] offset:0
v_pk_fma_f32 v[60:61], v[148:149], v[140:141], v[60:61]
v_pk_fma_f32 v[62:63], v[150:151], v[142:143], v[62:63]
v_cvt_pk_bf16_f32 v60, v60, v61
v_cvt_pk_bf16_f32 v61, v62, v63
ds_write_b64 v30, v[60:61] offset:0
v_pk_fma_f32 v[68:69], v[164:165], v[156:157], v[68:69]
v_pk_fma_f32 v[70:71], v[166:167], v[158:159], v[70:71]
v_cvt_pk_bf16_f32 v68, v68, v69
v_cvt_pk_bf16_f32 v69, v70, v71
ds_write_b64 v31, v[68:69] offset:0
v_pk_fma_f32 v[76:77], v[180:181], v[172:173], v[76:77]
v_pk_fma_f32 v[78:79], v[182:183], v[174:175], v[78:79]
v_cvt_pk_bf16_f32 v76, v76, v77
v_cvt_pk_bf16_f32 v77, v78, v79
ds_write_b64 v32, v[76:77] offset:0
v_pk_fma_f32 v[84:85], v[196:197], v[188:189], v[84:85]
v_pk_fma_f32 v[86:87], v[198:199], v[190:191], v[86:87]
v_cvt_pk_bf16_f32 v84, v84, v85
v_cvt_pk_bf16_f32 v85, v86, v87
ds_write_b64 v33, v[84:85] offset:0
v_pk_fma_f32 v[92:93], v[212:213], v[204:205], v[92:93]
v_pk_fma_f32 v[94:95], v[214:215], v[206:207], v[94:95]
v_cvt_pk_bf16_f32 v92, v92, v93
v_cvt_pk_bf16_f32 v93, v94, v95
ds_write_b64 v34, v[92:93] offset:0
v_pk_fma_f32 v[100:101], v[228:229], v[220:221], v[100:101]
v_pk_fma_f32 v[102:103], v[230:231], v[222:223], v[102:103]
v_cvt_pk_bf16_f32 v100, v100, v101
v_cvt_pk_bf16_f32 v101, v102, v103
ds_write_b64 v35, v[100:101] offset:0
ds_read_b128 v[108:111], v253 offset:0
ds_read_b128 v[124:127], v253 offset:1024
ds_read_b128 v[140:143], v253 offset:2048
ds_read_b128 v[156:159], v253 offset:3072
v_pk_fma_f32 v[48:49], v[120:121], v[112:113], v[48:49]
v_pk_fma_f32 v[50:51], v[122:123], v[114:115], v[50:51]
v_cvt_pk_bf16_f32 v48, v48, v49
v_cvt_pk_bf16_f32 v49, v50, v51
ds_write_b64 v28, v[48:49] offset:4096
v_pk_fma_f32 v[56:57], v[136:137], v[128:129], v[56:57]
v_pk_fma_f32 v[58:59], v[138:139], v[130:131], v[58:59]
v_cvt_pk_bf16_f32 v56, v56, v57
v_cvt_pk_bf16_f32 v57, v58, v59
ds_write_b64 v29, v[56:57] offset:4096
v_pk_fma_f32 v[64:65], v[152:153], v[144:145], v[64:65]
v_pk_fma_f32 v[66:67], v[154:155], v[146:147], v[66:67]
v_cvt_pk_bf16_f32 v64, v64, v65
v_cvt_pk_bf16_f32 v65, v66, v67
ds_write_b64 v30, v[64:65] offset:4096
v_pk_fma_f32 v[72:73], v[168:169], v[160:161], v[72:73]
v_pk_fma_f32 v[74:75], v[170:171], v[162:163], v[74:75]
v_cvt_pk_bf16_f32 v72, v72, v73
v_cvt_pk_bf16_f32 v73, v74, v75
s_waitcnt lgkmcnt(14)
ds_write_b64 v31, v[72:73] offset:4096
v_pk_fma_f32 v[80:81], v[184:185], v[176:177], v[80:81]
v_pk_fma_f32 v[82:83], v[186:187], v[178:179], v[82:83]
v_cvt_pk_bf16_f32 v80, v80, v81
v_cvt_pk_bf16_f32 v81, v82, v83
s_waitcnt lgkmcnt(14)
ds_write_b64 v32, v[80:81] offset:4096
s_waitcnt lgkmcnt(8)
buffer_store_dwordx4 v[108:111], v2, s[20:23], s88 offen offset:0
v_pk_fma_f32 v[88:89], v[200:201], v[192:193], v[88:89]
v_pk_fma_f32 v[90:91], v[202:203], v[194:195], v[90:91]
v_cvt_pk_bf16_f32 v88, v88, v89
v_cvt_pk_bf16_f32 v89, v90, v91
ds_write_b64 v33, v[88:89] offset:4096
s_waitcnt lgkmcnt(8)
buffer_store_dwordx4 v[124:127], v3, s[20:23], s88 offen offset:1024
v_pk_fma_f32 v[96:97], v[216:217], v[208:209], v[96:97]
v_pk_fma_f32 v[98:99], v[218:219], v[210:211], v[98:99]
v_cvt_pk_bf16_f32 v96, v96, v97
v_cvt_pk_bf16_f32 v97, v98, v99
ds_write_b64 v34, v[96:97] offset:4096
s_waitcnt lgkmcnt(8)
buffer_store_dwordx4 v[140:143], v4, s[20:23], s88 offen offset:2048
v_pk_fma_f32 v[104:105], v[232:233], v[224:225], v[104:105]
v_pk_fma_f32 v[106:107], v[234:235], v[226:227], v[106:107]
v_cvt_pk_bf16_f32 v104, v104, v105
v_cvt_pk_bf16_f32 v105, v106, v107
ds_write_b64 v35, v[104:105] offset:4096
s_waitcnt lgkmcnt(8)
buffer_store_dwordx4 v[156:159], v5, s[20:23], s88 offen offset:3072
ds_read_b128 v[172:175], v253 offset:4096
ds_read_b128 v[188:191], v253 offset:5120
ds_read_b128 v[204:207], v253 offset:6144
ds_read_b128 v[220:223], v253 offset:7168
s_waitcnt lgkmcnt(3)
buffer_store_dwordx4 v[172:175], v2, s[20:23], s89 offen offset:0
s_waitcnt lgkmcnt(2)
buffer_store_dwordx4 v[188:191], v3, s[20:23], s89 offen offset:1024
s_waitcnt lgkmcnt(1)
buffer_store_dwordx4 v[204:207], v4, s[20:23], s89 offen offset:2048
s_waitcnt lgkmcnt(0)
buffer_store_dwordx4 v[220:223], v5, s[20:23], s89 offen offset:3072
L2_end:
s_endpgm
L2_Y:
s_cmp_eq_u32 s36, 0
s_cselect_b32 s82, -2, 0
s_and_b32 s66, s64, 1
s_lshl_b32 s67, s66, 11
s_add_u32 s85, s85, s67
s_add_u32 s85, s85, 2048
s_andn2_b32 s87, s87, 32
s_lshl_b32 s86, s87, 7
s_add_u32 s86, s86, 41959424
s_lshl_b32 s87, s87, 14
s_lshl_b32 s66, s66, 13
s_add_u32 s87, s87, s66
s_add_u32 s87, s87, 33554432
s_add_u32 s93, s87, 4096
s_add_u32 s88, s87, 524288
s_add_u32 s89, s88, 4096
s_waitcnt vmcnt(42) lgkmcnt(6)
v_mfma_f32_16x16x32_bf16 v[108:111], v[44:47], a[192:195], v[108:111]
s_waitcnt vmcnt(39) lgkmcnt(4)
ds_read_b64_tr_b16 v[60:61], v30 offset:0
v_mfma_f32_16x16x32_bf16 v[108:111], v[48:51], a[208:211], v[108:111]
s_waitcnt vmcnt(38)
buffer_load_dwordx4 a[152:155], v253, s[4:7], s44 offen offset:2048 sc1
v_mfma_f32_16x16x32_bf16 v[112:115], v[48:51], a[212:215], v[112:115]
ds_read_b64_tr_b16 v[62:63], v30 offset:4096
v_mfma_f32_16x16x32_bf16 v[112:115], v[44:47], a[196:199], v[112:115]
s_waitcnt vmcnt(38)
v_mfma_f32_16x16x32_bf16 v[116:119], v[44:47], a[200:203], v[116:119]
s_waitcnt vmcnt(36)
ds_read_b64_tr_b16 v[64:65], v30 offset:8192
v_mfma_f32_16x16x32_bf16 v[116:119], v[48:51], a[216:219], v[116:119]
s_waitcnt vmcnt(35)
buffer_load_dwordx4 a[156:159], v253, s[4:7], s44 offen offset:3072 sc1
v_mfma_f32_16x16x32_bf16 v[120:123], v[48:51], a[220:223], v[120:123]
s_add_u32 s44, s44, s74
ds_read_b64_tr_b16 v[66:67], v30 offset:12288
v_mfma_f32_16x16x32_bf16 v[120:123], v[44:47], a[204:207], v[120:123]
s_waitcnt lgkmcnt(6)
v_mfma_f32_16x16x32_bf16 v[124:127], v[52:55], a[192:195], v[124:127]
s_waitcnt lgkmcnt(4)
ds_read_b64_tr_b16 v[68:69], v31 offset:0
v_mfma_f32_16x16x32_bf16 v[124:127], v[56:59], a[208:211], v[124:127]
v_mfma_f32_16x16x32_bf16 v[128:131], v[56:59], a[212:215], v[128:131]
ds_read_b64_tr_b16 v[70:71], v31 offset:4096
v_mfma_f32_16x16x32_bf16 v[128:131], v[52:55], a[196:199], v[128:131]
v_mfma_f32_16x16x32_bf16 v[132:135], v[52:55], a[200:203], v[132:135]
ds_read_b64_tr_b16 v[72:73], v31 offset:8192
v_mfma_f32_16x16x32_bf16 v[132:135], v[56:59], a[216:219], v[132:135]
v_mfma_f32_16x16x32_bf16 v[136:139], v[56:59], a[220:223], v[136:139]
ds_read_b64_tr_b16 v[74:75], v31 offset:12288
v_mfma_f32_16x16x32_bf16 v[136:139], v[52:55], a[204:207], v[136:139]
s_waitcnt lgkmcnt(6)
v_mfma_f32_16x16x32_bf16 v[140:143], v[60:63], a[192:195], v[140:143]
s_waitcnt lgkmcnt(4)
ds_read_b64_tr_b16 v[44:45], v32 offset:0
v_mfma_f32_16x16x32_bf16 v[140:143], v[64:67], a[208:211], v[140:143]
v_mfma_f32_16x16x32_bf16 v[144:147], v[64:67], a[212:215], v[144:147]
ds_read_b64_tr_b16 v[46:47], v32 offset:4096
v_mfma_f32_16x16x32_bf16 v[144:147], v[60:63], a[196:199], v[144:147]
v_mfma_f32_16x16x32_bf16 v[148:151], v[60:63], a[200:203], v[148:151]
ds_read_b64_tr_b16 v[48:49], v32 offset:8192
v_mfma_f32_16x16x32_bf16 v[148:151], v[64:67], a[216:219], v[148:151]
v_mfma_f32_16x16x32_bf16 v[152:155], v[64:67], a[220:223], v[152:155]
ds_read_b64_tr_b16 v[50:51], v32 offset:12288
v_mfma_f32_16x16x32_bf16 v[152:155], v[60:63], a[204:207], v[152:155]
s_waitcnt lgkmcnt(6)
s_barrier
v_mfma_f32_16x16x32_bf16 v[156:159], v[68:71], a[192:195], v[156:159]
s_waitcnt lgkmcnt(4)
s_add_u32 m0, s37, 49152
ds_read_b64_tr_b16 v[52:53], v32 offset:16384
v_mfma_f32_16x16x32_bf16 v[156:159], v[72:75], a[208:211], v[156:159]
buffer_load_dwordx4 v2, s[24:27], s43 offen offset:0 lds
v_mfma_f32_16x16x32_bf16 v[160:163], v[72:75], a[212:215], v[160:163]
ds_read_b64_tr_b16 v[54:55], v32 offset:20480
v_mfma_f32_16x16x32_bf16 v[160:163], v[68:71], a[196:199], v[160:163]
ds_read_b64_tr_b16 v[56:57], v32 offset:24576
v_mfma_f32_16x16x32_bf16 v[164:167], v[68:71], a[200:203], v[164:167]
ds_read_b64_tr_b16 v[58:59], v32 offset:28672
v_mfma_f32_16x16x32_bf16 v[164:167], v[72:75], a[216:219], v[164:167]
buffer_load_dwordx4 v3, s[24:27], s43 offen offset:1024 lds
v_mfma_f32_16x16x32_bf16 v[168:171], v[72:75], a[220:223], v[168:171]
v_mfma_f32_16x16x32_bf16 v[168:171], v[68:71], a[204:207], v[168:171]
s_waitcnt lgkmcnt(6)
s_mov_b32 s38, -2
.p2align 3
L2_sy:
v_mfma_f32_16x16x32_bf16 v[172:175], v[44:47], a[192:195], v[172:175]
s_waitcnt lgkmcnt(4)
ds_read_b64_tr_b16 v[60:61], v33 offset:0
v_mfma_f32_16x16x32_bf16 v[172:175], v[48:51], a[208:211], v[172:175]
s_waitcnt vmcnt(22) lgkmcnt(3)
buffer_load_dwordx4 v4, s[24:27], s43 offen offset:2048 lds
v_mfma_f32_16x16x32_bf16 v[172:175], v[52:55], a[224:227], v[172:175]
s_waitcnt vmcnt(21) lgkmcnt(1)
ds_read_b64_tr_b16 v[62:63], v33 offset:4096
v_mfma_f32_16x16x32_bf16 v[172:175], v[56:59], a[240:243], v[172:175]
s_waitcnt vmcnt(20)
v_mfma_f32_16x16x32_bf16 v[176:179], v[56:59], a[244:247], v[176:179]
ds_read_b64_tr_b16 v[64:65], v33 offset:8192
v_mfma_f32_16x16x32_bf16 v[176:179], v[52:55], a[228:231], v[176:179]
buffer_load_dwordx4 v5, s[24:27], s43 offen offset:3072 lds
v_mfma_f32_16x16x32_bf16 v[176:179], v[48:51], a[212:215], v[176:179]
s_add_u32 s43, s43, s73
ds_read_b64_tr_b16 v[66:67], v33 offset:12288
v_mfma_f32_16x16x32_bf16 v[176:179], v[44:47], a[196:199], v[176:179]
v_mfma_f32_16x16x32_bf16 v[180:183], v[44:47], a[200:203], v[180:183]
ds_read_b64_tr_b16 v[68:69], v33 offset:16384
v_mfma_f32_16x16x32_bf16 v[180:183], v[48:51], a[216:219], v[180:183]
s_waitcnt vmcnt(20)
buffer_load_dwordx4 a[160:163], v36, s[4:7], s44 offen offset:0 sc1
v_mfma_f32_16x16x32_bf16 v[180:183], v[52:55], a[232:235], v[180:183]
s_waitcnt vmcnt(19)
ds_read_b64_tr_b16 v[70:71], v33 offset:20480
v_mfma_f32_16x16x32_bf16 v[180:183], v[56:59], a[248:251], v[180:183]
s_waitcnt vmcnt(18)
ds_read_b64_tr_b16 v[72:73], v33 offset:24576
v_mfma_f32_16x16x32_bf16 v[184:187], v[56:59], a[252:255], v[184:187]
ds_read_b64_tr_b16 v[74:75], v33 offset:28672
v_mfma_f32_16x16x32_bf16 v[184:187], v[52:55], a[236:239], v[184:187]
buffer_load_dwordx4 a[164:167], v36, s[4:7], s44 offen offset:1024 sc1
v_mfma_f32_16x16x32_bf16 v[184:187], v[48:51], a[220:223], v[184:187]
v_mfma_f32_16x16x32_bf16 v[184:187], v[44:47], a[204:207], v[184:187]
s_waitcnt lgkmcnt(6)
v_mfma_f32_16x16x32_bf16 v[188:191], v[60:63], a[192:195], v[188:191]
s_waitcnt lgkmcnt(4)
ds_read_b64_tr_b16 v[44:45], v34 offset:0
v_mfma_f32_16x16x32_bf16 v[188:191], v[64:67], a[208:211], v[188:191]
s_waitcnt lgkmcnt(3)
buffer_load_dwordx4 a[176:179], v36, s[4:7], s44 offen offset:2048 sc1
v_mfma_f32_16x16x32_bf16 v[188:191], v[68:71], a[224:227], v[188:191]
s_waitcnt lgkmcnt(1)
ds_read_b64_tr_b16 v[46:47], v34 offset:4096
v_mfma_f32_16x16x32_bf16 v[188:191], v[72:75], a[240:243], v[188:191]
v_mfma_f32_16x16x32_bf16 v[192:195], v[72:75], a[244:247], v[192:195]
ds_read_b64_tr_b16 v[48:49], v34 offset:8192
v_mfma_f32_16x16x32_bf16 v[192:195], v[68:71], a[228:231], v[192:195]
buffer_load_dwordx4 a[180:183], v36, s[4:7], s44 offen offset:3072 sc1
v_mfma_f32_16x16x32_bf16 v[192:195], v[64:67], a[212:215], v[192:195]
ds_read_b64_tr_b16 v[50:51], v34 offset:12288
v_mfma_f32_16x16x32_bf16 v[192:195], v[60:63], a[196:199], v[192:195]
v_mfma_f32_16x16x32_bf16 v[196:199], v[60:63], a[200:203], v[196:199]
ds_read_b64_tr_b16 v[52:53], v34 offset:16384
v_mfma_f32_16x16x32_bf16 v[196:199], v[64:67], a[216:219], v[196:199]
buffer_load_dwordx4 a[168:171], v253, s[4:7], s44 offen offset:0 sc1
v_mfma_f32_16x16x32_bf16 v[196:199], v[68:71], a[232:235], v[196:199]
ds_read_b64_tr_b16 v[54:55], v34 offset:20480
v_mfma_f32_16x16x32_bf16 v[196:199], v[72:75], a[248:251], v[196:199]
ds_read_b64_tr_b16 v[56:57], v34 offset:24576
v_mfma_f32_16x16x32_bf16 v[200:203], v[72:75], a[252:255], v[200:203]
ds_read_b64_tr_b16 v[58:59], v34 offset:28672
v_mfma_f32_16x16x32_bf16 v[200:203], v[68:71], a[236:239], v[200:203]
buffer_load_dwordx4 a[172:175], v253, s[4:7], s44 offen offset:1024 sc1
v_mfma_f32_16x16x32_bf16 v[200:203], v[64:67], a[220:223], v[200:203]
v_mfma_f32_16x16x32_bf16 v[200:203], v[60:63], a[204:207], v[200:203]
s_waitcnt lgkmcnt(6)
v_mfma_f32_16x16x32_bf16 v[204:207], v[44:47], a[192:195], v[204:207]
s_waitcnt lgkmcnt(4)
ds_read_b64_tr_b16 v[60:61], v35 offset:0
v_mfma_f32_16x16x32_bf16 v[204:207], v[48:51], a[208:211], v[204:207]
s_waitcnt lgkmcnt(3)
buffer_load_dwordx4 a[184:187], v253, s[4:7], s44 offen offset:2048 sc1
v_mfma_f32_16x16x32_bf16 v[204:207], v[52:55], a[224:227], v[204:207]
s_waitcnt lgkmcnt(1)
ds_read_b64_tr_b16 v[62:63], v35 offset:4096
v_mfma_f32_16x16x32_bf16 v[204:207], v[56:59], a[240:243], v[204:207]
v_mfma_f32_16x16x32_bf16 v[208:211], v[56:59], a[244:247], v[208:211]
ds_read_b64_tr_b16 v[64:65], v35 offset:8192
v_mfma_f32_16x16x32_bf16 v[208:211], v[52:55], a[228:231], v[208:211]
buffer_load_dwordx4 a[188:191], v253, s[4:7], s44 offen offset:3072 sc1
v_mfma_f32_16x16x32_bf16 v[208:211], v[48:51], a[212:215], v[208:211]
s_add_u32 s44, s44, s75
ds_read_b64_tr_b16 v[66:67], v35 offset:12288
v_mfma_f32_16x16x32_bf16 v[208:211], v[44:47], a[196:199], v[208:211]
v_mfma_f32_16x16x32_bf16 v[212:215], v[44:47], a[200:203], v[212:215]
ds_read_b64_tr_b16 v[68:69], v35 offset:16384
v_mfma_f32_16x16x32_bf16 v[212:215], v[48:51], a[216:219], v[212:215]
v_mfma_f32_16x16x32_bf16 v[212:215], v[52:55], a[232:235], v[212:215]
ds_read_b64_tr_b16 v[70:71], v35 offset:20480
v_mfma_f32_16x16x32_bf16 v[212:215], v[56:59], a[248:251], v[212:215]
ds_read_b64_tr_b16 v[72:73], v35 offset:24576
v_mfma_f32_16x16x32_bf16 v[216:219], v[56:59], a[252:255], v[216:219]
ds_read_b64_tr_b16 v[74:75], v35 offset:28672
v_mfma_f32_16x16x32_bf16 v[216:219], v[52:55], a[236:239], v[216:219]
v_mfma_f32_16x16x32_bf16 v[216:219], v[48:51], a[220:223], v[216:219]
v_mfma_f32_16x16x32_bf16 v[216:219], v[44:47], a[204:207], v[216:219]
s_waitcnt lgkmcnt(6)
v_mfma_f32_16x16x32_bf16 v[220:223], v[60:63], a[192:195], v[220:223]
s_waitcnt lgkmcnt(4)
ds_read_b64_tr_b16 v[44:45], v28 offset:16384
v_mfma_f32_16x16x32_bf16 v[220:223], v[64:67], a[208:211], v[220:223]
s_waitcnt lgkmcnt(3)
v_mfma_f32_16x16x32_bf16 v[220:223], v[68:71], a[224:227], v[220:223]
s_waitcnt lgkmcnt(1)
ds_read_b64_tr_b16 v[46:47], v28 offset:20480
v_mfma_f32_16x16x32_bf16 v[220:223], v[72:75], a[240:243], v[220:223]
v_mfma_f32_16x16x32_bf16 v[224:227], v[72:75], a[244:247], v[224:227]
ds_read_b64_tr_b16 v[48:49], v28 offset:24576
v_mfma_f32_16x16x32_bf16 v[224:227], v[68:71], a[228:231], v[224:227]
v_mfma_f32_16x16x32_bf16 v[224:227], v[64:67], a[212:215], v[224:227]
ds_read_b64_tr_b16 v[50:51], v28 offset:28672
v_mfma_f32_16x16x32_bf16 v[224:227], v[60:63], a[196:199], v[224:227]
s_waitcnt vmcnt(14)
s_barrier
v_mfma_f32_16x16x32_bf16 v[228:231], v[60:63], a[200:203], v[228:231]
s_add_u32 m0, s37, 0
ds_read_b64_tr_b16 v[52:53], v28 offset:32768
v_mfma_f32_16x16x32_bf16 v[228:231], v[64:67], a[216:219], v[228:231]
buffer_load_dwordx4 v2, s[24:27], s43 offen offset:0 lds
v_mfma_f32_16x16x32_bf16 v[228:231], v[68:71], a[232:235], v[228:231]
ds_read_b64_tr_b16 v[54:55], v28 offset:36864
v_mfma_f32_16x16x32_bf16 v[228:231], v[72:75], a[248:251], v[228:231]
ds_read_b64_tr_b16 v[56:57], v28 offset:40960
v_mfma_f32_16x16x32_bf16 v[232:235], v[72:75], a[252:255], v[232:235]
ds_read_b64_tr_b16 v[58:59], v28 offset:45056
v_mfma_f32_16x16x32_bf16 v[232:235], v[68:71], a[236:239], v[232:235]
buffer_load_dwordx4 v3, s[24:27], s43 offen offset:1024 lds
v_mfma_f32_16x16x32_bf16 v[232:235], v[64:67], a[220:223], v[232:235]
s_cmp_eq_u32 s38, s82
s_cbranch_scc1 L2_yo
L2_yo_r:
v_mfma_f32_16x16x32_bf16 v[232:235], v[60:63], a[204:207], v[232:235]
s_waitcnt lgkmcnt(6)
v_mfma_f32_16x16x32_bf16 v[108:111], v[44:47], a[224:227], v[108:111]
s_waitcnt lgkmcnt(4)
ds_read_b64_tr_b16 v[60:61], v29 offset:16384
v_mfma_f32_16x16x32_bf16 v[108:111], v[48:51], a[240:243], v[108:111]
s_waitcnt vmcnt(22) lgkmcnt(3)
buffer_load_dwordx4 v4, s[24:27], s43 offen offset:2048 lds
v_mfma_f32_16x16x32_bf16 v[108:111], v[52:55], a[128:131], v[108:111]
s_waitcnt vmcnt(21) lgkmcnt(1)
ds_read_b64_tr_b16 v[62:63], v29 offset:20480
v_mfma_f32_16x16x32_bf16 v[108:111], v[56:59], a[144:147], v[108:111]
s_waitcnt vmcnt(19)
v_mfma_f32_16x16x32_bf16 v[112:115], v[56:59], a[148:151], v[112:115]
ds_read_b64_tr_b16 v[64:65], v29 offset:24576
v_mfma_f32_16x16x32_bf16 v[112:115], v[52:55], a[132:135], v[112:115]
buffer_load_dwordx4 v5, s[24:27], s43 offen offset:3072 lds
v_mfma_f32_16x16x32_bf16 v[112:115], v[48:51], a[244:247], v[112:115]
s_add_u32 s43, s43, s72
ds_read_b64_tr_b16 v[66:67], v29 offset:28672
v_mfma_f32_16x16x32_bf16 v[112:115], v[44:47], a[228:231], v[112:115]
v_mfma_f32_16x16x32_bf16 v[116:119], v[44:47], a[232:235], v[116:119]
ds_read_b64_tr_b16 v[68:69], v29 offset:32768
v_mfma_f32_16x16x32_bf16 v[116:119], v[48:51], a[248:251], v[116:119]
s_waitcnt vmcnt(19)
buffer_load_dwordx4 a[192:195], v36, s[4:7], s44 offen offset:0 sc1
v_mfma_f32_16x16x32_bf16 v[116:119], v[52:55], a[136:139], v[116:119]
s_waitcnt vmcnt(18)
ds_read_b64_tr_b16 v[70:71], v29 offset:36864
v_mfma_f32_16x16x32_bf16 v[116:119], v[56:59], a[152:155], v[116:119]
s_waitcnt vmcnt(17)
ds_read_b64_tr_b16 v[72:73], v29 offset:40960
v_mfma_f32_16x16x32_bf16 v[120:123], v[56:59], a[156:159], v[120:123]
ds_read_b64_tr_b16 v[74:75], v29 offset:45056
v_mfma_f32_16x16x32_bf16 v[120:123], v[52:55], a[140:143], v[120:123]
buffer_load_dwordx4 a[196:199], v36, s[4:7], s44 offen offset:1024 sc1
v_mfma_f32_16x16x32_bf16 v[120:123], v[48:51], a[252:255], v[120:123]
v_mfma_f32_16x16x32_bf16 v[120:123], v[44:47], a[236:239], v[120:123]
s_waitcnt lgkmcnt(6)
v_mfma_f32_16x16x32_bf16 v[124:127], v[60:63], a[224:227], v[124:127]
s_waitcnt lgkmcnt(4)
ds_read_b64_tr_b16 v[44:45], v30 offset:16384
v_mfma_f32_16x16x32_bf16 v[124:127], v[64:67], a[240:243], v[124:127]
s_waitcnt lgkmcnt(3)
buffer_load_dwordx4 a[208:211], v36, s[4:7], s44 offen offset:2048 sc1
v_mfma_f32_16x16x32_bf16 v[124:127], v[68:71], a[128:131], v[124:127]
s_waitcnt lgkmcnt(1)
ds_read_b64_tr_b16 v[46:47], v30 offset:20480
v_mfma_f32_16x16x32_bf16 v[124:127], v[72:75], a[144:147], v[124:127]
v_mfma_f32_16x16x32_bf16 v[128:131], v[72:75], a[148:151], v[128:131]
ds_read_b64_tr_b16 v[48:49], v30 offset:24576
v_mfma_f32_16x16x32_bf16 v[128:131], v[68:71], a[132:135], v[128:131]
buffer_load_dwordx4 a[212:215], v36, s[4:7], s44 offen offset:3072 sc1
v_mfma_f32_16x16x32_bf16 v[128:131], v[64:67], a[244:247], v[128:131]
ds_read_b64_tr_b16 v[50:51], v30 offset:28672
v_mfma_f32_16x16x32_bf16 v[128:131], v[60:63], a[228:231], v[128:131]
v_mfma_f32_16x16x32_bf16 v[132:135], v[60:63], a[232:235], v[132:135]
ds_read_b64_tr_b16 v[52:53], v30 offset:32768
v_mfma_f32_16x16x32_bf16 v[132:135], v[64:67], a[248:251], v[132:135]
buffer_load_dwordx4 a[200:203], v253, s[4:7], s44 offen offset:0 sc1
v_mfma_f32_16x16x32_bf16 v[132:135], v[68:71], a[136:139], v[132:135]
ds_read_b64_tr_b16 v[54:55], v30 offset:36864
v_mfma_f32_16x16x32_bf16 v[132:135], v[72:75], a[152:155], v[132:135]
ds_read_b64_tr_b16 v[56:57], v30 offset:40960
v_mfma_f32_16x16x32_bf16 v[136:139], v[72:75], a[156:159], v[136:139]
ds_read_b64_tr_b16 v[58:59], v30 offset:45056
v_mfma_f32_16x16x32_bf16 v[136:139], v[68:71], a[140:143], v[136:139]
buffer_load_dwordx4 a[204:207], v253, s[4:7], s44 offen offset:1024 sc1
v_mfma_f32_16x16x32_bf16 v[136:139], v[64:67], a[252:255], v[136:139]
v_mfma_f32_16x16x32_bf16 v[136:139], v[60:63], a[236:239], v[136:139]
s_waitcnt lgkmcnt(6)
v_mfma_f32_16x16x32_bf16 v[140:143], v[44:47], a[224:227], v[140:143]
s_waitcnt lgkmcnt(4)
ds_read_b64_tr_b16 v[60:61], v31 offset:16384
v_mfma_f32_16x16x32_bf16 v[140:143], v[48:51], a[240:243], v[140:143]
s_waitcnt lgkmcnt(3)
buffer_load_dwordx4 a[216:219], v253, s[4:7], s44 offen offset:2048 sc1
v_mfma_f32_16x16x32_bf16 v[140:143], v[52:55], a[128:131], v[140:143]
s_waitcnt lgkmcnt(1)
ds_read_b64_tr_b16 v[62:63], v31 offset:20480
v_mfma_f32_16x16x32_bf16 v[140:143], v[56:59], a[144:147], v[140:143]
v_mfma_f32_16x16x32_bf16 v[144:147], v[56:59], a[148:151], v[144:147]
ds_read_b64_tr_b16 v[64:65], v31 offset:24576
v_mfma_f32_16x16x32_bf16 v[144:147], v[52:55], a[132:135], v[144:147]
buffer_load_dwordx4 a[220:223], v253, s[4:7], s44 offen offset:3072 sc1
v_mfma_f32_16x16x32_bf16 v[144:147], v[48:51], a[244:247], v[144:147]
s_add_u32 s44, s44, s74
ds_read_b64_tr_b16 v[66:67], v31 offset:28672
v_mfma_f32_16x16x32_bf16 v[144:147], v[44:47], a[228:231], v[144:147]
v_mfma_f32_16x16x32_bf16 v[148:151], v[44:47], a[232:235], v[148:151]
ds_read_b64_tr_b16 v[68:69], v31 offset:32768
v_mfma_f32_16x16x32_bf16 v[148:151], v[48:51], a[248:251], v[148:151]
v_mfma_f32_16x16x32_bf16 v[148:151], v[52:55], a[136:139], v[148:151]
ds_read_b64_tr_b16 v[70:71], v31 offset:36864
v_mfma_f32_16x16x32_bf16 v[148:151], v[56:59], a[152:155], v[148:151]
ds_read_b64_tr_b16 v[72:73], v31 offset:40960
v_mfma_f32_16x16x32_bf16 v[152:155], v[56:59], a[156:159], v[152:155]
ds_read_b64_tr_b16 v[74:75], v31 offset:45056
v_mfma_f32_16x16x32_bf16 v[152:155], v[52:55], a[140:143], v[152:155]
v_mfma_f32_16x16x32_bf16 v[152:155], v[48:51], a[252:255], v[152:155]
v_mfma_f32_16x16x32_bf16 v[152:155], v[44:47], a[236:239], v[152:155]
s_waitcnt lgkmcnt(6)
v_mfma_f32_16x16x32_bf16 v[156:159], v[60:63], a[224:227], v[156:159]
s_waitcnt lgkmcnt(4)
ds_read_b64_tr_b16 v[44:45], v32 offset:32768
v_mfma_f32_16x16x32_bf16 v[156:159], v[64:67], a[240:243], v[156:159]
s_waitcnt lgkmcnt(3)
v_mfma_f32_16x16x32_bf16 v[156:159], v[68:71], a[128:131], v[156:159]
s_waitcnt lgkmcnt(1)
ds_read_b64_tr_b16 v[46:47], v32 offset:36864
v_mfma_f32_16x16x32_bf16 v[156:159], v[72:75], a[144:147], v[156:159]
v_mfma_f32_16x16x32_bf16 v[160:163], v[72:75], a[148:151], v[160:163]
ds_read_b64_tr_b16 v[48:49], v32 offset:40960
v_mfma_f32_16x16x32_bf16 v[160:163], v[68:71], a[132:135], v[160:163]
v_mfma_f32_16x16x32_bf16 v[160:163], v[64:67], a[244:247], v[160:163]
ds_read_b64_tr_b16 v[50:51], v32 offset:45056
v_mfma_f32_16x16x32_bf16 v[160:163], v[60:63], a[228:231], v[160:163]
s_waitcnt vmcnt(20)
s_barrier
v_mfma_f32_16x16x32_bf16 v[164:167], v[60:63], a[232:235], v[164:167]
s_add_u32 m0, s37, 16384
ds_read_b64_tr_b16 v[52:53], v32 offset:49152
v_mfma_f32_16x16x32_bf16 v[164:167], v[64:67], a[248:251], v[164:167]
buffer_load_dwordx4 v2, s[24:27], s43 offen offset:0 lds
v_mfma_f32_16x16x32_bf16 v[164:167], v[68:71], a[136:139], v[164:167]
ds_read_b64_tr_b16 v[54:55], v32 offset:53248
v_mfma_f32_16x16x32_bf16 v[164:167], v[72:75], a[152:155], v[164:167]
ds_read_b64_tr_b16 v[56:57], v32 offset:57344
v_mfma_f32_16x16x32_bf16 v[168:171], v[72:75], a[156:159], v[168:171]
ds_read_b64_tr_b16 v[58:59], v32 offset:61440
v_mfma_f32_16x16x32_bf16 v[168:171], v[68:71], a[140:143], v[168:171]
buffer_load_dwordx4 v3, s[24:27], s43 offen offset:1024 lds
v_mfma_f32_16x16x32_bf16 v[168:171], v[64:67], a[252:255], v[168:171]
v_mfma_f32_16x16x32_bf16 v[168:171], v[60:63], a[236:239], v[168:171]
s_waitcnt lgkmcnt(6)
v_mfma_f32_16x16x32_bf16 v[172:175], v[44:47], a[128:131], v[172:175]
s_waitcnt lgkmcnt(4)
ds_read_b64_tr_b16 v[60:61], v33 offset:32768
v_mfma_f32_16x16x32_bf16 v[172:175], v[48:51], a[144:147], v[172:175]
s_waitcnt vmcnt(21) lgkmcnt(3)
buffer_load_dwordx4 v4, s[24:27], s43 offen offset:2048 lds
v_mfma_f32_16x16x32_bf16 v[172:175], v[52:55], a[160:163], v[172:175]
s_waitcnt vmcnt(20) lgkmcnt(1)
ds_read_b64_tr_b16 v[62:63], v33 offset:36864
v_mfma_f32_16x16x32_bf16 v[172:175], v[56:59], a[176:179], v[172:175]
s_waitcnt vmcnt(19)
buffer_load_dword v252, off, s[4:7], s85 sc1
v_mfma_f32_16x16x32_bf16 v[176:179], v[56:59], a[180:183], v[176:179]
ds_read_b64_tr_b16 v[64:65], v33 offset:40960
v_mfma_f32_16x16x32_bf16 v[176:179], v[52:55], a[164:167], v[176:179]
buffer_load_dwordx4 v5, s[24:27], s43 offen offset:3072 lds
v_mfma_f32_16x16x32_bf16 v[176:179], v[48:51], a[148:151], v[176:179]
s_add_u32 s43, s43, s73
ds_read_b64_tr_b16 v[66:67], v33 offset:45056
v_mfma_f32_16x16x32_bf16 v[176:179], v[44:47], a[132:135], v[176:179]
v_mfma_f32_16x16x32_bf16 v[180:183], v[44:47], a[136:139], v[180:183]
ds_read_b64_tr_b16 v[68:69], v33 offset:49152
v_mfma_f32_16x16x32_bf16 v[180:183], v[48:51], a[152:155], v[180:183]
s_waitcnt vmcnt(20)
buffer_load_dwordx4 a[224:227], v36, s[4:7], s44 offen offset:0 sc1
v_mfma_f32_16x16x32_bf16 v[180:183], v[52:55], a[168:171], v[180:183]
s_waitcnt vmcnt(19)
ds_read_b64_tr_b16 v[70:71], v33 offset:53248
v_mfma_f32_16x16x32_bf16 v[180:183], v[56:59], a[184:187], v[180:183]
s_waitcnt vmcnt(18)
ds_read_b64_tr_b16 v[72:73], v33 offset:57344
v_mfma_f32_16x16x32_bf16 v[184:187], v[56:59], a[188:191], v[184:187]
ds_read_b64_tr_b16 v[74:75], v33 offset:61440
v_mfma_f32_16x16x32_bf16 v[184:187], v[52:55], a[172:175], v[184:187]
buffer_load_dwordx4 a[228:231], v36, s[4:7], s44 offen offset:1024 sc1
v_mfma_f32_16x16x32_bf16 v[184:187], v[48:51], a[156:159], v[184:187]
v_mfma_f32_16x16x32_bf16 v[184:187], v[44:47], a[140:143], v[184:187]
s_waitcnt lgkmcnt(6)
v_mfma_f32_16x16x32_bf16 v[188:191], v[60:63], a[128:131], v[188:191]
s_waitcnt lgkmcnt(4)
ds_read_b64_tr_b16 v[44:45], v34 offset:32768
v_mfma_f32_16x16x32_bf16 v[188:191], v[64:67], a[144:147], v[188:191]
s_waitcnt lgkmcnt(3)
buffer_load_dwordx4 a[240:243], v36, s[4:7], s44 offen offset:2048 sc1
v_mfma_f32_16x16x32_bf16 v[188:191], v[68:71], a[160:163], v[188:191]
s_waitcnt lgkmcnt(1)
ds_read_b64_tr_b16 v[46:47], v34 offset:36864
v_mfma_f32_16x16x32_bf16 v[188:191], v[72:75], a[176:179], v[188:191]
v_mfma_f32_16x16x32_bf16 v[192:195], v[72:75], a[180:183], v[192:195]
ds_read_b64_tr_b16 v[48:49], v34 offset:40960
v_mfma_f32_16x16x32_bf16 v[192:195], v[68:71], a[164:167], v[192:195]
buffer_load_dwordx4 a[244:247], v36, s[4:7], s44 offen offset:3072 sc1
v_mfma_f32_16x16x32_bf16 v[192:195], v[64:67], a[148:151], v[192:195]
ds_read_b64_tr_b16 v[50:51], v34 offset:45056
v_mfma_f32_16x16x32_bf16 v[192:195], v[60:63], a[132:135], v[192:195]
v_mfma_f32_16x16x32_bf16 v[196:199], v[60:63], a[136:139], v[196:199]
ds_read_b64_tr_b16 v[52:53], v34 offset:49152
v_mfma_f32_16x16x32_bf16 v[196:199], v[64:67], a[152:155], v[196:199]
buffer_load_dwordx4 a[232:235], v253, s[4:7], s44 offen offset:0 sc1
v_mfma_f32_16x16x32_bf16 v[196:199], v[68:71], a[168:171], v[196:199]
ds_read_b64_tr_b16 v[54:55], v34 offset:53248
v_mfma_f32_16x16x32_bf16 v[196:199], v[72:75], a[184:187], v[196:199]
ds_read_b64_tr_b16 v[56:57], v34 offset:57344
v_mfma_f32_16x16x32_bf16 v[200:203], v[72:75], a[188:191], v[200:203]
ds_read_b64_tr_b16 v[58:59], v34 offset:61440
v_mfma_f32_16x16x32_bf16 v[200:203], v[68:71], a[172:175], v[200:203]
buffer_load_dwordx4 a[236:239], v253, s[4:7], s44 offen offset:1024 sc1
v_mfma_f32_16x16x32_bf16 v[200:203], v[64:67], a[156:159], v[200:203]
v_mfma_f32_16x16x32_bf16 v[200:203], v[60:63], a[140:143], v[200:203]
s_waitcnt lgkmcnt(6)
v_mfma_f32_16x16x32_bf16 v[204:207], v[44:47], a[128:131], v[204:207]
s_waitcnt lgkmcnt(4)
ds_read_b64_tr_b16 v[60:61], v35 offset:32768
v_mfma_f32_16x16x32_bf16 v[204:207], v[48:51], a[144:147], v[204:207]
s_waitcnt lgkmcnt(3)
buffer_load_dwordx4 a[248:251], v253, s[4:7], s44 offen offset:2048 sc1
v_mfma_f32_16x16x32_bf16 v[204:207], v[52:55], a[160:163], v[204:207]
s_waitcnt lgkmcnt(1)
ds_read_b64_tr_b16 v[62:63], v35 offset:36864
v_mfma_f32_16x16x32_bf16 v[204:207], v[56:59], a[176:179], v[204:207]
v_mfma_f32_16x16x32_bf16 v[208:211], v[56:59], a[180:183], v[208:211]
ds_read_b64_tr_b16 v[64:65], v35 offset:40960
v_mfma_f32_16x16x32_bf16 v[208:211], v[52:55], a[164:167], v[208:211]
buffer_load_dwordx4 a[252:255], v253, s[4:7], s44 offen offset:3072 sc1
v_mfma_f32_16x16x32_bf16 v[208:211], v[48:51], a[148:151], v[208:211]
s_add_u32 s44, s44, s75
ds_read_b64_tr_b16 v[66:67], v35 offset:45056
v_mfma_f32_16x16x32_bf16 v[208:211], v[44:47], a[132:135], v[208:211]
v_mfma_f32_16x16x32_bf16 v[212:215], v[44:47], a[136:139], v[212:215]
ds_read_b64_tr_b16 v[68:69], v35 offset:49152
v_mfma_f32_16x16x32_bf16 v[212:215], v[48:51], a[152:155], v[212:215]
v_mfma_f32_16x16x32_bf16 v[212:215], v[52:55], a[168:171], v[212:215]
ds_read_b64_tr_b16 v[70:71], v35 offset:53248
v_mfma_f32_16x16x32_bf16 v[212:215], v[56:59], a[184:187], v[212:215]
ds_read_b64_tr_b16 v[72:73], v35 offset:57344
v_mfma_f32_16x16x32_bf16 v[216:219], v[56:59], a[188:191], v[216:219]
ds_read_b64_tr_b16 v[74:75], v35 offset:61440
v_mfma_f32_16x16x32_bf16 v[216:219], v[52:55], a[172:175], v[216:219]
v_mfma_f32_16x16x32_bf16 v[216:219], v[48:51], a[156:159], v[216:219]
v_mfma_f32_16x16x32_bf16 v[216:219], v[44:47], a[140:143], v[216:219]
s_waitcnt lgkmcnt(6)
v_mfma_f32_16x16x32_bf16 v[220:223], v[60:63], a[128:131], v[220:223]
s_waitcnt lgkmcnt(4)
ds_read_b64_tr_b16 v[44:45], v28 offset:49152
v_mfma_f32_16x16x32_bf16 v[220:223], v[64:67], a[144:147], v[220:223]
s_waitcnt lgkmcnt(3)
v_mfma_f32_16x16x32_bf16 v[220:223], v[68:71], a[160:163], v[220:223]
s_waitcnt lgkmcnt(1)
ds_read_b64_tr_b16 v[46:47], v28 offset:53248
v_mfma_f32_16x16x32_bf16 v[220:223], v[72:75], a[176:179], v[220:223]
v_mfma_f32_16x16x32_bf16 v[224:227], v[72:75], a[180:183], v[224:227]
ds_read_b64_tr_b16 v[48:49], v28 offset:57344
v_mfma_f32_16x16x32_bf16 v[224:227], v[68:71], a[164:167], v[224:227]
v_mfma_f32_16x16x32_bf16 v[224:227], v[64:67], a[148:151], v[224:227]
ds_read_b64_tr_b16 v[50:51], v28 offset:61440
v_mfma_f32_16x16x32_bf16 v[224:227], v[60:63], a[132:135], v[224:227]
s_waitcnt vmcnt(21)
s_barrier
v_mfma_f32_16x16x32_bf16 v[228:231], v[60:63], a[136:139], v[228:231]
s_add_u32 m0, s37, 32768
ds_read_b64_tr_b16 v[52:53], v28 offset:0
v_mfma_f32_16x16x32_bf16 v[228:231], v[64:67], a[152:155], v[228:231]
buffer_load_dwordx4 v2, s[24:27], s43 offen offset:0 lds
v_mfma_f32_16x16x32_bf16 v[228:231], v[68:71], a[168:171], v[228:231]
ds_read_b64_tr_b16 v[54:55], v28 offset:4096
v_mfma_f32_16x16x32_bf16 v[228:231], v[72:75], a[184:187], v[228:231]
s_waitcnt vmcnt(10)
ds_read_b64_tr_b16 v[56:57], v28 offset:8192
v_readfirstlane_b32 s54, v252
v_mfma_f32_16x16x32_bf16 v[232:235], v[72:75], a[188:191], v[232:235]
ds_read_b64_tr_b16 v[58:59], v28 offset:12288
v_mfma_f32_16x16x32_bf16 v[232:235], v[68:71], a[172:175], v[232:235]
buffer_load_dwordx4 v3, s[24:27], s43 offen offset:1024 lds
v_mfma_f32_16x16x32_bf16 v[232:235], v[64:67], a[156:159], v[232:235]
v_mfma_f32_16x16x32_bf16 v[232:235], v[60:63], a[140:143], v[232:235]
s_waitcnt lgkmcnt(6)
v_mfma_f32_16x16x32_bf16 v[108:111], v[44:47], a[160:163], v[108:111]
s_waitcnt lgkmcnt(4)
ds_read_b64_tr_b16 v[60:61], v29 offset:49152
v_mfma_f32_16x16x32_bf16 v[108:111], v[48:51], a[176:179], v[108:111]
s_waitcnt lgkmcnt(3)
buffer_load_dwordx4 v4, s[24:27], s43 offen offset:2048 lds
v_mfma_f32_16x16x32_bf16 v[108:111], v[52:55], a[192:195], v[108:111]
s_waitcnt lgkmcnt(1)
ds_read_b64_tr_b16 v[62:63], v29 offset:53248
v_mfma_f32_16x16x32_bf16 v[108:111], v[56:59], a[208:211], v[108:111]
s_bitcmp1_b32 1073741824, s38
s_cbranch_scc1 L2_hy
L2_hy_r:
v_mfma_f32_16x16x32_bf16 v[112:115], v[56:59], a[212:215], v[112:115]
ds_read_b64_tr_b16 v[64:65], v29 offset:57344
v_mfma_f32_16x16x32_bf16 v[112:115], v[52:55], a[196:199], v[112:115]
buffer_load_dwordx4 v5, s[24:27], s43 offen offset:3072 lds
v_mfma_f32_16x16x32_bf16 v[112:115], v[48:51], a[180:183], v[112:115]
s_add_u32 s43, s43, s72
ds_read_b64_tr_b16 v[66:67], v29 offset:61440
v_mfma_f32_16x16x32_bf16 v[112:115], v[44:47], a[164:167], v[112:115]
v_mfma_f32_16x16x32_bf16 v[116:119], v[44:47], a[168:171], v[116:119]
ds_read_b64_tr_b16 v[68:69], v29 offset:0
v_mfma_f32_16x16x32_bf16 v[116:119], v[48:51], a[184:187], v[116:119]
buffer_load_dwordx4 a[128:131], v36, s[4:7], s44 offen offset:0 sc1
v_mfma_f32_16x16x32_bf16 v[116:119], v[52:55], a[200:203], v[116:119]
ds_read_b64_tr_b16 v[70:71], v29 offset:4096
v_mfma_f32_16x16x32_bf16 v[116:119], v[56:59], a[216:219], v[116:119]
ds_read_b64_tr_b16 v[72:73], v29 offset:8192
v_mfma_f32_16x16x32_bf16 v[120:123], v[56:59], a[220:223], v[120:123]
ds_read_b64_tr_b16 v[74:75], v29 offset:12288
v_mfma_f32_16x16x32_bf16 v[120:123], v[52:55], a[204:207], v[120:123]
buffer_load_dwordx4 a[132:135], v36, s[4:7], s44 offen offset:1024 sc1
v_mfma_f32_16x16x32_bf16 v[120:123], v[48:51], a[188:191], v[120:123]
v_mfma_f32_16x16x32_bf16 v[120:123], v[44:47], a[172:175], v[120:123]
s_waitcnt lgkmcnt(6)
v_mfma_f32_16x16x32_bf16 v[124:127], v[60:63], a[160:163], v[124:127]
s_waitcnt lgkmcnt(4)
ds_read_b64_tr_b16 v[44:45], v30 offset:49152
v_mfma_f32_16x16x32_bf16 v[124:127], v[64:67], a[176:179], v[124:127]
s_waitcnt lgkmcnt(3)
buffer_load_dwordx4 a[144:147], v36, s[4:7], s44 offen offset:2048 sc1
v_mfma_f32_16x16x32_bf16 v[124:127], v[68:71], a[192:195], v[124:127]
s_waitcnt lgkmcnt(1)
ds_read_b64_tr_b16 v[46:47], v30 offset:53248
v_mfma_f32_16x16x32_bf16 v[124:127], v[72:75], a[208:211], v[124:127]
global_load_dword a60, v42, s[56:57]
v_mfma_f32_16x16x32_bf16 v[128:131], v[72:75], a[212:215], v[128:131]
ds_read_b64_tr_b16 v[48:49], v30 offset:57344
v_mfma_f32_16x16x32_bf16 v[128:131], v[68:71], a[196:199], v[128:131]
buffer_load_dwordx4 a[148:151], v36, s[4:7], s44 offen offset:3072 sc1
v_mfma_f32_16x16x32_bf16 v[128:131], v[64:67], a[180:183], v[128:131]
ds_read_b64_tr_b16 v[50:51], v30 offset:61440
v_mfma_f32_16x16x32_bf16 v[128:131], v[60:63], a[164:167], v[128:131]
v_mfma_f32_16x16x32_bf16 v[132:135], v[60:63], a[168:171], v[132:135]
ds_read_b64_tr_b16 v[52:53], v30 offset:0
v_mfma_f32_16x16x32_bf16 v[132:135], v[64:67], a[184:187], v[132:135]
buffer_load_dwordx4 a[136:139], v253, s[4:7], s44 offen offset:0 sc1
v_mfma_f32_16x16x32_bf16 v[132:135], v[68:71], a[200:203], v[132:135]
ds_read_b64_tr_b16 v[54:55], v30 offset:4096
v_mfma_f32_16x16x32_bf16 v[132:135], v[72:75], a[216:219], v[132:135]
ds_read_b64_tr_b16 v[56:57], v30 offset:8192
v_mfma_f32_16x16x32_bf16 v[136:139], v[72:75], a[220:223], v[136:139]
ds_read_b64_tr_b16 v[58:59], v30 offset:12288
v_mfma_f32_16x16x32_bf16 v[136:139], v[68:71], a[204:207], v[136:139]
buffer_load_dwordx4 a[140:143], v253, s[4:7], s44 offen offset:1024 sc1
v_mfma_f32_16x16x32_bf16 v[136:139], v[64:67], a[188:191], v[136:139]
v_mfma_f32_16x16x32_bf16 v[136:139], v[60:63], a[172:175], v[136:139]
s_waitcnt lgkmcnt(6)
v_mfma_f32_16x16x32_bf16 v[140:143], v[44:47], a[160:163], v[140:143]
s_waitcnt lgkmcnt(4)
ds_read_b64_tr_b16 v[60:61], v31 offset:49152
v_mfma_f32_16x16x32_bf16 v[140:143], v[48:51], a[176:179], v[140:143]
s_waitcnt lgkmcnt(3)
buffer_load_dwordx4 a[152:155], v253, s[4:7], s44 offen offset:2048 sc1
v_mfma_f32_16x16x32_bf16 v[140:143], v[52:55], a[192:195], v[140:143]
s_waitcnt lgkmcnt(1)
ds_read_b64_tr_b16 v[62:63], v31 offset:53248
v_mfma_f32_16x16x32_bf16 v[140:143], v[56:59], a[208:211], v[140:143]
v_mfma_f32_16x16x32_bf16 v[144:147], v[56:59], a[212:215], v[144:147]
ds_read_b64_tr_b16 v[64:65], v31 offset:57344
v_mfma_f32_16x16x32_bf16 v[144:147], v[52:55], a[196:199], v[144:147]
buffer_load_dwordx4 a[156:159], v253, s[4:7], s44 offen offset:3072 sc1
v_mfma_f32_16x16x32_bf16 v[144:147], v[48:51], a[180:183], v[144:147]
s_add_u32 s44, s44, s74
ds_read_b64_tr_b16 v[66:67], v31 offset:61440
v_mfma_f32_16x16x32_bf16 v[144:147], v[44:47], a[164:167], v[144:147]
v_mfma_f32_16x16x32_bf16 v[148:151], v[44:47], a[168:171], v[148:151]
ds_read_b64_tr_b16 v[68:69], v31 offset:0
v_mfma_f32_16x16x32_bf16 v[148:151], v[48:51], a[184:187], v[148:151]
v_mfma_f32_16x16x32_bf16 v[148:151], v[52:55], a[200:203], v[148:151]
ds_read_b64_tr_b16 v[70:71], v31 offset:4096
v_mfma_f32_16x16x32_bf16 v[148:151], v[56:59], a[216:219], v[148:151]
ds_read_b64_tr_b16 v[72:73], v31 offset:8192
v_mfma_f32_16x16x32_bf16 v[152:155], v[56:59], a[220:223], v[152:155]
ds_read_b64_tr_b16 v[74:75], v31 offset:12288
v_mfma_f32_16x16x32_bf16 v[152:155], v[52:55], a[204:207], v[152:155]
v_mfma_f32_16x16x32_bf16 v[152:155], v[48:51], a[188:191], v[152:155]
v_mfma_f32_16x16x32_bf16 v[152:155], v[44:47], a[172:175], v[152:155]
s_waitcnt lgkmcnt(6)
v_mfma_f32_16x16x32_bf16 v[156:159], v[60:63], a[160:163], v[156:159]
s_waitcnt lgkmcnt(4)
ds_read_b64_tr_b16 v[44:45], v32 offset:0
v_mfma_f32_16x16x32_bf16 v[156:159], v[64:67], a[176:179], v[156:159]
s_waitcnt lgkmcnt(3)
v_mfma_f32_16x16x32_bf16 v[156:159], v[68:71], a[192:195], v[156:159]
s_waitcnt lgkmcnt(1)
ds_read_b64_tr_b16 v[46:47], v32 offset:4096
v_mfma_f32_16x16x32_bf16 v[156:159], v[72:75], a[208:211], v[156:159]
v_mfma_f32_16x16x32_bf16 v[160:163], v[72:75], a[212:215], v[160:163]
ds_read_b64_tr_b16 v[48:49], v32 offset:8192
v_mfma_f32_16x16x32_bf16 v[160:163], v[68:71], a[196:199], v[160:163]
v_mfma_f32_16x16x32_bf16 v[160:163], v[64:67], a[180:183], v[160:163]
ds_read_b64_tr_b16 v[50:51], v32 offset:12288
v_mfma_f32_16x16x32_bf16 v[160:163], v[60:63], a[164:167], v[160:163]
s_waitcnt vmcnt(21)
s_barrier
v_mfma_f32_16x16x32_bf16 v[164:167], v[60:63], a[168:171], v[164:167]
s_add_u32 m0, s37, 49152
ds_read_b64_tr_b16 v[52:53], v32 offset:16384
v_mfma_f32_16x16x32_bf16 v[164:167], v[64:67], a[184:187], v[164:167]
buffer_load_dwordx4 v2, s[24:27], s43 offen offset:0 lds
v_mfma_f32_16x16x32_bf16 v[164:167], v[68:71], a[200:203], v[164:167]
ds_read_b64_tr_b16 v[54:55], v32 offset:20480
v_mfma_f32_16x16x32_bf16 v[164:167], v[72:75], a[216:219], v[164:167]
ds_read_b64_tr_b16 v[56:57], v32 offset:24576
v_mfma_f32_16x16x32_bf16 v[168:171], v[72:75], a[220:223], v[168:171]
ds_read_b64_tr_b16 v[58:59], v32 offset:28672
v_mfma_f32_16x16x32_bf16 v[168:171], v[68:71], a[204:207], v[168:171]
buffer_load_dwordx4 v3, s[24:27], s43 offen offset:1024 lds
v_mfma_f32_16x16x32_bf16 v[168:171], v[64:67], a[188:191], v[168:171]
v_mfma_f32_16x16x32_bf16 v[168:171], v[60:63], a[172:175], v[168:171]
s_waitcnt lgkmcnt(6)
s_add_u32 s38, s38, 1
s_cbranch_scc0 L2_sy
v_mfma_f32_16x16x32_bf16 v[172:175], v[44:47], a[192:195], v[172:175]
s_waitcnt lgkmcnt(4)
ds_read_b64_tr_b16 v[60:61], v33 offset:0
v_mfma_f32_16x16x32_bf16 v[172:175], v[48:51], a[208:211], v[172:175]
s_waitcnt vmcnt(22) lgkmcnt(3)
buffer_load_dwordx4 v4, s[24:27], s43 offen offset:2048 lds
v_mfma_f32_16x16x32_bf16 v[172:175], v[52:55], a[224:227], v[172:175]
s_waitcnt vmcnt(21) lgkmcnt(1)
ds_read_b64_tr_b16 v[62:63], v33 offset:4096
v_mfma_f32_16x16x32_bf16 v[172:175], v[56:59], a[240:243], v[172:175]
s_waitcnt vmcnt(20)
v_mfma_f32_16x16x32_bf16 v[176:179], v[56:59], a[244:247], v[176:179]
ds_read_b64_tr_b16 v[64:65], v33 offset:8192
v_mfma_f32_16x16x32_bf16 v[176:179], v[52:55], a[228:231], v[176:179]
buffer_load_dwordx4 v5, s[24:27], s43 offen offset:3072 lds
v_mfma_f32_16x16x32_bf16 v[176:179], v[48:51], a[212:215], v[176:179]
s_add_u32 s43, s43, s73
ds_read_b64_tr_b16 v[66:67], v33 offset:12288
v_mfma_f32_16x16x32_bf16 v[176:179], v[44:47], a[196:199], v[176:179]
v_mfma_f32_16x16x32_bf16 v[180:183], v[44:47], a[200:203], v[180:183]
ds_read_b64_tr_b16 v[68:69], v33 offset:16384
v_mfma_f32_16x16x32_bf16 v[180:183], v[48:51], a[216:219], v[180:183]
s_waitcnt vmcnt(20)
buffer_load_dwordx4 a[160:163], v36, s[4:7], s44 offen offset:0 sc1
v_mfma_f32_16x16x32_bf16 v[180:183], v[52:55], a[232:235], v[180:183]
s_waitcnt vmcnt(19)
ds_read_b64_tr_b16 v[70:71], v33 offset:20480
v_mfma_f32_16x16x32_bf16 v[180:183], v[56:59], a[248:251], v[180:183]
s_waitcnt vmcnt(18)
ds_read_b64_tr_b16 v[72:73], v33 offset:24576
v_mfma_f32_16x16x32_bf16 v[184:187], v[56:59], a[252:255], v[184:187]
ds_read_b64_tr_b16 v[74:75], v33 offset:28672
v_mfma_f32_16x16x32_bf16 v[184:187], v[52:55], a[236:239], v[184:187]
buffer_load_dwordx4 a[164:167], v36, s[4:7], s44 offen offset:1024 sc1
v_mfma_f32_16x16x32_bf16 v[184:187], v[48:51], a[220:223], v[184:187]
v_mfma_f32_16x16x32_bf16 v[184:187], v[44:47], a[204:207], v[184:187]
s_waitcnt lgkmcnt(6)
v_mfma_f32_16x16x32_bf16 v[188:191], v[60:63], a[192:195], v[188:191]
s_waitcnt lgkmcnt(4)
ds_read_b64_tr_b16 v[44:45], v34 offset:0
v_mfma_f32_16x16x32_bf16 v[188:191], v[64:67], a[208:211], v[188:191]
s_waitcnt lgkmcnt(3)
buffer_load_dwordx4 a[176:179], v36, s[4:7], s44 offen offset:2048 sc1
v_mfma_f32_16x16x32_bf16 v[188:191], v[68:71], a[224:227], v[188:191]
s_waitcnt lgkmcnt(1)
ds_read_b64_tr_b16 v[46:47], v34 offset:4096
v_mfma_f32_16x16x32_bf16 v[188:191], v[72:75], a[240:243], v[188:191]
v_mfma_f32_16x16x32_bf16 v[192:195], v[72:75], a[244:247], v[192:195]
ds_read_b64_tr_b16 v[48:49], v34 offset:8192
v_mfma_f32_16x16x32_bf16 v[192:195], v[68:71], a[228:231], v[192:195]
buffer_load_dwordx4 a[180:183], v36, s[4:7], s44 offen offset:3072 sc1
v_mfma_f32_16x16x32_bf16 v[192:195], v[64:67], a[212:215], v[192:195]
ds_read_b64_tr_b16 v[50:51], v34 offset:12288
v_mfma_f32_16x16x32_bf16 v[192:195], v[60:63], a[196:199], v[192:195]
v_mfma_f32_16x16x32_bf16 v[196:199], v[60:63], a[200:203], v[196:199]
ds_read_b64_tr_b16 v[52:53], v34 offset:16384
v_mfma_f32_16x16x32_bf16 v[196:199], v[64:67], a[216:219], v[196:199]
buffer_load_dwordx4 a[168:171], v253, s[4:7], s44 offen offset:0 sc1
v_mfma_f32_16x16x32_bf16 v[196:199], v[68:71], a[232:235], v[196:199]
ds_read_b64_tr_b16 v[54:55], v34 offset:20480
v_mfma_f32_16x16x32_bf16 v[196:199], v[72:75], a[248:251], v[196:199]
ds_read_b64_tr_b16 v[56:57], v34 offset:24576
v_mfma_f32_16x16x32_bf16 v[200:203], v[72:75], a[252:255], v[200:203]
ds_read_b64_tr_b16 v[58:59], v34 offset:28672
v_mfma_f32_16x16x32_bf16 v[200:203], v[68:71], a[236:239], v[200:203]
buffer_load_dwordx4 a[172:175], v253, s[4:7], s44 offen offset:1024 sc1
v_mfma_f32_16x16x32_bf16 v[200:203], v[64:67], a[220:223], v[200:203]
v_mfma_f32_16x16x32_bf16 v[200:203], v[60:63], a[204:207], v[200:203]
s_waitcnt lgkmcnt(6)
v_mfma_f32_16x16x32_bf16 v[204:207], v[44:47], a[192:195], v[204:207]
s_waitcnt lgkmcnt(4)
ds_read_b64_tr_b16 v[60:61], v35 offset:0
v_mfma_f32_16x16x32_bf16 v[204:207], v[48:51], a[208:211], v[204:207]
s_waitcnt lgkmcnt(3)
buffer_load_dwordx4 a[184:187], v253, s[4:7], s44 offen offset:2048 sc1
v_mfma_f32_16x16x32_bf16 v[204:207], v[52:55], a[224:227], v[204:207]
s_waitcnt lgkmcnt(1)
ds_read_b64_tr_b16 v[62:63], v35 offset:4096
v_mfma_f32_16x16x32_bf16 v[204:207], v[56:59], a[240:243], v[204:207]
v_mfma_f32_16x16x32_bf16 v[208:211], v[56:59], a[244:247], v[208:211]
ds_read_b64_tr_b16 v[64:65], v35 offset:8192
v_mfma_f32_16x16x32_bf16 v[208:211], v[52:55], a[228:231], v[208:211]
buffer_load_dwordx4 a[188:191], v253, s[4:7], s44 offen offset:3072 sc1
v_mfma_f32_16x16x32_bf16 v[208:211], v[48:51], a[212:215], v[208:211]
s_add_u32 s44, s44, s75
ds_read_b64_tr_b16 v[66:67], v35 offset:12288
v_mfma_f32_16x16x32_bf16 v[208:211], v[44:47], a[196:199], v[208:211]
v_mfma_f32_16x16x32_bf16 v[212:215], v[44:47], a[200:203], v[212:215]
ds_read_b64_tr_b16 v[68:69], v35 offset:16384
v_mfma_f32_16x16x32_bf16 v[212:215], v[48:51], a[216:219], v[212:215]
v_mfma_f32_16x16x32_bf16 v[212:215], v[52:55], a[232:235], v[212:215]
ds_read_b64_tr_b16 v[70:71], v35 offset:20480
v_mfma_f32_16x16x32_bf16 v[212:215], v[56:59], a[248:251], v[212:215]
ds_read_b64_tr_b16 v[72:73], v35 offset:24576
v_mfma_f32_16x16x32_bf16 v[216:219], v[56:59], a[252:255], v[216:219]
ds_read_b64_tr_b16 v[74:75], v35 offset:28672
v_mfma_f32_16x16x32_bf16 v[216:219], v[52:55], a[236:239], v[216:219]
v_mfma_f32_16x16x32_bf16 v[216:219], v[48:51], a[220:223], v[216:219]
v_mfma_f32_16x16x32_bf16 v[216:219], v[44:47], a[204:207], v[216:219]
s_waitcnt lgkmcnt(6)
v_mfma_f32_16x16x32_bf16 v[220:223], v[60:63], a[192:195], v[220:223]
s_waitcnt lgkmcnt(4)
ds_read_b64_tr_b16 v[44:45], v28 offset:16384
v_mfma_f32_16x16x32_bf16 v[220:223], v[64:67], a[208:211], v[220:223]
s_waitcnt lgkmcnt(3)
v_mfma_f32_16x16x32_bf16 v[220:223], v[68:71], a[224:227], v[220:223]
s_waitcnt lgkmcnt(1)
ds_read_b64_tr_b16 v[46:47], v28 offset:20480
v_mfma_f32_16x16x32_bf16 v[220:223], v[72:75], a[240:243], v[220:223]
v_mfma_f32_16x16x32_bf16 v[224:227], v[72:75], a[244:247], v[224:227]
ds_read_b64_tr_b16 v[48:49], v28 offset:24576
v_mfma_f32_16x16x32_bf16 v[224:227], v[68:71], a[228:231], v[224:227]
v_mfma_f32_16x16x32_bf16 v[224:227], v[64:67], a[212:215], v[224:227]
ds_read_b64_tr_b16 v[50:51], v28 offset:28672
v_mfma_f32_16x16x32_bf16 v[224:227], v[60:63], a[196:199], v[224:227]
s_waitcnt vmcnt(21)
s_barrier
v_mfma_f32_16x16x32_bf16 v[228:231], v[60:63], a[200:203], v[228:231]
ds_read_b64_tr_b16 v[52:53], v28 offset:32768
v_mfma_f32_16x16x32_bf16 v[228:231], v[64:67], a[216:219], v[228:231]
v_mfma_f32_16x16x32_bf16 v[228:231], v[68:71], a[232:235], v[228:231]
ds_read_b64_tr_b16 v[54:55], v28 offset:36864
v_mfma_f32_16x16x32_bf16 v[228:231], v[72:75], a[248:251], v[228:231]
ds_read_b64_tr_b16 v[56:57], v28 offset:40960
v_mfma_f32_16x16x32_bf16 v[232:235], v[72:75], a[252:255], v[232:235]
ds_read_b64_tr_b16 v[58:59], v28 offset:45056
v_mfma_f32_16x16x32_bf16 v[232:235], v[68:71], a[236:239], v[232:235]
v_mfma_f32_16x16x32_bf16 v[232:235], v[64:67], a[220:223], v[232:235]
v_mfma_f32_16x16x32_bf16 v[232:235], v[60:63], a[204:207], v[232:235]
s_waitcnt lgkmcnt(6)
v_mfma_f32_16x16x32_bf16 v[108:111], v[44:47], a[224:227], v[108:111]
s_waitcnt lgkmcnt(4)
ds_read_b64_tr_b16 v[60:61], v29 offset:16384
v_mfma_f32_16x16x32_bf16 v[108:111], v[48:51], a[240:243], v[108:111]
s_waitcnt vmcnt(20) lgkmcnt(3)
v_mfma_f32_16x16x32_bf16 v[108:111], v[52:55], a[128:131], v[108:111]
s_waitcnt vmcnt(18) lgkmcnt(1)
ds_read_b64_tr_b16 v[62:63], v29 offset:20480
v_mfma_f32_16x16x32_bf16 v[108:111], v[56:59], a[144:147], v[108:111]
s_waitcnt vmcnt(16)
v_mfma_f32_16x16x32_bf16 v[112:115], v[56:59], a[148:151], v[112:115]
ds_read_b64_tr_b16 v[64:65], v29 offset:24576
v_mfma_f32_16x16x32_bf16 v[112:115], v[52:55], a[132:135], v[112:115]
v_mfma_f32_16x16x32_bf16 v[112:115], v[48:51], a[244:247], v[112:115]
ds_read_b64_tr_b16 v[66:67], v29 offset:28672
v_mfma_f32_16x16x32_bf16 v[112:115], v[44:47], a[228:231], v[112:115]
v_mfma_f32_16x16x32_bf16 v[116:119], v[44:47], a[232:235], v[116:119]
ds_read_b64_tr_b16 v[68:69], v29 offset:32768
v_mfma_f32_16x16x32_bf16 v[116:119], v[48:51], a[248:251], v[116:119]
s_waitcnt vmcnt(15)
v_mfma_f32_16x16x32_bf16 v[116:119], v[52:55], a[136:139], v[116:119]
s_waitcnt vmcnt(13)
ds_read_b64_tr_b16 v[70:71], v29 offset:36864
v_mfma_f32_16x16x32_bf16 v[116:119], v[56:59], a[152:155], v[116:119]
s_waitcnt vmcnt(12)
ds_read_b64_tr_b16 v[72:73], v29 offset:40960
v_mfma_f32_16x16x32_bf16 v[120:123], v[56:59], a[156:159], v[120:123]
ds_read_b64_tr_b16 v[74:75], v29 offset:45056
v_mfma_f32_16x16x32_bf16 v[120:123], v[52:55], a[140:143], v[120:123]
v_mfma_f32_16x16x32_bf16 v[120:123], v[48:51], a[252:255], v[120:123]
v_mfma_f32_16x16x32_bf16 v[120:123], v[44:47], a[236:239], v[120:123]
s_waitcnt lgkmcnt(6)
v_mfma_f32_16x16x32_bf16 v[124:127], v[60:63], a[224:227], v[124:127]
s_waitcnt lgkmcnt(4)
ds_read_b64_tr_b16 v[44:45], v30 offset:16384
v_mfma_f32_16x16x32_bf16 v[124:127], v[64:67], a[240:243], v[124:127]
s_waitcnt lgkmcnt(3)
v_mfma_f32_16x16x32_bf16 v[124:127], v[68:71], a[128:131], v[124:127]
s_waitcnt lgkmcnt(1)
ds_read_b64_tr_b16 v[46:47], v30 offset:20480
v_mfma_f32_16x16x32_bf16 v[124:127], v[72:75], a[144:147], v[124:127]
v_mfma_f32_16x16x32_bf16 v[128:131], v[72:75], a[148:151], v[128:131]
ds_read_b64_tr_b16 v[48:49], v30 offset:24576
v_mfma_f32_16x16x32_bf16 v[128:131], v[68:71], a[132:135], v[128:131]
v_mfma_f32_16x16x32_bf16 v[128:131], v[64:67], a[244:247], v[128:131]
ds_read_b64_tr_b16 v[50:51], v30 offset:28672
v_mfma_f32_16x16x32_bf16 v[128:131], v[60:63], a[228:231], v[128:131]
v_mfma_f32_16x16x32_bf16 v[132:135], v[60:63], a[232:235], v[132:135]
ds_read_b64_tr_b16 v[52:53], v30 offset:32768
v_mfma_f32_16x16x32_bf16 v[132:135], v[64:67], a[248:251], v[132:135]
v_mfma_f32_16x16x32_bf16 v[132:135], v[68:71], a[136:139], v[132:135]
ds_read_b64_tr_b16 v[54:55], v30 offset:36864
v_mfma_f32_16x16x32_bf16 v[132:135], v[72:75], a[152:155], v[132:135]
ds_read_b64_tr_b16 v[56:57], v30 offset:40960
v_mfma_f32_16x16x32_bf16 v[136:139], v[72:75], a[156:159], v[136:139]
ds_read_b64_tr_b16 v[58:59], v30 offset:45056
v_mfma_f32_16x16x32_bf16 v[136:139], v[68:71], a[140:143], v[136:139]
v_mfma_f32_16x16x32_bf16 v[136:139], v[64:67], a[252:255], v[136:139]
v_mfma_f32_16x16x32_bf16 v[136:139], v[60:63], a[236:239], v[136:139]
s_waitcnt lgkmcnt(6)
v_mfma_f32_16x16x32_bf16 v[140:143], v[44:47], a[224:227], v[140:143]
s_waitcnt lgkmcnt(4)
ds_read_b64_tr_b16 v[60:61], v31 offset:16384
v_mfma_f32_16x16x32_bf16 v[140:143], v[48:51], a[240:243], v[140:143]
s_waitcnt lgkmcnt(3)
v_mfma_f32_16x16x32_bf16 v[140:143], v[52:55], a[128:131], v[140:143]
s_waitcnt lgkmcnt(1)
ds_read_b64_tr_b16 v[62:63], v31 offset:20480
v_mfma_f32_16x16x32_bf16 v[140:143], v[56:59], a[144:147], v[140:143]
v_mfma_f32_16x16x32_bf16 v[144:147], v[56:59], a[148:151], v[144:147]
ds_read_b64_tr_b16 v[64:65], v31 offset:24576
v_mfma_f32_16x16x32_bf16 v[144:147], v[52:55], a[132:135], v[144:147]
v_mfma_f32_16x16x32_bf16 v[144:147], v[48:51], a[244:247], v[144:147]
ds_read_b64_tr_b16 v[66:67], v31 offset:28672
v_mfma_f32_16x16x32_bf16 v[144:147], v[44:47], a[228:231], v[144:147]
v_mfma_f32_16x16x32_bf16 v[148:151], v[44:47], a[232:235], v[148:151]
ds_read_b64_tr_b16 v[68:69], v31 offset:32768
v_mfma_f32_16x16x32_bf16 v[148:151], v[48:51], a[248:251], v[148:151]
v_mfma_f32_16x16x32_bf16 v[148:151], v[52:55], a[136:139], v[148:151]
ds_read_b64_tr_b16 v[70:71], v31 offset:36864
v_mfma_f32_16x16x32_bf16 v[148:151], v[56:59], a[152:155], v[148:151]
ds_read_b64_tr_b16 v[72:73], v31 offset:40960
v_mfma_f32_16x16x32_bf16 v[152:155], v[56:59], a[156:159], v[152:155]
ds_read_b64_tr_b16 v[74:75], v31 offset:45056
v_mfma_f32_16x16x32_bf16 v[152:155], v[52:55], a[140:143], v[152:155]
v_mfma_f32_16x16x32_bf16 v[152:155], v[48:51], a[252:255], v[152:155]
v_mfma_f32_16x16x32_bf16 v[152:155], v[44:47], a[236:239], v[152:155]
s_waitcnt lgkmcnt(6)
v_mfma_f32_16x16x32_bf16 v[156:159], v[60:63], a[224:227], v[156:159]
s_waitcnt lgkmcnt(4)
ds_read_b64_tr_b16 v[44:45], v32 offset:32768
v_mfma_f32_16x16x32_bf16 v[156:159], v[64:67], a[240:243], v[156:159]
s_waitcnt lgkmcnt(3)
v_mfma_f32_16x16x32_bf16 v[156:159], v[68:71], a[128:131], v[156:159]
s_waitcnt lgkmcnt(1)
ds_read_b64_tr_b16 v[46:47], v32 offset:36864
v_mfma_f32_16x16x32_bf16 v[156:159], v[72:75], a[144:147], v[156:159]
v_mfma_f32_16x16x32_bf16 v[160:163], v[72:75], a[148:151], v[160:163]
ds_read_b64_tr_b16 v[48:49], v32 offset:40960
v_mfma_f32_16x16x32_bf16 v[160:163], v[68:71], a[132:135], v[160:163]
v_mfma_f32_16x16x32_bf16 v[160:163], v[64:67], a[244:247], v[160:163]
ds_read_b64_tr_b16 v[50:51], v32 offset:45056
v_mfma_f32_16x16x32_bf16 v[160:163], v[60:63], a[228:231], v[160:163]
s_waitcnt vmcnt(8)
s_barrier
v_mfma_f32_16x16x32_bf16 v[164:167], v[60:63], a[232:235], v[164:167]
ds_read_b64_tr_b16 v[52:53], v32 offset:49152
v_mfma_f32_16x16x32_bf16 v[164:167], v[64:67], a[248:251], v[164:167]
v_mfma_f32_16x16x32_bf16 v[164:167], v[68:71], a[136:139], v[164:167]
ds_read_b64_tr_b16 v[54:55], v32 offset:53248
v_mfma_f32_16x16x32_bf16 v[164:167], v[72:75], a[152:155], v[164:167]
ds_read_b64_tr_b16 v[56:57], v32 offset:57344
v_mfma_f32_16x16x32_bf16 v[168:171], v[72:75], a[156:159], v[168:171]
ds_read_b64_tr_b16 v[58:59], v32 offset:61440
v_mfma_f32_16x16x32_bf16 v[168:171], v[68:71], a[140:143], v[168:171]
v_mfma_f32_16x16x32_bf16 v[168:171], v[64:67], a[252:255], v[168:171]
v_mfma_f32_16x16x32_bf16 v[168:171], v[60:63], a[236:239], v[168:171]
s_waitcnt lgkmcnt(6)
v_mfma_f32_16x16x32_bf16 v[172:175], v[44:47], a[128:131], v[172:175]
s_waitcnt lgkmcnt(4)
ds_read_b64_tr_b16 v[60:61], v33 offset:32768
v_mfma_f32_16x16x32_bf16 v[172:175], v[48:51], a[144:147], v[172:175]
s_waitcnt vmcnt(7) lgkmcnt(3)
v_mfma_f32_16x16x32_bf16 v[172:175], v[52:55], a[160:163], v[172:175]
s_waitcnt vmcnt(5) lgkmcnt(1)
ds_read_b64_tr_b16 v[62:63], v33 offset:36864
v_mfma_f32_16x16x32_bf16 v[172:175], v[56:59], a[176:179], v[172:175]
s_waitcnt vmcnt(4)
v_mfma_f32_16x16x32_bf16 v[176:179], v[56:59], a[180:183], v[176:179]
ds_read_b64_tr_b16 v[64:65], v33 offset:40960
v_mfma_f32_16x16x32_bf16 v[176:179], v[52:55], a[164:167], v[176:179]
v_mfma_f32_16x16x32_bf16 v[176:179], v[48:51], a[148:151], v[176:179]
ds_read_b64_tr_b16 v[66:67], v33 offset:45056
v_mfma_f32_16x16x32_bf16 v[176:179], v[44:47], a[132:135], v[176:179]
v_mfma_f32_16x16x32_bf16 v[180:183], v[44:47], a[136:139], v[180:183]
ds_read_b64_tr_b16 v[68:69], v33 offset:49152
v_mfma_f32_16x16x32_bf16 v[180:183], v[48:51], a[152:155], v[180:183]
s_waitcnt vmcnt(3)
v_mfma_f32_16x16x32_bf16 v[180:183], v[52:55], a[168:171], v[180:183]
s_waitcnt vmcnt(1)
ds_read_b64_tr_b16 v[70:71], v33 offset:53248
v_mfma_f32_16x16x32_bf16 v[180:183], v[56:59], a[184:187], v[180:183]
s_waitcnt vmcnt(0)
ds_read_b64_tr_b16 v[72:73], v33 offset:57344
v_mfma_f32_16x16x32_bf16 v[184:187], v[56:59], a[188:191], v[184:187]
ds_read_b64_tr_b16 v[74:75], v33 offset:61440
v_mfma_f32_16x16x32_bf16 v[184:187], v[52:55], a[172:175], v[184:187]
v_mfma_f32_16x16x32_bf16 v[184:187], v[48:51], a[156:159], v[184:187]
v_mfma_f32_16x16x32_bf16 v[184:187], v[44:47], a[140:143], v[184:187]
s_waitcnt lgkmcnt(6)
v_mfma_f32_16x16x32_bf16 v[188:191], v[60:63], a[128:131], v[188:191]
s_waitcnt lgkmcnt(4)
ds_read_b64_tr_b16 v[44:45], v34 offset:32768
v_mfma_f32_16x16x32_bf16 v[188:191], v[64:67], a[144:147], v[188:191]
s_waitcnt lgkmcnt(3)
v_mfma_f32_16x16x32_bf16 v[188:191], v[68:71], a[160:163], v[188:191]
s_waitcnt lgkmcnt(1)
ds_read_b64_tr_b16 v[46:47], v34 offset:36864
v_mfma_f32_16x16x32_bf16 v[188:191], v[72:75], a[176:179], v[188:191]
v_mfma_f32_16x16x32_bf16 v[192:195], v[72:75], a[180:183], v[192:195]
ds_read_b64_tr_b16 v[48:49], v34 offset:40960
v_mfma_f32_16x16x32_bf16 v[192:195], v[68:71], a[164:167], v[192:195]
v_mfma_f32_16x16x32_bf16 v[192:195], v[64:67], a[148:151], v[192:195]
ds_read_b64_tr_b16 v[50:51], v34 offset:45056
v_mfma_f32_16x16x32_bf16 v[192:195], v[60:63], a[132:135], v[192:195]
v_mfma_f32_16x16x32_bf16 v[196:199], v[60:63], a[136:139], v[196:199]
ds_read_b64_tr_b16 v[52:53], v34 offset:49152
v_mfma_f32_16x16x32_bf16 v[196:199], v[64:67], a[152:155], v[196:199]
v_mfma_f32_16x16x32_bf16 v[196:199], v[68:71], a[168:171], v[196:199]
ds_read_b64_tr_b16 v[54:55], v34 offset:53248
v_mfma_f32_16x16x32_bf16 v[196:199], v[72:75], a[184:187], v[196:199]
ds_read_b64_tr_b16 v[56:57], v34 offset:57344
v_mfma_f32_16x16x32_bf16 v[200:203], v[72:75], a[188:191], v[200:203]
ds_read_b64_tr_b16 v[58:59], v34 offset:61440
v_mfma_f32_16x16x32_bf16 v[200:203], v[68:71], a[172:175], v[200:203]
v_mfma_f32_16x16x32_bf16 v[200:203], v[64:67], a[156:159], v[200:203]
v_mfma_f32_16x16x32_bf16 v[200:203], v[60:63], a[140:143], v[200:203]
s_waitcnt lgkmcnt(6)
v_mfma_f32_16x16x32_bf16 v[204:207], v[44:47], a[128:131], v[204:207]
s_waitcnt lgkmcnt(4)
ds_read_b64_tr_b16 v[60:61], v35 offset:32768
v_mfma_f32_16x16x32_bf16 v[204:207], v[48:51], a[144:147], v[204:207]
s_waitcnt lgkmcnt(3)
v_mfma_f32_16x16x32_bf16 v[204:207], v[52:55], a[160:163], v[204:207]
s_waitcnt lgkmcnt(1)
ds_read_b64_tr_b16 v[62:63], v35 offset:36864
v_mfma_f32_16x16x32_bf16 v[204:207], v[56:59], a[176:179], v[204:207]
v_mfma_f32_16x16x32_bf16 v[208:211], v[56:59], a[180:183], v[208:211]
ds_read_b64_tr_b16 v[64:65], v35 offset:40960
v_mfma_f32_16x16x32_bf16 v[208:211], v[52:55], a[164:167], v[208:211]
v_mfma_f32_16x16x32_bf16 v[208:211], v[48:51], a[148:151], v[208:211]
ds_read_b64_tr_b16 v[66:67], v35 offset:45056
v_mfma_f32_16x16x32_bf16 v[208:211], v[44:47], a[132:135], v[208:211]
v_mfma_f32_16x16x32_bf16 v[212:215], v[44:47], a[136:139], v[212:215]
ds_read_b64_tr_b16 v[68:69], v35 offset:49152
v_cvt_pk_bf16_f32 v172, v172, v173
v_mfma_f32_16x16x32_bf16 v[212:215], v[48:51], a[152:155], v[212:215]
v_cvt_pk_bf16_f32 v173, v174, v175
v_cvt_pk_bf16_f32 v174, v188, v189
v_mfma_f32_16x16x32_bf16 v[212:215], v[52:55], a[168:171], v[212:215]
ds_read_b64_tr_b16 v[70:71], v35 offset:53248
v_cvt_pk_bf16_f32 v175, v190, v191
v_mfma_f32_16x16x32_bf16 v[212:215], v[56:59], a[184:187], v[212:215]
ds_read_b64_tr_b16 v[72:73], v35 offset:57344
v_mfma_f32_16x16x32_bf16 v[216:219], v[56:59], a[188:191], v[216:219]
ds_read_b64_tr_b16 v[74:75], v35 offset:61440
v_mfma_f32_16x16x32_bf16 v[216:219], v[52:55], a[172:175], v[216:219]
buffer_store_dwordx4 v[172:175], v1, s[4:7], s87 offen offset:2048 sc1
v_mfma_f32_16x16x32_bf16 v[216:219], v[48:51], a[156:159], v[216:219]
v_cvt_pk_bf16_f32 v176, v176, v177
v_cvt_pk_bf16_f32 v177, v178, v179
v_mfma_f32_16x16x32_bf16 v[216:219], v[44:47], a[140:143], v[216:219]
s_waitcnt lgkmcnt(6)
v_cvt_pk_bf16_f32 v178, v192, v193
v_cvt_pk_bf16_f32 v179, v194, v195
v_mfma_f32_16x16x32_bf16 v[220:223], v[60:63], a[128:131], v[220:223]
s_waitcnt lgkmcnt(4)
ds_read_b64_tr_b16 v[44:45], v28 offset:49152
v_mfma_f32_16x16x32_bf16 v[220:223], v[64:67], a[144:147], v[220:223]
s_waitcnt lgkmcnt(3)
buffer_store_dwordx4 v[176:179], v1, s[4:7], s93 offen offset:2048 sc1
v_mfma_f32_16x16x32_bf16 v[220:223], v[68:71], a[160:163], v[220:223]
s_waitcnt lgkmcnt(1)
ds_read_b64_tr_b16 v[46:47], v28 offset:53248
v_cvt_pk_bf16_f32 v180, v180, v181
v_mfma_f32_16x16x32_bf16 v[220:223], v[72:75], a[176:179], v[220:223]
v_cvt_pk_bf16_f32 v181, v182, v183
v_cvt_pk_bf16_f32 v182, v196, v197
v_mfma_f32_16x16x32_bf16 v[224:227], v[72:75], a[180:183], v[224:227]
ds_read_b64_tr_b16 v[48:49], v28 offset:57344
v_cvt_pk_bf16_f32 v183, v198, v199
v_mfma_f32_16x16x32_bf16 v[224:227], v[68:71], a[164:167], v[224:227]
buffer_store_dwordx4 v[180:183], v1, s[4:7], s88 offen offset:2048 sc1
v_mfma_f32_16x16x32_bf16 v[224:227], v[64:67], a[148:151], v[224:227]
ds_read_b64_tr_b16 v[50:51], v28 offset:61440
v_cvt_pk_bf16_f32 v184, v184, v185
v_mfma_f32_16x16x32_bf16 v[224:227], v[60:63], a[132:135], v[224:227]
v_cvt_pk_bf16_f32 v185, v186, v187
v_cvt_pk_bf16_f32 v186, v200, v201
v_mfma_f32_16x16x32_bf16 v[228:231], v[60:63], a[136:139], v[228:231]
ds_read_b64_tr_b16 v[52:53], v29 offset:49152
v_cvt_pk_bf16_f32 v187, v202, v203
v_mfma_f32_16x16x32_bf16 v[228:231], v[64:67], a[152:155], v[228:231]
buffer_store_dwordx4 v[184:187], v1, s[4:7], s89 offen offset:2048 sc1
v_mfma_f32_16x16x32_bf16 v[228:231], v[68:71], a[168:171], v[228:231]
ds_read_b64_tr_b16 v[54:55], v29 offset:53248
v_mfma_f32_16x16x32_bf16 v[228:231], v[72:75], a[184:187], v[228:231]
v_mfma_f32_16x16x32_bf16 v[232:235], v[72:75], a[188:191], v[232:235]
ds_read_b64_tr_b16 v[56:57], v29 offset:57344
v_mfma_f32_16x16x32_bf16 v[232:235], v[68:71], a[172:175], v[232:235]
v_mfma_f32_16x16x32_bf16 v[232:235], v[64:67], a[156:159], v[232:235]
ds_read_b64_tr_b16 v[58:59], v29 offset:61440
v_mfma_f32_16x16x32_bf16 v[232:235], v[60:63], a[140:143], v[232:235]
s_waitcnt lgkmcnt(6)
v_mfma_f32_16x16x32_bf16 v[108:111], v[44:47], a[160:163], v[108:111]
s_waitcnt lgkmcnt(4)
ds_read_b64_tr_b16 v[60:61], v30 offset:49152
v_mfma_f32_16x16x32_bf16 v[108:111], v[48:51], a[176:179], v[108:111]
v_mfma_f32_16x16x32_bf16 v[112:115], v[48:51], a[180:183], v[112:115]
ds_read_b64_tr_b16 v[62:63], v30 offset:53248
v_mfma_f32_16x16x32_bf16 v[112:115], v[44:47], a[164:167], v[112:115]
v_mfma_f32_16x16x32_bf16 v[116:119], v[44:47], a[168:171], v[116:119]
ds_read_b64_tr_b16 v[64:65], v30 offset:57344
v_mfma_f32_16x16x32_bf16 v[116:119], v[48:51], a[184:187], v[116:119]
v_mfma_f32_16x16x32_bf16 v[120:123], v[48:51], a[188:191], v[120:123]
ds_read_b64_tr_b16 v[66:67], v30 offset:61440
v_mfma_f32_16x16x32_bf16 v[120:123], v[44:47], a[172:175], v[120:123]
s_waitcnt lgkmcnt(6)
v_mfma_f32_16x16x32_bf16 v[124:127], v[52:55], a[160:163], v[124:127]
s_waitcnt lgkmcnt(4)
ds_read_b64_tr_b16 v[68:69], v31 offset:49152
v_cvt_pk_bf16_f32 v204, v204, v205
v_mfma_f32_16x16x32_bf16 v[124:127], v[56:59], a[176:179], v[124:127]
v_cvt_pk_bf16_f32 v205, v206, v207
v_cvt_pk_bf16_f32 v206, v220, v221
v_mfma_f32_16x16x32_bf16 v[128:131], v[56:59], a[180:183], v[128:131]
ds_read_b64_tr_b16 v[70:71], v31 offset:53248
v_cvt_pk_bf16_f32 v207, v222, v223
v_mfma_f32_16x16x32_bf16 v[128:131], v[52:55], a[164:167], v[128:131]
buffer_store_dwordx4 v[204:207], v1, s[4:7], s87 offen offset:3072 sc1
v_mfma_f32_16x16x32_bf16 v[132:135], v[52:55], a[168:171], v[132:135]
ds_read_b64_tr_b16 v[72:73], v31 offset:57344
v_cvt_pk_bf16_f32 v208, v208, v209
v_mfma_f32_16x16x32_bf16 v[132:135], v[56:59], a[184:187], v[132:135]
v_cvt_pk_bf16_f32 v209, v210, v211
v_cvt_pk_bf16_f32 v210, v224, v225
v_mfma_f32_16x16x32_bf16 v[136:139], v[56:59], a[188:191], v[136:139]
ds_read_b64_tr_b16 v[74:75], v31 offset:61440
v_cvt_pk_bf16_f32 v211, v226, v227
v_mfma_f32_16x16x32_bf16 v[136:139], v[52:55], a[172:175], v[136:139]
s_waitcnt lgkmcnt(6)
buffer_store_dwordx4 v[208:211], v1, s[4:7], s93 offen offset:3072 sc1
v_mfma_f32_16x16x32_bf16 v[140:143], v[60:63], a[160:163], v[140:143]
s_waitcnt lgkmcnt(4)
v_cvt_pk_bf16_f32 v212, v212, v213
v_cvt_pk_bf16_f32 v213, v214, v215
v_mfma_f32_16x16x32_bf16 v[140:143], v[64:67], a[176:179], v[140:143]
v_cvt_pk_bf16_f32 v214, v228, v229
v_cvt_pk_bf16_f32 v215, v230, v231
v_mfma_f32_16x16x32_bf16 v[144:147], v[64:67], a[180:183], v[144:147]
buffer_store_dwordx4 v[212:215], v1, s[4:7], s88 offen offset:3072 sc1
v_mfma_f32_16x16x32_bf16 v[144:147], v[60:63], a[164:167], v[144:147]
v_cvt_pk_bf16_f32 v216, v216, v217
v_cvt_pk_bf16_f32 v217, v218, v219
v_mfma_f32_16x16x32_bf16 v[148:151], v[60:63], a[168:171], v[148:151]
v_cvt_pk_bf16_f32 v218, v232, v233
v_cvt_pk_bf16_f32 v219, v234, v235
v_mfma_f32_16x16x32_bf16 v[148:151], v[64:67], a[184:187], v[148:151]
buffer_store_dwordx4 v[216:219], v1, s[4:7], s89 offen offset:3072 sc1
v_mfma_f32_16x16x32_bf16 v[152:155], v[64:67], a[188:191], v[152:155]
v_mfma_f32_16x16x32_bf16 v[152:155], v[60:63], a[172:175], v[152:155]
s_waitcnt lgkmcnt(2)
v_mfma_f32_16x16x32_bf16 v[156:159], v[68:71], a[160:163], v[156:159]
s_waitcnt lgkmcnt(0)
v_cvt_pk_bf16_f32 v108, v108, v109
v_cvt_pk_bf16_f32 v109, v110, v111
v_mfma_f32_16x16x32_bf16 v[156:159], v[72:75], a[176:179], v[156:159]
v_cvt_pk_bf16_f32 v110, v124, v125
v_cvt_pk_bf16_f32 v111, v126, v127
v_mfma_f32_16x16x32_bf16 v[160:163], v[72:75], a[180:183], v[160:163]
buffer_store_dwordx4 v[108:111], v1, s[4:7], s87 offen offset:0 sc1
v_mfma_f32_16x16x32_bf16 v[160:163], v[68:71], a[164:167], v[160:163]
v_cvt_pk_bf16_f32 v112, v112, v113
v_cvt_pk_bf16_f32 v113, v114, v115
v_mfma_f32_16x16x32_bf16 v[164:167], v[68:71], a[168:171], v[164:167]
v_cvt_pk_bf16_f32 v114, v128, v129
v_cvt_pk_bf16_f32 v115, v130, v131
v_mfma_f32_16x16x32_bf16 v[164:167], v[72:75], a[184:187], v[164:167]
buffer_store_dwordx4 v[112:115], v1, s[4:7], s93 offen offset:0 sc1
v_mfma_f32_16x16x32_bf16 v[168:171], v[72:75], a[188:191], v[168:171]
v_cvt_pk_bf16_f32 v116, v116, v117
v_cvt_pk_bf16_f32 v117, v118, v119
v_mfma_f32_16x16x32_bf16 v[168:171], v[68:71], a[172:175], v[168:171]
v_cvt_pk_bf16_f32 v118, v132, v133
v_cvt_pk_bf16_f32 v119, v134, v135
buffer_store_dwordx4 v[116:119], v1, s[4:7], s88 offen offset:0 sc1
v_cvt_pk_bf16_f32 v120, v120, v121
v_cvt_pk_bf16_f32 v121, v122, v123
v_cvt_pk_bf16_f32 v122, v136, v137
v_cvt_pk_bf16_f32 v123, v138, v139
buffer_store_dwordx4 v[120:123], v1, s[4:7], s89 offen offset:0 sc1
v_cvt_pk_bf16_f32 v140, v140, v141
v_cvt_pk_bf16_f32 v141, v142, v143
v_cvt_pk_bf16_f32 v142, v156, v157
v_cvt_pk_bf16_f32 v143, v158, v159
buffer_store_dwordx4 v[140:143], v1, s[4:7], s87 offen offset:1024 sc1
v_cvt_pk_bf16_f32 v144, v144, v145
v_cvt_pk_bf16_f32 v145, v146, v147
v_cvt_pk_bf16_f32 v146, v160, v161
v_cvt_pk_bf16_f32 v147, v162, v163
buffer_store_dwordx4 v[144:147], v1, s[4:7], s93 offen offset:1024 sc1
v_cvt_pk_bf16_f32 v148, v148, v149
v_cvt_pk_bf16_f32 v149, v150, v151
v_cvt_pk_bf16_f32 v150, v164, v165
v_cvt_pk_bf16_f32 v151, v166, v167
buffer_store_dwordx4 v[148:151], v1, s[4:7], s88 offen offset:1024 sc1
v_cvt_pk_bf16_f32 v152, v152, v153
v_cvt_pk_bf16_f32 v153, v154, v155
v_cvt_pk_bf16_f32 v154, v168, v169
v_cvt_pk_bf16_f32 v155, v170, v171
buffer_store_dwordx4 v[152:155], v1, s[4:7], s89 offen offset:1024 sc1
v_and_b32 v38, 1, v0
v_lshlrev_b32 v38, 12, v38
s_waitcnt vmcnt(0)
s_mov_b64 exec, 3
buffer_atomic_add v43, v38, s[4:7], s86 offen sc1
s_mov_b64 exec, -1
s_waitcnt vmcnt(0)
s_endpgm
L2_G:
v_mfma_f32_16x16x32_bf16 v[172:175], a[0:3], a[128:131], v[172:175]
s_waitcnt lgkmcnt(7)
s_and_b32 s66, s60, 1
ds_read_b64_tr_b16 a[16:17], v33 offset:0
v_mfma_f32_16x16x32_bf16 v[172:175], a[4:7], a[144:147], v[172:175]
s_waitcnt lgkmcnt(5)
buffer_load_dwordx4 v4, s[8:11], s39 offen offset:2048 lds
v_mfma_f32_16x16x32_bf16 v[172:175], a[8:11], a[160:163], v[172:175]
s_waitcnt lgkmcnt(3)
s_lshl_b32 s66, s66, 1
ds_read_b64_tr_b16 a[18:19], v33 offset:1024
v_mfma_f32_16x16x32_bf16 v[172:175], a[12:15], a[176:179], v[172:175]
s_and_b32 s54, s61, 1
v_bfe_u32 v72, v0, 3, 1
v_and_b32 v73, 7, v0
v_mfma_f32_16x16x32_bf16 v[176:179], a[12:15], a[180:183], v[176:179]
s_add_u32 s66, s66, s54
ds_read_b64_tr_b16 a[20:21], v33 offset:8192
s_lshl_b32 s54, s66, 8
v_mfma_f32_16x16x32_bf16 v[176:179], a[8:11], a[164:167], v[176:179]
s_add_u32 s84, s54, 41951232
buffer_load_dwordx4 v5, s[8:11], s39 offen offset:3072 lds
v_mfma_f32_16x16x32_bf16 v[176:179], a[4:7], a[148:151], v[176:179]
s_lshr_b32 s54, s60, 1
s_add_u32 s39, s39, 524288
ds_read_b64_tr_b16 a[22:23], v33 offset:9216
v_mfma_f32_16x16x32_bf16 v[176:179], a[0:3], a[132:135], v[176:179]
s_mul_i32 s54, s54, 7
v_lshlrev_b32 v72, 7, v72
v_lshl_add_u32 v72, v73, 3, v72
v_smfmac_f32_16x16x64_bf16 v[52:55], v[44:47], a[0:7], v48
s_lshr_b32 s67, s61, 1
s_add_u32 s54, s54, s67
s_add_u32 s67, s67, s61
v_mfma_f32_16x16x32_bf16 v[180:183], a[0:3], a[136:139], v[180:183]
s_and_b32 s67, s67, 1
s_add_u32 m0, s37, 32768
ds_read_b64_tr_b16 a[24:25], v33 offset:16384
v_mfma_f32_16x16x32_bf16 v[180:183], a[4:7], a[152:155], v[180:183]
s_mul_i32 s80, s54, 256
buffer_load_dwordx4 v60, s[68:71], s40 offen offset:0 lds
v_mfma_f32_16x16x32_bf16 v[180:183], a[8:11], a[168:171], v[180:183]
s_and_b32 s88, s54, 0
ds_read_b64_tr_b16 a[26:27], v33 offset:17408
s_lshl_b32 s43, s88, 5
v_mfma_f32_16x16x32_bf16 v[180:183], a[12:15], a[184:187], v[180:183]
s_waitcnt lgkmcnt(6)
s_add_u32 s43, s43, s80
ds_read_b64_tr_b16 a[28:29], v33 offset:24576
v_mfma_f32_16x16x32_bf16 v[184:187], a[12:15], a[188:191], v[184:187]
s_mul_i32 s95, s88, -224
ds_read_b64_tr_b16 a[30:31], v33 offset:25600
s_add_u32 s95, s95, s43
v_mfma_f32_16x16x32_bf16 v[184:187], a[8:11], a[172:175], v[184:187]
s_mul_i32 s46, s54, 8
buffer_load_dwordx4 v61, s[68:71], s40 offen offset:1024 lds
v_mfma_f32_16x16x32_bf16 v[184:187], a[4:7], a[156:159], v[184:187]
s_add_u32 s46, s46, s88
s_lshl_b32 s46, s46, 10
s_mul_i32 s44, s88, -8184
v_mfma_f32_16x16x32_bf16 v[184:187], a[0:3], a[140:143], v[184:187]
s_add_u32 s44, s44, 6144
s_lshl_b32 s100, s63, 10
s_lshl_b32 s88, s88, 1
v_smfmac_f32_16x16x64_bf16 v[52:55], v[44:47], a[8:15], v48
s_waitcnt lgkmcnt(6)
s_lshl_b32 s54, s66, 2
s_add_u32 s54, s54, s36
v_mfma_f32_16x16x32_bf16 v[188:191], a[16:19], a[128:131], v[188:191]
s_waitcnt lgkmcnt(4)
s_lshl_b32 s81, s54, 18
ds_read_b64_tr_b16 a[0:1], v34 offset:0
v_mfma_f32_16x16x32_bf16 v[188:191], a[20:23], a[144:147], v[188:191]
s_waitcnt lgkmcnt(3)
buffer_load_dwordx4 v62, s[68:71], s40 offen offset:2048 lds
v_mfma_f32_16x16x32_bf16 v[188:191], a[24:27], a[160:163], v[188:191]
s_waitcnt lgkmcnt(1)
s_add_u32 s81, s81, 4194304
ds_read_b64_tr_b16 a[2:3], v34 offset:1024
v_mfma_f32_16x16x32_bf16 v[188:191], a[28:31], a[176:179], v[188:191]
s_mul_i32 s54, s54, 458752
s_add_u32 s46, s46, s54
s_add_u32 s46, s46, 8388608
v_mfma_f32_16x16x32_bf16 v[192:195], a[28:31], a[180:183], v[192:195]
s_movk_i32 s90, 7168
ds_read_b64_tr_b16 a[4:5], v34 offset:8192
v_mfma_f32_16x16x32_bf16 v[192:195], a[24:27], a[164:167], v[192:195]
buffer_load_dwordx4 v63, s[68:71], s40 offen offset:3072 lds
v_mfma_f32_16x16x32_bf16 v[192:195], a[20:23], a[148:151], v[192:195]
s_add_u32 s40, s40, 128
ds_read_b64_tr_b16 a[6:7], v34 offset:9216
v_mfma_f32_16x16x32_bf16 v[192:195], a[16:19], a[132:135], v[192:195]
s_cmp_lg_u32 s67, 0
s_cselect_b32 s54, -1, 1
s_cselect_b32 s55, 3, 1
v_smfmac_f32_16x16x64_bf16 v[56:59], v[44:47], a[16:23], v48
s_mul_i32 s76, s54, 458752
s_mul_i32 s77, s55, 458752
s_mul_i32 s78, s54, 8192
v_mfma_f32_16x16x32_bf16 v[196:199], a[16:19], a[136:139], v[196:199]
s_mul_i32 s79, s55, 8192
s_add_u32 m0, s37, 49152
ds_read_b64_tr_b16 a[8:9], v34 offset:16384
v_mfma_f32_16x16x32_bf16 v[196:199], a[20:23], a[152:155], v[196:199]
s_mul_i32 s54, s67, 458752
buffer_load_dwordx4 v60, s[68:71], s3 offen offset:0 lds
v_mfma_f32_16x16x32_bf16 v[196:199], a[24:27], a[168:171], v[196:199]
s_add_u32 s80, s80, s54
ds_read_b64_tr_b16 a[10:11], v34 offset:17408
s_mul_i32 s54, s67, 8192
v_mfma_f32_16x16x32_bf16 v[196:199], a[28:31], a[184:187], v[196:199]
s_add_u32 s81, s81, s54
ds_read_b64_tr_b16 a[12:13], v34 offset:24576
v_bfe_u32 v38, v0, 4, 2
v_mfma_f32_16x16x32_bf16 v[200:203], a[28:31], a[188:191], v[200:203]
ds_read_b64_tr_b16 a[14:15], v34 offset:25600
v_lshrrev_b32 v39, 6, v0
v_mfma_f32_16x16x32_bf16 v[200:203], a[24:27], a[172:175], v[200:203]
buffer_load_dwordx4 v61, s[68:71], s3 offen offset:1024 lds
v_mfma_f32_16x16x32_bf16 v[200:203], a[20:23], a[156:159], v[200:203]
v_lshl_add_u32 v39, v39, 4, v38
v_and_b32 v41, 15, v0
v_mfma_f32_16x16x32_bf16 v[200:203], a[16:19], a[140:143], v[200:203]
v_add_u32 v6, 0, v39
v_mul_u32_u24 v6, s90, v6
v_smfmac_f32_16x16x64_bf16 v[56:59], v[44:47], a[24:31], v48
s_waitcnt lgkmcnt(6)
v_or_b32 v40, 0, v38
v_lshlrev_b32 v40, 1, v40
v_mfma_f32_16x16x32_bf16 v[204:207], a[0:3], a[128:131], v[204:207]
s_waitcnt lgkmcnt(4)
ds_read_b64_tr_b16 a[16:17], v35 offset:0
v_xor_b32 v40, v40, v41
v_mfma_f32_16x16x32_bf16 v[204:207], a[4:7], a[144:147], v[204:207]
s_waitcnt lgkmcnt(3)
buffer_load_dwordx4 v62, s[68:71], s3 offen offset:2048 lds
v_mfma_f32_16x16x32_bf16 v[204:207], a[8:11], a[160:163], v[204:207]
s_waitcnt lgkmcnt(1)
ds_read_b64_tr_b16 a[18:19], v35 offset:1024
v_lshl_add_u32 v6, v40, 4, v6
v_mfma_f32_16x16x32_bf16 v[204:207], a[12:15], a[176:179], v[204:207]
s_waitcnt vmcnt(18)
ds_read_b128 a[192:195], v64 offset:32768
v_add_u32 v7, 4, v39
v_mfma_f32_16x16x32_bf16 v[208:211], a[12:15], a[180:183], v[208:211]
ds_read_b64_tr_b16 a[20:21], v35 offset:8192
v_mul_u32_u24 v7, s90, v7
v_mfma_f32_16x16x32_bf16 v[208:211], a[8:11], a[164:167], v[208:211]
buffer_load_dwordx4 v63, s[68:71], s3 offen offset:3072 lds
v_mfma_f32_16x16x32_bf16 v[208:211], a[4:7], a[148:151], v[208:211]
s_add_u32 s3, s3, 128
ds_read_b64_tr_b16 a[22:23], v35 offset:9216
v_or_b32 v40, 0, v38
v_mfma_f32_16x16x32_bf16 v[208:211], a[0:3], a[132:135], v[208:211]
ds_read_b128 a[208:211], v65 offset:32768
v_lshlrev_b32 v40, 1, v40
v_mfma_f32_16x16x32_bf16 v[212:215], a[0:3], a[136:139], v[212:215]
ds_read_b64_tr_b16 a[24:25], v35 offset:16384
v_xor_b32 v40, v40, v41
v_mfma_f32_16x16x32_bf16 v[212:215], a[4:7], a[152:155], v[212:215]
v_cmp_gt_u32 vcc, s101, v75
v_lshl_add_u32 v7, v40, 4, v7
v_mfma_f32_16x16x32_bf16 v[212:215], a[8:11], a[168:171], v[212:215]
ds_read_b64_tr_b16 a[26:27], v35 offset:17408
v_subrev_u32 v7, 1024, v7
v_mfma_f32_16x16x32_bf16 v[212:215], a[12:15], a[184:187], v[212:215]
ds_read_b64_tr_b16 a[28:29], v35 offset:24576
v_add_u32 v8, 8, v39
v_mfma_f32_16x16x32_bf16 v[216:219], a[12:15], a[188:191], v[216:219]
ds_read_b64_tr_b16 a[30:31], v35 offset:25600
v_mul_u32_u24 v8, s90, v8
v_mfma_f32_16x16x32_bf16 v[216:219], a[8:11], a[172:175], v[216:219]
s_cbranch_vccnz L2_wb
L2_wb_r:
v_or_b32 v40, 4, v38
v_lshlrev_b32 v40, 1, v40
v_mfma_f32_16x16x32_bf16 v[216:219], a[4:7], a[156:159], v[216:219]
s_waitcnt vmcnt(17)
ds_read_b128 a[196:199], v64 offset:34816
v_xor_b32 v40, v40, v41
v_mfma_f32_16x16x32_bf16 v[216:219], a[0:3], a[140:143], v[216:219]
s_waitcnt lgkmcnt(9)
ds_read_b128 a[212:215], v65 offset:34816
v_lshl_add_u32 v8, v40, 4, v8
v_mfma_f32_16x16x32_bf16 v[220:223], a[16:19], a[128:131], v[220:223]
s_waitcnt lgkmcnt(7)
ds_read_b64_tr_b16 a[0:1], v28 offset:16384
v_subrev_u32 v8, 2048, v8
v_mfma_f32_16x16x32_bf16 v[220:223], a[20:23], a[144:147], v[220:223]
s_waitcnt lgkmcnt(5)
v_add_u32 v9, 12, v39
v_mul_u32_u24 v9, s90, v9
v_mfma_f32_16x16x32_bf16 v[220:223], a[24:27], a[160:163], v[220:223]
s_waitcnt lgkmcnt(3)
ds_read_b64_tr_b16 a[2:3], v28 offset:17408
v_or_b32 v40, 4, v38
v_mfma_f32_16x16x32_bf16 v[220:223], a[28:31], a[176:179], v[220:223]
s_waitcnt vmcnt(15)
ds_read_b128 a[200:203], v64 offset:49152
v_lshlrev_b32 v40, 1, v40
v_mfma_f32_16x16x32_bf16 v[224:227], a[28:31], a[180:183], v[224:227]
ds_read_b64_tr_b16 a[4:5], v28 offset:24576
v_xor_b32 v40, v40, v41
v_mfma_f32_16x16x32_bf16 v[224:227], a[24:27], a[164:167], v[224:227]
v_lshl_add_u32 v9, v40, 4, v9
v_subrev_u32 v9, 3072, v9
v_mfma_f32_16x16x32_bf16 v[224:227], a[20:23], a[148:151], v[224:227]
ds_read_b64_tr_b16 a[6:7], v28 offset:25600
v_bfe_u32 v252, v0, 4, 2
v_mfma_f32_16x16x32_bf16 v[224:227], a[16:19], a[132:135], v[224:227]
ds_read_b128 a[216:219], v65 offset:49152
s_barrier
v_mfma_f32_16x16x32_bf16 v[228:231], a[16:19], a[136:139], v[228:231]
s_add_u32 m0, s37, 98304
ds_read_b64_tr_b16 a[8:9], v28 offset:32768
v_lshlrev_b32 v252, 3, v252
v_mfma_f32_16x16x32_bf16 v[228:231], a[20:23], a[152:155], v[228:231]
buffer_load_dwordx4 v6, s[20:23], s80 offen offset:0 lds
v_mfma_f32_16x16x32_bf16 v[228:231], a[24:27], a[168:171], v[228:231]
ds_read_b64_tr_b16 a[10:11], v28 offset:33792
v_mfma_f32_16x16x32_bf16 v[228:231], a[28:31], a[184:187], v[228:231]
ds_read_b64_tr_b16 a[12:13], v28 offset:40960
v_mfma_f32_16x16x32_bf16 v[232:235], a[28:31], a[188:191], v[232:235]
ds_read_b64_tr_b16 a[14:15], v28 offset:41984
v_mfma_f32_16x16x32_bf16 v[232:235], a[24:27], a[172:175], v[232:235]
buffer_load_dwordx4 v7, s[20:23], s80 offen offset:1024 lds
v_mfma_f32_16x16x32_bf16 v[232:235], a[20:23], a[156:159], v[232:235]
s_waitcnt vmcnt(15)
ds_read_b128 a[204:207], v64 offset:51200
v_mfma_f32_16x16x32_bf16 v[232:235], a[16:19], a[140:143], v[232:235]
s_waitcnt lgkmcnt(9)
ds_read_b128 a[220:223], v65 offset:51200
v_mfma_f32_16x16x32_bf16 v[108:111], a[0:3], a[160:163], v[108:111]
s_waitcnt lgkmcnt(7)
ds_read_b64_tr_b16 a[16:17], v29 offset:16384
v_mfma_f32_16x16x32_bf16 v[108:111], a[4:7], a[176:179], v[108:111]
s_waitcnt lgkmcnt(5)
buffer_load_dwordx4 v8, s[20:23], s80 offen offset:2048 lds
v_mfma_f32_16x16x32_bf16 v[108:111], a[8:11], a[192:195], v[108:111]
s_waitcnt lgkmcnt(3)
ds_read_b64_tr_b16 a[18:19], v29 offset:17408
v_mfma_f32_16x16x32_bf16 v[108:111], a[12:15], a[208:211], v[108:111]
buffer_load_dwordx2 v[236:237], v252, s[32:35], s43 offen offset:0
v_mfma_f32_16x16x32_bf16 v[112:115], a[12:15], a[212:215], v[112:115]
ds_read_b64_tr_b16 a[20:21], v29 offset:24576
v_mfma_f32_16x16x32_bf16 v[112:115], a[8:11], a[196:199], v[112:115]
buffer_load_dwordx4 v9, s[20:23], s80 offen offset:3072 lds
v_mfma_f32_16x16x32_bf16 v[112:115], a[4:7], a[180:183], v[112:115]
s_add_u32 s80, s80, s76
ds_read_b64_tr_b16 a[22:23], v29 offset:25600
v_mfma_f32_16x16x32_bf16 v[112:115], a[0:3], a[164:167], v[112:115]
buffer_load_dwordx2 v[238:239], v252, s[32:35], s43 offen offset:32
v_mfma_f32_16x16x32_bf16 v[116:119], a[0:3], a[168:171], v[116:119]
ds_read_b64_tr_b16 a[24:25], v29 offset:32768
v_mfma_f32_16x16x32_bf16 v[116:119], a[4:7], a[184:187], v[116:119]
buffer_load_dwordx4 a[128:131], v1, s[4:7], s81 offen offset:0 sc1
v_mfma_f32_16x16x32_bf16 v[116:119], a[8:11], a[200:203], v[116:119]
ds_read_b64_tr_b16 a[26:27], v29 offset:33792
v_mfma_f32_16x16x32_bf16 v[116:119], a[12:15], a[216:219], v[116:119]
s_waitcnt lgkmcnt(6)
ds_read_b64_tr_b16 a[28:29], v29 offset:40960
v_mfma_f32_16x16x32_bf16 v[120:123], a[12:15], a[220:223], v[120:123]
ds_read_b64_tr_b16 a[30:31], v29 offset:41984
v_mfma_f32_16x16x32_bf16 v[120:123], a[8:11], a[204:207], v[120:123]
buffer_load_dwordx4 a[132:135], v1, s[4:7], s81 offen offset:1024 sc1
v_mfma_f32_16x16x32_bf16 v[120:123], a[4:7], a[188:191], v[120:123]
buffer_load_dwordx2 v[240:241], v252, s[32:35], s43 offen offset:64
v_mfma_f32_16x16x32_bf16 v[120:123], a[0:3], a[172:175], v[120:123]
s_waitcnt lgkmcnt(6)
buffer_load_dwordx2 v[242:243], v252, s[32:35], s43 offen offset:96
v_mfma_f32_16x16x32_bf16 v[124:127], a[16:19], a[160:163], v[124:127]
s_waitcnt lgkmcnt(4)
ds_read_b64_tr_b16 a[0:1], v30 offset:16384
v_mfma_f32_16x16x32_bf16 v[124:127], a[20:23], a[176:179], v[124:127]
s_waitcnt lgkmcnt(3)
buffer_load_dwordx4 a[136:139], v1, s[4:7], s81 offen offset:2048 sc1
v_mfma_f32_16x16x32_bf16 v[124:127], a[24:27], a[192:195], v[124:127]
s_waitcnt lgkmcnt(1)
ds_read_b64_tr_b16 a[2:3], v30 offset:17408
v_mfma_f32_16x16x32_bf16 v[124:127], a[28:31], a[208:211], v[124:127]
buffer_load_dwordx2 v[244:245], v252, s[32:35], s43 offen offset:128
v_mfma_f32_16x16x32_bf16 v[128:131], a[28:31], a[212:215], v[128:131]
ds_read_b64_tr_b16 a[4:5], v30 offset:24576
v_mfma_f32_16x16x32_bf16 v[128:131], a[24:27], a[196:199], v[128:131]
buffer_load_dwordx4 a[140:143], v1, s[4:7], s81 offen offset:3072 sc1
v_mfma_f32_16x16x32_bf16 v[128:131], a[20:23], a[180:183], v[128:131]
ds_read_b64_tr_b16 a[6:7], v30 offset:25600
v_mfma_f32_16x16x32_bf16 v[128:131], a[16:19], a[164:167], v[128:131]
buffer_load_dwordx2 v[246:247], v252, s[32:35], s43 offen offset:160
v_mfma_f32_16x16x32_bf16 v[132:135], a[16:19], a[168:171], v[132:135]
ds_read_b64_tr_b16 a[8:9], v30 offset:32768
v_mfma_f32_16x16x32_bf16 v[132:135], a[20:23], a[184:187], v[132:135]
buffer_load_dwordx4 a[144:147], v253, s[4:7], s81 offen offset:0 sc1
v_mfma_f32_16x16x32_bf16 v[132:135], a[24:27], a[200:203], v[132:135]
ds_read_b64_tr_b16 a[10:11], v30 offset:33792
v_mfma_f32_16x16x32_bf16 v[132:135], a[28:31], a[216:219], v[132:135]
ds_read_b64_tr_b16 a[12:13], v30 offset:40960
v_mfma_f32_16x16x32_bf16 v[136:139], a[28:31], a[220:223], v[136:139]
ds_read_b64_tr_b16 a[14:15], v30 offset:41984
v_mfma_f32_16x16x32_bf16 v[136:139], a[24:27], a[204:207], v[136:139]
buffer_load_dwordx4 a[148:151], v253, s[4:7], s81 offen offset:1024 sc1
v_mfma_f32_16x16x32_bf16 v[136:139], a[20:23], a[188:191], v[136:139]
buffer_load_dwordx2 v[248:249], v252, s[32:35], s95 offen offset:192
v_mfma_f32_16x16x32_bf16 v[136:139], a[16:19], a[172:175], v[136:139]
s_waitcnt lgkmcnt(6)
buffer_load_dwordx2 v[250:251], v252, s[32:35], s95 offen offset:224
v_mfma_f32_16x16x32_bf16 v[140:143], a[0:3], a[160:163], v[140:143]
s_waitcnt lgkmcnt(4)
ds_read_b64_tr_b16 a[16:17], v31 offset:16384
v_mfma_f32_16x16x32_bf16 v[140:143], a[4:7], a[176:179], v[140:143]
s_waitcnt lgkmcnt(3)
buffer_load_dwordx4 a[152:155], v253, s[4:7], s81 offen offset:2048 sc1
v_mfma_f32_16x16x32_bf16 v[140:143], a[8:11], a[192:195], v[140:143]
s_waitcnt lgkmcnt(1)
ds_read_b64_tr_b16 a[18:19], v31 offset:17408
v_mfma_f32_16x16x32_bf16 v[140:143], a[12:15], a[208:211], v[140:143]
s_waitcnt vmcnt(25)
ds_read_b128 a[224:227], v64 offset:0
v_mfma_f32_16x16x32_bf16 v[144:147], a[12:15], a[212:215], v[144:147]
ds_read_b64_tr_b16 a[20:21], v31 offset:24576
v_mfma_f32_16x16x32_bf16 v[144:147], a[8:11], a[196:199], v[144:147]
buffer_load_dwordx4 a[156:159], v253, s[4:7], s81 offen offset:3072 sc1
v_mfma_f32_16x16x32_bf16 v[144:147], a[4:7], a[180:183], v[144:147]
s_add_u32 s81, s81, s78
ds_read_b64_tr_b16 a[22:23], v31 offset:25600
v_mfma_f32_16x16x32_bf16 v[144:147], a[0:3], a[164:167], v[144:147]
ds_read_b128 a[240:243], v65 offset:0
v_mfma_f32_16x16x32_bf16 v[148:151], a[0:3], a[168:171], v[148:151]
ds_read_b64_tr_b16 a[24:25], v31 offset:32768
v_mfma_f32_16x16x32_bf16 v[148:151], a[4:7], a[184:187], v[148:151]
buffer_load_dwordx2 v[10:11], v72, s[4:7], s100 offen offset:0 sc1
v_mfma_f32_16x16x32_bf16 v[148:151], a[8:11], a[200:203], v[148:151]
ds_read_b64_tr_b16 a[26:27], v31 offset:33792
v_mfma_f32_16x16x32_bf16 v[148:151], a[12:15], a[216:219], v[148:151]
ds_read_b64_tr_b16 a[28:29], v31 offset:40960
v_mfma_f32_16x16x32_bf16 v[152:155], a[12:15], a[220:223], v[152:155]
ds_read_b64_tr_b16 a[30:31], v31 offset:41984
v_mfma_f32_16x16x32_bf16 v[152:155], a[8:11], a[204:207], v[152:155]
buffer_load_dwordx2 v[12:13], v72, s[4:7], s100 offen offset:256 sc1
v_mfma_f32_16x16x32_bf16 v[152:155], a[4:7], a[188:191], v[152:155]
s_waitcnt vmcnt(26)
ds_read_b128 a[228:231], v64 offset:2048
v_mfma_f32_16x16x32_bf16 v[152:155], a[0:3], a[172:175], v[152:155]
s_waitcnt lgkmcnt(9)
ds_read_b128 a[244:247], v65 offset:2048
v_mfma_f32_16x16x32_bf16 v[156:159], a[16:19], a[160:163], v[156:159]
s_waitcnt lgkmcnt(7)
ds_read_b64_tr_b16 a[0:1], v32 offset:32768
v_mfma_f32_16x16x32_bf16 v[156:159], a[20:23], a[176:179], v[156:159]
s_waitcnt lgkmcnt(5)
buffer_load_dwordx2 v[14:15], v72, s[4:7], s100 offen offset:512 sc1
v_mfma_f32_16x16x32_bf16 v[156:159], a[24:27], a[192:195], v[156:159]
s_waitcnt lgkmcnt(3)
ds_read_b64_tr_b16 a[2:3], v32 offset:33792
v_mfma_f32_16x16x32_bf16 v[156:159], a[28:31], a[208:211], v[156:159]
s_waitcnt vmcnt(25)
ds_read_b128 a[232:235], v64 offset:16384
v_mfma_f32_16x16x32_bf16 v[160:163], a[28:31], a[212:215], v[160:163]
ds_read_b64_tr_b16 a[4:5], v32 offset:40960
v_mfma_f32_16x16x32_bf16 v[160:163], a[24:27], a[196:199], v[160:163]
buffer_load_dwordx2 v[16:17], v72, s[4:7], s100 offen offset:768 sc1
v_mfma_f32_16x16x32_bf16 v[160:163], a[20:23], a[180:183], v[160:163]
ds_read_b64_tr_b16 a[6:7], v32 offset:41984
v_mfma_f32_16x16x32_bf16 v[160:163], a[16:19], a[164:167], v[160:163]
ds_read_b128 a[248:251], v65 offset:16384
s_barrier
v_mfma_f32_16x16x32_bf16 v[164:167], a[16:19], a[168:171], v[164:167]
s_add_u32 m0, s37, 114688
ds_read_b64_tr_b16 a[8:9], v32 offset:49152
v_mfma_f32_16x16x32_bf16 v[164:167], a[20:23], a[184:187], v[164:167]
buffer_load_dwordx4 v6, s[20:23], s80 offen offset:0 lds
v_mfma_f32_16x16x32_bf16 v[164:167], a[24:27], a[200:203], v[164:167]
ds_read_b64_tr_b16 a[10:11], v32 offset:50176
v_mfma_f32_16x16x32_bf16 v[164:167], a[28:31], a[216:219], v[164:167]
ds_read_b64_tr_b16 a[12:13], v32 offset:57344
v_mfma_f32_16x16x32_bf16 v[168:171], a[28:31], a[220:223], v[168:171]
ds_read_b64_tr_b16 a[14:15], v32 offset:58368
v_mfma_f32_16x16x32_bf16 v[168:171], a[24:27], a[204:207], v[168:171]
buffer_load_dwordx4 v7, s[20:23], s80 offen offset:1024 lds
v_mfma_f32_16x16x32_bf16 v[168:171], a[20:23], a[188:191], v[168:171]
s_waitcnt vmcnt(26)
ds_read_b128 a[236:239], v64 offset:18432
v_mfma_f32_16x16x32_bf16 v[168:171], a[16:19], a[172:175], v[168:171]
s_waitcnt lgkmcnt(9)
ds_read_b128 a[252:255], v65 offset:18432
v_mfma_f32_16x16x32_bf16 v[172:175], a[0:3], a[192:195], v[172:175]
s_waitcnt lgkmcnt(7)
ds_read_b64_tr_b16 a[16:17], v33 offset:32768
v_mfma_f32_16x16x32_bf16 v[172:175], a[4:7], a[208:211], v[172:175]
s_waitcnt lgkmcnt(5)
buffer_load_dwordx4 v8, s[20:23], s80 offen offset:2048 lds
v_mfma_f32_16x16x32_bf16 v[172:175], a[8:11], a[224:227], v[172:175]
s_waitcnt lgkmcnt(3)
ds_read_b64_tr_b16 a[18:19], v33 offset:33792
v_mfma_f32_16x16x32_bf16 v[172:175], a[12:15], a[240:243], v[172:175]
v_mfma_f32_16x16x32_bf16 v[176:179], a[12:15], a[244:247], v[176:179]
ds_read_b64_tr_b16 a[20:21], v33 offset:40960
v_mfma_f32_16x16x32_bf16 v[176:179], a[8:11], a[228:231], v[176:179]
buffer_load_dwordx4 v9, s[20:23], s80 offen offset:3072 lds
v_mfma_f32_16x16x32_bf16 v[176:179], a[4:7], a[212:215], v[176:179]
s_add_u32 s80, s80, s77
ds_read_b64_tr_b16 a[22:23], v33 offset:41984
v_mfma_f32_16x16x32_bf16 v[176:179], a[0:3], a[196:199], v[176:179]
v_smfmac_f32_16x16x64_bf16 v[52:55], v[44:47], a[0:7], v48
v_mfma_f32_16x16x32_bf16 v[180:183], a[0:3], a[200:203], v[180:183]
ds_read_b64_tr_b16 a[24:25], v33 offset:49152
v_mfma_f32_16x16x32_bf16 v[180:183], a[4:7], a[216:219], v[180:183]
buffer_load_dwordx4 a[160:163], v1, s[4:7], s81 offen offset:0 sc1
v_mfma_f32_16x16x32_bf16 v[180:183], a[8:11], a[232:235], v[180:183]
ds_read_b64_tr_b16 a[26:27], v33 offset:50176
v_mfma_f32_16x16x32_bf16 v[180:183], a[12:15], a[248:251], v[180:183]
s_waitcnt lgkmcnt(6)
ds_read_b64_tr_b16 a[28:29], v33 offset:57344
v_mfma_f32_16x16x32_bf16 v[184:187], a[12:15], a[252:255], v[184:187]
ds_read_b64_tr_b16 a[30:31], v33 offset:58368
v_mfma_f32_16x16x32_bf16 v[184:187], a[8:11], a[236:239], v[184:187]
buffer_load_dwordx4 a[164:167], v1, s[4:7], s81 offen offset:1024 sc1
v_mfma_f32_16x16x32_bf16 v[184:187], a[4:7], a[220:223], v[184:187]
v_mfma_f32_16x16x32_bf16 v[184:187], a[0:3], a[204:207], v[184:187]
v_smfmac_f32_16x16x64_bf16 v[52:55], v[44:47], a[8:15], v48
s_waitcnt lgkmcnt(6)
v_mfma_f32_16x16x32_bf16 v[188:191], a[16:19], a[192:195], v[188:191]
s_waitcnt lgkmcnt(4)
ds_read_b64_tr_b16 a[0:1], v34 offset:32768
v_mfma_f32_16x16x32_bf16 v[188:191], a[20:23], a[208:211], v[188:191]
s_waitcnt lgkmcnt(3)
buffer_load_dwordx4 a[168:171], v1, s[4:7], s81 offen offset:2048 sc1
v_mfma_f32_16x16x32_bf16 v[188:191], a[24:27], a[224:227], v[188:191]
s_waitcnt lgkmcnt(1)
ds_read_b64_tr_b16 a[2:3], v34 offset:33792
v_mfma_f32_16x16x32_bf16 v[188:191], a[28:31], a[240:243], v[188:191]
v_mfma_f32_16x16x32_bf16 v[192:195], a[28:31], a[244:247], v[192:195]
ds_read_b64_tr_b16 a[4:5], v34 offset:40960
v_mfma_f32_16x16x32_bf16 v[192:195], a[24:27], a[228:231], v[192:195]
buffer_load_dwordx4 a[172:175], v1, s[4:7], s81 offen offset:3072 sc1
v_mfma_f32_16x16x32_bf16 v[192:195], a[20:23], a[212:215], v[192:195]
ds_read_b64_tr_b16 a[6:7], v34 offset:41984
v_mfma_f32_16x16x32_bf16 v[192:195], a[16:19], a[196:199], v[192:195]
v_smfmac_f32_16x16x64_bf16 v[56:59], v[44:47], a[16:23], v48
v_mfma_f32_16x16x32_bf16 v[196:199], a[16:19], a[200:203], v[196:199]
ds_read_b64_tr_b16 a[8:9], v34 offset:49152
v_mfma_f32_16x16x32_bf16 v[196:199], a[20:23], a[216:219], v[196:199]
buffer_load_dwordx4 a[176:179], v253, s[4:7], s81 offen offset:0 sc1
v_mfma_f32_16x16x32_bf16 v[196:199], a[24:27], a[232:235], v[196:199]
ds_read_b64_tr_b16 a[10:11], v34 offset:50176
v_mfma_f32_16x16x32_bf16 v[196:199], a[28:31], a[248:251], v[196:199]
ds_read_b64_tr_b16 a[12:13], v34 offset:57344
v_mfma_f32_16x16x32_bf16 v[200:203], a[28:31], a[252:255], v[200:203]
ds_read_b64_tr_b16 a[14:15], v34 offset:58368
v_mfma_f32_16x16x32_bf16 v[200:203], a[24:27], a[236:239], v[200:203]
buffer_load_dwordx4 a[180:183], v253, s[4:7], s81 offen offset:1024 sc1
v_mfma_f32_16x16x32_bf16 v[200:203], a[20:23], a[220:223], v[200:203]
v_mfma_f32_16x16x32_bf16 v[200:203], a[16:19], a[204:207], v[200:203]
v_smfmac_f32_16x16x64_bf16 v[56:59], v[44:47], a[24:31], v48
s_waitcnt lgkmcnt(6)
v_mfma_f32_16x16x32_bf16 v[204:207], a[0:3], a[192:195], v[204:207]
s_waitcnt lgkmcnt(4)
ds_read_b64_tr_b16 a[16:17], v35 offset:32768
v_mfma_f32_16x16x32_bf16 v[204:207], a[4:7], a[208:211], v[204:207]
s_waitcnt lgkmcnt(3)
buffer_load_dwordx4 a[184:187], v253, s[4:7], s81 offen offset:2048 sc1
v_mfma_f32_16x16x32_bf16 v[204:207], a[8:11], a[224:227], v[204:207]
s_waitcnt lgkmcnt(1)
ds_read_b64_tr_b16 a[18:19], v35 offset:33792
v_mfma_f32_16x16x32_bf16 v[204:207], a[12:15], a[240:243], v[204:207]
v_mfma_f32_16x16x32_bf16 v[208:211], a[12:15], a[244:247], v[208:211]
ds_read_b64_tr_b16 a[20:21], v35 offset:40960
v_mfma_f32_16x16x32_bf16 v[208:211], a[8:11], a[228:231], v[208:211]
buffer_load_dwordx4 a[188:191], v253, s[4:7], s81 offen offset:3072 sc1
v_mfma_f32_16x16x32_bf16 v[208:211], a[4:7], a[212:215], v[208:211]
s_add_u32 s81, s81, s79
ds_read_b64_tr_b16 a[22:23], v35 offset:41984
v_mfma_f32_16x16x32_bf16 v[208:211], a[0:3], a[196:199], v[208:211]
v_mfma_f32_16x16x32_bf16 v[212:215], a[0:3], a[200:203], v[212:215]
ds_read_b64_tr_b16 a[24:25], v35 offset:49152
v_mfma_f32_16x16x32_bf16 v[212:215], a[4:7], a[216:219], v[212:215]
v_mfma_f32_16x16x32_bf16 v[212:215], a[8:11], a[232:235], v[212:215]
ds_read_b64_tr_b16 a[26:27], v35 offset:50176
v_mfma_f32_16x16x32_bf16 v[212:215], a[12:15], a[248:251], v[212:215]
ds_read_b64_tr_b16 a[28:29], v35 offset:57344
v_mfma_f32_16x16x32_bf16 v[216:219], a[12:15], a[252:255], v[216:219]
ds_read_b64_tr_b16 a[30:31], v35 offset:58368
v_mfma_f32_16x16x32_bf16 v[216:219], a[8:11], a[236:239], v[216:219]
v_add_f32 v52, v52, v53
v_add_f32 v56, v56, v57
v_mfma_f32_16x16x32_bf16 v[216:219], a[4:7], a[220:223], v[216:219]
v_mfma_f32_16x16x32_bf16 v[216:219], a[0:3], a[204:207], v[216:219]
s_waitcnt lgkmcnt(6)
ds_write2_b32 v66, v52, v56 offset0:0 offset1:16
v_mfma_f32_16x16x32_bf16 v[220:223], a[16:19], a[192:195], v[220:223]
s_waitcnt lgkmcnt(5)
ds_read_b64_tr_b16 a[0:1], v28 offset:49152
v_mfma_f32_16x16x32_bf16 v[220:223], a[20:23], a[208:211], v[220:223]
s_waitcnt lgkmcnt(4)
v_mfma_f32_16x16x32_bf16 v[220:223], a[24:27], a[224:227], v[220:223]
s_waitcnt lgkmcnt(2)
ds_read_b64_tr_b16 a[2:3], v28 offset:50176
v_mfma_f32_16x16x32_bf16 v[220:223], a[28:31], a[240:243], v[220:223]
v_mfma_f32_16x16x32_bf16 v[224:227], a[28:31], a[244:247], v[224:227]
ds_read_b64_tr_b16 a[4:5], v28 offset:57344
v_mfma_f32_16x16x32_bf16 v[224:227], a[24:27], a[228:231], v[224:227]
v_mfma_f32_16x16x32_bf16 v[224:227], a[20:23], a[212:215], v[224:227]
ds_read_b64_tr_b16 a[6:7], v28 offset:58368
v_mfma_f32_16x16x32_bf16 v[224:227], a[16:19], a[196:199], v[224:227]
s_waitcnt vmcnt(31) lgkmcnt(4)
s_barrier
v_mfma_f32_16x16x32_bf16 v[228:231], a[16:19], a[200:203], v[228:231]
s_add_u32 m0, s37, 131072
ds_read_b64_tr_b16 a[8:9], v29 offset:49152
v_mfma_f32_16x16x32_bf16 v[228:231], a[20:23], a[216:219], v[228:231]
buffer_load_dwordx4 v6, s[20:23], s80 offen offset:0 lds
v_mfma_f32_16x16x32_bf16 v[228:231], a[24:27], a[232:235], v[228:231]
ds_read_b64_tr_b16 a[10:11], v29 offset:50176
v_mfma_f32_16x16x32_bf16 v[228:231], a[28:31], a[248:251], v[228:231]
ds_read_b128 v[76:79], v68 offset:0
v_mfma_f32_16x16x32_bf16 v[232:235], a[28:31], a[252:255], v[232:235]
ds_read_b64_tr_b16 a[12:13], v29 offset:57344
v_mfma_f32_16x16x32_bf16 v[232:235], a[24:27], a[236:239], v[232:235]
buffer_load_dwordx4 v7, s[20:23], s80 offen offset:1024 lds
v_mfma_f32_16x16x32_bf16 v[232:235], a[20:23], a[220:223], v[232:235]
ds_read_b64_tr_b16 a[14:15], v29 offset:58368
v_mfma_f32_16x16x32_bf16 v[232:235], a[16:19], a[204:207], v[232:235]
s_waitcnt lgkmcnt(7)
ds_read_b128 v[92:95], v68 offset:64
v_mfma_f32_16x16x32_bf16 v[108:111], a[0:3], a[224:227], v[108:111]
s_waitcnt lgkmcnt(6)
ds_read_b64_tr_b16 a[16:17], v30 offset:49152
v_mfma_f32_16x16x32_bf16 v[108:111], a[4:7], a[240:243], v[108:111]
buffer_load_dwordx4 v8, s[20:23], s80 offen offset:2048 lds
v_mfma_f32_16x16x32_bf16 v[112:115], a[4:7], a[244:247], v[112:115]
ds_read_b64_tr_b16 a[18:19], v30 offset:50176
v_mfma_f32_16x16x32_bf16 v[112:115], a[0:3], a[228:231], v[112:115]
v_xor_b32 v28, s49, v28
v_xor_b32 v29, s49, v29
v_mfma_f32_16x16x32_bf16 v[116:119], a[0:3], a[232:235], v[116:119]
ds_read_b64_tr_b16 a[20:21], v30 offset:57344
v_mfma_f32_16x16x32_bf16 v[116:119], a[4:7], a[248:251], v[116:119]
buffer_load_dwordx4 v9, s[20:23], s80 offen offset:3072 lds
v_mfma_f32_16x16x32_bf16 v[120:123], a[4:7], a[252:255], v[120:123]
s_add_u32 s80, s80, s76
ds_read_b64_tr_b16 a[22:23], v30 offset:58368
v_mfma_f32_16x16x32_bf16 v[120:123], a[0:3], a[236:239], v[120:123]
s_waitcnt lgkmcnt(8)
ds_read_b128 v[80:83], v69 offset:0
v_mfma_f32_16x16x32_bf16 v[124:127], a[8:11], a[224:227], v[124:127]
s_waitcnt lgkmcnt(6)
ds_read_b64_tr_b16 a[24:25], v31 offset:49152
v_mfma_f32_16x16x32_bf16 v[124:127], a[12:15], a[240:243], v[124:127]
buffer_load_dwordx4 a[192:195], v1, s[4:7], s81 offen offset:0 sc1
v_mfma_f32_16x16x32_bf16 v[128:131], a[12:15], a[244:247], v[128:131]
ds_read_b64_tr_b16 a[26:27], v31 offset:50176
v_mfma_f32_16x16x32_bf16 v[128:131], a[8:11], a[228:231], v[128:131]
ds_read_b128 v[96:99], v69 offset:64
v_mfma_f32_16x16x32_bf16 v[132:135], a[8:11], a[232:235], v[132:135]
ds_read_b64_tr_b16 a[28:29], v31 offset:57344
v_mfma_f32_16x16x32_bf16 v[132:135], a[12:15], a[248:251], v[132:135]
buffer_load_dwordx4 a[196:199], v1, s[4:7], s81 offen offset:1024 sc1
v_mfma_f32_16x16x32_bf16 v[136:139], a[12:15], a[252:255], v[136:139]
ds_read_b64_tr_b16 a[30:31], v31 offset:58368
v_mfma_f32_16x16x32_bf16 v[136:139], a[8:11], a[236:239], v[136:139]
s_waitcnt lgkmcnt(8)
ds_read_b128 v[84:87], v70 offset:0
v_mfma_f32_16x16x32_bf16 v[140:143], a[16:19], a[224:227], v[140:143]
s_waitcnt lgkmcnt(7)
ds_read_b64_tr_b16 a[0:1], v28 offset:0
v_mfma_f32_16x16x32_bf16 v[140:143], a[20:23], a[240:243], v[140:143]
buffer_load_dwordx4 a[200:203], v1, s[4:7], s81 offen offset:2048 sc1
v_mfma_f32_16x16x32_bf16 v[144:147], a[20:23], a[244:247], v[144:147]
ds_read_b64_tr_b16 a[2:3], v28 offset:1024
v_mfma_f32_16x16x32_bf16 v[144:147], a[16:19], a[228:231], v[144:147]
ds_read_b128 v[100:103], v70 offset:64
v_mfma_f32_16x16x32_bf16 v[148:151], a[16:19], a[232:235], v[148:151]
ds_read_b64_tr_b16 a[4:5], v28 offset:8192
v_mfma_f32_16x16x32_bf16 v[148:151], a[20:23], a[248:251], v[148:151]
buffer_load_dwordx4 a[204:207], v1, s[4:7], s81 offen offset:3072 sc1
v_mfma_f32_16x16x32_bf16 v[152:155], a[20:23], a[252:255], v[152:155]
ds_read_b64_tr_b16 a[6:7], v28 offset:9216
v_mfma_f32_16x16x32_bf16 v[152:155], a[16:19], a[236:239], v[152:155]
s_waitcnt lgkmcnt(9)
ds_read_b128 v[88:91], v71 offset:0
v_mfma_f32_16x16x32_bf16 v[156:159], a[24:27], a[224:227], v[156:159]
s_waitcnt lgkmcnt(7)
ds_read_b64_tr_b16 a[8:9], v29 offset:0
v_mfma_f32_16x16x32_bf16 v[156:159], a[28:31], a[240:243], v[156:159]
buffer_load_dwordx4 a[208:211], v253, s[4:7], s81 offen offset:0 sc1
v_mfma_f32_16x16x32_bf16 v[160:163], a[28:31], a[244:247], v[160:163]
ds_read_b64_tr_b16 a[10:11], v29 offset:1024
v_mfma_f32_16x16x32_bf16 v[160:163], a[24:27], a[228:231], v[160:163]
ds_read_b128 v[104:107], v71 offset:64
v_xor_b32 v30, s49, v30
v_mfma_f32_16x16x32_bf16 v[164:167], a[24:27], a[232:235], v[164:167]
ds_read_b64_tr_b16 a[12:13], v29 offset:8192
v_xor_b32 v31, s49, v31
v_mfma_f32_16x16x32_bf16 v[164:167], a[28:31], a[248:251], v[164:167]
buffer_load_dwordx4 a[212:215], v253, s[4:7], s81 offen offset:1024 sc1
v_mfma_f32_16x16x32_bf16 v[168:171], a[28:31], a[252:255], v[168:171]
ds_read_b64_tr_b16 a[14:15], v29 offset:9216
v_xor_b32 v32, s49, v32
v_mfma_f32_16x16x32_bf16 v[168:171], a[24:27], a[236:239], v[168:171]
v_xor_b32 v33, s49, v33
v_xor_b32 v34, s49, v34
v_xor_b32 v35, s49, v35
s_waitcnt vmcnt(25)
v_pk_mul_f32 v[108:109], v[108:109], v[10:11] op_sel:[0,1] op_sel_hi:[1,1]
v_pk_mul_f32 v[110:111], v[110:111], v[10:11] op_sel:[0,1] op_sel_hi:[1,1]
v_pk_mul_f32 v[124:125], v[124:125], v[10:11] op_sel:[0,1] op_sel_hi:[1,1]
v_pk_mul_f32 v[126:127], v[126:127], v[10:11] op_sel:[0,1] op_sel_hi:[1,1]
v_pk_fma_f32 v[108:109], v[76:77], v[10:11], v[108:109] op_sel_hi:[1,0,1]
v_pk_fma_f32 v[110:111], v[78:79], v[10:11], v[110:111] op_sel_hi:[1,0,1]
v_pk_fma_f32 v[124:125], v[92:93], v[10:11], v[124:125] op_sel_hi:[1,0,1]
v_pk_fma_f32 v[126:127], v[94:95], v[10:11], v[126:127] op_sel_hi:[1,0,1]
s_waitcnt vmcnt(24)
s_nop 0
v_pk_mul_f32 v[112:113], v[112:113], v[12:13] op_sel:[0,1] op_sel_hi:[1,1]
v_pk_mul_f32 v[114:115], v[114:115], v[12:13] op_sel:[0,1] op_sel_hi:[1,1]
v_pk_mul_f32 v[128:129], v[128:129], v[12:13] op_sel:[0,1] op_sel_hi:[1,1]
v_pk_mul_f32 v[130:131], v[130:131], v[12:13] op_sel:[0,1] op_sel_hi:[1,1]
v_pk_fma_f32 v[112:113], v[76:77], v[12:13], v[112:113] op_sel_hi:[1,0,1]
v_pk_fma_f32 v[114:115], v[78:79], v[12:13], v[114:115] op_sel_hi:[1,0,1]
v_pk_fma_f32 v[128:129], v[92:93], v[12:13], v[128:129] op_sel_hi:[1,0,1]
v_pk_fma_f32 v[130:131], v[94:95], v[12:13], v[130:131] op_sel_hi:[1,0,1]
s_waitcnt vmcnt(23)
s_nop 0
v_pk_mul_f32 v[116:117], v[116:117], v[14:15] op_sel:[0,1] op_sel_hi:[1,1]
v_pk_mul_f32 v[118:119], v[118:119], v[14:15] op_sel:[0,1] op_sel_hi:[1,1]
v_pk_mul_f32 v[132:133], v[132:133], v[14:15] op_sel:[0,1] op_sel_hi:[1,1]
v_pk_mul_f32 v[134:135], v[134:135], v[14:15] op_sel:[0,1] op_sel_hi:[1,1]
v_pk_fma_f32 v[116:117], v[76:77], v[14:15], v[116:117] op_sel_hi:[1,0,1]
v_pk_fma_f32 v[118:119], v[78:79], v[14:15], v[118:119] op_sel_hi:[1,0,1]
v_pk_fma_f32 v[132:133], v[92:93], v[14:15], v[132:133] op_sel_hi:[1,0,1]
v_pk_fma_f32 v[134:135], v[94:95], v[14:15], v[134:135] op_sel_hi:[1,0,1]
s_waitcnt vmcnt(22)
s_nop 0
v_pk_mul_f32 v[120:121], v[120:121], v[16:17] op_sel:[0,1] op_sel_hi:[1,1]
v_pk_mul_f32 v[122:123], v[122:123], v[16:17] op_sel:[0,1] op_sel_hi:[1,1]
v_pk_mul_f32 v[136:137], v[136:137], v[16:17] op_sel:[0,1] op_sel_hi:[1,1]
v_pk_mul_f32 v[138:139], v[138:139], v[16:17] op_sel:[0,1] op_sel_hi:[1,1]
v_pk_fma_f32 v[120:121], v[76:77], v[16:17], v[120:121] op_sel_hi:[1,0,1]
v_pk_fma_f32 v[122:123], v[78:79], v[16:17], v[122:123] op_sel_hi:[1,0,1]
v_pk_fma_f32 v[136:137], v[92:93], v[16:17], v[136:137] op_sel_hi:[1,0,1]
v_pk_fma_f32 v[138:139], v[94:95], v[16:17], v[138:139] op_sel_hi:[1,0,1]
v_cvt_pk_bf16_f32 v44, v108, v109
v_cvt_pk_bf16_f32 v45, v110, v111
v_cvt_pk_bf16_f32 v46, v124, v125
v_cvt_pk_bf16_f32 v47, v126, v127
v_cvt_pk_bf16_f32 v60, v112, v113
v_cvt_pk_bf16_f32 v61, v114, v115
v_cvt_pk_bf16_f32 v62, v128, v129
v_cvt_pk_bf16_f32 v63, v130, v131
v_cvt_pk_bf16_f32 v76, v116, v117
v_cvt_pk_bf16_f32 v77, v118, v119
v_cvt_pk_bf16_f32 v78, v132, v133
v_cvt_pk_bf16_f32 v79, v134, v135
v_cvt_pk_bf16_f32 v92, v120, v121
v_cvt_pk_bf16_f32 v93, v122, v123
v_cvt_pk_bf16_f32 v94, v136, v137
v_cvt_pk_bf16_f32 v95, v138, v139
v_permlane16_swap_b32 v44, v46
v_permlane16_swap_b32 v45, v47
v_permlane16_swap_b32 v60, v62
v_permlane16_swap_b32 v61, v63
v_permlane16_swap_b32 v76, v78
v_permlane16_swap_b32 v77, v79
v_permlane16_swap_b32 v92, v94
v_permlane16_swap_b32 v93, v95
v_pk_mul_f32 v[140:141], v[140:141], v[10:11] op_sel:[0,1] op_sel_hi:[1,1]
v_pk_mul_f32 v[142:143], v[142:143], v[10:11] op_sel:[0,1] op_sel_hi:[1,1]
v_pk_mul_f32 v[156:157], v[156:157], v[10:11] op_sel:[0,1] op_sel_hi:[1,1]
v_pk_mul_f32 v[158:159], v[158:159], v[10:11] op_sel:[0,1] op_sel_hi:[1,1]
v_pk_fma_f32 v[140:141], v[80:81], v[10:11], v[140:141] op_sel_hi:[1,0,1]
v_pk_fma_f32 v[142:143], v[82:83], v[10:11], v[142:143] op_sel_hi:[1,0,1]
v_pk_fma_f32 v[156:157], v[96:97], v[10:11], v[156:157] op_sel_hi:[1,0,1]
v_pk_fma_f32 v[158:159], v[98:99], v[10:11], v[158:159] op_sel_hi:[1,0,1]
v_pk_mul_f32 v[144:145], v[144:145], v[12:13] op_sel:[0,1] op_sel_hi:[1,1]
v_pk_mul_f32 v[146:147], v[146:147], v[12:13] op_sel:[0,1] op_sel_hi:[1,1]
v_pk_mul_f32 v[160:161], v[160:161], v[12:13] op_sel:[0,1] op_sel_hi:[1,1]
v_pk_mul_f32 v[162:163], v[162:163], v[12:13] op_sel:[0,1] op_sel_hi:[1,1]
v_pk_fma_f32 v[144:145], v[80:81], v[12:13], v[144:145] op_sel_hi:[1,0,1]
v_pk_fma_f32 v[146:147], v[82:83], v[12:13], v[146:147] op_sel_hi:[1,0,1]
v_pk_fma_f32 v[160:161], v[96:97], v[12:13], v[160:161] op_sel_hi:[1,0,1]
v_pk_fma_f32 v[162:163], v[98:99], v[12:13], v[162:163] op_sel_hi:[1,0,1]
v_pk_mul_f32 v[148:149], v[148:149], v[14:15] op_sel:[0,1] op_sel_hi:[1,1]
v_pk_mul_f32 v[150:151], v[150:151], v[14:15] op_sel:[0,1] op_sel_hi:[1,1]
v_pk_mul_f32 v[164:165], v[164:165], v[14:15] op_sel:[0,1] op_sel_hi:[1,1]
v_pk_mul_f32 v[166:167], v[166:167], v[14:15] op_sel:[0,1] op_sel_hi:[1,1]
v_pk_fma_f32 v[148:149], v[80:81], v[14:15], v[148:149] op_sel_hi:[1,0,1]
v_pk_fma_f32 v[150:151], v[82:83], v[14:15], v[150:151] op_sel_hi:[1,0,1]
v_pk_fma_f32 v[164:165], v[96:97], v[14:15], v[164:165] op_sel_hi:[1,0,1]
v_pk_fma_f32 v[166:167], v[98:99], v[14:15], v[166:167] op_sel_hi:[1,0,1]
v_pk_mul_f32 v[152:153], v[152:153], v[16:17] op_sel:[0,1] op_sel_hi:[1,1]
v_pk_mul_f32 v[154:155], v[154:155], v[16:17] op_sel:[0,1] op_sel_hi:[1,1]
v_pk_mul_f32 v[168:169], v[168:169], v[16:17] op_sel:[0,1] op_sel_hi:[1,1]
v_pk_mul_f32 v[170:171], v[170:171], v[16:17] op_sel:[0,1] op_sel_hi:[1,1]
v_pk_fma_f32 v[152:153], v[80:81], v[16:17], v[152:153] op_sel_hi:[1,0,1]
v_pk_fma_f32 v[154:155], v[82:83], v[16:17], v[154:155] op_sel_hi:[1,0,1]
v_pk_fma_f32 v[168:169], v[96:97], v[16:17], v[168:169] op_sel_hi:[1,0,1]
v_pk_fma_f32 v[170:171], v[98:99], v[16:17], v[170:171] op_sel_hi:[1,0,1]
v_cvt_pk_bf16_f32 v48, v140, v141
v_cvt_pk_bf16_f32 v49, v142, v143
v_cvt_pk_bf16_f32 v50, v156, v157
v_cvt_pk_bf16_f32 v51, v158, v159
v_cvt_pk_bf16_f32 v64, v144, v145
v_cvt_pk_bf16_f32 v65, v146, v147
v_cvt_pk_bf16_f32 v66, v160, v161
v_cvt_pk_bf16_f32 v67, v162, v163
v_cvt_pk_bf16_f32 v80, v148, v149
v_cvt_pk_bf16_f32 v81, v150, v151
v_cvt_pk_bf16_f32 v82, v164, v165
v_cvt_pk_bf16_f32 v83, v166, v167
v_cvt_pk_bf16_f32 v96, v152, v153
v_cvt_pk_bf16_f32 v97, v154, v155
v_cvt_pk_bf16_f32 v98, v168, v169
v_cvt_pk_bf16_f32 v99, v170, v171
v_permlane16_swap_b32 v48, v50
v_permlane16_swap_b32 v49, v51
v_permlane16_swap_b32 v64, v66
v_permlane16_swap_b32 v65, v67
v_permlane16_swap_b32 v80, v82
v_permlane16_swap_b32 v81, v83
v_permlane16_swap_b32 v96, v98
v_permlane16_swap_b32 v97, v99
v_pk_mul_f32 v[172:173], v[172:173], v[10:11] op_sel:[0,1] op_sel_hi:[1,1]
v_pk_mul_f32 v[174:175], v[174:175], v[10:11] op_sel:[0,1] op_sel_hi:[1,1]
v_pk_mul_f32 v[188:189], v[188:189], v[10:11] op_sel:[0,1] op_sel_hi:[1,1]
v_pk_mul_f32 v[190:191], v[190:191], v[10:11] op_sel:[0,1] op_sel_hi:[1,1]
s_waitcnt lgkmcnt(11)
v_pk_fma_f32 v[172:173], v[84:85], v[10:11], v[172:173] op_sel_hi:[1,0,1]
v_pk_fma_f32 v[174:175], v[86:87], v[10:11], v[174:175] op_sel_hi:[1,0,1]
s_waitcnt lgkmcnt(8)
v_pk_fma_f32 v[188:189], v[100:101], v[10:11], v[188:189] op_sel_hi:[1,0,1]
v_pk_fma_f32 v[190:191], v[102:103], v[10:11], v[190:191] op_sel_hi:[1,0,1]
v_pk_mul_f32 v[176:177], v[176:177], v[12:13] op_sel:[0,1] op_sel_hi:[1,1]
v_pk_mul_f32 v[178:179], v[178:179], v[12:13] op_sel:[0,1] op_sel_hi:[1,1]
v_pk_mul_f32 v[192:193], v[192:193], v[12:13] op_sel:[0,1] op_sel_hi:[1,1]
v_pk_mul_f32 v[194:195], v[194:195], v[12:13] op_sel:[0,1] op_sel_hi:[1,1]
v_pk_fma_f32 v[176:177], v[84:85], v[12:13], v[176:177] op_sel_hi:[1,0,1]
v_pk_fma_f32 v[178:179], v[86:87], v[12:13], v[178:179] op_sel_hi:[1,0,1]
v_pk_fma_f32 v[192:193], v[100:101], v[12:13], v[192:193] op_sel_hi:[1,0,1]
v_pk_fma_f32 v[194:195], v[102:103], v[12:13], v[194:195] op_sel_hi:[1,0,1]
v_pk_mul_f32 v[180:181], v[180:181], v[14:15] op_sel:[0,1] op_sel_hi:[1,1]
v_pk_mul_f32 v[182:183], v[182:183], v[14:15] op_sel:[0,1] op_sel_hi:[1,1]
v_pk_mul_f32 v[196:197], v[196:197], v[14:15] op_sel:[0,1] op_sel_hi:[1,1]
v_pk_mul_f32 v[198:199], v[198:199], v[14:15] op_sel:[0,1] op_sel_hi:[1,1]
v_pk_fma_f32 v[180:181], v[84:85], v[14:15], v[180:181] op_sel_hi:[1,0,1]
v_pk_fma_f32 v[182:183], v[86:87], v[14:15], v[182:183] op_sel_hi:[1,0,1]
v_pk_fma_f32 v[196:197], v[100:101], v[14:15], v[196:197] op_sel_hi:[1,0,1]
v_pk_fma_f32 v[198:199], v[102:103], v[14:15], v[198:199] op_sel_hi:[1,0,1]
v_pk_mul_f32 v[184:185], v[184:185], v[16:17] op_sel:[0,1] op_sel_hi:[1,1]
v_pk_mul_f32 v[186:187], v[186:187], v[16:17] op_sel:[0,1] op_sel_hi:[1,1]
v_pk_mul_f32 v[200:201], v[200:201], v[16:17] op_sel:[0,1] op_sel_hi:[1,1]
v_pk_mul_f32 v[202:203], v[202:203], v[16:17] op_sel:[0,1] op_sel_hi:[1,1]
v_pk_fma_f32 v[184:185], v[84:85], v[16:17], v[184:185] op_sel_hi:[1,0,1]
v_pk_fma_f32 v[186:187], v[86:87], v[16:17], v[186:187] op_sel_hi:[1,0,1]
v_pk_fma_f32 v[200:201], v[100:101], v[16:17], v[200:201] op_sel_hi:[1,0,1]
v_pk_fma_f32 v[202:203], v[102:103], v[16:17], v[202:203] op_sel_hi:[1,0,1]
v_cvt_pk_bf16_f32 v52, v172, v173
v_cvt_pk_bf16_f32 v53, v174, v175
v_cvt_pk_bf16_f32 v54, v188, v189
v_cvt_pk_bf16_f32 v55, v190, v191
v_cvt_pk_bf16_f32 v68, v176, v177
v_cvt_pk_bf16_f32 v69, v178, v179
v_cvt_pk_bf16_f32 v70, v192, v193
v_cvt_pk_bf16_f32 v71, v194, v195
v_cvt_pk_bf16_f32 v84, v180, v181
v_cvt_pk_bf16_f32 v85, v182, v183
v_cvt_pk_bf16_f32 v86, v196, v197
v_cvt_pk_bf16_f32 v87, v198, v199
v_cvt_pk_bf16_f32 v100, v184, v185
v_cvt_pk_bf16_f32 v101, v186, v187
v_cvt_pk_bf16_f32 v102, v200, v201
v_cvt_pk_bf16_f32 v103, v202, v203
v_permlane16_swap_b32 v52, v54
v_permlane16_swap_b32 v53, v55
v_permlane16_swap_b32 v68, v70
v_permlane16_swap_b32 v69, v71
v_permlane16_swap_b32 v84, v86
v_permlane16_swap_b32 v85, v87
v_permlane16_swap_b32 v100, v102
v_permlane16_swap_b32 v101, v103
v_pk_mul_f32 v[204:205], v[204:205], v[10:11] op_sel:[0,1] op_sel_hi:[1,1]
v_pk_mul_f32 v[206:207], v[206:207], v[10:11] op_sel:[0,1] op_sel_hi:[1,1]
v_pk_mul_f32 v[220:221], v[220:221], v[10:11] op_sel:[0,1] op_sel_hi:[1,1]
v_pk_mul_f32 v[222:223], v[222:223], v[10:11] op_sel:[0,1] op_sel_hi:[1,1]
s_waitcnt lgkmcnt(5)
v_pk_fma_f32 v[204:205], v[88:89], v[10:11], v[204:205] op_sel_hi:[1,0,1]
v_pk_fma_f32 v[206:207], v[90:91], v[10:11], v[206:207] op_sel_hi:[1,0,1]
s_waitcnt lgkmcnt(2)
v_pk_fma_f32 v[220:221], v[104:105], v[10:11], v[220:221] op_sel_hi:[1,0,1]
v_pk_fma_f32 v[222:223], v[106:107], v[10:11], v[222:223] op_sel_hi:[1,0,1]
v_pk_mul_f32 v[208:209], v[208:209], v[12:13] op_sel:[0,1] op_sel_hi:[1,1]
v_pk_mul_f32 v[210:211], v[210:211], v[12:13] op_sel:[0,1] op_sel_hi:[1,1]
v_pk_mul_f32 v[224:225], v[224:225], v[12:13] op_sel:[0,1] op_sel_hi:[1,1]
v_pk_mul_f32 v[226:227], v[226:227], v[12:13] op_sel:[0,1] op_sel_hi:[1,1]
v_pk_fma_f32 v[208:209], v[88:89], v[12:13], v[208:209] op_sel_hi:[1,0,1]
v_pk_fma_f32 v[210:211], v[90:91], v[12:13], v[210:211] op_sel_hi:[1,0,1]
v_pk_fma_f32 v[224:225], v[104:105], v[12:13], v[224:225] op_sel_hi:[1,0,1]
v_pk_fma_f32 v[226:227], v[106:107], v[12:13], v[226:227] op_sel_hi:[1,0,1]
v_pk_mul_f32 v[212:213], v[212:213], v[14:15] op_sel:[0,1] op_sel_hi:[1,1]
v_pk_mul_f32 v[214:215], v[214:215], v[14:15] op_sel:[0,1] op_sel_hi:[1,1]
v_pk_mul_f32 v[228:229], v[228:229], v[14:15] op_sel:[0,1] op_sel_hi:[1,1]
v_pk_mul_f32 v[230:231], v[230:231], v[14:15] op_sel:[0,1] op_sel_hi:[1,1]
v_pk_fma_f32 v[212:213], v[88:89], v[14:15], v[212:213] op_sel_hi:[1,0,1]
v_pk_fma_f32 v[214:215], v[90:91], v[14:15], v[214:215] op_sel_hi:[1,0,1]
v_pk_fma_f32 v[228:229], v[104:105], v[14:15], v[228:229] op_sel_hi:[1,0,1]
v_pk_fma_f32 v[230:231], v[106:107], v[14:15], v[230:231] op_sel_hi:[1,0,1]
v_pk_mul_f32 v[216:217], v[216:217], v[16:17] op_sel:[0,1] op_sel_hi:[1,1]
v_pk_mul_f32 v[218:219], v[218:219], v[16:17] op_sel:[0,1] op_sel_hi:[1,1]
v_pk_mul_f32 v[232:233], v[232:233], v[16:17] op_sel:[0,1] op_sel_hi:[1,1]
v_pk_mul_f32 v[234:235], v[234:235], v[16:17] op_sel:[0,1] op_sel_hi:[1,1]
v_pk_fma_f32 v[216:217], v[88:89], v[16:17], v[216:217] op_sel_hi:[1,0,1]
v_pk_fma_f32 v[218:219], v[90:91], v[16:17], v[218:219] op_sel_hi:[1,0,1]
v_pk_fma_f32 v[232:233], v[104:105], v[16:17], v[232:233] op_sel_hi:[1,0,1]
v_pk_fma_f32 v[234:235], v[106:107], v[16:17], v[234:235] op_sel_hi:[1,0,1]
v_cvt_pk_bf16_f32 v56, v204, v205
v_cvt_pk_bf16_f32 v57, v206, v207
v_cvt_pk_bf16_f32 v58, v220, v221
v_cvt_pk_bf16_f32 v59, v222, v223
v_cvt_pk_bf16_f32 v72, v208, v209
v_cvt_pk_bf16_f32 v73, v210, v211
v_cvt_pk_bf16_f32 v74, v224, v225
v_cvt_pk_bf16_f32 v75, v226, v227
v_cvt_pk_bf16_f32 v88, v212, v213
v_cvt_pk_bf16_f32 v89, v214, v215
v_cvt_pk_bf16_f32 v90, v228, v229
v_cvt_pk_bf16_f32 v91, v230, v231
v_cvt_pk_bf16_f32 v104, v216, v217
v_cvt_pk_bf16_f32 v105, v218, v219
v_cvt_pk_bf16_f32 v106, v232, v233
v_cvt_pk_bf16_f32 v107, v234, v235
v_permlane16_swap_b32 v56, v58
v_permlane16_swap_b32 v57, v59
v_permlane16_swap_b32 v72, v74
v_permlane16_swap_b32 v73, v75
v_permlane16_swap_b32 v88, v90
v_permlane16_swap_b32 v89, v91
v_permlane16_swap_b32 v104, v106
v_permlane16_swap_b32 v105, v107
v_lshlrev_b32 v108, 16, v236
v_and_b32 v109, 0xffff0000, v236
v_lshlrev_b32 v110, 16, v237
v_and_b32 v111, 0xffff0000, v237
v_mov_b64 v[112:113], v[108:109]
v_mov_b64 v[114:115], v[110:111]
v_mov_b64 v[116:117], v[108:109]
v_mov_b64 v[118:119], v[110:111]
v_mov_b64 v[120:121], v[108:109]
v_mov_b64 v[122:123], v[110:111]
v_lshlrev_b32 v124, 16, v238
v_and_b32 v125, 0xffff0000, v238
v_lshlrev_b32 v126, 16, v239
v_and_b32 v127, 0xffff0000, v239
v_mov_b64 v[128:129], v[124:125]
v_mov_b64 v[130:131], v[126:127]
v_mov_b64 v[132:133], v[124:125]
v_mov_b64 v[134:135], v[126:127]
v_mov_b64 v[136:137], v[124:125]
v_mov_b64 v[138:139], v[126:127]
v_lshlrev_b32 v140, 16, v240
v_and_b32 v141, 0xffff0000, v240
v_lshlrev_b32 v142, 16, v241
v_and_b32 v143, 0xffff0000, v241
v_mov_b64 v[144:145], v[140:141]
v_mov_b64 v[146:147], v[142:143]
v_mov_b64 v[148:149], v[140:141]
v_mov_b64 v[150:151], v[142:143]
v_mov_b64 v[152:153], v[140:141]
v_mov_b64 v[154:155], v[142:143]
v_lshlrev_b32 v156, 16, v242
v_and_b32 v157, 0xffff0000, v242
v_lshlrev_b32 v158, 16, v243
v_and_b32 v159, 0xffff0000, v243
v_mov_b64 v[160:161], v[156:157]
v_mov_b64 v[162:163], v[158:159]
v_mov_b64 v[164:165], v[156:157]
v_mov_b64 v[166:167], v[158:159]
v_mov_b64 v[168:169], v[156:157]
v_mov_b64 v[170:171], v[158:159]
v_lshlrev_b32 v172, 16, v244
v_and_b32 v173, 0xffff0000, v244
v_lshlrev_b32 v174, 16, v245
v_and_b32 v175, 0xffff0000, v245
v_mov_b64 v[176:177], v[172:173]
v_mov_b64 v[178:179], v[174:175]
v_mov_b64 v[180:181], v[172:173]
v_mov_b64 v[182:183], v[174:175]
v_mov_b64 v[184:185], v[172:173]
v_mov_b64 v[186:187], v[174:175]
v_lshlrev_b32 v188, 16, v246
v_and_b32 v189, 0xffff0000, v246
v_lshlrev_b32 v190, 16, v247
v_and_b32 v191, 0xffff0000, v247
v_mov_b64 v[192:193], v[188:189]
v_mov_b64 v[194:195], v[190:191]
v_mov_b64 v[196:197], v[188:189]
v_mov_b64 v[198:199], v[190:191]
v_mov_b64 v[200:201], v[188:189]
v_mov_b64 v[202:203], v[190:191]
v_lshlrev_b32 v204, 16, v248
v_and_b32 v205, 0xffff0000, v248
v_lshlrev_b32 v206, 16, v249
v_and_b32 v207, 0xffff0000, v249
v_mov_b64 v[208:209], v[204:205]
v_mov_b64 v[210:211], v[206:207]
v_mov_b64 v[212:213], v[204:205]
v_mov_b64 v[214:215], v[206:207]
v_mov_b64 v[216:217], v[204:205]
v_mov_b64 v[218:219], v[206:207]
v_lshlrev_b32 v220, 16, v250
v_and_b32 v221, 0xffff0000, v250
v_lshlrev_b32 v222, 16, v251
v_and_b32 v223, 0xffff0000, v251
v_mov_b64 v[224:225], v[220:221]
v_mov_b64 v[226:227], v[222:223]
v_mov_b64 v[228:229], v[220:221]
v_mov_b64 v[230:231], v[222:223]
v_mov_b64 v[232:233], v[220:221]
v_mov_b64 v[234:235], v[222:223]
v_mfma_f32_16x16x32_bf16 v[108:111], a[0:3], a[128:131], v[108:111]
ds_read_b64_tr_b16 a[16:17], v30 offset:0
v_mfma_f32_16x16x32_bf16 v[108:111], a[4:7], a[144:147], v[108:111]
buffer_load_dwordx4 a[216:219], v253, s[4:7], s81 offen offset:2048 sc1
v_mfma_f32_16x16x32_bf16 v[112:115], a[4:7], a[148:151], v[112:115]
ds_read_b64_tr_b16 a[18:19], v30 offset:1024
v_mfma_f32_16x16x32_bf16 v[112:115], a[0:3], a[132:135], v[112:115]
v_mfma_f32_16x16x32_bf16 v[116:119], a[0:3], a[136:139], v[116:119]
ds_read_b64_tr_b16 a[20:21], v30 offset:8192
v_mfma_f32_16x16x32_bf16 v[116:119], a[4:7], a[152:155], v[116:119]
buffer_load_dwordx4 a[220:223], v253, s[4:7], s81 offen offset:3072 sc1
v_mfma_f32_16x16x32_bf16 v[120:123], a[4:7], a[156:159], v[120:123]
s_add_u32 s81, s81, s78
ds_read_b64_tr_b16 a[22:23], v30 offset:9216
v_mfma_f32_16x16x32_bf16 v[120:123], a[0:3], a[140:143], v[120:123]
v_mfma_f32_16x16x32_bf16 v[124:127], a[8:11], a[128:131], v[124:127]
s_waitcnt lgkmcnt(4)
ds_read_b64_tr_b16 a[24:25], v31 offset:0
v_mfma_f32_16x16x32_bf16 v[124:127], a[12:15], a[144:147], v[124:127]
v_mfma_f32_16x16x32_bf16 v[128:131], a[12:15], a[148:151], v[128:131]
ds_read_b64_tr_b16 a[26:27], v31 offset:1024
v_mfma_f32_16x16x32_bf16 v[128:131], a[8:11], a[132:135], v[128:131]
v_mfma_f32_16x16x32_bf16 v[132:135], a[8:11], a[136:139], v[132:135]
ds_read_b64_tr_b16 a[28:29], v31 offset:8192
v_mfma_f32_16x16x32_bf16 v[132:135], a[12:15], a[152:155], v[132:135]
v_mfma_f32_16x16x32_bf16 v[136:139], a[12:15], a[156:159], v[136:139]
ds_read_b64_tr_b16 a[30:31], v31 offset:9216
v_mfma_f32_16x16x32_bf16 v[136:139], a[8:11], a[140:143], v[136:139]
s_waitcnt lgkmcnt(6)
v_mfma_f32_16x16x32_bf16 v[140:143], a[16:19], a[128:131], v[140:143]
s_waitcnt lgkmcnt(4)
ds_read_b64_tr_b16 a[0:1], v32 offset:0
v_mfma_f32_16x16x32_bf16 v[140:143], a[20:23], a[144:147], v[140:143]
v_mfma_f32_16x16x32_bf16 v[144:147], a[20:23], a[148:151], v[144:147]
ds_read_b64_tr_b16 a[2:3], v32 offset:1024
v_mfma_f32_16x16x32_bf16 v[144:147], a[16:19], a[132:135], v[144:147]
v_mfma_f32_16x16x32_bf16 v[148:151], a[16:19], a[136:139], v[148:151]
ds_read_b64_tr_b16 a[4:5], v32 offset:8192
v_mfma_f32_16x16x32_bf16 v[148:151], a[20:23], a[152:155], v[148:151]
v_mfma_f32_16x16x32_bf16 v[152:155], a[20:23], a[156:159], v[152:155]
ds_read_b64_tr_b16 a[6:7], v32 offset:9216
v_mfma_f32_16x16x32_bf16 v[152:155], a[16:19], a[140:143], v[152:155]
s_waitcnt vmcnt(20) lgkmcnt(6)
s_barrier
v_mfma_f32_16x16x32_bf16 v[156:159], a[24:27], a[128:131], v[156:159]
s_waitcnt lgkmcnt(4)
s_add_u32 m0, s37, 147456
ds_read_b64_tr_b16 a[8:9], v32 offset:16384
v_mfma_f32_16x16x32_bf16 v[156:159], a[28:31], a[144:147], v[156:159]
buffer_load_dwordx4 v6, s[20:23], s80 offen offset:0 lds
v_mfma_f32_16x16x32_bf16 v[160:163], a[28:31], a[148:151], v[160:163]
ds_read_b64_tr_b16 a[10:11], v32 offset:17408
v_mfma_f32_16x16x32_bf16 v[160:163], a[24:27], a[132:135], v[160:163]
ds_read_b64_tr_b16 a[12:13], v32 offset:24576
v_mfma_f32_16x16x32_bf16 v[164:167], a[24:27], a[136:139], v[164:167]
ds_read_b64_tr_b16 a[14:15], v32 offset:25600
v_mfma_f32_16x16x32_bf16 v[164:167], a[28:31], a[152:155], v[164:167]
buffer_load_dwordx4 v7, s[20:23], s80 offen offset:1024 lds
v_mfma_f32_16x16x32_bf16 v[168:171], a[28:31], a[156:159], v[168:171]
v_mfma_f32_16x16x32_bf16 v[168:171], a[24:27], a[140:143], v[168:171]
s_waitcnt lgkmcnt(6)
s_mov_b32 s38, -7
.p2align 3
L2_g:
v_mfma_f32_16x16x32_bf16 v[172:175], a[0:3], a[128:131], v[172:175]
s_waitcnt lgkmcnt(4)
ds_read_b64_tr_b16 a[16:17], v33 offset:0
v_mfma_f32_16x16x32_bf16 v[172:175], a[4:7], a[144:147], v[172:175]
s_waitcnt vmcnt(21) lgkmcnt(3)
buffer_load_dwordx4 v8, s[20:23], s80 offen offset:2048 lds
v_mfma_f32_16x16x32_bf16 v[172:175], a[8:11], a[160:163], v[172:175]
s_waitcnt vmcnt(18) lgkmcnt(1)
ds_read_b64_tr_b16 a[18:19], v33 offset:1024
v_mfma_f32_16x16x32_bf16 v[172:175], a[12:15], a[176:179], v[172:175]
s_waitcnt vmcnt(17)
v_mfma_f32_16x16x32_bf16 v[176:179], a[12:15], a[180:183], v[176:179]
ds_read_b64_tr_b16 a[20:21], v33 offset:8192
v_mfma_f32_16x16x32_bf16 v[176:179], a[8:11], a[164:167], v[176:179]
buffer_load_dwordx4 v9, s[20:23], s80 offen offset:3072 lds
v_mfma_f32_16x16x32_bf16 v[176:179], a[4:7], a[148:151], v[176:179]
s_add_u32 s80, s80, s77
ds_read_b64_tr_b16 a[22:23], v33 offset:9216
v_mfma_f32_16x16x32_bf16 v[176:179], a[0:3], a[132:135], v[176:179]
v_mfma_f32_16x16x32_bf16 v[180:183], a[0:3], a[136:139], v[180:183]
ds_read_b64_tr_b16 a[24:25], v33 offset:16384
v_mfma_f32_16x16x32_bf16 v[180:183], a[4:7], a[152:155], v[180:183]
buffer_load_dwordx4 a[224:227], v1, s[4:7], s81 offen offset:0 sc1
v_mfma_f32_16x16x32_bf16 v[180:183], a[8:11], a[168:171], v[180:183]
s_waitcnt vmcnt(18)
ds_read_b64_tr_b16 a[26:27], v33 offset:17408
v_mfma_f32_16x16x32_bf16 v[180:183], a[12:15], a[184:187], v[180:183]
s_waitcnt vmcnt(17)
ds_read_b64_tr_b16 a[28:29], v33 offset:24576
v_mfma_f32_16x16x32_bf16 v[184:187], a[12:15], a[188:191], v[184:187]
ds_read_b64_tr_b16 a[30:31], v33 offset:25600
v_mfma_f32_16x16x32_bf16 v[184:187], a[8:11], a[172:175], v[184:187]
buffer_load_dwordx4 a[228:231], v1, s[4:7], s81 offen offset:1024 sc1
v_mfma_f32_16x16x32_bf16 v[184:187], a[4:7], a[156:159], v[184:187]
v_mfma_f32_16x16x32_bf16 v[184:187], a[0:3], a[140:143], v[184:187]
s_waitcnt lgkmcnt(6)
v_mfma_f32_16x16x32_bf16 v[188:191], a[16:19], a[128:131], v[188:191]
s_waitcnt lgkmcnt(4)
ds_read_b64_tr_b16 a[0:1], v34 offset:0
v_mfma_f32_16x16x32_bf16 v[188:191], a[20:23], a[144:147], v[188:191]
s_waitcnt lgkmcnt(3)
buffer_load_dwordx4 a[232:235], v1, s[4:7], s81 offen offset:2048 sc1
v_mfma_f32_16x16x32_bf16 v[188:191], a[24:27], a[160:163], v[188:191]
s_waitcnt lgkmcnt(1)
ds_read_b64_tr_b16 a[2:3], v34 offset:1024
v_mfma_f32_16x16x32_bf16 v[188:191], a[28:31], a[176:179], v[188:191]
v_mfma_f32_16x16x32_bf16 v[192:195], a[28:31], a[180:183], v[192:195]
ds_read_b64_tr_b16 a[4:5], v34 offset:8192
v_mfma_f32_16x16x32_bf16 v[192:195], a[24:27], a[164:167], v[192:195]
buffer_load_dwordx4 a[236:239], v1, s[4:7], s81 offen offset:3072 sc1
v_mfma_f32_16x16x32_bf16 v[192:195], a[20:23], a[148:151], v[192:195]
ds_read_b64_tr_b16 a[6:7], v34 offset:9216
v_mfma_f32_16x16x32_bf16 v[192:195], a[16:19], a[132:135], v[192:195]
v_mfma_f32_16x16x32_bf16 v[196:199], a[16:19], a[136:139], v[196:199]
ds_read_b64_tr_b16 a[8:9], v34 offset:16384
v_mfma_f32_16x16x32_bf16 v[196:199], a[20:23], a[152:155], v[196:199]
buffer_load_dwordx4 a[240:243], v253, s[4:7], s81 offen offset:0 sc1
v_mfma_f32_16x16x32_bf16 v[196:199], a[24:27], a[168:171], v[196:199]
ds_read_b64_tr_b16 a[10:11], v34 offset:17408
v_mfma_f32_16x16x32_bf16 v[196:199], a[28:31], a[184:187], v[196:199]
ds_read_b64_tr_b16 a[12:13], v34 offset:24576
v_mfma_f32_16x16x32_bf16 v[200:203], a[28:31], a[188:191], v[200:203]
ds_read_b64_tr_b16 a[14:15], v34 offset:25600
v_mfma_f32_16x16x32_bf16 v[200:203], a[24:27], a[172:175], v[200:203]
buffer_load_dwordx4 a[244:247], v253, s[4:7], s81 offen offset:1024 sc1
v_mfma_f32_16x16x32_bf16 v[200:203], a[20:23], a[156:159], v[200:203]
v_mfma_f32_16x16x32_bf16 v[200:203], a[16:19], a[140:143], v[200:203]
s_waitcnt lgkmcnt(6)
v_mfma_f32_16x16x32_bf16 v[204:207], a[0:3], a[128:131], v[204:207]
s_waitcnt lgkmcnt(4)
ds_read_b64_tr_b16 a[16:17], v35 offset:0
v_mfma_f32_16x16x32_bf16 v[204:207], a[4:7], a[144:147], v[204:207]
s_waitcnt lgkmcnt(3)
buffer_load_dwordx4 a[248:251], v253, s[4:7], s81 offen offset:2048 sc1
v_mfma_f32_16x16x32_bf16 v[204:207], a[8:11], a[160:163], v[204:207]
s_waitcnt lgkmcnt(1)
ds_read_b64_tr_b16 a[18:19], v35 offset:1024
v_mfma_f32_16x16x32_bf16 v[204:207], a[12:15], a[176:179], v[204:207]
v_mfma_f32_16x16x32_bf16 v[208:211], a[12:15], a[180:183], v[208:211]
ds_read_b64_tr_b16 a[20:21], v35 offset:8192
v_mfma_f32_16x16x32_bf16 v[208:211], a[8:11], a[164:167], v[208:211]
buffer_load_dwordx4 a[252:255], v253, s[4:7], s81 offen offset:3072 sc1
v_mfma_f32_16x16x32_bf16 v[208:211], a[4:7], a[148:151], v[208:211]
s_add_u32 s81, s81, s79
ds_read_b64_tr_b16 a[22:23], v35 offset:9216
v_mfma_f32_16x16x32_bf16 v[208:211], a[0:3], a[132:135], v[208:211]
v_mfma_f32_16x16x32_bf16 v[212:215], a[0:3], a[136:139], v[212:215]
ds_read_b64_tr_b16 a[24:25], v35 offset:16384
v_mfma_f32_16x16x32_bf16 v[212:215], a[4:7], a[152:155], v[212:215]
v_mfma_f32_16x16x32_bf16 v[212:215], a[8:11], a[168:171], v[212:215]
ds_read_b64_tr_b16 a[26:27], v35 offset:17408
v_mfma_f32_16x16x32_bf16 v[212:215], a[12:15], a[184:187], v[212:215]
ds_read_b64_tr_b16 a[28:29], v35 offset:24576
v_mfma_f32_16x16x32_bf16 v[216:219], a[12:15], a[188:191], v[216:219]
ds_read_b64_tr_b16 a[30:31], v35 offset:25600
v_mfma_f32_16x16x32_bf16 v[216:219], a[8:11], a[172:175], v[216:219]
v_mfma_f32_16x16x32_bf16 v[216:219], a[4:7], a[156:159], v[216:219]
v_mfma_f32_16x16x32_bf16 v[216:219], a[0:3], a[140:143], v[216:219]
s_waitcnt lgkmcnt(6)
v_mfma_f32_16x16x32_bf16 v[220:223], a[16:19], a[128:131], v[220:223]
s_waitcnt lgkmcnt(4)
ds_read_b64_tr_b16 a[0:1], v28 offset:16384
v_mfma_f32_16x16x32_bf16 v[220:223], a[20:23], a[144:147], v[220:223]
s_waitcnt lgkmcnt(3)
v_mfma_f32_16x16x32_bf16 v[220:223], a[24:27], a[160:163], v[220:223]
s_waitcnt lgkmcnt(1)
ds_read_b64_tr_b16 a[2:3], v28 offset:17408
v_mfma_f32_16x16x32_bf16 v[220:223], a[28:31], a[176:179], v[220:223]
v_mfma_f32_16x16x32_bf16 v[224:227], a[28:31], a[180:183], v[224:227]
ds_read_b64_tr_b16 a[4:5], v28 offset:24576
v_mfma_f32_16x16x32_bf16 v[224:227], a[24:27], a[164:167], v[224:227]
v_mfma_f32_16x16x32_bf16 v[224:227], a[20:23], a[148:151], v[224:227]
ds_read_b64_tr_b16 a[6:7], v28 offset:25600
v_mfma_f32_16x16x32_bf16 v[224:227], a[16:19], a[132:135], v[224:227]
s_waitcnt vmcnt(20)
s_barrier
v_mfma_f32_16x16x32_bf16 v[228:231], a[16:19], a[136:139], v[228:231]
s_add_u32 m0, s37, 98304
ds_read_b64_tr_b16 a[8:9], v28 offset:32768
v_mfma_f32_16x16x32_bf16 v[228:231], a[20:23], a[152:155], v[228:231]
buffer_load_dwordx4 v6, s[20:23], s80 offen offset:0 lds
v_mfma_f32_16x16x32_bf16 v[228:231], a[24:27], a[168:171], v[228:231]
ds_read_b64_tr_b16 a[10:11], v28 offset:33792
v_mfma_f32_16x16x32_bf16 v[228:231], a[28:31], a[184:187], v[228:231]
ds_read_b64_tr_b16 a[12:13], v28 offset:40960
v_mfma_f32_16x16x32_bf16 v[232:235], a[28:31], a[188:191], v[232:235]
ds_read_b64_tr_b16 a[14:15], v28 offset:41984
v_mfma_f32_16x16x32_bf16 v[232:235], a[24:27], a[172:175], v[232:235]
buffer_load_dwordx4 v7, s[20:23], s80 offen offset:1024 lds
v_mfma_f32_16x16x32_bf16 v[232:235], a[20:23], a[156:159], v[232:235]
v_mfma_f32_16x16x32_bf16 v[232:235], a[16:19], a[140:143], v[232:235]
s_waitcnt lgkmcnt(6)
v_mfma_f32_16x16x32_bf16 v[108:111], a[0:3], a[160:163], v[108:111]
s_waitcnt lgkmcnt(4)
ds_read_b64_tr_b16 a[16:17], v29 offset:16384
v_mfma_f32_16x16x32_bf16 v[108:111], a[4:7], a[176:179], v[108:111]
s_waitcnt vmcnt(21) lgkmcnt(3)
buffer_load_dwordx4 v8, s[20:23], s80 offen offset:2048 lds
v_mfma_f32_16x16x32_bf16 v[108:111], a[8:11], a[192:195], v[108:111]
s_waitcnt vmcnt(18) lgkmcnt(1)
ds_read_b64_tr_b16 a[18:19], v29 offset:17408
v_mfma_f32_16x16x32_bf16 v[108:111], a[12:15], a[208:211], v[108:111]
s_waitcnt vmcnt(17)
v_mfma_f32_16x16x32_bf16 v[112:115], a[12:15], a[212:215], v[112:115]
ds_read_b64_tr_b16 a[20:21], v29 offset:24576
v_mfma_f32_16x16x32_bf16 v[112:115], a[8:11], a[196:199], v[112:115]
buffer_load_dwordx4 v9, s[20:23], s80 offen offset:3072 lds
v_mfma_f32_16x16x32_bf16 v[112:115], a[4:7], a[180:183], v[112:115]
s_add_u32 s80, s80, s76
ds_read_b64_tr_b16 a[22:23], v29 offset:25600
v_mfma_f32_16x16x32_bf16 v[112:115], a[0:3], a[164:167], v[112:115]
v_mfma_f32_16x16x32_bf16 v[116:119], a[0:3], a[168:171], v[116:119]
ds_read_b64_tr_b16 a[24:25], v29 offset:32768
v_mfma_f32_16x16x32_bf16 v[116:119], a[4:7], a[184:187], v[116:119]
buffer_load_dwordx4 a[128:131], v1, s[4:7], s81 offen offset:0 sc1
v_mfma_f32_16x16x32_bf16 v[116:119], a[8:11], a[200:203], v[116:119]
s_waitcnt vmcnt(18)
ds_read_b64_tr_b16 a[26:27], v29 offset:33792
v_mfma_f32_16x16x32_bf16 v[116:119], a[12:15], a[216:219], v[116:119]
s_waitcnt vmcnt(17)
ds_read_b64_tr_b16 a[28:29], v29 offset:40960
v_mfma_f32_16x16x32_bf16 v[120:123], a[12:15], a[220:223], v[120:123]
ds_read_b64_tr_b16 a[30:31], v29 offset:41984
v_mfma_f32_16x16x32_bf16 v[120:123], a[8:11], a[204:207], v[120:123]
buffer_load_dwordx4 a[132:135], v1, s[4:7], s81 offen offset:1024 sc1
v_mfma_f32_16x16x32_bf16 v[120:123], a[4:7], a[188:191], v[120:123]
v_mfma_f32_16x16x32_bf16 v[120:123], a[0:3], a[172:175], v[120:123]
s_waitcnt lgkmcnt(6)
v_mfma_f32_16x16x32_bf16 v[124:127], a[16:19], a[160:163], v[124:127]
s_waitcnt lgkmcnt(4)
ds_read_b64_tr_b16 a[0:1], v30 offset:16384
v_mfma_f32_16x16x32_bf16 v[124:127], a[20:23], a[176:179], v[124:127]
s_waitcnt lgkmcnt(3)
buffer_load_dwordx4 a[136:139], v1, s[4:7], s81 offen offset:2048 sc1
v_mfma_f32_16x16x32_bf16 v[124:127], a[24:27], a[192:195], v[124:127]
s_waitcnt lgkmcnt(1)
ds_read_b64_tr_b16 a[2:3], v30 offset:17408
v_mfma_f32_16x16x32_bf16 v[124:127], a[28:31], a[208:211], v[124:127]
v_mfma_f32_16x16x32_bf16 v[128:131], a[28:31], a[212:215], v[128:131]
ds_read_b64_tr_b16 a[4:5], v30 offset:24576
v_mfma_f32_16x16x32_bf16 v[128:131], a[24:27], a[196:199], v[128:131]
buffer_load_dwordx4 a[140:143], v1, s[4:7], s81 offen offset:3072 sc1
v_mfma_f32_16x16x32_bf16 v[128:131], a[20:23], a[180:183], v[128:131]
ds_read_b64_tr_b16 a[6:7], v30 offset:25600
v_mfma_f32_16x16x32_bf16 v[128:131], a[16:19], a[164:167], v[128:131]
v_mfma_f32_16x16x32_bf16 v[132:135], a[16:19], a[168:171], v[132:135]
ds_read_b64_tr_b16 a[8:9], v30 offset:32768
v_mfma_f32_16x16x32_bf16 v[132:135], a[20:23], a[184:187], v[132:135]
buffer_load_dwordx4 a[144:147], v253, s[4:7], s81 offen offset:0 sc1
v_mfma_f32_16x16x32_bf16 v[132:135], a[24:27], a[200:203], v[132:135]
ds_read_b64_tr_b16 a[10:11], v30 offset:33792
v_mfma_f32_16x16x32_bf16 v[132:135], a[28:31], a[216:219], v[132:135]
ds_read_b64_tr_b16 a[12:13], v30 offset:40960
v_mfma_f32_16x16x32_bf16 v[136:139], a[28:31], a[220:223], v[136:139]
ds_read_b64_tr_b16 a[14:15], v30 offset:41984
v_mfma_f32_16x16x32_bf16 v[136:139], a[24:27], a[204:207], v[136:139]
buffer_load_dwordx4 a[148:151], v253, s[4:7], s81 offen offset:1024 sc1
v_mfma_f32_16x16x32_bf16 v[136:139], a[20:23], a[188:191], v[136:139]
v_mfma_f32_16x16x32_bf16 v[136:139], a[16:19], a[172:175], v[136:139]
s_waitcnt lgkmcnt(6)
v_mfma_f32_16x16x32_bf16 v[140:143], a[0:3], a[160:163], v[140:143]
s_waitcnt lgkmcnt(4)
ds_read_b64_tr_b16 a[16:17], v31 offset:16384
v_mfma_f32_16x16x32_bf16 v[140:143], a[4:7], a[176:179], v[140:143]
s_waitcnt lgkmcnt(3)
buffer_load_dwordx4 a[152:155], v253, s[4:7], s81 offen offset:2048 sc1
v_mfma_f32_16x16x32_bf16 v[140:143], a[8:11], a[192:195], v[140:143]
s_waitcnt lgkmcnt(1)
ds_read_b64_tr_b16 a[18:19], v31 offset:17408
v_mfma_f32_16x16x32_bf16 v[140:143], a[12:15], a[208:211], v[140:143]
v_mfma_f32_16x16x32_bf16 v[144:147], a[12:15], a[212:215], v[144:147]
ds_read_b64_tr_b16 a[20:21], v31 offset:24576
v_mfma_f32_16x16x32_bf16 v[144:147], a[8:11], a[196:199], v[144:147]
buffer_load_dwordx4 a[156:159], v253, s[4:7], s81 offen offset:3072 sc1
v_mfma_f32_16x16x32_bf16 v[144:147], a[4:7], a[180:183], v[144:147]
s_add_u32 s81, s81, s78
ds_read_b64_tr_b16 a[22:23], v31 offset:25600
v_mfma_f32_16x16x32_bf16 v[144:147], a[0:3], a[164:167], v[144:147]
v_mfma_f32_16x16x32_bf16 v[148:151], a[0:3], a[168:171], v[148:151]
ds_read_b64_tr_b16 a[24:25], v31 offset:32768
v_mfma_f32_16x16x32_bf16 v[148:151], a[4:7], a[184:187], v[148:151]
global_load_dword a60, v42, s[56:57]
v_mfma_f32_16x16x32_bf16 v[148:151], a[8:11], a[200:203], v[148:151]
ds_read_b64_tr_b16 a[26:27], v31 offset:33792
v_mfma_f32_16x16x32_bf16 v[148:151], a[12:15], a[216:219], v[148:151]
ds_read_b64_tr_b16 a[28:29], v31 offset:40960
v_mfma_f32_16x16x32_bf16 v[152:155], a[12:15], a[220:223], v[152:155]
ds_read_b64_tr_b16 a[30:31], v31 offset:41984
v_mfma_f32_16x16x32_bf16 v[152:155], a[8:11], a[204:207], v[152:155]
v_mfma_f32_16x16x32_bf16 v[152:155], a[4:7], a[188:191], v[152:155]
v_mfma_f32_16x16x32_bf16 v[152:155], a[0:3], a[172:175], v[152:155]
s_waitcnt lgkmcnt(6)
v_mfma_f32_16x16x32_bf16 v[156:159], a[16:19], a[160:163], v[156:159]
s_waitcnt lgkmcnt(4)
ds_read_b64_tr_b16 a[0:1], v32 offset:32768
v_mfma_f32_16x16x32_bf16 v[156:159], a[20:23], a[176:179], v[156:159]
s_waitcnt lgkmcnt(3)
v_mfma_f32_16x16x32_bf16 v[156:159], a[24:27], a[192:195], v[156:159]
s_waitcnt lgkmcnt(1)
ds_read_b64_tr_b16 a[2:3], v32 offset:33792
v_mfma_f32_16x16x32_bf16 v[156:159], a[28:31], a[208:211], v[156:159]
v_mfma_f32_16x16x32_bf16 v[160:163], a[28:31], a[212:215], v[160:163]
ds_read_b64_tr_b16 a[4:5], v32 offset:40960
v_mfma_f32_16x16x32_bf16 v[160:163], a[24:27], a[196:199], v[160:163]
v_mfma_f32_16x16x32_bf16 v[160:163], a[20:23], a[180:183], v[160:163]
ds_read_b64_tr_b16 a[6:7], v32 offset:41984
v_mfma_f32_16x16x32_bf16 v[160:163], a[16:19], a[164:167], v[160:163]
s_waitcnt vmcnt(21)
s_barrier
v_mfma_f32_16x16x32_bf16 v[164:167], a[16:19], a[168:171], v[164:167]
s_add_u32 m0, s37, 114688
ds_read_b64_tr_b16 a[8:9], v32 offset:49152
v_mfma_f32_16x16x32_bf16 v[164:167], a[20:23], a[184:187], v[164:167]
buffer_load_dwordx4 v6, s[20:23], s80 offen offset:0 lds
v_mfma_f32_16x16x32_bf16 v[164:167], a[24:27], a[200:203], v[164:167]
ds_read_b64_tr_b16 a[10:11], v32 offset:50176
v_mfma_f32_16x16x32_bf16 v[164:167], a[28:31], a[216:219], v[164:167]
ds_read_b64_tr_b16 a[12:13], v32 offset:57344
v_mfma_f32_16x16x32_bf16 v[168:171], a[28:31], a[220:223], v[168:171]
ds_read_b64_tr_b16 a[14:15], v32 offset:58368
v_mfma_f32_16x16x32_bf16 v[168:171], a[24:27], a[204:207], v[168:171]
buffer_load_dwordx4 v7, s[20:23], s80 offen offset:1024 lds
v_mfma_f32_16x16x32_bf16 v[168:171], a[20:23], a[188:191], v[168:171]
v_mfma_f32_16x16x32_bf16 v[168:171], a[16:19], a[172:175], v[168:171]
s_waitcnt lgkmcnt(6)
v_mfma_f32_16x16x32_bf16 v[172:175], a[0:3], a[192:195], v[172:175]
s_waitcnt lgkmcnt(4)
ds_read_b64_tr_b16 a[16:17], v33 offset:32768
v_mfma_f32_16x16x32_bf16 v[172:175], a[4:7], a[208:211], v[172:175]
s_waitcnt vmcnt(22) lgkmcnt(3)
buffer_load_dwordx4 v8, s[20:23], s80 offen offset:2048 lds
v_mfma_f32_16x16x32_bf16 v[172:175], a[8:11], a[224:227], v[172:175]
s_waitcnt vmcnt(19) lgkmcnt(1)
ds_read_b64_tr_b16 a[18:19], v33 offset:33792
v_mfma_f32_16x16x32_bf16 v[172:175], a[12:15], a[240:243], v[172:175]
s_waitcnt vmcnt(18)
v_mfma_f32_16x16x32_bf16 v[176:179], a[12:15], a[244:247], v[176:179]
ds_read_b64_tr_b16 a[20:21], v33 offset:40960
v_mfma_f32_16x16x32_bf16 v[176:179], a[8:11], a[228:231], v[176:179]
buffer_load_dwordx4 v9, s[20:23], s80 offen offset:3072 lds
v_mfma_f32_16x16x32_bf16 v[176:179], a[4:7], a[212:215], v[176:179]
s_add_u32 s80, s80, s77
ds_read_b64_tr_b16 a[22:23], v33 offset:41984
v_mfma_f32_16x16x32_bf16 v[176:179], a[0:3], a[196:199], v[176:179]
v_mfma_f32_16x16x32_bf16 v[180:183], a[0:3], a[200:203], v[180:183]
ds_read_b64_tr_b16 a[24:25], v33 offset:49152
v_mfma_f32_16x16x32_bf16 v[180:183], a[4:7], a[216:219], v[180:183]
buffer_load_dwordx4 a[160:163], v1, s[4:7], s81 offen offset:0 sc1
v_mfma_f32_16x16x32_bf16 v[180:183], a[8:11], a[232:235], v[180:183]
s_waitcnt vmcnt(19)
ds_read_b64_tr_b16 a[26:27], v33 offset:50176
v_mfma_f32_16x16x32_bf16 v[180:183], a[12:15], a[248:251], v[180:183]
s_waitcnt vmcnt(18)
ds_read_b64_tr_b16 a[28:29], v33 offset:57344
v_mfma_f32_16x16x32_bf16 v[184:187], a[12:15], a[252:255], v[184:187]
ds_read_b64_tr_b16 a[30:31], v33 offset:58368
v_mfma_f32_16x16x32_bf16 v[184:187], a[8:11], a[236:239], v[184:187]
buffer_load_dwordx4 a[164:167], v1, s[4:7], s81 offen offset:1024 sc1
v_mfma_f32_16x16x32_bf16 v[184:187], a[4:7], a[220:223], v[184:187]
v_mfma_f32_16x16x32_bf16 v[184:187], a[0:3], a[204:207], v[184:187]
s_waitcnt lgkmcnt(6)
v_mfma_f32_16x16x32_bf16 v[188:191], a[16:19], a[192:195], v[188:191]
s_waitcnt lgkmcnt(4)
ds_read_b64_tr_b16 a[0:1], v34 offset:32768
v_mfma_f32_16x16x32_bf16 v[188:191], a[20:23], a[208:211], v[188:191]
s_waitcnt lgkmcnt(3)
buffer_load_dwordx4 a[168:171], v1, s[4:7], s81 offen offset:2048 sc1
v_mfma_f32_16x16x32_bf16 v[188:191], a[24:27], a[224:227], v[188:191]
s_waitcnt lgkmcnt(1)
ds_read_b64_tr_b16 a[2:3], v34 offset:33792
v_mfma_f32_16x16x32_bf16 v[188:191], a[28:31], a[240:243], v[188:191]
v_mfma_f32_16x16x32_bf16 v[192:195], a[28:31], a[244:247], v[192:195]
ds_read_b64_tr_b16 a[4:5], v34 offset:40960
v_mfma_f32_16x16x32_bf16 v[192:195], a[24:27], a[228:231], v[192:195]
buffer_load_dwordx4 a[172:175], v1, s[4:7], s81 offen offset:3072 sc1
v_mfma_f32_16x16x32_bf16 v[192:195], a[20:23], a[212:215], v[192:195]
ds_read_b64_tr_b16 a[6:7], v34 offset:41984
v_mfma_f32_16x16x32_bf16 v[192:195], a[16:19], a[196:199], v[192:195]
v_mfma_f32_16x16x32_bf16 v[196:199], a[16:19], a[200:203], v[196:199]
ds_read_b64_tr_b16 a[8:9], v34 offset:49152
v_mfma_f32_16x16x32_bf16 v[196:199], a[20:23], a[216:219], v[196:199]
buffer_load_dwordx4 a[176:179], v253, s[4:7], s81 offen offset:0 sc1
v_mfma_f32_16x16x32_bf16 v[196:199], a[24:27], a[232:235], v[196:199]
ds_read_b64_tr_b16 a[10:11], v34 offset:50176
v_mfma_f32_16x16x32_bf16 v[196:199], a[28:31], a[248:251], v[196:199]
ds_read_b64_tr_b16 a[12:13], v34 offset:57344
v_mfma_f32_16x16x32_bf16 v[200:203], a[28:31], a[252:255], v[200:203]
ds_read_b64_tr_b16 a[14:15], v34 offset:58368
v_mfma_f32_16x16x32_bf16 v[200:203], a[24:27], a[236:239], v[200:203]
buffer_load_dwordx4 a[180:183], v253, s[4:7], s81 offen offset:1024 sc1
v_mfma_f32_16x16x32_bf16 v[200:203], a[20:23], a[220:223], v[200:203]
v_mfma_f32_16x16x32_bf16 v[200:203], a[16:19], a[204:207], v[200:203]
s_waitcnt lgkmcnt(6)
v_mfma_f32_16x16x32_bf16 v[204:207], a[0:3], a[192:195], v[204:207]
s_waitcnt lgkmcnt(4)
ds_read_b64_tr_b16 a[16:17], v35 offset:32768
v_mfma_f32_16x16x32_bf16 v[204:207], a[4:7], a[208:211], v[204:207]
s_waitcnt lgkmcnt(3)
buffer_load_dwordx4 a[184:187], v253, s[4:7], s81 offen offset:2048 sc1
v_mfma_f32_16x16x32_bf16 v[204:207], a[8:11], a[224:227], v[204:207]
s_waitcnt lgkmcnt(1)
ds_read_b64_tr_b16 a[18:19], v35 offset:33792
v_mfma_f32_16x16x32_bf16 v[204:207], a[12:15], a[240:243], v[204:207]
v_mfma_f32_16x16x32_bf16 v[208:211], a[12:15], a[244:247], v[208:211]
ds_read_b64_tr_b16 a[20:21], v35 offset:40960
v_mfma_f32_16x16x32_bf16 v[208:211], a[8:11], a[228:231], v[208:211]
buffer_load_dwordx4 a[188:191], v253, s[4:7], s81 offen offset:3072 sc1
v_mfma_f32_16x16x32_bf16 v[208:211], a[4:7], a[212:215], v[208:211]
s_add_u32 s81, s81, s79
ds_read_b64_tr_b16 a[22:23], v35 offset:41984
v_mfma_f32_16x16x32_bf16 v[208:211], a[0:3], a[196:199], v[208:211]
v_mfma_f32_16x16x32_bf16 v[212:215], a[0:3], a[200:203], v[212:215]
ds_read_b64_tr_b16 a[24:25], v35 offset:49152
v_mfma_f32_16x16x32_bf16 v[212:215], a[4:7], a[216:219], v[212:215]
v_mfma_f32_16x16x32_bf16 v[212:215], a[8:11], a[232:235], v[212:215]
ds_read_b64_tr_b16 a[26:27], v35 offset:50176
v_mfma_f32_16x16x32_bf16 v[212:215], a[12:15], a[248:251], v[212:215]
ds_read_b64_tr_b16 a[28:29], v35 offset:57344
v_mfma_f32_16x16x32_bf16 v[216:219], a[12:15], a[252:255], v[216:219]
ds_read_b64_tr_b16 a[30:31], v35 offset:58368
v_mfma_f32_16x16x32_bf16 v[216:219], a[8:11], a[236:239], v[216:219]
v_mfma_f32_16x16x32_bf16 v[216:219], a[4:7], a[220:223], v[216:219]
v_mfma_f32_16x16x32_bf16 v[216:219], a[0:3], a[204:207], v[216:219]
s_waitcnt lgkmcnt(6)
v_mfma_f32_16x16x32_bf16 v[220:223], a[16:19], a[192:195], v[220:223]
s_waitcnt lgkmcnt(4)
ds_read_b64_tr_b16 a[0:1], v28 offset:49152
v_mfma_f32_16x16x32_bf16 v[220:223], a[20:23], a[208:211], v[220:223]
s_waitcnt lgkmcnt(3)
v_mfma_f32_16x16x32_bf16 v[220:223], a[24:27], a[224:227], v[220:223]
s_waitcnt lgkmcnt(1)
ds_read_b64_tr_b16 a[2:3], v28 offset:50176
v_mfma_f32_16x16x32_bf16 v[220:223], a[28:31], a[240:243], v[220:223]
v_mfma_f32_16x16x32_bf16 v[224:227], a[28:31], a[244:247], v[224:227]
ds_read_b64_tr_b16 a[4:5], v28 offset:57344
v_mfma_f32_16x16x32_bf16 v[224:227], a[24:27], a[228:231], v[224:227]
v_mfma_f32_16x16x32_bf16 v[224:227], a[20:23], a[212:215], v[224:227]
ds_read_b64_tr_b16 a[6:7], v28 offset:58368
v_mfma_f32_16x16x32_bf16 v[224:227], a[16:19], a[196:199], v[224:227]
s_waitcnt vmcnt(21)
s_barrier
v_mfma_f32_16x16x32_bf16 v[228:231], a[16:19], a[200:203], v[228:231]
s_add_u32 m0, s37, 131072
ds_read_b64_tr_b16 a[8:9], v28 offset:0
v_mfma_f32_16x16x32_bf16 v[228:231], a[20:23], a[216:219], v[228:231]
buffer_load_dwordx4 v6, s[20:23], s80 offen offset:0 lds
v_mfma_f32_16x16x32_bf16 v[228:231], a[24:27], a[232:235], v[228:231]
ds_read_b64_tr_b16 a[10:11], v28 offset:1024
v_mfma_f32_16x16x32_bf16 v[228:231], a[28:31], a[248:251], v[228:231]
ds_read_b64_tr_b16 a[12:13], v28 offset:8192
v_mfma_f32_16x16x32_bf16 v[232:235], a[28:31], a[252:255], v[232:235]
ds_read_b64_tr_b16 a[14:15], v28 offset:9216
v_mfma_f32_16x16x32_bf16 v[232:235], a[24:27], a[236:239], v[232:235]
buffer_load_dwordx4 v7, s[20:23], s80 offen offset:1024 lds
v_mfma_f32_16x16x32_bf16 v[232:235], a[20:23], a[220:223], v[232:235]
v_mfma_f32_16x16x32_bf16 v[232:235], a[16:19], a[204:207], v[232:235]
s_waitcnt lgkmcnt(6)
v_mfma_f32_16x16x32_bf16 v[108:111], a[0:3], a[224:227], v[108:111]
s_waitcnt lgkmcnt(4)
ds_read_b64_tr_b16 a[16:17], v29 offset:49152
v_mfma_f32_16x16x32_bf16 v[108:111], a[4:7], a[240:243], v[108:111]
s_waitcnt vmcnt(22) lgkmcnt(3)
buffer_load_dwordx4 v8, s[20:23], s80 offen offset:2048 lds
v_mfma_f32_16x16x32_bf16 v[108:111], a[8:11], a[128:131], v[108:111]
s_waitcnt vmcnt(19) lgkmcnt(1)
ds_read_b64_tr_b16 a[18:19], v29 offset:50176
v_mfma_f32_16x16x32_bf16 v[108:111], a[12:15], a[144:147], v[108:111]
s_waitcnt vmcnt(18)
v_mfma_f32_16x16x32_bf16 v[112:115], a[12:15], a[148:151], v[112:115]
ds_read_b64_tr_b16 a[20:21], v29 offset:57344
v_mfma_f32_16x16x32_bf16 v[112:115], a[8:11], a[132:135], v[112:115]
buffer_load_dwordx4 v9, s[20:23], s80 offen offset:3072 lds
v_mfma_f32_16x16x32_bf16 v[112:115], a[4:7], a[244:247], v[112:115]
s_add_u32 s80, s80, s76
ds_read_b64_tr_b16 a[22:23], v29 offset:58368
v_mfma_f32_16x16x32_bf16 v[112:115], a[0:3], a[228:231], v[112:115]
v_mfma_f32_16x16x32_bf16 v[116:119], a[0:3], a[232:235], v[116:119]
ds_read_b64_tr_b16 a[24:25], v29 offset:0
v_mfma_f32_16x16x32_bf16 v[116:119], a[4:7], a[248:251], v[116:119]
buffer_load_dwordx4 a[192:195], v1, s[4:7], s81 offen offset:0 sc1
v_mfma_f32_16x16x32_bf16 v[116:119], a[8:11], a[136:139], v[116:119]
s_waitcnt vmcnt(19)
ds_read_b64_tr_b16 a[26:27], v29 offset:1024
v_mfma_f32_16x16x32_bf16 v[116:119], a[12:15], a[152:155], v[116:119]
s_waitcnt vmcnt(18)
ds_read_b64_tr_b16 a[28:29], v29 offset:8192
v_mfma_f32_16x16x32_bf16 v[120:123], a[12:15], a[156:159], v[120:123]
ds_read_b64_tr_b16 a[30:31], v29 offset:9216
v_mfma_f32_16x16x32_bf16 v[120:123], a[8:11], a[140:143], v[120:123]
buffer_load_dwordx4 a[196:199], v1, s[4:7], s81 offen offset:1024 sc1
v_mfma_f32_16x16x32_bf16 v[120:123], a[4:7], a[252:255], v[120:123]
v_mfma_f32_16x16x32_bf16 v[120:123], a[0:3], a[236:239], v[120:123]
s_waitcnt lgkmcnt(6)
v_mfma_f32_16x16x32_bf16 v[124:127], a[16:19], a[224:227], v[124:127]
s_waitcnt lgkmcnt(4)
ds_read_b64_tr_b16 a[0:1], v30 offset:49152
v_mfma_f32_16x16x32_bf16 v[124:127], a[20:23], a[240:243], v[124:127]
s_waitcnt lgkmcnt(3)
buffer_load_dwordx4 a[200:203], v1, s[4:7], s81 offen offset:2048 sc1
v_mfma_f32_16x16x32_bf16 v[124:127], a[24:27], a[128:131], v[124:127]
s_waitcnt lgkmcnt(1)
ds_read_b64_tr_b16 a[2:3], v30 offset:50176
v_mfma_f32_16x16x32_bf16 v[124:127], a[28:31], a[144:147], v[124:127]
v_mfma_f32_16x16x32_bf16 v[128:131], a[28:31], a[148:151], v[128:131]
ds_read_b64_tr_b16 a[4:5], v30 offset:57344
v_mfma_f32_16x16x32_bf16 v[128:131], a[24:27], a[132:135], v[128:131]
buffer_load_dwordx4 a[204:207], v1, s[4:7], s81 offen offset:3072 sc1
v_mfma_f32_16x16x32_bf16 v[128:131], a[20:23], a[244:247], v[128:131]
ds_read_b64_tr_b16 a[6:7], v30 offset:58368
v_mfma_f32_16x16x32_bf16 v[128:131], a[16:19], a[228:231], v[128:131]
v_mfma_f32_16x16x32_bf16 v[132:135], a[16:19], a[232:235], v[132:135]
ds_read_b64_tr_b16 a[8:9], v30 offset:0
v_mfma_f32_16x16x32_bf16 v[132:135], a[20:23], a[248:251], v[132:135]
buffer_load_dwordx4 a[208:211], v253, s[4:7], s81 offen offset:0 sc1
v_mfma_f32_16x16x32_bf16 v[132:135], a[24:27], a[136:139], v[132:135]
ds_read_b64_tr_b16 a[10:11], v30 offset:1024
v_mfma_f32_16x16x32_bf16 v[132:135], a[28:31], a[152:155], v[132:135]
ds_read_b64_tr_b16 a[12:13], v30 offset:8192
v_mfma_f32_16x16x32_bf16 v[136:139], a[28:31], a[156:159], v[136:139]
ds_read_b64_tr_b16 a[14:15], v30 offset:9216
v_mfma_f32_16x16x32_bf16 v[136:139], a[24:27], a[140:143], v[136:139]
buffer_load_dwordx4 a[212:215], v253, s[4:7], s81 offen offset:1024 sc1
v_mfma_f32_16x16x32_bf16 v[136:139], a[20:23], a[252:255], v[136:139]
v_mfma_f32_16x16x32_bf16 v[136:139], a[16:19], a[236:239], v[136:139]
s_waitcnt lgkmcnt(6)
v_mfma_f32_16x16x32_bf16 v[140:143], a[0:3], a[224:227], v[140:143]
s_waitcnt lgkmcnt(4)
ds_read_b64_tr_b16 a[16:17], v31 offset:49152
v_mfma_f32_16x16x32_bf16 v[140:143], a[4:7], a[240:243], v[140:143]
s_waitcnt lgkmcnt(3)
buffer_load_dwordx4 a[216:219], v253, s[4:7], s81 offen offset:2048 sc1
v_mfma_f32_16x16x32_bf16 v[140:143], a[8:11], a[128:131], v[140:143]
s_waitcnt lgkmcnt(1)
ds_read_b64_tr_b16 a[18:19], v31 offset:50176
v_mfma_f32_16x16x32_bf16 v[140:143], a[12:15], a[144:147], v[140:143]
v_mfma_f32_16x16x32_bf16 v[144:147], a[12:15], a[148:151], v[144:147]
ds_read_b64_tr_b16 a[20:21], v31 offset:57344
v_mfma_f32_16x16x32_bf16 v[144:147], a[8:11], a[132:135], v[144:147]
buffer_load_dwordx4 a[220:223], v253, s[4:7], s81 offen offset:3072 sc1
v_mfma_f32_16x16x32_bf16 v[144:147], a[4:7], a[244:247], v[144:147]
s_add_u32 s81, s81, s78
ds_read_b64_tr_b16 a[22:23], v31 offset:58368
v_mfma_f32_16x16x32_bf16 v[144:147], a[0:3], a[228:231], v[144:147]
v_mfma_f32_16x16x32_bf16 v[148:151], a[0:3], a[232:235], v[148:151]
ds_read_b64_tr_b16 a[24:25], v31 offset:0
v_mfma_f32_16x16x32_bf16 v[148:151], a[4:7], a[248:251], v[148:151]
v_mfma_f32_16x16x32_bf16 v[148:151], a[8:11], a[136:139], v[148:151]
ds_read_b64_tr_b16 a[26:27], v31 offset:1024
v_mfma_f32_16x16x32_bf16 v[148:151], a[12:15], a[152:155], v[148:151]
ds_read_b64_tr_b16 a[28:29], v31 offset:8192
v_mfma_f32_16x16x32_bf16 v[152:155], a[12:15], a[156:159], v[152:155]
ds_read_b64_tr_b16 a[30:31], v31 offset:9216
v_mfma_f32_16x16x32_bf16 v[152:155], a[8:11], a[140:143], v[152:155]
v_mfma_f32_16x16x32_bf16 v[152:155], a[4:7], a[252:255], v[152:155]
v_mfma_f32_16x16x32_bf16 v[152:155], a[0:3], a[236:239], v[152:155]
s_waitcnt lgkmcnt(6)
v_mfma_f32_16x16x32_bf16 v[156:159], a[16:19], a[224:227], v[156:159]
s_waitcnt lgkmcnt(4)
ds_read_b64_tr_b16 a[0:1], v32 offset:0
v_mfma_f32_16x16x32_bf16 v[156:159], a[20:23], a[240:243], v[156:159]
s_waitcnt lgkmcnt(3)
v_mfma_f32_16x16x32_bf16 v[156:159], a[24:27], a[128:131], v[156:159]
s_waitcnt lgkmcnt(1)
ds_read_b64_tr_b16 a[2:3], v32 offset:1024
v_mfma_f32_16x16x32_bf16 v[156:159], a[28:31], a[144:147], v[156:159]
v_mfma_f32_16x16x32_bf16 v[160:163], a[28:31], a[148:151], v[160:163]
ds_read_b64_tr_b16 a[4:5], v32 offset:8192
v_mfma_f32_16x16x32_bf16 v[160:163], a[24:27], a[132:135], v[160:163]
v_mfma_f32_16x16x32_bf16 v[160:163], a[20:23], a[244:247], v[160:163]
ds_read_b64_tr_b16 a[6:7], v32 offset:9216
v_mfma_f32_16x16x32_bf16 v[160:163], a[16:19], a[228:231], v[160:163]
s_waitcnt vmcnt(20)
s_barrier
v_mfma_f32_16x16x32_bf16 v[164:167], a[16:19], a[232:235], v[164:167]
s_add_u32 m0, s37, 147456
ds_read_b64_tr_b16 a[8:9], v32 offset:16384
v_mfma_f32_16x16x32_bf16 v[164:167], a[20:23], a[248:251], v[164:167]
buffer_load_dwordx4 v6, s[20:23], s80 offen offset:0 lds
v_mfma_f32_16x16x32_bf16 v[164:167], a[24:27], a[136:139], v[164:167]
ds_read_b64_tr_b16 a[10:11], v32 offset:17408
v_mfma_f32_16x16x32_bf16 v[164:167], a[28:31], a[152:155], v[164:167]
ds_read_b64_tr_b16 a[12:13], v32 offset:24576
v_mfma_f32_16x16x32_bf16 v[168:171], a[28:31], a[156:159], v[168:171]
ds_read_b64_tr_b16 a[14:15], v32 offset:25600
v_mfma_f32_16x16x32_bf16 v[168:171], a[24:27], a[140:143], v[168:171]
buffer_load_dwordx4 v7, s[20:23], s80 offen offset:1024 lds
v_mfma_f32_16x16x32_bf16 v[168:171], a[20:23], a[252:255], v[168:171]
v_mfma_f32_16x16x32_bf16 v[168:171], a[16:19], a[236:239], v[168:171]
s_waitcnt lgkmcnt(6)
s_add_u32 s38, s38, 1
s_cbranch_scc0 L2_g
v_mfma_f32_16x16x32_bf16 v[172:175], a[0:3], a[128:131], v[172:175]
s_waitcnt lgkmcnt(4)
s_lshl_b32 s50, s62, 19
ds_read_b64_tr_b16 a[16:17], v33 offset:0
v_mfma_f32_16x16x32_bf16 v[172:175], a[4:7], a[144:147], v[172:175]
s_waitcnt vmcnt(21) lgkmcnt(3)
buffer_load_dwordx4 v8, s[20:23], s80 offen offset:2048 lds
v_mfma_f32_16x16x32_bf16 v[172:175], a[8:11], a[160:163], v[172:175]
s_waitcnt vmcnt(18) lgkmcnt(1)
s_mov_b32 s41, s50
ds_read_b64_tr_b16 a[18:19], v33 offset:1024
v_mfma_f32_16x16x32_bf16 v[172:175], a[12:15], a[176:179], v[172:175]
s_waitcnt vmcnt(17)
s_mov_b32 s42, s50
v_bfe_u32 v38, v0, 4, 2
v_mfma_f32_16x16x32_bf16 v[176:179], a[12:15], a[180:183], v[176:179]
ds_read_b64_tr_b16 a[20:21], v33 offset:8192
v_lshrrev_b32 v39, 6, v0
v_mfma_f32_16x16x32_bf16 v[176:179], a[8:11], a[164:167], v[176:179]
buffer_load_dwordx4 v9, s[20:23], s80 offen offset:3072 lds
v_mfma_f32_16x16x32_bf16 v[176:179], a[4:7], a[148:151], v[176:179]
s_add_u32 s80, s80, s77
ds_read_b64_tr_b16 a[22:23], v33 offset:9216
v_lshl_add_u32 v39, v39, 4, v38
v_mfma_f32_16x16x32_bf16 v[176:179], a[0:3], a[132:135], v[176:179]
v_lshlrev_b32 v39, 8, v39
v_and_b32 v40, 15, v0
v_mfma_f32_16x16x32_bf16 v[180:183], a[0:3], a[136:139], v[180:183]
ds_read_b64_tr_b16 a[24:25], v33 offset:16384
v_or_b32 v41, 0, v38
v_mfma_f32_16x16x32_bf16 v[180:183], a[4:7], a[152:155], v[180:183]
buffer_load_dwordx4 a[224:227], v1, s[4:7], s81 offen offset:0 sc1
v_mfma_f32_16x16x32_bf16 v[180:183], a[8:11], a[168:171], v[180:183]
s_waitcnt vmcnt(18)
ds_read_b64_tr_b16 a[26:27], v33 offset:17408
v_xor_b32 v41, v41, v40
v_mfma_f32_16x16x32_bf16 v[180:183], a[12:15], a[184:187], v[180:183]
s_waitcnt vmcnt(17)
ds_read_b64_tr_b16 a[28:29], v33 offset:24576
v_lshl_add_u32 v10, v41, 4, v39
v_mfma_f32_16x16x32_bf16 v[184:187], a[12:15], a[188:191], v[184:187]
ds_read_b64_tr_b16 a[30:31], v33 offset:25600
v_or_b32 v41, 4, v38
v_mfma_f32_16x16x32_bf16 v[184:187], a[8:11], a[172:175], v[184:187]
buffer_load_dwordx4 a[228:231], v1, s[4:7], s81 offen offset:1024 sc1
v_mfma_f32_16x16x32_bf16 v[184:187], a[4:7], a[156:159], v[184:187]
v_xor_b32 v41, v41, v40
v_lshl_add_u32 v11, v41, 4, v39
v_mfma_f32_16x16x32_bf16 v[184:187], a[0:3], a[140:143], v[184:187]
s_waitcnt lgkmcnt(6)
v_or_b32 v41, 8, v38
v_xor_b32 v41, v41, v40
v_mfma_f32_16x16x32_bf16 v[188:191], a[16:19], a[128:131], v[188:191]
s_waitcnt lgkmcnt(4)
ds_read_b64_tr_b16 a[0:1], v34 offset:0
v_lshl_add_u32 v12, v41, 4, v39
v_mfma_f32_16x16x32_bf16 v[188:191], a[20:23], a[144:147], v[188:191]
s_waitcnt lgkmcnt(3)
buffer_load_dwordx4 a[232:235], v1, s[4:7], s81 offen offset:2048 sc1
v_mfma_f32_16x16x32_bf16 v[188:191], a[24:27], a[160:163], v[188:191]
s_waitcnt lgkmcnt(1)
ds_read_b64_tr_b16 a[2:3], v34 offset:1024
v_or_b32 v41, 12, v38
v_mfma_f32_16x16x32_bf16 v[188:191], a[28:31], a[176:179], v[188:191]
v_xor_b32 v41, v41, v40
v_lshl_add_u32 v13, v41, 4, v39
v_mfma_f32_16x16x32_bf16 v[192:195], a[28:31], a[180:183], v[192:195]
ds_read_b64_tr_b16 a[4:5], v34 offset:8192
v_or_b32 v41, 0, v38
v_mfma_f32_16x16x32_bf16 v[192:195], a[24:27], a[164:167], v[192:195]
buffer_load_dwordx4 a[236:239], v1, s[4:7], s81 offen offset:3072 sc1
v_mfma_f32_16x16x32_bf16 v[192:195], a[20:23], a[148:151], v[192:195]
ds_read_b64_tr_b16 a[6:7], v34 offset:9216
v_lshlrev_b32 v41, 1, v41
v_mfma_f32_16x16x32_bf16 v[192:195], a[16:19], a[132:135], v[192:195]
v_xor_b32 v41, v41, v40
v_lshl_add_u32 v14, v41, 4, v39
v_mfma_f32_16x16x32_bf16 v[196:199], a[16:19], a[136:139], v[196:199]
ds_read_b64_tr_b16 a[8:9], v34 offset:16384
v_or_b32 v41, 4, v38
v_mfma_f32_16x16x32_bf16 v[196:199], a[20:23], a[152:155], v[196:199]
buffer_load_dwordx4 a[240:243], v253, s[4:7], s81 offen offset:0 sc1
v_mfma_f32_16x16x32_bf16 v[196:199], a[24:27], a[168:171], v[196:199]
ds_read_b64_tr_b16 a[10:11], v34 offset:17408
v_lshlrev_b32 v41, 1, v41
v_mfma_f32_16x16x32_bf16 v[196:199], a[28:31], a[184:187], v[196:199]
ds_read_b64_tr_b16 a[12:13], v34 offset:24576
v_xor_b32 v41, v41, v40
v_mfma_f32_16x16x32_bf16 v[200:203], a[28:31], a[188:191], v[200:203]
ds_read_b64_tr_b16 a[14:15], v34 offset:25600
v_lshl_add_u32 v15, v41, 4, v39
v_mfma_f32_16x16x32_bf16 v[200:203], a[24:27], a[172:175], v[200:203]
buffer_load_dwordx4 a[244:247], v253, s[4:7], s81 offen offset:1024 sc1
v_mfma_f32_16x16x32_bf16 v[200:203], a[20:23], a[156:159], v[200:203]
v_and_b32 v39, 1, v38
v_lshlrev_b32 v39, 1, v39
v_mfma_f32_16x16x32_bf16 v[200:203], a[16:19], a[140:143], v[200:203]
s_waitcnt lgkmcnt(6)
v_lshrrev_b32 v41, 1, v38
v_or_b32 v39, v39, v41
v_mfma_f32_16x16x32_bf16 v[204:207], a[0:3], a[128:131], v[204:207]
s_waitcnt lgkmcnt(4)
s_lshl_b32 s54, s36, 2
ds_read_b64_tr_b16 a[16:17], v35 offset:0
v_mfma_f32_16x16x32_bf16 v[204:207], a[4:7], a[144:147], v[204:207]
s_waitcnt lgkmcnt(3)
buffer_load_dwordx4 a[248:251], v253, s[4:7], s81 offen offset:2048 sc1
v_mfma_f32_16x16x32_bf16 v[204:207], a[8:11], a[160:163], v[204:207]
s_waitcnt lgkmcnt(1)
ds_read_b64_tr_b16 a[18:19], v35 offset:1024
v_xor_b32 v39, s54, v39
v_mfma_f32_16x16x32_bf16 v[204:207], a[12:15], a[176:179], v[204:207]
v_xor_b32 v39, v39, v40
v_lshlrev_b32 v40, 8, v40
v_mfma_f32_16x16x32_bf16 v[208:211], a[12:15], a[180:183], v[208:211]
ds_read_b64_tr_b16 a[20:21], v35 offset:8192
v_xor_b32 v41, 0, v39
v_mfma_f32_16x16x32_bf16 v[208:211], a[8:11], a[164:167], v[208:211]
buffer_load_dwordx4 a[252:255], v253, s[4:7], s81 offen offset:3072 sc1
v_mfma_f32_16x16x32_bf16 v[208:211], a[4:7], a[148:151], v[208:211]
s_add_u32 s81, s81, s79
ds_read_b64_tr_b16 a[22:23], v35 offset:9216
v_lshl_add_u32 v16, v41, 4, v40
v_mfma_f32_16x16x32_bf16 v[208:211], a[0:3], a[132:135], v[208:211]
v_xor_b32 v41, 4, v39
v_lshl_add_u32 v17, v41, 4, v40
v_mfma_f32_16x16x32_bf16 v[212:215], a[0:3], a[136:139], v[212:215]
ds_read_b64_tr_b16 a[24:25], v35 offset:16384
v_xor_b32 v41, 8, v39
v_mfma_f32_16x16x32_bf16 v[212:215], a[4:7], a[152:155], v[212:215]
v_lshl_add_u32 v18, v41, 4, v40
v_xor_b32 v41, 12, v39
v_mfma_f32_16x16x32_bf16 v[212:215], a[8:11], a[168:171], v[212:215]
ds_read_b64_tr_b16 a[26:27], v35 offset:17408
v_lshl_add_u32 v19, v41, 4, v40
v_mfma_f32_16x16x32_bf16 v[212:215], a[12:15], a[184:187], v[212:215]
ds_read_b64_tr_b16 a[28:29], v35 offset:24576
v_bfe_u32 v38, v0, 4, 2
v_mfma_f32_16x16x32_bf16 v[216:219], a[12:15], a[188:191], v[216:219]
ds_read_b64_tr_b16 a[30:31], v35 offset:25600
v_bfe_u32 v39, v0, 2, 2
v_mfma_f32_16x16x32_bf16 v[216:219], a[8:11], a[172:175], v[216:219]
v_and_b32 v40, 1, v38
v_lshl_or_b32 v40, v40, 2, v39
v_mfma_f32_16x16x32_bf16 v[216:219], a[4:7], a[156:159], v[216:219]
v_lshl_add_u32 v38, v38, 2, v39
v_lshlrev_b32 v38, 8, v38
v_mfma_f32_16x16x32_bf16 v[216:219], a[0:3], a[140:143], v[216:219]
s_waitcnt lgkmcnt(6)
v_and_b32 v39, 3, v0
v_lshl_add_u32 v38, v39, 3, v38
v_mfma_f32_16x16x32_bf16 v[220:223], a[16:19], a[128:131], v[220:223]
s_waitcnt lgkmcnt(4)
ds_read_b64_tr_b16 a[0:1], v28 offset:16384
v_add_u32 v38, 65536, v38
v_mfma_f32_16x16x32_bf16 v[220:223], a[20:23], a[144:147], v[220:223]
s_waitcnt lgkmcnt(3)
v_xor_b32 v39, 0, v40
v_lshl_add_u32 v20, v39, 5, v38
v_mfma_f32_16x16x32_bf16 v[220:223], a[24:27], a[160:163], v[220:223]
s_waitcnt lgkmcnt(1)
ds_read_b64_tr_b16 a[2:3], v28 offset:17408
v_xor_b32 v39, 1, v40
v_mfma_f32_16x16x32_bf16 v[220:223], a[28:31], a[176:179], v[220:223]
v_lshl_add_u32 v21, v39, 5, v38
v_xor_b32 v39, 2, v40
v_mfma_f32_16x16x32_bf16 v[224:227], a[28:31], a[180:183], v[224:227]
ds_read_b64_tr_b16 a[4:5], v28 offset:24576
v_lshl_add_u32 v22, v39, 5, v38
v_mfma_f32_16x16x32_bf16 v[224:227], a[24:27], a[164:167], v[224:227]
v_xor_b32 v39, 3, v40
v_lshl_add_u32 v23, v39, 5, v38
v_mfma_f32_16x16x32_bf16 v[224:227], a[20:23], a[148:151], v[224:227]
ds_read_b64_tr_b16 a[6:7], v28 offset:25600
v_xor_b32 v39, 4, v40
v_mfma_f32_16x16x32_bf16 v[224:227], a[16:19], a[132:135], v[224:227]
s_waitcnt vmcnt(20)
s_barrier
v_lshl_add_u32 v24, v39, 5, v38
v_mfma_f32_16x16x32_bf16 v[228:231], a[16:19], a[136:139], v[228:231]
s_add_u32 m0, s37, 0
ds_read_b64_tr_b16 a[8:9], v28 offset:32768
v_xor_b32 v39, 5, v40
v_mfma_f32_16x16x32_bf16 v[228:231], a[20:23], a[152:155], v[228:231]
buffer_load_dwordx4 v10, s[12:15], s41 offen offset:0 lds
v_mfma_f32_16x16x32_bf16 v[228:231], a[24:27], a[168:171], v[228:231]
ds_read_b64_tr_b16 a[10:11], v28 offset:33792
v_lshl_add_u32 v25, v39, 5, v38
v_mfma_f32_16x16x32_bf16 v[228:231], a[28:31], a[184:187], v[228:231]
ds_read_b64_tr_b16 a[12:13], v28 offset:40960
v_xor_b32 v39, 6, v40
v_mfma_f32_16x16x32_bf16 v[232:235], a[28:31], a[188:191], v[232:235]
ds_read_b64_tr_b16 a[14:15], v28 offset:41984
v_lshl_add_u32 v26, v39, 5, v38
v_mfma_f32_16x16x32_bf16 v[232:235], a[24:27], a[172:175], v[232:235]
buffer_load_dwordx4 v11, s[12:15], s41 offen offset:1024 lds
v_mfma_f32_16x16x32_bf16 v[232:235], a[20:23], a[156:159], v[232:235]
v_xor_b32 v39, 7, v40
v_lshl_add_u32 v27, v39, 5, v38
v_mfma_f32_16x16x32_bf16 v[232:235], a[16:19], a[140:143], v[232:235]
s_waitcnt lgkmcnt(6)
s_mov_b32 s10, 0
s_mov_b32 s58, 0xbdd2d3e8
v_mfma_f32_16x16x32_bf16 v[108:111], a[0:3], a[160:163], v[108:111]
s_waitcnt lgkmcnt(4)
s_mov_b32 s59, 0xbdd2d3e8
ds_read_b64_tr_b16 a[16:17], v29 offset:16384
v_mfma_f32_16x16x32_bf16 v[108:111], a[4:7], a[176:179], v[108:111]
s_waitcnt vmcnt(21) lgkmcnt(3)
buffer_load_dwordx4 v12, s[12:15], s41 offen offset:2048 lds
v_mfma_f32_16x16x32_bf16 v[108:111], a[8:11], a[192:195], v[108:111]
s_waitcnt vmcnt(18) lgkmcnt(1)
s_lshl_b32 s45, s63, 19
ds_read_b64_tr_b16 a[18:19], v29 offset:17408
v_mfma_f32_16x16x32_bf16 v[108:111], a[12:15], a[208:211], v[108:111]
s_waitcnt vmcnt(17)
s_lshl_b32 s54, s62, 13
s_add_u32 s45, s45, s54
v_mfma_f32_16x16x32_bf16 v[112:115], a[12:15], a[212:215], v[112:115]
s_add_u32 s45, s45, 16777216
ds_read_b64_tr_b16 a[20:21], v29 offset:24576
s_lshl_b32 s55, s92, 3
v_mfma_f32_16x16x32_bf16 v[112:115], a[8:11], a[196:199], v[112:115]
s_and_b32 s54, s61, 7
buffer_load_dwordx4 v13, s[12:15], s41 offen offset:3072 lds
v_mfma_f32_16x16x32_bf16 v[112:115], a[4:7], a[180:183], v[112:115]
s_add_u32 s54, s54, s55
s_add_u32 s41, s41, 16384
ds_read_b64_tr_b16 a[22:23], v29 offset:25600
v_mfma_f32_16x16x32_bf16 v[112:115], a[0:3], a[164:167], v[112:115]
s_lshl_b32 s54, s54, 8
s_add_u32 s83, s54, 41943040
s_and_b32 s64, s60, 3
v_mfma_f32_16x16x32_bf16 v[116:119], a[0:3], a[168:171], v[116:119]
s_lshl_b32 s64, s64, 2
s_add_u32 m0, s37, 16384
ds_read_b64_tr_b16 a[24:25], v29 offset:32768
v_mfma_f32_16x16x32_bf16 v[116:119], a[4:7], a[184:187], v[116:119]
s_and_b32 s54, s61, 3
buffer_load_dwordx4 v10, s[12:15], s41 offen offset:0 lds
v_mfma_f32_16x16x32_bf16 v[116:119], a[8:11], a[200:203], v[116:119]
s_waitcnt vmcnt(18)
s_add_u32 s64, s64, s54
ds_read_b64_tr_b16 a[26:27], v29 offset:33792
v_mfma_f32_16x16x32_bf16 v[116:119], a[12:15], a[216:219], v[116:119]
s_waitcnt vmcnt(17)
s_and_b32 s65, s60, 4
ds_read_b64_tr_b16 a[28:29], v29 offset:40960
v_mfma_f32_16x16x32_bf16 v[120:123], a[12:15], a[220:223], v[120:123]
s_lshr_b32 s54, s61, 2
ds_read_b64_tr_b16 a[30:31], v29 offset:41984
s_add_u32 s65, s65, s54
v_mfma_f32_16x16x32_bf16 v[120:123], a[8:11], a[204:207], v[120:123]
s_lshl_b32 s54, s64, 3
buffer_load_dwordx4 v11, s[12:15], s41 offen offset:1024 lds
v_mfma_f32_16x16x32_bf16 v[120:123], a[4:7], a[188:191], v[120:123]
s_add_u32 s54, s54, s65
s_lshl_b32 s54, s54, 2
s_add_u32 s54, s54, s36
v_mfma_f32_16x16x32_bf16 v[120:123], a[0:3], a[172:175], v[120:123]
s_waitcnt lgkmcnt(6)
s_mov_b32 s87, s54
s_lshl_b32 s54, s61, 3
v_mfma_f32_16x16x32_bf16 v[124:127], a[16:19], a[160:163], v[124:127]
s_waitcnt lgkmcnt(4)
s_add_u32 s54, s54, s60
ds_read_b64_tr_b16 a[0:1], v30 offset:16384
v_mfma_f32_16x16x32_bf16 v[124:127], a[20:23], a[176:179], v[124:127]
s_waitcnt lgkmcnt(3)
buffer_load_dwordx4 v12, s[12:15], s41 offen offset:2048 lds
v_mfma_f32_16x16x32_bf16 v[124:127], a[24:27], a[192:195], v[124:127]
s_waitcnt lgkmcnt(1)
s_lshl_b32 s54, s54, 2
ds_read_b64_tr_b16 a[2:3], v30 offset:17408
v_mfma_f32_16x16x32_bf16 v[124:127], a[28:31], a[208:211], v[124:127]
s_add_u32 s54, s54, s36
s_mul_i32 s53, s54, 28672
s_mov_b32 s48, 0
v_mfma_f32_16x16x32_bf16 v[128:131], a[28:31], a[212:215], v[128:131]
s_lshl_b32 s55, s64, 2
ds_read_b64_tr_b16 a[4:5], v30 offset:24576
s_add_u32 s55, s55, s36
v_mfma_f32_16x16x32_bf16 v[128:131], a[24:27], a[196:199], v[128:131]
s_lshl_b32 s88, s55, 16
buffer_load_dwordx4 v13, s[12:15], s41 offen offset:3072 lds
v_mfma_f32_16x16x32_bf16 v[128:131], a[20:23], a[180:183], v[128:131]
s_lshl_b32 s66, s65, 8
s_add_u32 s41, s41, 16384
ds_read_b64_tr_b16 a[6:7], v30 offset:25600
v_mfma_f32_16x16x32_bf16 v[128:131], a[16:19], a[164:167], v[128:131]
s_add_u32 s88, s88, s66
s_add_u32 s89, s88, 32768
s_andn2_b32 s55, s55, 4
v_mfma_f32_16x16x32_bf16 v[132:135], a[16:19], a[168:171], v[132:135]
s_lshl_b32 s55, s55, 18
s_add_u32 m0, s37, 65536
ds_read_b64_tr_b16 a[8:9], v30 offset:32768
v_mfma_f32_16x16x32_bf16 v[132:135], a[20:23], a[184:187], v[132:135]
s_add_u32 s55, s55, 16777216
buffer_load_dwordx4 v14, s[16:19], s42 offen offset:0 lds
v_mfma_f32_16x16x32_bf16 v[132:135], a[24:27], a[200:203], v[132:135]
s_and_b32 s54, s64, 1
ds_read_b64_tr_b16 a[10:11], v30 offset:33792
s_mul_i32 s67, s54, 49152
v_mfma_f32_16x16x32_bf16 v[132:135], a[28:31], a[216:219], v[132:135]
s_add_u32 s55, s55, s67
ds_read_b64_tr_b16 a[12:13], v30 offset:40960
s_mul_i32 s67, s54, 1572864
v_mfma_f32_16x16x32_bf16 v[136:139], a[28:31], a[220:223], v[136:139]
s_add_u32 s66, s66, s67
ds_read_b64_tr_b16 a[14:15], v30 offset:41984
s_andn2_b32 s54, s65, 1
v_mfma_f32_16x16x32_bf16 v[136:139], a[24:27], a[204:207], v[136:139]
s_lshl_b32 s54, s54, 2
buffer_load_dwordx4 v15, s[16:19], s42 offen offset:1024 lds
v_mfma_f32_16x16x32_bf16 v[136:139], a[20:23], a[188:191], v[136:139]
s_add_u32 s54, s54, s36
s_mul_i32 s52, s54, 229376
s_add_u32 s52, s52, 8388608
v_mfma_f32_16x16x32_bf16 v[136:139], a[16:19], a[172:175], v[136:139]
s_waitcnt lgkmcnt(6)
s_and_b32 s54, s65, 1
s_mul_i32 s67, s54, 114688
v_mfma_f32_16x16x32_bf16 v[140:143], a[0:3], a[160:163], v[140:143]
s_waitcnt lgkmcnt(4)
s_add_u32 s52, s52, s67
ds_read_b64_tr_b16 a[16:17], v31 offset:16384
v_mfma_f32_16x16x32_bf16 v[140:143], a[4:7], a[176:179], v[140:143]
s_waitcnt lgkmcnt(3)
buffer_load_dwordx4 v14, s[16:19], s42 offen offset:2048 lds
v_mfma_f32_16x16x32_bf16 v[140:143], a[8:11], a[192:195], v[140:143]
s_waitcnt lgkmcnt(1)
s_mul_i32 s51, s54, 7340032
ds_read_b64_tr_b16 a[18:19], v31 offset:17408
v_mfma_f32_16x16x32_bf16 v[140:143], a[12:15], a[208:211], v[140:143]
s_lshl_b32 s67, s64, 8
s_add_u32 s51, s51, s67
s_lshr_b32 s85, s65, 1
v_mfma_f32_16x16x32_bf16 v[144:147], a[12:15], a[212:215], v[144:147]
s_add_u32 s49, s85, s64
ds_read_b64_tr_b16 a[20:21], v31 offset:24576
s_add_u32 s85, s85, 32
v_mfma_f32_16x16x32_bf16 v[144:147], a[8:11], a[196:199], v[144:147]
s_lshr_b32 s91, s64, 1
buffer_load_dwordx4 v15, s[16:19], s42 offen offset:3072 lds
v_mfma_f32_16x16x32_bf16 v[144:147], a[4:7], a[180:183], v[144:147]
s_add_u32 s54, s91, s65
s_add_u32 s42, s42, 16384
ds_read_b64_tr_b16 a[22:23], v31 offset:25600
v_mfma_f32_16x16x32_bf16 v[144:147], a[0:3], a[164:167], v[144:147]
s_cmp_eq_u32 s94, 0
s_cselect_b32 s52, s52, s55
s_cselect_b32 s51, s51, s66
v_mfma_f32_16x16x32_bf16 v[148:151], a[0:3], a[168:171], v[148:151]
ds_read_b64_tr_b16 a[24:25], v31 offset:32768
v_mfma_f32_16x16x32_bf16 v[148:151], a[4:7], a[184:187], v[148:151]
s_cmp_eq_u32 s94, 0
s_cselect_b32 s49, s49, s54
s_cselect_b32 s95, s67, 0x10000
v_mfma_f32_16x16x32_bf16 v[148:151], a[8:11], a[200:203], v[148:151]
ds_read_b64_tr_b16 a[26:27], v31 offset:33792
v_mfma_f32_16x16x32_bf16 v[148:151], a[12:15], a[216:219], v[148:151]
ds_read_b64_tr_b16 a[28:29], v31 offset:40960
v_mfma_f32_16x16x32_bf16 v[152:155], a[12:15], a[220:223], v[152:155]
ds_read_b64_tr_b16 a[30:31], v31 offset:41984
v_mfma_f32_16x16x32_bf16 v[152:155], a[8:11], a[204:207], v[152:155]
s_cmp_eq_u32 s94, 0
s_cselect_b32 s85, s85, s91
s_cselect_b32 s91, 28, 16
v_mfma_f32_16x16x32_bf16 v[152:155], a[4:7], a[188:191], v[152:155]
s_lshl_b32 s85, s85, 8
s_add_u32 s85, s85, 41943040
v_mfma_f32_16x16x32_bf16 v[152:155], a[0:3], a[172:175], v[152:155]
s_waitcnt lgkmcnt(6)
s_cmp_lt_u32 s61, 14
s_cselect_b32 s82, s94, 0
v_mfma_f32_16x16x32_bf16 v[156:159], a[16:19], a[160:163], v[156:159]
s_waitcnt lgkmcnt(4)
ds_read_b64_tr_b16 a[0:1], v32 offset:32768
v_mfma_f32_16x16x32_bf16 v[156:159], a[20:23], a[176:179], v[156:159]
s_waitcnt lgkmcnt(3)
s_cmp_eq_u32 s36, 0
s_cselect_b32 s82, s82, 0
v_mfma_f32_16x16x32_bf16 v[156:159], a[24:27], a[192:195], v[156:159]
s_waitcnt lgkmcnt(1)
s_mul_i32 s82, s82, -7
ds_read_b64_tr_b16 a[2:3], v32 offset:33792
v_mfma_f32_16x16x32_bf16 v[156:159], a[28:31], a[208:211], v[156:159]
s_lshr_b32 s90, 4096, s94
s_lshl_b32 s66, s90, 6
s_and_b32 s49, s49, 1
v_mfma_f32_16x16x32_bf16 v[160:163], a[28:31], a[212:215], v[160:163]
ds_read_b64_tr_b16 a[4:5], v32 offset:40960
v_mfma_f32_16x16x32_bf16 v[160:163], a[24:27], a[196:199], v[160:163]
s_cmp_lg_u32 s49, 0
s_cselect_b32 s54, -1, 1
s_cselect_b32 s55, 3, 1
v_mfma_f32_16x16x32_bf16 v[160:163], a[20:23], a[180:183], v[160:163]
s_mul_i32 s72, s54, s66
ds_read_b64_tr_b16 a[6:7], v32 offset:41984
s_mul_i32 s73, s55, s66
v_mfma_f32_16x16x32_bf16 v[160:163], a[16:19], a[164:167], v[160:163]
s_waitcnt vmcnt(20)
s_mul_i32 s74, s54, 4096
s_barrier
v_mfma_f32_16x16x32_bf16 v[164:167], a[16:19], a[168:171], v[164:167]
s_mul_i32 s75, s55, 4096
s_add_u32 m0, s37, 81920
ds_read_b64_tr_b16 a[8:9], v32 offset:49152
v_mfma_f32_16x16x32_bf16 v[164:167], a[20:23], a[184:187], v[164:167]
s_mul_i32 s54, s49, s66
buffer_load_dwordx4 v14, s[16:19], s42 offen offset:0 lds
v_mfma_f32_16x16x32_bf16 v[164:167], a[24:27], a[200:203], v[164:167]
s_add_u32 s51, s51, s54
ds_read_b64_tr_b16 a[10:11], v32 offset:50176
s_mul_i32 s54, s49, 4096
v_mfma_f32_16x16x32_bf16 v[164:167], a[28:31], a[216:219], v[164:167]
s_add_u32 s52, s52, s54
ds_read_b64_tr_b16 a[12:13], v32 offset:57344
v_bfe_u32 v38, v0, 4, 2
v_mfma_f32_16x16x32_bf16 v[168:171], a[28:31], a[220:223], v[168:171]
ds_read_b64_tr_b16 a[14:15], v32 offset:58368
v_lshrrev_b32 v39, 6, v0
v_mfma_f32_16x16x32_bf16 v[168:171], a[24:27], a[204:207], v[168:171]
buffer_load_dwordx4 v15, s[16:19], s42 offen offset:1024 lds
v_mfma_f32_16x16x32_bf16 v[168:171], a[20:23], a[188:191], v[168:171]
v_lshl_add_u32 v39, v39, 4, v38
v_and_b32 v41, 15, v0
v_mfma_f32_16x16x32_bf16 v[168:171], a[16:19], a[172:175], v[168:171]
s_waitcnt lgkmcnt(6)
v_add_u32 v2, 0, v39
v_mul_u32_u24 v2, s90, v2
v_mfma_f32_16x16x32_bf16 v[172:175], a[0:3], a[192:195], v[172:175]
s_waitcnt lgkmcnt(4)
ds_read_b64_tr_b16 a[16:17], v33 offset:32768
v_or_b32 v40, 0, v38
v_mfma_f32_16x16x32_bf16 v[172:175], a[4:7], a[208:211], v[172:175]
s_waitcnt vmcnt(21) lgkmcnt(3)
buffer_load_dwordx4 v14, s[16:19], s42 offen offset:2048 lds
v_mfma_f32_16x16x32_bf16 v[172:175], a[8:11], a[224:227], v[172:175]
s_waitcnt vmcnt(18) lgkmcnt(1)
ds_read_b64_tr_b16 a[18:19], v33 offset:33792
v_lshlrev_b32 v40, 1, v40
v_mfma_f32_16x16x32_bf16 v[172:175], a[12:15], a[240:243], v[172:175]
s_waitcnt vmcnt(17)
v_xor_b32 v40, v40, v41
v_lshl_add_u32 v2, v40, 4, v2
v_mfma_f32_16x16x32_bf16 v[176:179], a[12:15], a[244:247], v[176:179]
ds_read_b64_tr_b16 a[20:21], v33 offset:40960
v_add_u32 v3, 4, v39
v_mfma_f32_16x16x32_bf16 v[176:179], a[8:11], a[228:231], v[176:179]
buffer_load_dwordx4 v15, s[16:19], s42 offen offset:3072 lds
v_mfma_f32_16x16x32_bf16 v[176:179], a[4:7], a[212:215], v[176:179]
s_add_u32 s42, s42, 16384
ds_read_b64_tr_b16 a[22:23], v33 offset:41984
v_mul_u32_u24 v3, s90, v3
v_mfma_f32_16x16x32_bf16 v[176:179], a[0:3], a[196:199], v[176:179]
v_or_b32 v40, 4, v38
v_lshlrev_b32 v40, 1, v40
v_mfma_f32_16x16x32_bf16 v[180:183], a[0:3], a[200:203], v[180:183]
s_add_u32 m0, s37, 32768
ds_read_b64_tr_b16 a[24:25], v33 offset:49152
v_xor_b32 v40, v40, v41
v_mfma_f32_16x16x32_bf16 v[180:183], a[4:7], a[216:219], v[180:183]
buffer_load_dwordx4 v10, s[12:15], s41 offen offset:0 lds
v_mfma_f32_16x16x32_bf16 v[180:183], a[8:11], a[232:235], v[180:183]
s_waitcnt vmcnt(18)
ds_read_b64_tr_b16 a[26:27], v33 offset:50176
v_lshl_add_u32 v3, v40, 4, v3
v_mfma_f32_16x16x32_bf16 v[180:183], a[12:15], a[248:251], v[180:183]
s_waitcnt vmcnt(17)
ds_read_b64_tr_b16 a[28:29], v33 offset:57344
v_subrev_u32 v3, 1024, v3
v_mfma_f32_16x16x32_bf16 v[184:187], a[12:15], a[252:255], v[184:187]
ds_read_b64_tr_b16 a[30:31], v33 offset:58368
v_add_u32 v4, 8, v39
v_mfma_f32_16x16x32_bf16 v[184:187], a[8:11], a[236:239], v[184:187]
buffer_load_dwordx4 v11, s[12:15], s41 offen offset:1024 lds
v_mfma_f32_16x16x32_bf16 v[184:187], a[4:7], a[220:223], v[184:187]
v_mul_u32_u24 v4, s90, v4
v_or_b32 v40, 0, v38
v_mfma_f32_16x16x32_bf16 v[184:187], a[0:3], a[204:207], v[184:187]
s_waitcnt lgkmcnt(6)
v_lshlrev_b32 v40, 1, v40
v_xor_b32 v40, v40, v41
v_mfma_f32_16x16x32_bf16 v[188:191], a[16:19], a[192:195], v[188:191]
s_waitcnt lgkmcnt(4)
ds_read_b64_tr_b16 a[0:1], v34 offset:32768
v_lshl_add_u32 v4, v40, 4, v4
v_mfma_f32_16x16x32_bf16 v[188:191], a[20:23], a[208:211], v[188:191]
s_waitcnt lgkmcnt(3)
buffer_load_dwordx4 v12, s[12:15], s41 offen offset:2048 lds
v_mfma_f32_16x16x32_bf16 v[188:191], a[24:27], a[224:227], v[188:191]
s_waitcnt lgkmcnt(1)
ds_read_b64_tr_b16 a[2:3], v34 offset:33792
v_subrev_u32 v4, 2048, v4
v_mfma_f32_16x16x32_bf16 v[188:191], a[28:31], a[240:243], v[188:191]
v_add_u32 v5, 12, v39
v_mul_u32_u24 v5, s90, v5
v_mfma_f32_16x16x32_bf16 v[192:195], a[28:31], a[244:247], v[192:195]
ds_read_b64_tr_b16 a[4:5], v34 offset:40960
v_or_b32 v40, 4, v38
v_mfma_f32_16x16x32_bf16 v[192:195], a[24:27], a[228:231], v[192:195]
buffer_load_dwordx4 v13, s[12:15], s41 offen offset:3072 lds
v_mfma_f32_16x16x32_bf16 v[192:195], a[20:23], a[212:215], v[192:195]
s_add_u32 s41, s41, 16384
ds_read_b64_tr_b16 a[6:7], v34 offset:41984
v_lshlrev_b32 v40, 1, v40
v_mfma_f32_16x16x32_bf16 v[192:195], a[16:19], a[196:199], v[192:195]
v_xor_b32 v40, v40, v41
v_lshl_add_u32 v5, v40, 4, v5
v_mfma_f32_16x16x32_bf16 v[196:199], a[16:19], a[200:203], v[196:199]
ds_read_b64_tr_b16 a[8:9], v34 offset:49152
v_subrev_u32 v5, 3072, v5
v_mfma_f32_16x16x32_bf16 v[196:199], a[20:23], a[216:219], v[196:199]
v_mov_b32 v39, 131072
v_mfma_f32_16x16x32_bf16 v[196:199], a[24:27], a[232:235], v[196:199]
ds_read_b64_tr_b16 a[10:11], v34 offset:50176
v_mfma_f32_16x16x32_bf16 v[196:199], a[28:31], a[248:251], v[196:199]
ds_read_b64_tr_b16 a[12:13], v34 offset:57344
v_mfma_f32_16x16x32_bf16 v[200:203], a[28:31], a[252:255], v[200:203]
ds_read_b64_tr_b16 a[14:15], v34 offset:58368
v_mfma_f32_16x16x32_bf16 v[200:203], a[24:27], a[236:239], v[200:203]
v_mfma_f32_16x16x32_bf16 v[200:203], a[20:23], a[220:223], v[200:203]
v_mfma_f32_16x16x32_bf16 v[200:203], a[16:19], a[204:207], v[200:203]
s_waitcnt lgkmcnt(6)
v_mfma_f32_16x16x32_bf16 v[204:207], a[0:3], a[192:195], v[204:207]
s_waitcnt lgkmcnt(4)
ds_read_b64_tr_b16 a[16:17], v35 offset:32768
v_mfma_f32_16x16x32_bf16 v[204:207], a[4:7], a[208:211], v[204:207]
s_waitcnt lgkmcnt(3)
v_mfma_f32_16x16x32_bf16 v[204:207], a[8:11], a[224:227], v[204:207]
s_waitcnt lgkmcnt(1)
ds_read_b64_tr_b16 a[18:19], v35 offset:33792
v_mfma_f32_16x16x32_bf16 v[204:207], a[12:15], a[240:243], v[204:207]
v_mfma_f32_16x16x32_bf16 v[208:211], a[12:15], a[244:247], v[208:211]
ds_read_b64_tr_b16 a[20:21], v35 offset:40960
v_mfma_f32_16x16x32_bf16 v[208:211], a[8:11], a[228:231], v[208:211]
v_mfma_f32_16x16x32_bf16 v[208:211], a[4:7], a[212:215], v[208:211]
ds_read_b64_tr_b16 a[22:23], v35 offset:41984
v_mfma_f32_16x16x32_bf16 v[208:211], a[0:3], a[196:199], v[208:211]
v_mfma_f32_16x16x32_bf16 v[212:215], a[0:3], a[200:203], v[212:215]
ds_read_b64_tr_b16 a[24:25], v35 offset:49152
v_mfma_f32_16x16x32_bf16 v[212:215], a[4:7], a[216:219], v[212:215]
v_mfma_f32_16x16x32_bf16 v[212:215], a[8:11], a[232:235], v[212:215]
ds_read_b64_tr_b16 a[26:27], v35 offset:50176
v_mfma_f32_16x16x32_bf16 v[212:215], a[12:15], a[248:251], v[212:215]
ds_read_b64_tr_b16 a[28:29], v35 offset:57344
v_mfma_f32_16x16x32_bf16 v[216:219], a[12:15], a[252:255], v[216:219]
ds_read_b64_tr_b16 a[30:31], v35 offset:58368
v_mfma_f32_16x16x32_bf16 v[216:219], a[8:11], a[236:239], v[216:219]
v_mfma_f32_16x16x32_bf16 v[216:219], a[4:7], a[220:223], v[216:219]
v_mfma_f32_16x16x32_bf16 v[216:219], a[0:3], a[204:207], v[216:219]
s_waitcnt lgkmcnt(6)
v_mfma_f32_16x16x32_bf16 v[220:223], a[16:19], a[192:195], v[220:223]
s_waitcnt lgkmcnt(4)
ds_read_b64_tr_b16 a[0:1], v28 offset:49152
v_mfma_f32_16x16x32_bf16 v[220:223], a[20:23], a[208:211], v[220:223]
s_waitcnt lgkmcnt(3)
v_mfma_f32_16x16x32_bf16 v[220:223], a[24:27], a[224:227], v[220:223]
s_waitcnt lgkmcnt(1)
ds_read_b64_tr_b16 a[2:3], v28 offset:50176
v_mfma_f32_16x16x32_bf16 v[220:223], a[28:31], a[240:243], v[220:223]
v_mfma_f32_16x16x32_bf16 v[224:227], a[28:31], a[244:247], v[224:227]
ds_read_b64_tr_b16 a[4:5], v28 offset:57344
v_mfma_f32_16x16x32_bf16 v[224:227], a[24:27], a[228:231], v[224:227]
v_mfma_f32_16x16x32_bf16 v[224:227], a[20:23], a[212:215], v[224:227]
ds_read_b64_tr_b16 a[6:7], v28 offset:58368
v_mfma_f32_16x16x32_bf16 v[224:227], a[16:19], a[196:199], v[224:227]
s_waitcnt vmcnt(16)
s_barrier
v_mfma_f32_16x16x32_bf16 v[228:231], a[16:19], a[200:203], v[228:231]
ds_read_b64_tr_b16 a[8:9], v29 offset:49152
v_mfma_f32_16x16x32_bf16 v[228:231], a[20:23], a[216:219], v[228:231]
ds_read_b128 a[128:131], v16 offset:0
v_mfma_f32_16x16x32_bf16 v[228:231], a[24:27], a[232:235], v[228:231]
ds_read_b64_tr_b16 a[10:11], v29 offset:50176
v_mfma_f32_16x16x32_bf16 v[228:231], a[28:31], a[248:251], v[228:231]
ds_read_b128 a[132:135], v17 offset:0
v_mfma_f32_16x16x32_bf16 v[232:235], a[28:31], a[252:255], v[232:235]
ds_read_b64_tr_b16 a[12:13], v29 offset:57344
v_mfma_f32_16x16x32_bf16 v[232:235], a[24:27], a[236:239], v[232:235]
ds_read_b128 a[136:139], v18 offset:0
v_mfma_f32_16x16x32_bf16 v[232:235], a[20:23], a[220:223], v[232:235]
ds_read_b64_tr_b16 a[14:15], v29 offset:58368
v_mfma_f32_16x16x32_bf16 v[232:235], a[16:19], a[204:207], v[232:235]
s_waitcnt lgkmcnt(9)
ds_read_b128 a[140:143], v19 offset:0
v_mfma_f32_16x16x32_bf16 v[108:111], a[0:3], a[224:227], v[108:111]
s_waitcnt lgkmcnt(8)
ds_read_b64_tr_b16 a[16:17], v30 offset:49152
v_mfma_f32_16x16x32_bf16 v[108:111], a[4:7], a[240:243], v[108:111]
ds_read_b128 a[144:147], v16 offset:4096
v_mfma_f32_16x16x32_bf16 v[112:115], a[4:7], a[244:247], v[112:115]
ds_read_b64_tr_b16 a[18:19], v30 offset:50176
v_mfma_f32_16x16x32_bf16 v[112:115], a[0:3], a[228:231], v[112:115]
ds_write_b32 v39, v37
v_mfma_f32_16x16x32_bf16 v[116:119], a[0:3], a[232:235], v[116:119]
ds_read_b64_tr_b16 a[20:21], v30 offset:57344
v_mfma_f32_16x16x32_bf16 v[116:119], a[4:7], a[248:251], v[116:119]
v_mfma_f32_16x16x32_bf16 v[120:123], a[4:7], a[252:255], v[120:123]
ds_read_b64_tr_b16 a[22:23], v30 offset:58368
v_mfma_f32_16x16x32_bf16 v[120:123], a[0:3], a[236:239], v[120:123]
s_waitcnt lgkmcnt(11)
v_mfma_f32_16x16x32_bf16 v[124:127], a[8:11], a[224:227], v[124:127]
s_waitcnt lgkmcnt(7)
ds_read_b64_tr_b16 a[24:25], v31 offset:49152
v_mfma_f32_16x16x32_bf16 v[124:127], a[12:15], a[240:243], v[124:127]
v_mfma_f32_16x16x32_bf16 v[128:131], a[12:15], a[244:247], v[128:131]
ds_read_b64_tr_b16 a[26:27], v31 offset:50176
v_mfma_f32_16x16x32_bf16 v[128:131], a[8:11], a[228:231], v[128:131]
v_mfma_f32_16x16x32_bf16 v[132:135], a[8:11], a[232:235], v[132:135]
ds_read_b64_tr_b16 a[28:29], v31 offset:57344
v_mfma_f32_16x16x32_bf16 v[132:135], a[12:15], a[248:251], v[132:135]
v_mfma_f32_16x16x32_bf16 v[136:139], a[12:15], a[252:255], v[136:139]
ds_read_b64_tr_b16 a[30:31], v31 offset:58368
v_mfma_f32_16x16x32_bf16 v[136:139], a[8:11], a[236:239], v[136:139]
s_waitcnt lgkmcnt(7)
v_mfma_f32_16x16x32_bf16 v[140:143], a[16:19], a[224:227], v[140:143]
s_waitcnt lgkmcnt(4)
v_mfma_f32_16x16x32_bf16 v[140:143], a[20:23], a[240:243], v[140:143]
v_mfma_f32_16x16x32_bf16 v[144:147], a[20:23], a[244:247], v[144:147]
v_mfma_f32_16x16x32_bf16 v[144:147], a[16:19], a[228:231], v[144:147]
v_mfma_f32_16x16x32_bf16 v[148:151], a[16:19], a[232:235], v[148:151]
v_mfma_f32_16x16x32_bf16 v[148:151], a[20:23], a[248:251], v[148:151]
v_mfma_f32_16x16x32_bf16 v[152:155], a[20:23], a[252:255], v[152:155]
v_mfma_f32_16x16x32_bf16 v[152:155], a[16:19], a[236:239], v[152:155]
s_waitcnt lgkmcnt(2)
v_mfma_f32_16x16x32_bf16 v[156:159], a[24:27], a[224:227], v[156:159]
s_waitcnt lgkmcnt(0)
v_mfma_f32_16x16x32_bf16 v[156:159], a[28:31], a[240:243], v[156:159]
v_mfma_f32_16x16x32_bf16 v[160:163], a[28:31], a[244:247], v[160:163]
v_mfma_f32_16x16x32_bf16 v[160:163], a[24:27], a[228:231], v[160:163]
v_mfma_f32_16x16x32_bf16 v[164:167], a[24:27], a[232:235], v[164:167]
v_mfma_f32_16x16x32_bf16 v[164:167], a[28:31], a[248:251], v[164:167]
v_mfma_f32_16x16x32_bf16 v[168:171], a[28:31], a[252:255], v[168:171]
v_mfma_f32_16x16x32_bf16 v[168:171], a[24:27], a[236:239], v[168:171]
s_nop 0
v_mov_b32 v40, 0xc0135761
v_mov_b32 v41, 0xc0135761
s_add_u32 s54, s46, 4096
s_add_u32 s55, s46, 229376
s_add_u32 s66, s55, 4096
v_pk_mul_f32 v[236:237], v[108:109], v[108:109]
v_pk_mul_f32 v[238:239], v[110:111], v[110:111]
v_pk_mul_f32 v[240:241], v[124:125], v[124:125]
v_pk_mul_f32 v[242:243], v[126:127], v[126:127]
v_pk_fma_f32 v[236:237], v[236:237], s[58:59], v[40:41]
v_pk_fma_f32 v[238:239], v[238:239], s[58:59], v[40:41]
v_pk_fma_f32 v[240:241], v[240:241], s[58:59], v[40:41]
v_pk_fma_f32 v[242:243], v[242:243], s[58:59], v[40:41]
v_pk_mul_f32 v[236:237], v[236:237], v[108:109]
v_pk_mul_f32 v[238:239], v[238:239], v[110:111]
v_pk_mul_f32 v[240:241], v[240:241], v[124:125]
v_pk_mul_f32 v[242:243], v[242:243], v[126:127]
v_exp_f32 v236, v236
v_exp_f32 v237, v237
v_exp_f32 v238, v238
v_exp_f32 v239, v239
v_exp_f32 v240, v240
v_exp_f32 v241, v241
v_exp_f32 v242, v242
v_exp_f32 v243, v243
v_pk_add_f32 v[236:237], v[236:237], 1.0 op_sel_hi:[1,0]
v_pk_add_f32 v[238:239], v[238:239], 1.0 op_sel_hi:[1,0]
v_pk_add_f32 v[240:241], v[240:241], 1.0 op_sel_hi:[1,0]
v_pk_add_f32 v[242:243], v[242:243], 1.0 op_sel_hi:[1,0]
v_rcp_f32 v236, v236
v_rcp_f32 v237, v237
v_rcp_f32 v238, v238
v_rcp_f32 v239, v239
v_rcp_f32 v240, v240
v_rcp_f32 v241, v241
v_rcp_f32 v242, v242
v_rcp_f32 v243, v243
v_pk_mul_f32 v[236:237], v[236:237], v[108:109]
v_pk_mul_f32 v[238:239], v[238:239], v[110:111]
v_pk_mul_f32 v[240:241], v[240:241], v[124:125]
v_pk_mul_f32 v[242:243], v[242:243], v[126:127]
v_cvt_pk_bf16_f32 v108, v236, v237
v_cvt_pk_bf16_f32 v109, v238, v239
v_cvt_pk_bf16_f32 v110, v240, v241
v_cvt_pk_bf16_f32 v111, v242, v243
buffer_store_dwordx4 v[108:111], v1, s[4:7], s46 offen offset:0 sc1
v_pk_mul_f32 v[244:245], v[112:113], v[112:113]
v_pk_mul_f32 v[246:247], v[114:115], v[114:115]
v_pk_mul_f32 v[248:249], v[128:129], v[128:129]
v_pk_mul_f32 v[250:251], v[130:131], v[130:131]
v_pk_fma_f32 v[244:245], v[244:245], s[58:59], v[40:41]
v_pk_fma_f32 v[246:247], v[246:247], s[58:59], v[40:41]
v_pk_fma_f32 v[248:249], v[248:249], s[58:59], v[40:41]
v_pk_fma_f32 v[250:251], v[250:251], s[58:59], v[40:41]
v_pk_mul_f32 v[244:245], v[244:245], v[112:113]
v_pk_mul_f32 v[246:247], v[246:247], v[114:115]
v_pk_mul_f32 v[248:249], v[248:249], v[128:129]
v_pk_mul_f32 v[250:251], v[250:251], v[130:131]
v_exp_f32 v244, v244
v_exp_f32 v245, v245
v_exp_f32 v246, v246
v_exp_f32 v247, v247
v_exp_f32 v248, v248
v_exp_f32 v249, v249
v_exp_f32 v250, v250
v_exp_f32 v251, v251
v_pk_add_f32 v[244:245], v[244:245], 1.0 op_sel_hi:[1,0]
v_pk_add_f32 v[246:247], v[246:247], 1.0 op_sel_hi:[1,0]
v_pk_add_f32 v[248:249], v[248:249], 1.0 op_sel_hi:[1,0]
v_pk_add_f32 v[250:251], v[250:251], 1.0 op_sel_hi:[1,0]
v_rcp_f32 v244, v244
v_rcp_f32 v245, v245
v_rcp_f32 v246, v246
v_rcp_f32 v247, v247
v_rcp_f32 v248, v248
v_rcp_f32 v249, v249
v_rcp_f32 v250, v250
v_rcp_f32 v251, v251
v_pk_mul_f32 v[244:245], v[244:245], v[112:113]
v_pk_mul_f32 v[246:247], v[246:247], v[114:115]
v_pk_mul_f32 v[248:249], v[248:249], v[128:129]
v_pk_mul_f32 v[250:251], v[250:251], v[130:131]
v_cvt_pk_bf16_f32 v112, v244, v245
v_cvt_pk_bf16_f32 v113, v246, v247
v_cvt_pk_bf16_f32 v114, v248, v249
v_cvt_pk_bf16_f32 v115, v250, v251
buffer_store_dwordx4 v[112:115], v1, s[4:7], s46 offen offset:1024 sc1
v_pk_mul_f32 v[236:237], v[116:117], v[116:117]
v_pk_mul_f32 v[238:239], v[118:119], v[118:119]
v_pk_mul_f32 v[240:241], v[132:133], v[132:133]
v_pk_mul_f32 v[242:243], v[134:135], v[134:135]
v_pk_fma_f32 v[236:237], v[236:237], s[58:59], v[40:41]
v_pk_fma_f32 v[238:239], v[238:239], s[58:59], v[40:41]
v_pk_fma_f32 v[240:241], v[240:241], s[58:59], v[40:41]
v_pk_fma_f32 v[242:243], v[242:243], s[58:59], v[40:41]
v_pk_mul_f32 v[236:237], v[236:237], v[116:117]
v_pk_mul_f32 v[238:239], v[238:239], v[118:119]
v_pk_mul_f32 v[240:241], v[240:241], v[132:133]
v_pk_mul_f32 v[242:243], v[242:243], v[134:135]
v_exp_f32 v236, v236
v_exp_f32 v237, v237
v_exp_f32 v238, v238
v_exp_f32 v239, v239
v_exp_f32 v240, v240
v_exp_f32 v241, v241
v_exp_f32 v242, v242
v_exp_f32 v243, v243
v_pk_add_f32 v[236:237], v[236:237], 1.0 op_sel_hi:[1,0]
v_pk_add_f32 v[238:239], v[238:239], 1.0 op_sel_hi:[1,0]
v_pk_add_f32 v[240:241], v[240:241], 1.0 op_sel_hi:[1,0]
v_pk_add_f32 v[242:243], v[242:243], 1.0 op_sel_hi:[1,0]
v_rcp_f32 v236, v236
v_rcp_f32 v237, v237
v_rcp_f32 v238, v238
v_rcp_f32 v239, v239
v_rcp_f32 v240, v240
v_rcp_f32 v241, v241
v_rcp_f32 v242, v242
v_rcp_f32 v243, v243
v_pk_mul_f32 v[236:237], v[236:237], v[116:117]
v_pk_mul_f32 v[238:239], v[238:239], v[118:119]
v_pk_mul_f32 v[240:241], v[240:241], v[132:133]
v_pk_mul_f32 v[242:243], v[242:243], v[134:135]
v_cvt_pk_bf16_f32 v116, v236, v237
v_cvt_pk_bf16_f32 v117, v238, v239
v_cvt_pk_bf16_f32 v118, v240, v241
v_cvt_pk_bf16_f32 v119, v242, v243
buffer_store_dwordx4 v[116:119], v1, s[4:7], s55 offen offset:0 sc1
v_pk_mul_f32 v[244:245], v[120:121], v[120:121]
v_pk_mul_f32 v[246:247], v[122:123], v[122:123]
v_pk_mul_f32 v[248:249], v[136:137], v[136:137]
v_pk_mul_f32 v[250:251], v[138:139], v[138:139]
v_pk_fma_f32 v[244:245], v[244:245], s[58:59], v[40:41]
v_pk_fma_f32 v[246:247], v[246:247], s[58:59], v[40:41]
v_pk_fma_f32 v[248:249], v[248:249], s[58:59], v[40:41]
v_pk_fma_f32 v[250:251], v[250:251], s[58:59], v[40:41]
v_pk_mul_f32 v[244:245], v[244:245], v[120:121]
v_pk_mul_f32 v[246:247], v[246:247], v[122:123]
v_pk_mul_f32 v[248:249], v[248:249], v[136:137]
v_pk_mul_f32 v[250:251], v[250:251], v[138:139]
v_exp_f32 v244, v244
v_exp_f32 v245, v245
v_exp_f32 v246, v246
v_exp_f32 v247, v247
v_exp_f32 v248, v248
v_exp_f32 v249, v249
v_exp_f32 v250, v250
v_exp_f32 v251, v251
v_pk_add_f32 v[244:245], v[244:245], 1.0 op_sel_hi:[1,0]
v_pk_add_f32 v[246:247], v[246:247], 1.0 op_sel_hi:[1,0]
v_pk_add_f32 v[248:249], v[248:249], 1.0 op_sel_hi:[1,0]
v_pk_add_f32 v[250:251], v[250:251], 1.0 op_sel_hi:[1,0]
v_rcp_f32 v244, v244
v_rcp_f32 v245, v245
v_rcp_f32 v246, v246
v_rcp_f32 v247, v247
v_rcp_f32 v248, v248
v_rcp_f32 v249, v249
v_rcp_f32 v250, v250
v_rcp_f32 v251, v251
v_pk_mul_f32 v[244:245], v[244:245], v[120:121]
v_pk_mul_f32 v[246:247], v[246:247], v[122:123]
v_pk_mul_f32 v[248:249], v[248:249], v[136:137]
v_pk_mul_f32 v[250:251], v[250:251], v[138:139]
v_cvt_pk_bf16_f32 v120, v244, v245
v_cvt_pk_bf16_f32 v121, v246, v247
v_cvt_pk_bf16_f32 v122, v248, v249
v_cvt_pk_bf16_f32 v123, v250, v251
buffer_store_dwordx4 v[120:123], v1, s[4:7], s55 offen offset:1024 sc1
v_pk_mul_f32 v[236:237], v[140:141], v[140:141]
v_pk_mul_f32 v[238:239], v[142:143], v[142:143]
v_pk_mul_f32 v[240:241], v[156:157], v[156:157]
v_pk_mul_f32 v[242:243], v[158:159], v[158:159]
v_pk_fma_f32 v[236:237], v[236:237], s[58:59], v[40:41]
v_pk_fma_f32 v[238:239], v[238:239], s[58:59], v[40:41]
v_pk_fma_f32 v[240:241], v[240:241], s[58:59], v[40:41]
v_pk_fma_f32 v[242:243], v[242:243], s[58:59], v[40:41]
v_pk_mul_f32 v[236:237], v[236:237], v[140:141]
v_pk_mul_f32 v[238:239], v[238:239], v[142:143]
v_pk_mul_f32 v[240:241], v[240:241], v[156:157]
v_pk_mul_f32 v[242:243], v[242:243], v[158:159]
v_exp_f32 v236, v236
v_exp_f32 v237, v237
v_exp_f32 v238, v238
v_exp_f32 v239, v239
v_exp_f32 v240, v240
v_exp_f32 v241, v241
v_exp_f32 v242, v242
v_exp_f32 v243, v243
v_pk_add_f32 v[236:237], v[236:237], 1.0 op_sel_hi:[1,0]
v_pk_add_f32 v[238:239], v[238:239], 1.0 op_sel_hi:[1,0]
v_pk_add_f32 v[240:241], v[240:241], 1.0 op_sel_hi:[1,0]
v_pk_add_f32 v[242:243], v[242:243], 1.0 op_sel_hi:[1,0]
v_rcp_f32 v236, v236
v_rcp_f32 v237, v237
v_rcp_f32 v238, v238
v_rcp_f32 v239, v239
v_rcp_f32 v240, v240
v_rcp_f32 v241, v241
v_rcp_f32 v242, v242
v_rcp_f32 v243, v243
v_pk_mul_f32 v[236:237], v[236:237], v[140:141]
v_pk_mul_f32 v[238:239], v[238:239], v[142:143]
v_pk_mul_f32 v[240:241], v[240:241], v[156:157]
v_pk_mul_f32 v[242:243], v[242:243], v[158:159]
v_cvt_pk_bf16_f32 v140, v236, v237
v_cvt_pk_bf16_f32 v141, v238, v239
v_cvt_pk_bf16_f32 v142, v240, v241
v_cvt_pk_bf16_f32 v143, v242, v243
buffer_store_dwordx4 v[140:143], v1, s[4:7], s46 offen offset:2048 sc1
v_pk_mul_f32 v[244:245], v[144:145], v[144:145]
v_pk_mul_f32 v[246:247], v[146:147], v[146:147]
v_pk_mul_f32 v[248:249], v[160:161], v[160:161]
v_pk_mul_f32 v[250:251], v[162:163], v[162:163]
v_pk_fma_f32 v[244:245], v[244:245], s[58:59], v[40:41]
v_pk_fma_f32 v[246:247], v[246:247], s[58:59], v[40:41]
v_pk_fma_f32 v[248:249], v[248:249], s[58:59], v[40:41]
v_pk_fma_f32 v[250:251], v[250:251], s[58:59], v[40:41]
v_pk_mul_f32 v[244:245], v[244:245], v[144:145]
v_pk_mul_f32 v[246:247], v[246:247], v[146:147]
v_pk_mul_f32 v[248:249], v[248:249], v[160:161]
v_pk_mul_f32 v[250:251], v[250:251], v[162:163]
v_exp_f32 v244, v244
v_exp_f32 v245, v245
v_exp_f32 v246, v246
v_exp_f32 v247, v247
v_exp_f32 v248, v248
v_exp_f32 v249, v249
v_exp_f32 v250, v250
v_exp_f32 v251, v251
v_pk_add_f32 v[244:245], v[244:245], 1.0 op_sel_hi:[1,0]
v_pk_add_f32 v[246:247], v[246:247], 1.0 op_sel_hi:[1,0]
v_pk_add_f32 v[248:249], v[248:249], 1.0 op_sel_hi:[1,0]
v_pk_add_f32 v[250:251], v[250:251], 1.0 op_sel_hi:[1,0]
v_rcp_f32 v244, v244
v_rcp_f32 v245, v245
v_rcp_f32 v246, v246
v_rcp_f32 v247, v247
v_rcp_f32 v248, v248
v_rcp_f32 v249, v249
v_rcp_f32 v250, v250
v_rcp_f32 v251, v251
v_pk_mul_f32 v[244:245], v[244:245], v[144:145]
v_pk_mul_f32 v[246:247], v[246:247], v[146:147]
v_pk_mul_f32 v[248:249], v[248:249], v[160:161]
v_pk_mul_f32 v[250:251], v[250:251], v[162:163]
v_cvt_pk_bf16_f32 v144, v244, v245
v_cvt_pk_bf16_f32 v145, v246, v247
v_cvt_pk_bf16_f32 v146, v248, v249
v_cvt_pk_bf16_f32 v147, v250, v251
buffer_store_dwordx4 v[144:147], v1, s[4:7], s46 offen offset:3072 sc1
v_pk_mul_f32 v[236:237], v[148:149], v[148:149]
v_pk_mul_f32 v[238:239], v[150:151], v[150:151]
v_pk_mul_f32 v[240:241], v[164:165], v[164:165]
v_pk_mul_f32 v[242:243], v[166:167], v[166:167]
v_pk_fma_f32 v[236:237], v[236:237], s[58:59], v[40:41]
v_pk_fma_f32 v[238:239], v[238:239], s[58:59], v[40:41]
v_pk_fma_f32 v[240:241], v[240:241], s[58:59], v[40:41]
v_pk_fma_f32 v[242:243], v[242:243], s[58:59], v[40:41]
v_pk_mul_f32 v[236:237], v[236:237], v[148:149]
v_pk_mul_f32 v[238:239], v[238:239], v[150:151]
v_pk_mul_f32 v[240:241], v[240:241], v[164:165]
v_pk_mul_f32 v[242:243], v[242:243], v[166:167]
v_exp_f32 v236, v236
v_exp_f32 v237, v237
v_exp_f32 v238, v238
v_exp_f32 v239, v239
v_exp_f32 v240, v240
v_exp_f32 v241, v241
v_exp_f32 v242, v242
v_exp_f32 v243, v243
v_pk_add_f32 v[236:237], v[236:237], 1.0 op_sel_hi:[1,0]
v_pk_add_f32 v[238:239], v[238:239], 1.0 op_sel_hi:[1,0]
v_pk_add_f32 v[240:241], v[240:241], 1.0 op_sel_hi:[1,0]
v_pk_add_f32 v[242:243], v[242:243], 1.0 op_sel_hi:[1,0]
v_rcp_f32 v236, v236
v_rcp_f32 v237, v237
v_rcp_f32 v238, v238
v_rcp_f32 v239, v239
v_rcp_f32 v240, v240
v_rcp_f32 v241, v241
v_rcp_f32 v242, v242
v_rcp_f32 v243, v243
v_pk_mul_f32 v[236:237], v[236:237], v[148:149]
v_pk_mul_f32 v[238:239], v[238:239], v[150:151]
v_pk_mul_f32 v[240:241], v[240:241], v[164:165]
v_pk_mul_f32 v[242:243], v[242:243], v[166:167]
v_cvt_pk_bf16_f32 v148, v236, v237
v_cvt_pk_bf16_f32 v149, v238, v239
v_cvt_pk_bf16_f32 v150, v240, v241
v_cvt_pk_bf16_f32 v151, v242, v243
buffer_store_dwordx4 v[148:151], v1, s[4:7], s55 offen offset:2048 sc1
v_pk_mul_f32 v[244:245], v[152:153], v[152:153]
v_pk_mul_f32 v[246:247], v[154:155], v[154:155]
v_pk_mul_f32 v[248:249], v[168:169], v[168:169]
v_pk_mul_f32 v[250:251], v[170:171], v[170:171]
v_pk_fma_f32 v[244:245], v[244:245], s[58:59], v[40:41]
v_pk_fma_f32 v[246:247], v[246:247], s[58:59], v[40:41]
v_pk_fma_f32 v[248:249], v[248:249], s[58:59], v[40:41]
v_pk_fma_f32 v[250:251], v[250:251], s[58:59], v[40:41]
v_pk_mul_f32 v[244:245], v[244:245], v[152:153]
v_pk_mul_f32 v[246:247], v[246:247], v[154:155]
v_pk_mul_f32 v[248:249], v[248:249], v[168:169]
v_pk_mul_f32 v[250:251], v[250:251], v[170:171]
v_exp_f32 v244, v244
v_exp_f32 v245, v245
v_exp_f32 v246, v246
v_exp_f32 v247, v247
v_exp_f32 v248, v248
v_exp_f32 v249, v249
v_exp_f32 v250, v250
v_exp_f32 v251, v251
v_pk_add_f32 v[244:245], v[244:245], 1.0 op_sel_hi:[1,0]
v_pk_add_f32 v[246:247], v[246:247], 1.0 op_sel_hi:[1,0]
v_pk_add_f32 v[248:249], v[248:249], 1.0 op_sel_hi:[1,0]
v_pk_add_f32 v[250:251], v[250:251], 1.0 op_sel_hi:[1,0]
v_rcp_f32 v244, v244
v_rcp_f32 v245, v245
v_rcp_f32 v246, v246
v_rcp_f32 v247, v247
v_rcp_f32 v248, v248
v_rcp_f32 v249, v249
v_rcp_f32 v250, v250
v_rcp_f32 v251, v251
v_pk_mul_f32 v[244:245], v[244:245], v[152:153]
v_pk_mul_f32 v[246:247], v[246:247], v[154:155]
v_pk_mul_f32 v[248:249], v[248:249], v[168:169]
v_pk_mul_f32 v[250:251], v[250:251], v[170:171]
v_cvt_pk_bf16_f32 v152, v244, v245
v_cvt_pk_bf16_f32 v153, v246, v247
v_cvt_pk_bf16_f32 v154, v248, v249
v_cvt_pk_bf16_f32 v155, v250, v251
buffer_store_dwordx4 v[152:155], v1, s[4:7], s55 offen offset:3072 sc1
v_pk_mul_f32 v[236:237], v[172:173], v[172:173]
v_pk_mul_f32 v[238:239], v[174:175], v[174:175]
v_pk_mul_f32 v[240:241], v[188:189], v[188:189]
v_pk_mul_f32 v[242:243], v[190:191], v[190:191]
v_pk_fma_f32 v[236:237], v[236:237], s[58:59], v[40:41]
v_pk_fma_f32 v[238:239], v[238:239], s[58:59], v[40:41]
v_pk_fma_f32 v[240:241], v[240:241], s[58:59], v[40:41]
v_pk_fma_f32 v[242:243], v[242:243], s[58:59], v[40:41]
v_pk_mul_f32 v[236:237], v[236:237], v[172:173]
v_pk_mul_f32 v[238:239], v[238:239], v[174:175]
v_pk_mul_f32 v[240:241], v[240:241], v[188:189]
v_pk_mul_f32 v[242:243], v[242:243], v[190:191]
v_exp_f32 v236, v236
v_exp_f32 v237, v237
v_exp_f32 v238, v238
v_exp_f32 v239, v239
v_exp_f32 v240, v240
v_exp_f32 v241, v241
v_exp_f32 v242, v242
v_exp_f32 v243, v243
v_pk_add_f32 v[236:237], v[236:237], 1.0 op_sel_hi:[1,0]
v_pk_add_f32 v[238:239], v[238:239], 1.0 op_sel_hi:[1,0]
v_pk_add_f32 v[240:241], v[240:241], 1.0 op_sel_hi:[1,0]
v_pk_add_f32 v[242:243], v[242:243], 1.0 op_sel_hi:[1,0]
v_rcp_f32 v236, v236
v_rcp_f32 v237, v237
v_rcp_f32 v238, v238
v_rcp_f32 v239, v239
v_rcp_f32 v240, v240
v_rcp_f32 v241, v241
v_rcp_f32 v242, v242
v_rcp_f32 v243, v243
v_pk_mul_f32 v[236:237], v[236:237], v[172:173]
v_pk_mul_f32 v[238:239], v[238:239], v[174:175]
v_pk_mul_f32 v[240:241], v[240:241], v[188:189]
v_pk_mul_f32 v[242:243], v[242:243], v[190:191]
v_cvt_pk_bf16_f32 v172, v236, v237
v_cvt_pk_bf16_f32 v173, v238, v239
v_cvt_pk_bf16_f32 v174, v240, v241
v_cvt_pk_bf16_f32 v175, v242, v243
buffer_store_dwordx4 v[172:175], v1, s[4:7], s54 offen offset:0 sc1
v_pk_mul_f32 v[244:245], v[176:177], v[176:177]
v_pk_mul_f32 v[246:247], v[178:179], v[178:179]
v_pk_mul_f32 v[248:249], v[192:193], v[192:193]
v_pk_mul_f32 v[250:251], v[194:195], v[194:195]
v_pk_fma_f32 v[244:245], v[244:245], s[58:59], v[40:41]
v_pk_fma_f32 v[246:247], v[246:247], s[58:59], v[40:41]
v_pk_fma_f32 v[248:249], v[248:249], s[58:59], v[40:41]
v_pk_fma_f32 v[250:251], v[250:251], s[58:59], v[40:41]
v_pk_mul_f32 v[244:245], v[244:245], v[176:177]
v_pk_mul_f32 v[246:247], v[246:247], v[178:179]
v_pk_mul_f32 v[248:249], v[248:249], v[192:193]
v_pk_mul_f32 v[250:251], v[250:251], v[194:195]
v_exp_f32 v244, v244
v_exp_f32 v245, v245
v_exp_f32 v246, v246
v_exp_f32 v247, v247
v_exp_f32 v248, v248
v_exp_f32 v249, v249
v_exp_f32 v250, v250
v_exp_f32 v251, v251
v_pk_add_f32 v[244:245], v[244:245], 1.0 op_sel_hi:[1,0]
v_pk_add_f32 v[246:247], v[246:247], 1.0 op_sel_hi:[1,0]
v_pk_add_f32 v[248:249], v[248:249], 1.0 op_sel_hi:[1,0]
v_pk_add_f32 v[250:251], v[250:251], 1.0 op_sel_hi:[1,0]
v_rcp_f32 v244, v244
v_rcp_f32 v245, v245
v_rcp_f32 v246, v246
v_rcp_f32 v247, v247
v_rcp_f32 v248, v248
v_rcp_f32 v249, v249
v_rcp_f32 v250, v250
v_rcp_f32 v251, v251
v_pk_mul_f32 v[244:245], v[244:245], v[176:177]
v_pk_mul_f32 v[246:247], v[246:247], v[178:179]
v_pk_mul_f32 v[248:249], v[248:249], v[192:193]
v_pk_mul_f32 v[250:251], v[250:251], v[194:195]
v_cvt_pk_bf16_f32 v176, v244, v245
v_cvt_pk_bf16_f32 v177, v246, v247
v_cvt_pk_bf16_f32 v178, v248, v249
v_cvt_pk_bf16_f32 v179, v250, v251
buffer_store_dwordx4 v[176:179], v1, s[4:7], s54 offen offset:1024 sc1
v_pk_mul_f32 v[236:237], v[180:181], v[180:181]
v_pk_mul_f32 v[238:239], v[182:183], v[182:183]
v_pk_mul_f32 v[240:241], v[196:197], v[196:197]
v_pk_mul_f32 v[242:243], v[198:199], v[198:199]
v_pk_fma_f32 v[236:237], v[236:237], s[58:59], v[40:41]
v_pk_fma_f32 v[238:239], v[238:239], s[58:59], v[40:41]
v_pk_fma_f32 v[240:241], v[240:241], s[58:59], v[40:41]
v_pk_fma_f32 v[242:243], v[242:243], s[58:59], v[40:41]
v_pk_mul_f32 v[236:237], v[236:237], v[180:181]
v_pk_mul_f32 v[238:239], v[238:239], v[182:183]
v_pk_mul_f32 v[240:241], v[240:241], v[196:197]
v_pk_mul_f32 v[242:243], v[242:243], v[198:199]
v_exp_f32 v236, v236
v_exp_f32 v237, v237
v_exp_f32 v238, v238
v_exp_f32 v239, v239
v_exp_f32 v240, v240
v_exp_f32 v241, v241
v_exp_f32 v242, v242
v_exp_f32 v243, v243
v_pk_add_f32 v[236:237], v[236:237], 1.0 op_sel_hi:[1,0]
v_pk_add_f32 v[238:239], v[238:239], 1.0 op_sel_hi:[1,0]
v_pk_add_f32 v[240:241], v[240:241], 1.0 op_sel_hi:[1,0]
v_pk_add_f32 v[242:243], v[242:243], 1.0 op_sel_hi:[1,0]
v_rcp_f32 v236, v236
v_rcp_f32 v237, v237
v_rcp_f32 v238, v238
v_rcp_f32 v239, v239
v_rcp_f32 v240, v240
v_rcp_f32 v241, v241
v_rcp_f32 v242, v242
v_rcp_f32 v243, v243
v_pk_mul_f32 v[236:237], v[236:237], v[180:181]
v_pk_mul_f32 v[238:239], v[238:239], v[182:183]
v_pk_mul_f32 v[240:241], v[240:241], v[196:197]
v_pk_mul_f32 v[242:243], v[242:243], v[198:199]
v_cvt_pk_bf16_f32 v180, v236, v237
v_cvt_pk_bf16_f32 v181, v238, v239
v_cvt_pk_bf16_f32 v182, v240, v241
v_cvt_pk_bf16_f32 v183, v242, v243
buffer_store_dwordx4 v[180:183], v1, s[4:7], s66 offen offset:0 sc1
v_pk_mul_f32 v[244:245], v[184:185], v[184:185]
v_pk_mul_f32 v[246:247], v[186:187], v[186:187]
v_pk_mul_f32 v[248:249], v[200:201], v[200:201]
v_pk_mul_f32 v[250:251], v[202:203], v[202:203]
v_pk_fma_f32 v[244:245], v[244:245], s[58:59], v[40:41]
v_pk_fma_f32 v[246:247], v[246:247], s[58:59], v[40:41]
v_pk_fma_f32 v[248:249], v[248:249], s[58:59], v[40:41]
v_pk_fma_f32 v[250:251], v[250:251], s[58:59], v[40:41]
v_pk_mul_f32 v[244:245], v[244:245], v[184:185]
v_pk_mul_f32 v[246:247], v[246:247], v[186:187]
v_pk_mul_f32 v[248:249], v[248:249], v[200:201]
v_pk_mul_f32 v[250:251], v[250:251], v[202:203]
v_exp_f32 v244, v244
v_exp_f32 v245, v245
v_exp_f32 v246, v246
v_exp_f32 v247, v247
v_exp_f32 v248, v248
v_exp_f32 v249, v249
v_exp_f32 v250, v250
v_exp_f32 v251, v251
v_pk_add_f32 v[244:245], v[244:245], 1.0 op_sel_hi:[1,0]
v_pk_add_f32 v[246:247], v[246:247], 1.0 op_sel_hi:[1,0]
v_pk_add_f32 v[248:249], v[248:249], 1.0 op_sel_hi:[1,0]
v_pk_add_f32 v[250:251], v[250:251], 1.0 op_sel_hi:[1,0]
v_rcp_f32 v244, v244
v_rcp_f32 v245, v245
v_rcp_f32 v246, v246
v_rcp_f32 v247, v247
v_rcp_f32 v248, v248
v_rcp_f32 v249, v249
v_rcp_f32 v250, v250
v_rcp_f32 v251, v251
v_pk_mul_f32 v[244:245], v[244:245], v[184:185]
v_pk_mul_f32 v[246:247], v[246:247], v[186:187]
v_pk_mul_f32 v[248:249], v[248:249], v[200:201]
v_pk_mul_f32 v[250:251], v[250:251], v[202:203]
v_cvt_pk_bf16_f32 v184, v244, v245
v_cvt_pk_bf16_f32 v185, v246, v247
v_cvt_pk_bf16_f32 v186, v248, v249
v_cvt_pk_bf16_f32 v187, v250, v251
buffer_store_dwordx4 v[184:187], v1, s[4:7], s66 offen offset:1024 sc1
v_pk_mul_f32 v[236:237], v[204:205], v[204:205]
v_pk_mul_f32 v[238:239], v[206:207], v[206:207]
v_pk_mul_f32 v[240:241], v[220:221], v[220:221]
v_pk_mul_f32 v[242:243], v[222:223], v[222:223]
v_pk_fma_f32 v[236:237], v[236:237], s[58:59], v[40:41]
v_pk_fma_f32 v[238:239], v[238:239], s[58:59], v[40:41]
v_pk_fma_f32 v[240:241], v[240:241], s[58:59], v[40:41]
v_pk_fma_f32 v[242:243], v[242:243], s[58:59], v[40:41]
v_pk_mul_f32 v[236:237], v[236:237], v[204:205]
v_pk_mul_f32 v[238:239], v[238:239], v[206:207]
v_pk_mul_f32 v[240:241], v[240:241], v[220:221]
v_pk_mul_f32 v[242:243], v[242:243], v[222:223]
v_exp_f32 v236, v236
v_exp_f32 v237, v237
v_exp_f32 v238, v238
v_exp_f32 v239, v239
v_exp_f32 v240, v240
v_exp_f32 v241, v241
v_exp_f32 v242, v242
v_exp_f32 v243, v243
v_pk_add_f32 v[236:237], v[236:237], 1.0 op_sel_hi:[1,0]
v_pk_add_f32 v[238:239], v[238:239], 1.0 op_sel_hi:[1,0]
v_pk_add_f32 v[240:241], v[240:241], 1.0 op_sel_hi:[1,0]
v_pk_add_f32 v[242:243], v[242:243], 1.0 op_sel_hi:[1,0]
v_rcp_f32 v236, v236
v_rcp_f32 v237, v237
v_rcp_f32 v238, v238
v_rcp_f32 v239, v239
v_rcp_f32 v240, v240
v_rcp_f32 v241, v241
v_rcp_f32 v242, v242
v_rcp_f32 v243, v243
v_pk_mul_f32 v[236:237], v[236:237], v[204:205]
v_pk_mul_f32 v[238:239], v[238:239], v[206:207]
v_pk_mul_f32 v[240:241], v[240:241], v[220:221]
v_pk_mul_f32 v[242:243], v[242:243], v[222:223]
v_cvt_pk_bf16_f32 v204, v236, v237
v_cvt_pk_bf16_f32 v205, v238, v239
v_cvt_pk_bf16_f32 v206, v240, v241
v_cvt_pk_bf16_f32 v207, v242, v243
buffer_store_dwordx4 v[204:207], v1, s[4:7], s54 offen offset:2048 sc1
v_pk_mul_f32 v[244:245], v[208:209], v[208:209]
v_pk_mul_f32 v[246:247], v[210:211], v[210:211]
v_pk_mul_f32 v[248:249], v[224:225], v[224:225]
v_pk_mul_f32 v[250:251], v[226:227], v[226:227]
v_pk_fma_f32 v[244:245], v[244:245], s[58:59], v[40:41]
v_pk_fma_f32 v[246:247], v[246:247], s[58:59], v[40:41]
v_pk_fma_f32 v[248:249], v[248:249], s[58:59], v[40:41]
v_pk_fma_f32 v[250:251], v[250:251], s[58:59], v[40:41]
v_pk_mul_f32 v[244:245], v[244:245], v[208:209]
v_pk_mul_f32 v[246:247], v[246:247], v[210:211]
v_pk_mul_f32 v[248:249], v[248:249], v[224:225]
v_pk_mul_f32 v[250:251], v[250:251], v[226:227]
v_exp_f32 v244, v244
v_exp_f32 v245, v245
v_exp_f32 v246, v246
v_exp_f32 v247, v247
v_exp_f32 v248, v248
v_exp_f32 v249, v249
v_exp_f32 v250, v250
v_exp_f32 v251, v251
v_pk_add_f32 v[244:245], v[244:245], 1.0 op_sel_hi:[1,0]
v_pk_add_f32 v[246:247], v[246:247], 1.0 op_sel_hi:[1,0]
v_pk_add_f32 v[248:249], v[248:249], 1.0 op_sel_hi:[1,0]
v_pk_add_f32 v[250:251], v[250:251], 1.0 op_sel_hi:[1,0]
v_rcp_f32 v244, v244
v_rcp_f32 v245, v245
v_rcp_f32 v246, v246
v_rcp_f32 v247, v247
v_rcp_f32 v248, v248
v_rcp_f32 v249, v249
v_rcp_f32 v250, v250
v_rcp_f32 v251, v251
v_pk_mul_f32 v[244:245], v[244:245], v[208:209]
v_pk_mul_f32 v[246:247], v[246:247], v[210:211]
v_pk_mul_f32 v[248:249], v[248:249], v[224:225]
v_pk_mul_f32 v[250:251], v[250:251], v[226:227]
v_cvt_pk_bf16_f32 v208, v244, v245
v_cvt_pk_bf16_f32 v209, v246, v247
v_cvt_pk_bf16_f32 v210, v248, v249
v_cvt_pk_bf16_f32 v211, v250, v251
buffer_store_dwordx4 v[208:211], v1, s[4:7], s54 offen offset:3072 sc1
v_pk_mul_f32 v[236:237], v[212:213], v[212:213]
v_pk_mul_f32 v[238:239], v[214:215], v[214:215]
v_pk_mul_f32 v[240:241], v[228:229], v[228:229]
v_pk_mul_f32 v[242:243], v[230:231], v[230:231]
v_pk_fma_f32 v[236:237], v[236:237], s[58:59], v[40:41]
v_pk_fma_f32 v[238:239], v[238:239], s[58:59], v[40:41]
v_pk_fma_f32 v[240:241], v[240:241], s[58:59], v[40:41]
v_pk_fma_f32 v[242:243], v[242:243], s[58:59], v[40:41]
v_pk_mul_f32 v[236:237], v[236:237], v[212:213]
v_pk_mul_f32 v[238:239], v[238:239], v[214:215]
v_pk_mul_f32 v[240:241], v[240:241], v[228:229]
v_pk_mul_f32 v[242:243], v[242:243], v[230:231]
v_exp_f32 v236, v236
v_exp_f32 v237, v237
v_exp_f32 v238, v238
v_exp_f32 v239, v239
v_exp_f32 v240, v240
v_exp_f32 v241, v241
v_exp_f32 v242, v242
v_exp_f32 v243, v243
v_pk_add_f32 v[236:237], v[236:237], 1.0 op_sel_hi:[1,0]
v_pk_add_f32 v[238:239], v[238:239], 1.0 op_sel_hi:[1,0]
v_pk_add_f32 v[240:241], v[240:241], 1.0 op_sel_hi:[1,0]
v_pk_add_f32 v[242:243], v[242:243], 1.0 op_sel_hi:[1,0]
v_rcp_f32 v236, v236
v_rcp_f32 v237, v237
v_rcp_f32 v238, v238
v_rcp_f32 v239, v239
v_rcp_f32 v240, v240
v_rcp_f32 v241, v241
v_rcp_f32 v242, v242
v_rcp_f32 v243, v243
v_pk_mul_f32 v[236:237], v[236:237], v[212:213]
v_pk_mul_f32 v[238:239], v[238:239], v[214:215]
v_pk_mul_f32 v[240:241], v[240:241], v[228:229]
v_pk_mul_f32 v[242:243], v[242:243], v[230:231]
v_cvt_pk_bf16_f32 v212, v236, v237
v_cvt_pk_bf16_f32 v213, v238, v239
v_cvt_pk_bf16_f32 v214, v240, v241
v_cvt_pk_bf16_f32 v215, v242, v243
buffer_store_dwordx4 v[212:215], v1, s[4:7], s66 offen offset:2048 sc1
v_pk_mul_f32 v[244:245], v[216:217], v[216:217]
v_pk_mul_f32 v[246:247], v[218:219], v[218:219]
v_pk_mul_f32 v[248:249], v[232:233], v[232:233]
v_pk_mul_f32 v[250:251], v[234:235], v[234:235]
v_pk_fma_f32 v[244:245], v[244:245], s[58:59], v[40:41]
v_pk_fma_f32 v[246:247], v[246:247], s[58:59], v[40:41]
v_pk_fma_f32 v[248:249], v[248:249], s[58:59], v[40:41]
v_pk_fma_f32 v[250:251], v[250:251], s[58:59], v[40:41]
v_pk_mul_f32 v[244:245], v[244:245], v[216:217]
v_pk_mul_f32 v[246:247], v[246:247], v[218:219]
v_pk_mul_f32 v[248:249], v[248:249], v[232:233]
v_pk_mul_f32 v[250:251], v[250:251], v[234:235]
v_exp_f32 v244, v244
v_exp_f32 v245, v245
v_exp_f32 v246, v246
v_exp_f32 v247, v247
v_exp_f32 v248, v248
v_exp_f32 v249, v249
v_exp_f32 v250, v250
v_exp_f32 v251, v251
v_pk_add_f32 v[244:245], v[244:245], 1.0 op_sel_hi:[1,0]
v_pk_add_f32 v[246:247], v[246:247], 1.0 op_sel_hi:[1,0]
v_pk_add_f32 v[248:249], v[248:249], 1.0 op_sel_hi:[1,0]
v_pk_add_f32 v[250:251], v[250:251], 1.0 op_sel_hi:[1,0]
v_rcp_f32 v244, v244
v_rcp_f32 v245, v245
v_rcp_f32 v246, v246
v_rcp_f32 v247, v247
v_rcp_f32 v248, v248
v_rcp_f32 v249, v249
v_rcp_f32 v250, v250
v_rcp_f32 v251, v251
v_pk_mul_f32 v[244:245], v[244:245], v[216:217]
v_pk_mul_f32 v[246:247], v[246:247], v[218:219]
v_pk_mul_f32 v[248:249], v[248:249], v[232:233]
v_pk_mul_f32 v[250:251], v[250:251], v[234:235]
v_cvt_pk_bf16_f32 v216, v244, v245
v_cvt_pk_bf16_f32 v217, v246, v247
v_cvt_pk_bf16_f32 v218, v248, v249
v_cvt_pk_bf16_f32 v219, v250, v251
buffer_store_dwordx4 v[216:219], v1, s[4:7], s66 offen offset:3072 sc1
s_add_u32 s54, s46, s44
s_add_u32 s55, s55, s44
s_waitcnt vmcnt(16)
s_branch L2_join
L2_sl0:
s_mov_b64 exec, 1
buffer_atomic_add v43, off, s[72:75], s84 sc1
s_mov_b64 exec, -1
s_branch L2_sl0_r
L2_sl1:
s_mov_b64 exec, 1
buffer_atomic_add v43, off, s[72:75], s84 sc1
s_mov_b64 exec, -1
s_branch L2_sl1_r
L2_sl2:
s_mov_b64 exec, 1
buffer_atomic_add v43, off, s[72:75], s84 sc1
s_mov_b64 exec, -1
s_branch L2_sl2_r
L2_sl3:
s_mov_b64 exec, 1
buffer_atomic_add v43, off, s[72:75], s84 sc1
s_mov_b64 exec, -1
s_branch L2_sl3_r
L2_wa:
s_mov_b32 s38, -1048576
L2_wa1:
buffer_load_dword v75, v74, s[72:75], s93 offen sc1
s_add_u32 s38, s38, 1
s_cbranch_scc1 L2_wa_x
s_waitcnt vmcnt(0)
v_cmp_gt_u32 vcc, s101, v75
s_nop 4
s_cbranch_vccnz L2_wa1
L2_wa_x:
s_waitcnt vmcnt(0)
s_branch L2_wa_r
L2_su:
s_mov_b64 exec, 1
buffer_atomic_add v43, off, s[4:7], s84 sc1
s_mov_b64 exec, -1
s_mov_b32 s82, 0
s_branch L2_su_r
L2_wn:
s_mov_b32 s55, -1048576
L2_wn1:
buffer_load_dword v252, off, s[4:7], s85 sc1
s_add_u32 s55, s55, 1
s_cbranch_scc1 L2_wn1_x
s_waitcnt vmcnt(0)
v_readfirstlane_b32 s54, v252
s_nop 0
s_cmp_lt_u32 s54, s91
s_cbranch_scc1 L2_wn1
L2_wn1_x:
s_waitcnt vmcnt(0)
s_branch L2_wn_r
L2_bad:
ds_write_b32 v39, v43
s_waitcnt lgkmcnt(0)
s_branch L2_bad_r
L2_ra:
s_mov_b32 s3, 1
s_nop 7
s_nop 0
v_accvgpr_read_b32 v28, a32
v_accvgpr_read_b32 v38, a33
v_accvgpr_read_b32 v29, a36
v_accvgpr_read_b32 v40, a37
v_accvgpr_read_b32 v30, a40
v_accvgpr_read_b32 v41, a41
v_accvgpr_read_b32 v31, a44
v_accvgpr_read_b32 v252, a45
v_add_f32 v28, v28, v38
v_add_f32 v29, v29, v40
v_add_f32 v30, v30, v41
v_add_f32 v31, v31, v252
v_frexp_exp_i32_f32 v28, v28
v_frexp_exp_i32_f32 v29, v29
v_frexp_exp_i32_f32 v30, v30
v_frexp_exp_i32_f32 v31, v31
v_sub_u32 v28, -101, v28
v_sub_u32 v29, -101, v29
v_sub_u32 v30, -101, v30
v_sub_u32 v31, -101, v31
v_ldexp_f32 v38, 1.0, v28
v_cvt_f32_i32 v28, v28
v_ldexp_f32 v40, 1.0, v29
v_cvt_f32_i32 v29, v29
v_ldexp_f32 v41, 1.0, v30
v_cvt_f32_i32 v30, v30
v_ldexp_f32 v252, 1.0, v31
v_cvt_f32_i32 v31, v31
v_add_f32 v236, v236, v28
v_add_f32 v237, v237, v28
v_add_f32 v238, v238, v28
v_add_f32 v239, v239, v28
v_add_f32 v240, v240, v29
v_add_f32 v241, v241, v29
v_add_f32 v242, v242, v29
v_add_f32 v243, v243, v29
v_add_f32 v244, v244, v30
v_add_f32 v245, v245, v30
v_add_f32 v246, v246, v30
v_add_f32 v247, v247, v30
v_add_f32 v248, v248, v31
v_add_f32 v249, v249, v31
v_add_f32 v250, v250, v31
v_add_f32 v251, v251, v31
s_branch L2_ra_r
L2_rb:
s_mov_b32 s3, 0
v_mov_b32 v31, 0x7f800000
s_nop 7
v_accvgpr_read_b32 v28, a32
v_accvgpr_read_b32 v29, a33
v_add_f32 v30, v28, v29
v_cmp_ge_f32 vcc, 0x47800000, v30
s_nop 1
v_cndmask_b32 v38, v31, v38, vcc
v_pk_mul_f32 v[28:29], v[28:29], v[38:39] op_sel:[0,0] op_sel_hi:[1,0]
v_accvgpr_write_b32 a32, v28
v_accvgpr_write_b32 a33, v29
v_accvgpr_read_b32 v28, a36
v_accvgpr_read_b32 v29, a37
v_add_f32 v30, v28, v29
v_cmp_ge_f32 vcc, 0x47800000, v30
s_nop 1
v_cndmask_b32 v40, v31, v40, vcc
v_pk_mul_f32 v[28:29], v[28:29], v[40:41] op_sel:[0,0] op_sel_hi:[1,0]
v_accvgpr_write_b32 a36, v28
v_accvgpr_write_b32 a37, v29
v_accvgpr_read_b32 v28, a40
v_accvgpr_read_b32 v29, a41
v_add_f32 v30, v28, v29
v_cmp_ge_f32 vcc, 0x47800000, v30
s_nop 1
v_cndmask_b32 v41, v31, v41, vcc
v_pk_mul_f32 v[28:29], v[28:29], v[40:41] op_sel:[0,1] op_sel_hi:[1,1]
v_accvgpr_write_b32 a40, v28
v_accvgpr_write_b32 a41, v29
v_accvgpr_read_b32 v28, a44
v_accvgpr_read_b32 v29, a45
v_add_f32 v30, v28, v29
s_nop 0
v_cmp_ge_f32 vcc, 0x47800000, v30
s_nop 1
v_cndmask_b32 v252, v31, v252, vcc
v_pk_mul_f32 v[28:29], v[28:29], v[252:253] op_sel:[0,0] op_sel_hi:[1,0]
v_accvgpr_write_b32 a44, v28
v_accvgpr_write_b32 a45, v29
v_pk_mul_f32 v[108:109], v[108:109], v[38:39] op_sel:[0,0] op_sel_hi:[1,0]
v_pk_mul_f32 v[110:111], v[110:111], v[38:39] op_sel:[0,0] op_sel_hi:[1,0]
v_pk_mul_f32 v[112:113], v[112:113], v[40:41] op_sel:[0,0] op_sel_hi:[1,0]
v_pk_mul_f32 v[114:115], v[114:115], v[40:41] op_sel:[0,0] op_sel_hi:[1,0]
v_pk_mul_f32 v[116:117], v[116:117], v[40:41] op_sel:[0,1] op_sel_hi:[1,1]
v_pk_mul_f32 v[118:119], v[118:119], v[40:41] op_sel:[0,1] op_sel_hi:[1,1]
v_pk_mul_f32 v[120:121], v[120:121], v[252:253] op_sel:[0,0] op_sel_hi:[1,0]
v_pk_mul_f32 v[122:123], v[122:123], v[252:253] op_sel:[0,0] op_sel_hi:[1,0]
v_pk_mul_f32 v[124:125], v[124:125], v[38:39] op_sel:[0,0] op_sel_hi:[1,0]
v_pk_mul_f32 v[126:127], v[126:127], v[38:39] op_sel:[0,0] op_sel_hi:[1,0]
v_pk_mul_f32 v[128:129], v[128:129], v[40:41] op_sel:[0,0] op_sel_hi:[1,0]
v_pk_mul_f32 v[130:131], v[130:131], v[40:41] op_sel:[0,0] op_sel_hi:[1,0]
v_pk_mul_f32 v[132:133], v[132:133], v[40:41] op_sel:[0,1] op_sel_hi:[1,1]
v_pk_mul_f32 v[134:135], v[134:135], v[40:41] op_sel:[0,1] op_sel_hi:[1,1]
v_pk_mul_f32 v[136:137], v[136:137], v[252:253] op_sel:[0,0] op_sel_hi:[1,0]
v_pk_mul_f32 v[138:139], v[138:139], v[252:253] op_sel:[0,0] op_sel_hi:[1,0]
v_pk_mul_f32 v[140:141], v[140:141], v[38:39] op_sel:[0,0] op_sel_hi:[1,0]
v_pk_mul_f32 v[142:143], v[142:143], v[38:39] op_sel:[0,0] op_sel_hi:[1,0]
v_pk_mul_f32 v[144:145], v[144:145], v[40:41] op_sel:[0,0] op_sel_hi:[1,0]
v_pk_mul_f32 v[146:147], v[146:147], v[40:41] op_sel:[0,0] op_sel_hi:[1,0]
v_pk_mul_f32 v[148:149], v[148:149], v[40:41] op_sel:[0,1] op_sel_hi:[1,1]
v_pk_mul_f32 v[150:151], v[150:151], v[40:41] op_sel:[0,1] op_sel_hi:[1,1]
v_pk_mul_f32 v[152:153], v[152:153], v[252:253] op_sel:[0,0] op_sel_hi:[1,0]
v_pk_mul_f32 v[154:155], v[154:155], v[252:253] op_sel:[0,0] op_sel_hi:[1,0]
v_pk_mul_f32 v[156:157], v[156:157], v[38:39] op_sel:[0,0] op_sel_hi:[1,0]
v_pk_mul_f32 v[158:159], v[158:159], v[38:39] op_sel:[0,0] op_sel_hi:[1,0]
v_pk_mul_f32 v[160:161], v[160:161], v[40:41] op_sel:[0,0] op_sel_hi:[1,0]
v_pk_mul_f32 v[162:163], v[162:163], v[40:41] op_sel:[0,0] op_sel_hi:[1,0]
v_pk_mul_f32 v[164:165], v[164:165], v[40:41] op_sel:[0,1] op_sel_hi:[1,1]
v_pk_mul_f32 v[166:167], v[166:167], v[40:41] op_sel:[0,1] op_sel_hi:[1,1]
v_pk_mul_f32 v[168:169], v[168:169], v[252:253] op_sel:[0,0] op_sel_hi:[1,0]
v_pk_mul_f32 v[170:171], v[170:171], v[252:253] op_sel:[0,0] op_sel_hi:[1,0]
v_pk_mul_f32 v[172:173], v[172:173], v[38:39] op_sel:[0,0] op_sel_hi:[1,0]
v_pk_mul_f32 v[174:175], v[174:175], v[38:39] op_sel:[0,0] op_sel_hi:[1,0]
v_pk_mul_f32 v[176:177], v[176:177], v[40:41] op_sel:[0,0] op_sel_hi:[1,0]
v_pk_mul_f32 v[178:179], v[178:179], v[40:41] op_sel:[0,0] op_sel_hi:[1,0]
v_pk_mul_f32 v[180:181], v[180:181], v[40:41] op_sel:[0,1] op_sel_hi:[1,1]
v_pk_mul_f32 v[182:183], v[182:183], v[40:41] op_sel:[0,1] op_sel_hi:[1,1]
v_pk_mul_f32 v[184:185], v[184:185], v[252:253] op_sel:[0,0] op_sel_hi:[1,0]
v_pk_mul_f32 v[186:187], v[186:187], v[252:253] op_sel:[0,0] op_sel_hi:[1,0]
v_pk_mul_f32 v[188:189], v[188:189], v[38:39] op_sel:[0,0] op_sel_hi:[1,0]
v_pk_mul_f32 v[190:191], v[190:191], v[38:39] op_sel:[0,0] op_sel_hi:[1,0]
v_pk_mul_f32 v[192:193], v[192:193], v[40:41] op_sel:[0,0] op_sel_hi:[1,0]
v_pk_mul_f32 v[194:195], v[194:195], v[40:41] op_sel:[0,0] op_sel_hi:[1,0]
v_pk_mul_f32 v[196:197], v[196:197], v[40:41] op_sel:[0,1] op_sel_hi:[1,1]
v_pk_mul_f32 v[198:199], v[198:199], v[40:41] op_sel:[0,1] op_sel_hi:[1,1]
v_pk_mul_f32 v[200:201], v[200:201], v[252:253] op_sel:[0,0] op_sel_hi:[1,0]
v_pk_mul_f32 v[202:203], v[202:203], v[252:253] op_sel:[0,0] op_sel_hi:[1,0]
v_pk_mul_f32 v[204:205], v[204:205], v[38:39] op_sel:[0,0] op_sel_hi:[1,0]
v_pk_mul_f32 v[206:207], v[206:207], v[38:39] op_sel:[0,0] op_sel_hi:[1,0]
v_pk_mul_f32 v[208:209], v[208:209], v[40:41] op_sel:[0,0] op_sel_hi:[1,0]
v_pk_mul_f32 v[210:211], v[210:211], v[40:41] op_sel:[0,0] op_sel_hi:[1,0]
v_pk_mul_f32 v[212:213], v[212:213], v[40:41] op_sel:[0,1] op_sel_hi:[1,1]
v_pk_mul_f32 v[214:215], v[214:215], v[40:41] op_sel:[0,1] op_sel_hi:[1,1]
v_pk_mul_f32 v[216:217], v[216:217], v[252:253] op_sel:[0,0] op_sel_hi:[1,0]
v_pk_mul_f32 v[218:219], v[218:219], v[252:253] op_sel:[0,0] op_sel_hi:[1,0]
v_pk_mul_f32 v[220:221], v[220:221], v[38:39] op_sel:[0,0] op_sel_hi:[1,0]
v_pk_mul_f32 v[222:223], v[222:223], v[38:39] op_sel:[0,0] op_sel_hi:[1,0]
v_pk_mul_f32 v[224:225], v[224:225], v[40:41] op_sel:[0,0] op_sel_hi:[1,0]
v_pk_mul_f32 v[226:227], v[226:227], v[40:41] op_sel:[0,0] op_sel_hi:[1,0]
v_pk_mul_f32 v[228:229], v[228:229], v[40:41] op_sel:[0,1] op_sel_hi:[1,1]
v_pk_mul_f32 v[230:231], v[230:231], v[40:41] op_sel:[0,1] op_sel_hi:[1,1]
v_pk_mul_f32 v[232:233], v[232:233], v[252:253] op_sel:[0,0] op_sel_hi:[1,0]
v_pk_mul_f32 v[234:235], v[234:235], v[252:253] op_sel:[0,0] op_sel_hi:[1,0]
s_branch L2_rb_r
L2_so:
s_mov_b64 exec, 1
buffer_atomic_add v43, off, s[4:7], s83 sc1
s_mov_b64 exec, -1
s_mov_b32 s82, 0
s_branch L2_so_r
L2_h4o:
s_cmp_ge_u32 s54, 16
s_cbranch_scc1 L2_c0_k
s_mov_b32 s55, -1048576
L2_c0:
buffer_load_dword v252, off, s[4:7], s85 sc1
s_add_u32 s55, s55, 1
s_cbranch_scc1 L2_c0_x
s_waitcnt vmcnt(0)
v_readfirstlane_b32 s54, v252
s_nop 0
s_cmp_lt_u32 s54, 16
s_cbranch_scc1 L2_c0
L2_c0_x:
s_waitcnt vmcnt(0)
L2_c0_k:
s_branch L2_h4o_r
L2_sy1:
s_mov_b64 exec, 1
buffer_atomic_add v43, off, s[4:7], s83 sc1
s_mov_b64 exec, -1
s_mov_b32 s82, 0
s_branch L2_sy1_r
L2_h3:
s_cmp_lg_u32 s38, -7
s_cbranch_scc1 L2_h3_9
s_cmp_ge_u32 s54, 1
s_cbranch_scc1 L2_cy_k
s_mov_b32 s55, -1048576
L2_cy:
buffer_load_dword v252, off, s[4:7], s85 sc1
s_add_u32 s55, s55, 1
s_cbranch_scc1 L2_cy_x
s_waitcnt vmcnt(0)
v_readfirstlane_b32 s54, v252
s_nop 0
s_cmp_lt_u32 s54, 1
s_cbranch_scc1 L2_cy
L2_cy_x:
s_waitcnt vmcnt(0)
L2_cy_k:
s_lshl_b32 s93, s87, 13
s_add_u32 s93, s93, 46137344
s_add_u32 s100, s93, 4096
s_mov_b32 s85, s84
buffer_load_dwordx4 a[96:99], v1, s[4:7], s93 offen offset:0 sc1
buffer_load_dwordx4 a[100:103], v1, s[4:7], s93 offen offset:1024 sc1
buffer_load_dwordx4 a[104:107], v1, s[4:7], s93 offen offset:2048 sc1
buffer_load_dwordx4 a[108:111], v1, s[4:7], s93 offen offset:3072 sc1
buffer_load_dwordx4 a[112:115], v1, s[4:7], s100 offen offset:0 sc1
buffer_load_dwordx4 a[116:119], v1, s[4:7], s100 offen offset:1024 sc1
buffer_load_dwordx4 a[120:123], v1, s[4:7], s100 offen offset:2048 sc1
buffer_load_dwordx4 a[124:127], v1, s[4:7], s100 offen offset:3072 sc1
L2_h3_9:
s_cmp_lg_u32 s38, -6
s_cbranch_scc1 L2_h3_13
v_mfma_f32_16x16x32_bf16 v[108:111], v[12:15], a[96:99], v[108:111]
v_mfma_f32_16x16x32_bf16 v[112:115], v[10:13], a[96:99], v[112:115]
v_mfma_f32_16x16x32_bf16 v[124:127], v[12:15], a[100:103], v[124:127]
v_mfma_f32_16x16x32_bf16 v[128:131], v[10:13], a[100:103], v[128:131]
v_mfma_f32_16x16x32_bf16 v[140:143], v[12:15], a[104:107], v[140:143]
v_mfma_f32_16x16x32_bf16 v[144:147], v[10:13], a[104:107], v[144:147]
v_mfma_f32_16x16x32_bf16 v[156:159], v[12:15], a[108:111], v[156:159]
v_mfma_f32_16x16x32_bf16 v[160:163], v[10:13], a[108:111], v[160:163]
v_mfma_f32_16x16x32_bf16 v[172:175], v[12:15], a[112:115], v[172:175]
v_mfma_f32_16x16x32_bf16 v[176:179], v[10:13], a[112:115], v[176:179]
v_mfma_f32_16x16x32_bf16 v[188:191], v[12:15], a[116:119], v[188:191]
v_mfma_f32_16x16x32_bf16 v[192:195], v[10:13], a[116:119], v[192:195]
v_mfma_f32_16x16x32_bf16 v[204:207], v[12:15], a[120:123], v[204:207]
v_mfma_f32_16x16x32_bf16 v[208:211], v[10:13], a[120:123], v[208:211]
v_mfma_f32_16x16x32_bf16 v[220:223], v[12:15], a[124:127], v[220:223]
v_mfma_f32_16x16x32_bf16 v[224:227], v[10:13], a[124:127], v[224:227]
v_pk_mul_f32 v[236:237], v[108:109], s[58:59]
v_pk_mul_f32 v[238:239], v[110:111], s[58:59]
v_pk_mul_f32 v[240:241], v[112:113], s[58:59]
v_pk_mul_f32 v[242:243], v[114:115], s[58:59]
v_exp_f32 v236, v236
v_exp_f32 v237, v237
v_exp_f32 v238, v238
v_exp_f32 v239, v239
v_exp_f32 v240, v240
v_exp_f32 v241, v241
v_exp_f32 v242, v242
v_exp_f32 v243, v243
v_pk_add_f32 v[236:237], v[236:237], 1.0 op_sel_hi:[1,0]
v_pk_add_f32 v[238:239], v[238:239], 1.0 op_sel_hi:[1,0]
v_pk_add_f32 v[240:241], v[240:241], 1.0 op_sel_hi:[1,0]
v_pk_add_f32 v[242:243], v[242:243], 1.0 op_sel_hi:[1,0]
v_rcp_f32 v236, v236
v_rcp_f32 v237, v237
v_rcp_f32 v238, v238
v_rcp_f32 v239, v239
v_rcp_f32 v240, v240
v_rcp_f32 v241, v241
v_rcp_f32 v242, v242
v_rcp_f32 v243, v243
v_pk_mul_f32 v[108:109], v[236:237], v[108:109]
v_pk_mul_f32 v[110:111], v[238:239], v[110:111]
v_pk_mul_f32 v[112:113], v[240:241], v[112:113]
v_pk_mul_f32 v[114:115], v[242:243], v[114:115]
s_waitcnt lgkmcnt(0)
s_nop 0
ds_write_b128 v38, v[108:111] offset:0
ds_write_b128 v38, v[112:115] offset:1024
v_pk_mul_f32 v[244:245], v[124:125], s[58:59]
v_pk_mul_f32 v[246:247], v[126:127], s[58:59]
v_pk_mul_f32 v[248:249], v[128:129], s[58:59]
v_pk_mul_f32 v[250:251], v[130:131], s[58:59]
v_exp_f32 v244, v244
v_exp_f32 v245, v245
v_exp_f32 v246, v246
v_exp_f32 v247, v247
v_exp_f32 v248, v248
v_exp_f32 v249, v249
v_exp_f32 v250, v250
v_exp_f32 v251, v251
v_pk_add_f32 v[244:245], v[244:245], 1.0 op_sel_hi:[1,0]
v_pk_add_f32 v[246:247], v[246:247], 1.0 op_sel_hi:[1,0]
v_pk_add_f32 v[248:249], v[248:249], 1.0 op_sel_hi:[1,0]
v_pk_add_f32 v[250:251], v[250:251], 1.0 op_sel_hi:[1,0]
v_rcp_f32 v244, v244
v_rcp_f32 v245, v245
v_rcp_f32 v246, v246
v_rcp_f32 v247, v247
v_rcp_f32 v248, v248
v_rcp_f32 v249, v249
v_rcp_f32 v250, v250
v_rcp_f32 v251, v251
v_pk_mul_f32 v[124:125], v[244:245], v[124:125]
v_pk_mul_f32 v[126:127], v[246:247], v[126:127]
v_pk_mul_f32 v[128:129], v[248:249], v[128:129]
v_pk_mul_f32 v[130:131], v[250:251], v[130:131]
ds_write_b128 v38, v[124:127] offset:8192
ds_write_b128 v38, v[128:131] offset:9216
v_pk_mul_f32 v[236:237], v[140:141], s[58:59]
v_pk_mul_f32 v[238:239], v[142:143], s[58:59]
v_pk_mul_f32 v[240:241], v[144:145], s[58:59]
v_pk_mul_f32 v[242:243], v[146:147], s[58:59]
v_exp_f32 v236, v236
v_exp_f32 v237, v237
v_exp_f32 v238, v238
v_exp_f32 v239, v239
v_exp_f32 v240, v240
v_exp_f32 v241, v241
v_exp_f32 v242, v242
v_exp_f32 v243, v243
v_pk_add_f32 v[236:237], v[236:237], 1.0 op_sel_hi:[1,0]
v_pk_add_f32 v[238:239], v[238:239], 1.0 op_sel_hi:[1,0]
v_pk_add_f32 v[240:241], v[240:241], 1.0 op_sel_hi:[1,0]
v_pk_add_f32 v[242:243], v[242:243], 1.0 op_sel_hi:[1,0]
v_rcp_f32 v236, v236
v_rcp_f32 v237, v237
v_rcp_f32 v238, v238
v_rcp_f32 v239, v239
v_rcp_f32 v240, v240
v_rcp_f32 v241, v241
v_rcp_f32 v242, v242
v_rcp_f32 v243, v243
v_pk_mul_f32 v[140:141], v[236:237], v[140:141]
v_pk_mul_f32 v[142:143], v[238:239], v[142:143]
v_pk_mul_f32 v[144:145], v[240:241], v[144:145]
v_pk_mul_f32 v[146:147], v[242:243], v[146:147]
ds_write_b128 v38, v[140:143] offset:16384
ds_write_b128 v38, v[144:147] offset:17408
v_pk_mul_f32 v[244:245], v[156:157], s[58:59]
v_pk_mul_f32 v[246:247], v[158:159], s[58:59]
v_pk_mul_f32 v[248:249], v[160:161], s[58:59]
v_pk_mul_f32 v[250:251], v[162:163], s[58:59]
v_exp_f32 v244, v244
v_exp_f32 v245, v245
v_exp_f32 v246, v246
v_exp_f32 v247, v247
v_exp_f32 v248, v248
v_exp_f32 v249, v249
v_exp_f32 v250, v250
v_exp_f32 v251, v251
v_pk_add_f32 v[244:245], v[244:245], 1.0 op_sel_hi:[1,0]
v_pk_add_f32 v[246:247], v[246:247], 1.0 op_sel_hi:[1,0]
v_pk_add_f32 v[248:249], v[248:249], 1.0 op_sel_hi:[1,0]
v_pk_add_f32 v[250:251], v[250:251], 1.0 op_sel_hi:[1,0]
v_rcp_f32 v244, v244
v_rcp_f32 v245, v245
v_rcp_f32 v246, v246
v_rcp_f32 v247, v247
v_rcp_f32 v248, v248
v_rcp_f32 v249, v249
v_rcp_f32 v250, v250
v_rcp_f32 v251, v251
v_pk_mul_f32 v[156:157], v[244:245], v[156:157]
v_pk_mul_f32 v[158:159], v[246:247], v[158:159]
v_pk_mul_f32 v[160:161], v[248:249], v[160:161]
v_pk_mul_f32 v[162:163], v[250:251], v[162:163]
ds_write_b128 v38, v[156:159] offset:24576
ds_write_b128 v38, v[160:163] offset:25600
v_pk_mul_f32 v[236:237], v[172:173], s[58:59]
v_pk_mul_f32 v[238:239], v[174:175], s[58:59]
v_pk_mul_f32 v[240:241], v[176:177], s[58:59]
v_pk_mul_f32 v[242:243], v[178:179], s[58:59]
v_exp_f32 v236, v236
v_exp_f32 v237, v237
v_exp_f32 v238, v238
v_exp_f32 v239, v239
v_exp_f32 v240, v240
v_exp_f32 v241, v241
v_exp_f32 v242, v242
v_exp_f32 v243, v243
v_pk_add_f32 v[236:237], v[236:237], 1.0 op_sel_hi:[1,0]
v_pk_add_f32 v[238:239], v[238:239], 1.0 op_sel_hi:[1,0]
v_pk_add_f32 v[240:241], v[240:241], 1.0 op_sel_hi:[1,0]
v_pk_add_f32 v[242:243], v[242:243], 1.0 op_sel_hi:[1,0]
v_rcp_f32 v236, v236
v_rcp_f32 v237, v237
v_rcp_f32 v238, v238
v_rcp_f32 v239, v239
v_rcp_f32 v240, v240
v_rcp_f32 v241, v241
v_rcp_f32 v242, v242
v_rcp_f32 v243, v243
v_pk_mul_f32 v[172:173], v[236:237], v[172:173]
v_pk_mul_f32 v[174:175], v[238:239], v[174:175]
v_pk_mul_f32 v[176:177], v[240:241], v[176:177]
v_pk_mul_f32 v[178:179], v[242:243], v[178:179]
s_waitcnt lgkmcnt(0)
s_nop 0
ds_write_b128 v38, v[172:175] offset:32768
ds_write_b128 v38, v[176:179] offset:33792
v_pk_mul_f32 v[244:245], v[188:189], s[58:59]
v_pk_mul_f32 v[246:247], v[190:191], s[58:59]
v_pk_mul_f32 v[248:249], v[192:193], s[58:59]
v_pk_mul_f32 v[250:251], v[194:195], s[58:59]
v_exp_f32 v244, v244
v_exp_f32 v245, v245
v_exp_f32 v246, v246
v_exp_f32 v247, v247
v_exp_f32 v248, v248
v_exp_f32 v249, v249
v_exp_f32 v250, v250
v_exp_f32 v251, v251
v_pk_add_f32 v[244:245], v[244:245], 1.0 op_sel_hi:[1,0]
v_pk_add_f32 v[246:247], v[246:247], 1.0 op_sel_hi:[1,0]
v_pk_add_f32 v[248:249], v[248:249], 1.0 op_sel_hi:[1,0]
v_pk_add_f32 v[250:251], v[250:251], 1.0 op_sel_hi:[1,0]
v_rcp_f32 v244, v244
v_rcp_f32 v245, v245
v_rcp_f32 v246, v246
v_rcp_f32 v247, v247
v_rcp_f32 v248, v248
v_rcp_f32 v249, v249
v_rcp_f32 v250, v250
v_rcp_f32 v251, v251
v_pk_mul_f32 v[188:189], v[244:245], v[188:189]
v_pk_mul_f32 v[190:191], v[246:247], v[190:191]
v_pk_mul_f32 v[192:193], v[248:249], v[192:193]
v_pk_mul_f32 v[194:195], v[250:251], v[194:195]
ds_write_b128 v38, v[188:191] offset:40960
ds_write_b128 v38, v[192:195] offset:41984
v_pk_mul_f32 v[236:237], v[204:205], s[58:59]
v_pk_mul_f32 v[238:239], v[206:207], s[58:59]
v_pk_mul_f32 v[240:241], v[208:209], s[58:59]
v_pk_mul_f32 v[242:243], v[210:211], s[58:59]
v_exp_f32 v236, v236
v_exp_f32 v237, v237
v_exp_f32 v238, v238
v_exp_f32 v239, v239
v_exp_f32 v240, v240
v_exp_f32 v241, v241
v_exp_f32 v242, v242
v_exp_f32 v243, v243
v_pk_add_f32 v[236:237], v[236:237], 1.0 op_sel_hi:[1,0]
v_pk_add_f32 v[238:239], v[238:239], 1.0 op_sel_hi:[1,0]
v_pk_add_f32 v[240:241], v[240:241], 1.0 op_sel_hi:[1,0]
v_pk_add_f32 v[242:243], v[242:243], 1.0 op_sel_hi:[1,0]
v_rcp_f32 v236, v236
v_rcp_f32 v237, v237
v_rcp_f32 v238, v238
v_rcp_f32 v239, v239
v_rcp_f32 v240, v240
v_rcp_f32 v241, v241
v_rcp_f32 v242, v242
v_rcp_f32 v243, v243
v_pk_mul_f32 v[204:205], v[236:237], v[204:205]
v_pk_mul_f32 v[206:207], v[238:239], v[206:207]
v_pk_mul_f32 v[208:209], v[240:241], v[208:209]
v_pk_mul_f32 v[210:211], v[242:243], v[210:211]
ds_write_b128 v38, v[204:207] offset:49152
ds_write_b128 v38, v[208:211] offset:50176
v_pk_mul_f32 v[244:245], v[220:221], s[58:59]
v_pk_mul_f32 v[246:247], v[222:223], s[58:59]
v_pk_mul_f32 v[248:249], v[224:225], s[58:59]
v_pk_mul_f32 v[250:251], v[226:227], s[58:59]
v_exp_f32 v244, v244
v_exp_f32 v245, v245
v_exp_f32 v246, v246
v_exp_f32 v247, v247
v_exp_f32 v248, v248
v_exp_f32 v249, v249
v_exp_f32 v250, v250
v_exp_f32 v251, v251
v_pk_add_f32 v[244:245], v[244:245], 1.0 op_sel_hi:[1,0]
v_pk_add_f32 v[246:247], v[246:247], 1.0 op_sel_hi:[1,0]
v_pk_add_f32 v[248:249], v[248:249], 1.0 op_sel_hi:[1,0]
v_pk_add_f32 v[250:251], v[250:251], 1.0 op_sel_hi:[1,0]
v_rcp_f32 v244, v244
v_rcp_f32 v245, v245
v_rcp_f32 v246, v246
v_rcp_f32 v247, v247
v_rcp_f32 v248, v248
v_rcp_f32 v249, v249
v_rcp_f32 v250, v250
v_rcp_f32 v251, v251
v_pk_mul_f32 v[220:221], v[244:245], v[220:221]
v_pk_mul_f32 v[222:223], v[246:247], v[222:223]
v_pk_mul_f32 v[224:225], v[248:249], v[224:225]
v_pk_mul_f32 v[226:227], v[250:251], v[226:227]
ds_write_b128 v38, v[220:223] offset:57344
ds_write_b128 v38, v[224:227] offset:58368
s_waitcnt lgkmcnt(0)
L2_h3_13:
s_cmp_lg_u32 s38, -5
s_cbranch_scc1 L2_h3_17
s_cmp_ge_u32 s54, 10
s_cbranch_scc1 L2_c2_k
s_mov_b32 s55, -1048576
L2_c2:
buffer_load_dword v252, off, s[4:7], s85 sc1
s_add_u32 s55, s55, 1
s_cbranch_scc1 L2_c2_x
s_waitcnt vmcnt(0)
v_readfirstlane_b32 s54, v252
s_nop 0
s_cmp_lt_u32 s54, 10
s_cbranch_scc1 L2_c2
L2_c2_x:
s_waitcnt vmcnt(0)
L2_c2_k:
L2_h3_17:
s_branch L2_h3_r
L2_wg:
s_mov_b32 s55, -1048576
L2_wg1:
buffer_load_dword v252, off, s[4:7], s86 sc1
s_add_u32 s55, s55, 1
s_cbranch_scc1 L2_wg1_x
s_waitcnt vmcnt(0)
v_readfirstlane_b32 s54, v252
s_nop 0
s_cmp_lt_u32 s54, 2
s_cbranch_scc1 L2_wg1
L2_wg1_x:
s_waitcnt vmcnt(0)
s_mov_b32 s93, s87
s_nop 0
s_add_u32 s100, s93, 4096
s_add_u32 s67, s93, 8192
s_add_u32 s84, s93, 12288
buffer_load_dwordx4 a[128:131], v1, s[4:7], s93 offen offset:0 sc1
buffer_load_dwordx4 a[132:135], v1, s[4:7], s93 offen offset:1024 sc1
buffer_load_dwordx4 a[136:139], v1, s[4:7], s93 offen offset:2048 sc1
buffer_load_dwordx4 a[140:143], v1, s[4:7], s93 offen offset:3072 sc1
buffer_load_dwordx4 a[144:147], v1, s[4:7], s100 offen offset:0 sc1
buffer_load_dwordx4 a[148:151], v1, s[4:7], s100 offen offset:1024 sc1
buffer_load_dwordx4 a[152:155], v1, s[4:7], s100 offen offset:2048 sc1
buffer_load_dwordx4 a[156:159], v1, s[4:7], s100 offen offset:3072 sc1
buffer_load_dwordx4 a[160:163], v1, s[4:7], s67 offen offset:0 sc1
buffer_load_dwordx4 a[164:167], v1, s[4:7], s67 offen offset:1024 sc1
buffer_load_dwordx4 a[168:171], v1, s[4:7], s67 offen offset:2048 sc1
buffer_load_dwordx4 a[172:175], v1, s[4:7], s67 offen offset:3072 sc1
buffer_load_dwordx4 a[176:179], v1, s[4:7], s84 offen offset:0 sc1
buffer_load_dwordx4 a[180:183], v1, s[4:7], s84 offen offset:1024 sc1
buffer_load_dwordx4 a[184:187], v1, s[4:7], s84 offen offset:2048 sc1
buffer_load_dwordx4 a[188:191], v1, s[4:7], s84 offen offset:3072 sc1
s_branch L2_wg_r
L2_yo:
s_mov_b64 exec, 1
buffer_atomic_add v43, off, s[4:7], s83 sc1
s_mov_b64 exec, -1
s_mov_b32 s82, 0
s_branch L2_yo_r
L2_hy:
s_cmp_lg_u32 s38, -2
s_cbranch_scc1 L2_hy_4
s_cmp_ge_u32 s54, 3
s_cbranch_scc1 L2_c1_k
s_mov_b32 s55, -1048576
L2_c1:
buffer_load_dword v252, off, s[4:7], s85 sc1
s_add_u32 s55, s55, 1
s_cbranch_scc1 L2_c1_x
s_waitcnt vmcnt(0)
v_readfirstlane_b32 s54, v252
s_nop 0
s_cmp_lt_u32 s54, 3
s_cbranch_scc1 L2_c1
L2_c1_x:
s_waitcnt vmcnt(0)
L2_c1_k:
L2_hy_4:
s_branch L2_hy_r
L2_wb:
s_mov_b32 s38, -1048576
L2_wb1:
buffer_load_dword v75, v74, s[72:75], s93 offen sc1
s_add_u32 s38, s38, 1
s_cbranch_scc1 L2_wb_x
s_waitcnt vmcnt(0)
v_cmp_gt_u32 vcc, s101, v75
s_nop 4
s_cbranch_vccnz L2_wb1
L2_wb_x:
s_waitcnt vmcnt(0)
s_branch L2_wb_r
L2_redo:
s_mov_b32 s48, 1
s_mov_b32 s40, 0
s_mov_b32 s41, s50
s_nop 0
s_mov_b32 s38, -32
v_and_b32 v36, 63, v0
v_lshlrev_b32 v36, 6, v36
v_accvgpr_read_b32 v44, a64
v_accvgpr_read_b32 v45, a65
v_accvgpr_read_b32 v46, a66
v_accvgpr_read_b32 v47, a67
v_accvgpr_read_b32 v48, a68
v_accvgpr_read_b32 v49, a69
v_accvgpr_read_b32 v50, a70
v_accvgpr_read_b32 v51, a71
v_accvgpr_read_b32 v52, a72
v_accvgpr_read_b32 v53, a73
v_accvgpr_read_b32 v54, a74
v_accvgpr_read_b32 v55, a75
v_accvgpr_read_b32 v56, a76
v_accvgpr_read_b32 v57, a77
v_accvgpr_read_b32 v58, a78
v_accvgpr_read_b32 v59, a79
v_accvgpr_read_b32 v60, a80
v_accvgpr_read_b32 v61, a81
v_accvgpr_read_b32 v62, a82
v_accvgpr_read_b32 v63, a83
v_accvgpr_read_b32 v64, a84
v_accvgpr_read_b32 v65, a85
v_accvgpr_read_b32 v66, a86
v_accvgpr_read_b32 v67, a87
v_accvgpr_read_b32 v68, a88
v_accvgpr_read_b32 v69, a89
v_accvgpr_read_b32 v70, a90
v_accvgpr_read_b32 v71, a91
v_accvgpr_read_b32 v72, a92
v_accvgpr_read_b32 v73, a93
v_accvgpr_read_b32 v74, a94
v_accvgpr_read_b32 v75, a95
v_accvgpr_read_b32 v76, a96
v_accvgpr_read_b32 v77, a97
v_accvgpr_read_b32 v78, a98
v_accvgpr_read_b32 v79, a99
v_accvgpr_read_b32 v80, a100
v_accvgpr_read_b32 v81, a101
v_accvgpr_read_b32 v82, a102
v_accvgpr_read_b32 v83, a103
v_accvgpr_read_b32 v84, a104
v_accvgpr_read_b32 v85, a105
v_accvgpr_read_b32 v86, a106
v_accvgpr_read_b32 v87, a107
v_accvgpr_read_b32 v88, a108
v_accvgpr_read_b32 v89, a109
v_accvgpr_read_b32 v90, a110
v_accvgpr_read_b32 v91, a111
v_accvgpr_read_b32 v92, a112
v_accvgpr_read_b32 v93, a113
v_accvgpr_read_b32 v94, a114
v_accvgpr_read_b32 v95, a115
v_accvgpr_read_b32 v96, a116
v_accvgpr_read_b32 v97, a117
v_accvgpr_read_b32 v98, a118
v_accvgpr_read_b32 v99, a119
v_accvgpr_read_b32 v100, a120
v_accvgpr_read_b32 v101, a121
v_accvgpr_read_b32 v102, a122
v_accvgpr_read_b32 v103, a123
v_accvgpr_read_b32 v104, a124
v_accvgpr_read_b32 v105, a125
v_accvgpr_read_b32 v106, a126
v_accvgpr_read_b32 v107, a127
v_mov_b32 v6, 0xff800000
v_mov_b32 v7, 0xff800000
v_mov_b32 v8, 0xff800000
v_mov_b32 v9, 0xff800000
L2_mx:
s_waitcnt vmcnt(0) lgkmcnt(0)
s_barrier
s_add_u32 m0, s37, 0
s_nop 0
buffer_load_dwordx4 v10, s[12:15], s41 offen offset:0 lds
buffer_load_dwordx4 v11, s[12:15], s41 offen offset:1024 lds
buffer_load_dwordx4 v12, s[12:15], s41 offen offset:2048 lds
buffer_load_dwordx4 v13, s[12:15], s41 offen offset:3072 lds
s_add_u32 s41, s41, 16384
s_waitcnt vmcnt(0)
s_barrier
ds_read_b128 a[128:131], v16 offset:0
ds_read_b128 a[132:135], v17 offset:0
ds_read_b128 a[136:139], v18 offset:0
ds_read_b128 a[140:143], v19 offset:0
s_waitcnt lgkmcnt(0)
v_mfma_f32_16x16x32_bf16 v[108:111], a[128:131], v[44:47], 0
v_mfma_f32_16x16x32_bf16 v[108:111], a[132:135], v[48:51], v[108:111]
v_mfma_f32_16x16x32_bf16 v[108:111], a[136:139], v[52:55], v[108:111]
v_mfma_f32_16x16x32_bf16 v[108:111], a[140:143], v[56:59], v[108:111]
v_mfma_f32_16x16x32_bf16 v[112:115], a[128:131], v[60:63], 0
v_mfma_f32_16x16x32_bf16 v[112:115], a[132:135], v[64:67], v[112:115]
v_mfma_f32_16x16x32_bf16 v[112:115], a[136:139], v[68:71], v[112:115]
v_mfma_f32_16x16x32_bf16 v[112:115], a[140:143], v[72:75], v[112:115]
v_mfma_f32_16x16x32_bf16 v[116:119], a[128:131], v[76:79], 0
v_mfma_f32_16x16x32_bf16 v[116:119], a[132:135], v[80:83], v[116:119]
v_mfma_f32_16x16x32_bf16 v[116:119], a[136:139], v[84:87], v[116:119]
v_mfma_f32_16x16x32_bf16 v[116:119], a[140:143], v[88:91], v[116:119]
v_mfma_f32_16x16x32_bf16 v[120:123], a[128:131], v[92:95], 0
v_mfma_f32_16x16x32_bf16 v[120:123], a[132:135], v[96:99], v[120:123]
v_mfma_f32_16x16x32_bf16 v[120:123], a[136:139], v[100:103], v[120:123]
v_mfma_f32_16x16x32_bf16 v[120:123], a[140:143], v[104:107], v[120:123]
s_nop 7
v_max3_f32 v6, v6, v108, v109
v_max3_f32 v6, v6, v110, v111
v_max3_f32 v7, v7, v112, v113
v_max3_f32 v7, v7, v114, v115
v_max3_f32 v8, v8, v116, v117
v_max3_f32 v8, v8, v118, v119
v_max3_f32 v9, v9, v120, v121
v_max3_f32 v9, v9, v122, v123
ds_read_b128 a[144:147], v16 offset:4096
ds_read_b128 a[148:151], v17 offset:4096
ds_read_b128 a[152:155], v18 offset:4096
ds_read_b128 a[156:159], v19 offset:4096
s_waitcnt lgkmcnt(0)
v_mfma_f32_16x16x32_bf16 v[108:111], a[144:147], v[44:47], 0
v_mfma_f32_16x16x32_bf16 v[108:111], a[148:151], v[48:51], v[108:111]
v_mfma_f32_16x16x32_bf16 v[108:111], a[152:155], v[52:55], v[108:111]
v_mfma_f32_16x16x32_bf16 v[108:111], a[156:159], v[56:59], v[108:111]
v_mfma_f32_16x16x32_bf16 v[112:115], a[144:147], v[60:63], 0
v_mfma_f32_16x16x32_bf16 v[112:115], a[148:151], v[64:67], v[112:115]
v_mfma_f32_16x16x32_bf16 v[112:115], a[152:155], v[68:71], v[112:115]
v_mfma_f32_16x16x32_bf16 v[112:115], a[156:159], v[72:75], v[112:115]
v_mfma_f32_16x16x32_bf16 v[116:119], a[144:147], v[76:79], 0
v_mfma_f32_16x16x32_bf16 v[116:119], a[148:151], v[80:83], v[116:119]
v_mfma_f32_16x16x32_bf16 v[116:119], a[152:155], v[84:87], v[116:119]
v_mfma_f32_16x16x32_bf16 v[116:119], a[156:159], v[88:91], v[116:119]
v_mfma_f32_16x16x32_bf16 v[120:123], a[144:147], v[92:95], 0
v_mfma_f32_16x16x32_bf16 v[120:123], a[148:151], v[96:99], v[120:123]
v_mfma_f32_16x16x32_bf16 v[120:123], a[152:155], v[100:103], v[120:123]
v_mfma_f32_16x16x32_bf16 v[120:123], a[156:159], v[104:107], v[120:123]
s_nop 7
v_max3_f32 v6, v6, v108, v109
v_max3_f32 v6, v6, v110, v111
v_max3_f32 v7, v7, v112, v113
v_max3_f32 v7, v7, v114, v115
v_max3_f32 v8, v8, v116, v117
v_max3_f32 v8, v8, v118, v119
v_max3_f32 v9, v9, v120, v121
v_max3_f32 v9, v9, v122, v123
ds_read_b128 a[128:131], v16 offset:8192
ds_read_b128 a[132:135], v17 offset:8192
ds_read_b128 a[136:139], v18 offset:8192
ds_read_b128 a[140:143], v19 offset:8192
s_waitcnt lgkmcnt(0)
v_mfma_f32_16x16x32_bf16 v[108:111], a[128:131], v[44:47], 0
v_mfma_f32_16x16x32_bf16 v[108:111], a[132:135], v[48:51], v[108:111]
v_mfma_f32_16x16x32_bf16 v[108:111], a[136:139], v[52:55], v[108:111]
v_mfma_f32_16x16x32_bf16 v[108:111], a[140:143], v[56:59], v[108:111]
v_mfma_f32_16x16x32_bf16 v[112:115], a[128:131], v[60:63], 0
v_mfma_f32_16x16x32_bf16 v[112:115], a[132:135], v[64:67], v[112:115]
v_mfma_f32_16x16x32_bf16 v[112:115], a[136:139], v[68:71], v[112:115]
v_mfma_f32_16x16x32_bf16 v[112:115], a[140:143], v[72:75], v[112:115]
v_mfma_f32_16x16x32_bf16 v[116:119], a[128:131], v[76:79], 0
v_mfma_f32_16x16x32_bf16 v[116:119], a[132:135], v[80:83], v[116:119]
v_mfma_f32_16x16x32_bf16 v[116:119], a[136:139], v[84:87], v[116:119]
v_mfma_f32_16x16x32_bf16 v[116:119], a[140:143], v[88:91], v[116:119]
v_mfma_f32_16x16x32_bf16 v[120:123], a[128:131], v[92:95], 0
v_mfma_f32_16x16x32_bf16 v[120:123], a[132:135], v[96:99], v[120:123]
v_mfma_f32_16x16x32_bf16 v[120:123], a[136:139], v[100:103], v[120:123]
v_mfma_f32_16x16x32_bf16 v[120:123], a[140:143], v[104:107], v[120:123]
s_nop 7
v_max3_f32 v6, v6, v108, v109
v_max3_f32 v6, v6, v110, v111
v_max3_f32 v7, v7, v112, v113
v_max3_f32 v7, v7, v114, v115
v_max3_f32 v8, v8, v116, v117
v_max3_f32 v8, v8, v118, v119
v_max3_f32 v9, v9, v120, v121
v_max3_f32 v9, v9, v122, v123
ds_read_b128 a[144:147], v16 offset:12288
ds_read_b128 a[148:151], v17 offset:12288
ds_read_b128 a[152:155], v18 offset:12288
ds_read_b128 a[156:159], v19 offset:12288
s_waitcnt lgkmcnt(0)
v_mfma_f32_16x16x32_bf16 v[108:111], a[144:147], v[44:47], 0
v_mfma_f32_16x16x32_bf16 v[108:111], a[148:151], v[48:51], v[108:111]
v_mfma_f32_16x16x32_bf16 v[108:111], a[152:155], v[52:55], v[108:111]
v_mfma_f32_16x16x32_bf16 v[108:111], a[156:159], v[56:59], v[108:111]
v_mfma_f32_16x16x32_bf16 v[112:115], a[144:147], v[60:63], 0
v_mfma_f32_16x16x32_bf16 v[112:115], a[148:151], v[64:67], v[112:115]
v_mfma_f32_16x16x32_bf16 v[112:115], a[152:155], v[68:71], v[112:115]
v_mfma_f32_16x16x32_bf16 v[112:115], a[156:159], v[72:75], v[112:115]
v_mfma_f32_16x16x32_bf16 v[116:119], a[144:147], v[76:79], 0
v_mfma_f32_16x16x32_bf16 v[116:119], a[148:151], v[80:83], v[116:119]
v_mfma_f32_16x16x32_bf16 v[116:119], a[152:155], v[84:87], v[116:119]
v_mfma_f32_16x16x32_bf16 v[116:119], a[156:159], v[88:91], v[116:119]
v_mfma_f32_16x16x32_bf16 v[120:123], a[144:147], v[92:95], 0
v_mfma_f32_16x16x32_bf16 v[120:123], a[148:151], v[96:99], v[120:123]
v_mfma_f32_16x16x32_bf16 v[120:123], a[152:155], v[100:103], v[120:123]
v_mfma_f32_16x16x32_bf16 v[120:123], a[156:159], v[104:107], v[120:123]
s_nop 7
v_max3_f32 v6, v6, v108, v109
v_max3_f32 v6, v6, v110, v111
v_max3_f32 v7, v7, v112, v113
v_max3_f32 v7, v7, v114, v115
v_max3_f32 v8, v8, v116, v117
v_max3_f32 v8, v8, v118, v119
v_max3_f32 v9, v9, v120, v121
v_max3_f32 v9, v9, v122, v123
s_add_u32 s38, s38, 1
s_cbranch_scc0 L2_mx
v_mov_b32 v28, v6
v_mov_b32 v29, v7
v_mov_b32 v30, v8
v_mov_b32 v31, v9
v_permlane16_swap_b32 v28, v6
v_permlane16_swap_b32 v29, v7
v_permlane16_swap_b32 v30, v8
v_permlane16_swap_b32 v31, v9
v_max_f32 v6, v6, v28
v_max_f32 v7, v7, v29
v_max_f32 v8, v8, v30
v_max_f32 v9, v9, v31
v_mov_b32 v28, v6
v_mov_b32 v29, v7
v_mov_b32 v30, v8
v_mov_b32 v31, v9
v_permlane32_swap_b32 v28, v6
v_permlane32_swap_b32 v29, v7
v_permlane32_swap_b32 v30, v8
v_permlane32_swap_b32 v31, v9
v_max_f32 v6, v6, v28
v_max_f32 v7, v7, v29
v_max_f32 v8, v8, v30
v_max_f32 v9, v9, v31
v_sub_f32 v236, 0x80000000, v6
v_sub_f32 v237, 0x80000000, v6
v_mov_b64 v[238:239], v[236:237]
v_sub_f32 v240, 0x80000000, v7
v_sub_f32 v241, 0x80000000, v7
v_mov_b64 v[242:243], v[240:241]
v_sub_f32 v244, 0x80000000, v8
v_sub_f32 v245, 0x80000000, v8
v_mov_b64 v[246:247], v[244:245]
s_nop 0
v_sub_f32 v248, 0x80000000, v9
v_sub_f32 v249, 0x80000000, v9
v_mov_b64 v[250:251], v[248:249]
s_mov_b32 s41, s50
s_mov_b32 s42, s50
s_barrier
s_add_u32 m0, s37, 0
s_nop 0
buffer_load_dwordx4 v10, s[12:15], s41 offen offset:0 lds
buffer_load_dwordx4 v11, s[12:15], s41 offen offset:1024 lds
buffer_load_dwordx4 v12, s[12:15], s41 offen offset:2048 lds
buffer_load_dwordx4 v13, s[12:15], s41 offen offset:3072 lds
s_add_u32 s41, s41, 16384
s_add_u32 m0, s37, 16384
s_nop 0
buffer_load_dwordx4 v10, s[12:15], s41 offen offset:0 lds
buffer_load_dwordx4 v11, s[12:15], s41 offen offset:1024 lds
buffer_load_dwordx4 v12, s[12:15], s41 offen offset:2048 lds
buffer_load_dwordx4 v13, s[12:15], s41 offen offset:3072 lds
s_add_u32 s41, s41, 16384
s_add_u32 m0, s37, 65536
s_nop 0
buffer_load_dwordx4 v14, s[16:19], s42 offen offset:0 lds
buffer_load_dwordx4 v15, s[16:19], s42 offen offset:1024 lds
buffer_load_dwordx4 v14, s[16:19], s42 offen offset:2048 lds
buffer_load_dwordx4 v15, s[16:19], s42 offen offset:3072 lds
s_add_u32 s42, s42, 16384
s_add_u32 m0, s37, 81920
s_nop 0
buffer_load_dwordx4 v14, s[16:19], s42 offen offset:0 lds
buffer_load_dwordx4 v15, s[16:19], s42 offen offset:1024 lds
buffer_load_dwordx4 v14, s[16:19], s42 offen offset:2048 lds
buffer_load_dwordx4 v15, s[16:19], s42 offen offset:3072 lds
s_add_u32 s42, s42, 16384
s_add_u32 m0, s37, 32768
s_nop 0
buffer_load_dwordx4 v10, s[12:15], s41 offen offset:0 lds
buffer_load_dwordx4 v11, s[12:15], s41 offen offset:1024 lds
buffer_load_dwordx4 v12, s[12:15], s41 offen offset:2048 lds
buffer_load_dwordx4 v13, s[12:15], s41 offen offset:3072 lds
s_add_u32 s41, s41, 16384
s_waitcnt vmcnt(0)
s_barrier
ds_read_b128 a[128:131], v16 offset:0
ds_read_b128 a[132:135], v17 offset:0
ds_read_b128 a[136:139], v18 offset:0
ds_read_b128 a[140:143], v19 offset:0
ds_read_b128 a[144:147], v16 offset:4096
s_waitcnt lgkmcnt(0)
s_branch L2_att
.section .rodata,"a"
.p2align 6
.amdhsa_kernel recurrent_scan__mha_block_cached__mixer_token_mlp__prompt_kernel
  .amdhsa_next_free_vgpr 512
  .amdhsa_next_free_sgpr 102
  .amdhsa_accum_offset 256
  .amdhsa_group_segment_fixed_size 0
  .amdhsa_kernarg_size 104
  .amdhsa_user_sgpr_count 2
  .amdhsa_user_sgpr_kernarg_segment_ptr 1
  .amdhsa_system_sgpr_workgroup_id_x 1
  .amdhsa_float_denorm_mode_32 3
.end_amdhsa_kernel
```
